```python
import torch

def _softmax(x, axis=-1):
    return torch.softmax(x, dim=axis)

def _gelu(x):
    return torch.nn.functional.gelu(x, approximate='tanh')

def _silu(x):
    return torch.nn.functional.silu(x)

def _sigmoid(x):
    return torch.sigmoid(x)

def _layernorm(x, axis=-1, eps=1e-05):
    m = x.mean(dim=axis, keepdim=True)
    v = x.var(dim=axis, keepdim=True, unbiased=False)
    return (x - m) / torch.sqrt(v + eps)

def _scatter_add(tgt, idx, src, axis=0):
    return tgt.clone().index_add_(axis, idx, src)

def _segment_sum(src, seg, n):
    out = torch.zeros((n,) + src.shape[1:], dtype=src.dtype)
    return out.index_add_(0, seg, src)

def _pad(x, pw):
    flat = tuple((v for pair in reversed(pw) for v in pair))
    return torch.nn.functional.pad(x, flat)
kernel_name = 'concat_heads__memory_aug_recurrent_mem_tr__ssm_conv_s5__prompt'

def setup_inputs():

    _w = lambda a: (lambda t: t.to(torch.bfloat16) if t.is_floating_point() else t)(torch.as_tensor(a))

    def _A_setup():
        B, S, Dm = (1, 2048, 640)
        H, Dh = (32, 192)
        M, seg = (8, 32)
        seg = min(seg, S)
        S = S // seg * seg
        return {'x': _w((lambda *s: torch.randn(*s, dtype=torch.bfloat16) * 0.05)(B, S, Dm)), 'mem0': _w((lambda *s: torch.randn(*s, dtype=torch.bfloat16) * 0.8)(B, M, Dm)), 'Wq': _w((lambda *s: torch.randn(*s, dtype=torch.bfloat16) * 1.6)(Dm, H, Dh) * Dm ** (-0.5)), 'Wk': _w((lambda *s: torch.randn(*s, dtype=torch.bfloat16) * 1.6)(Dm, H, Dh) * Dm ** (-0.5)), 'Wv': _w((lambda *s: torch.randn(*s, dtype=torch.bfloat16) * 0.8)(Dm, H, Dh) * Dm ** (-0.5)), 'Wo': _w((lambda *s: torch.randn(*s, dtype=torch.bfloat16) * 0.8)(H, Dh, Dm) * (H * Dh) ** (-0.5)), 'seg_len': seg}
    _A_in = _A_setup()

    def _B_setup():
        B, S, D = (1, 2048, 640)
        P = D
        Lambda_re = -0.5 * (lambda _x: torch.exp(torch.as_tensor(_x)))((lambda *s: torch.randn(*s, dtype=torch.bfloat16) * 0.8)(P))
        Lambda_im = (lambda *s: torch.randn(*s, dtype=torch.bfloat16) * 0.8)(P) * 1.0
        B_re = (lambda *s: torch.randn(*s, dtype=torch.bfloat16) * 0.8)(P, D) * D ** (-0.5)
        B_im = (lambda *s: torch.randn(*s, dtype=torch.bfloat16) * 0.8)(P, D) * D ** (-0.5)
        C_re = (lambda *s: torch.randn(*s, dtype=torch.bfloat16) * 0.8)(D, P) * P ** (-0.5)
        C_im = (lambda *s: torch.randn(*s, dtype=torch.bfloat16) * 0.8)(D, P) * P ** (-0.5)
        log_dt = (lambda *s: torch.randn(*s, dtype=torch.bfloat16) * 0.8)(P) * 0.3 - 2.0
        Dskip = (lambda *s: torch.randn(*s, dtype=torch.bfloat16) * 0.8)(D)
        return {'x': _w((lambda *s: torch.randn(*s, dtype=torch.bfloat16) * 0.05)(B, S, D)), 'Lambda_re': _w(Lambda_re), 'Lambda_im': _w(Lambda_im), 'B_re': _w(B_re), 'B_im': _w(B_im), 'C_re': _w(C_re), 'C_im': _w(C_im), 'log_dt': _w(log_dt), 'Dskip': _w(Dskip)}
    _B_in = _B_setup()
    return {'A_x': _A_in['x'], 'A_mem0': _A_in['mem0'], 'A_Wq': _A_in['Wq'], 'A_Wk': _A_in['Wk'], 'A_Wv': _A_in['Wv'], 'A_Wo': _A_in['Wo'], 'A_seg_len': _A_in['seg_len'], 'B_x': _B_in['x'], 'B_Lambda_re': _B_in['Lambda_re'], 'B_Lambda_im': _B_in['Lambda_im'], 'B_B_re': _B_in['B_re'], 'B_B_im': _B_in['B_im'], 'B_C_re': _B_in['C_re'], 'B_C_im': _B_in['C_im'], 'B_log_dt': _B_in['log_dt'], 'B_Dskip': _B_in['Dskip']}

def reference(A_x, A_mem0, A_Wq, A_Wk, A_Wv, A_Wo, A_seg_len, B_x, B_Lambda_re, B_Lambda_im, B_B_re, B_B_im, B_C_re, B_C_im, B_log_dt, B_Dskip):

    def _A_ref(x, mem0, Wq, Wk, Wv, Wo, seg_len):
        B, S, Dm = x.shape
        H, Dh = (Wq.shape[1], Wq.shape[2])
        M = mem0.shape[1]
        scale = Dh ** (-0.5)
        n_seg = S // seg_len
        L = M + seg_len
        idx = torch.arange(L)
        mask = (idx[:, None] < M) | (idx[:, None] >= idx[None, :])
        mem = mem0
        outs = []
        for s in range(n_seg):
            xs = x[:, s * seg_len:(s + 1) * seg_len, :].clone()
            h = torch.concatenate([mem, xs], axis=1)
            q = torch.einsum('btd,dhe->bhte', h, Wq)
            k = torch.einsum('btd,dhe->bhte', h, Wk)
            v = torch.einsum('btd,dhe->bhte', h, Wv)
            scores = torch.einsum('bhqe,bhke->bhqk', q, k) * scale
            scores = torch.where(mask[None, None], scores, -1000000000.0)
            p = _softmax(scores, axis=-1)
            o = torch.einsum('bhqk,bhke->bhqe', p, v)
            o = torch.einsum('bhte,hed->btd', o, Wo)
            mem = o[:, :M, :].clone()
            outs.append(o[:, M:, :])
        return torch.concatenate(outs, axis=1)

    def _B_ref(x, Lambda_re, Lambda_im, B_re, B_im, C_re, C_im, log_dt, Dskip):
        Bsz, L, H = x.shape
        Lam = Lambda_re + 1j * Lambda_im
        Bmat = B_re + 1j * B_im
        Cmat = C_re + 1j * C_im
        dt = torch.exp(log_dt)
        Lam_bar = torch.exp(dt * Lam)
        B_bar = ((Lam_bar - 1.0) / Lam)[:, None] * Bmat
        Bu = torch.einsum('bld,pd->blp', x + 0j, B_bar)
        h = torch.zeros_like(Bu[:, 0, :])
        hs = []
        for t in range(L):
            h = Lam_bar[None, :] * h + Bu[:, t, :]
            hs.append(h)
        hseq = torch.stack(hs, 1)
        y = 2.0 * torch.einsum('blp,dp->bld', hseq, Cmat).real + x * Dskip[None, None, :]
        return y
    a = _A_ref(A_x, A_mem0, A_Wq, A_Wk, A_Wv, A_Wo, A_seg_len)
    b = _B_ref(B_x, B_Lambda_re, B_Lambda_im, B_B_re, B_B_im, B_C_re, B_C_im, B_log_dt, B_Dskip)
    return torch.concatenate([a, b], axis=-1)
```

```asm
; @launch grid=(256,1,1) block=(256,1,1) lds=163840
.amdgcn_target "amdgcn-amd-amdhsa--gfx950"
.text
.globl concat_heads__memory_aug_recurrent_mem_tr__ssm_conv_s5__prompt_kernel
.p2align 8
.type concat_heads__memory_aug_recurrent_mem_tr__ssm_conv_s5__prompt_kernel,@function
concat_heads__memory_aug_recurrent_mem_tr__ssm_conv_s5__prompt_kernel:
    s_cmp_ge_u32 s2, 256
    s_cbranch_scc1 L_exit
    s_and_b32 s3, s2, 7
    s_cmp_ge_u32 s3, 2
    s_cbranch_scc1 L_work
    s_branch L_rec
L_exit:
    s_endpgm
L_work:
    s_and_b32 s32, s2, 7
    s_sub_u32 s32, s32, 2
    s_lshl_b32 s32, s32, 5
    s_lshr_b32 s33, s2, 3
    s_add_u32 s32, s32, s33
    s_mov_b32 s43, s32
    s_mov_b32 s44, 0x40000
    s_mul_i32 s33, s32, 0xaaab
    s_lshr_b32 s33, s33, 17
    s_mul_i32 s34, s33, 3
    s_sub_u32 s30, s32, s34
    s_lshr_b32 s29, s33, 1
    s_bitcmp1_b32 s33, 0
    s_cbranch_scc1 role_vw_1
    s_load_dwordx2 s[4:5], s[0:1], 144
    s_load_dwordx2 s[6:7], s[0:1], 136
    s_load_dwordx2 s[56:57], s[0:1], 0
    s_load_dwordx8 s[60:67], s[0:1], 16
    v_lshrrev_b32 v30, 6, v0
    s_nop 0
    v_readfirstlane_b32 s28, v30
    v_and_b32 v0, 63, v0
    s_waitcnt lgkmcnt(0)
    s_mov_b32 s8, s4
    s_mov_b32 s9, s5
    s_mov_b32 s10, 0x10000000
    s_mov_b32 s11, 0x20000
    s_mov_b32 s12, s6
    s_mov_b32 s13, s7
    s_mov_b32 s14, 0x100
    s_mov_b32 s15, 0x20000
    s_mov_b32 s24, s56
    s_mov_b32 s25, s57
    s_mov_b32 s26, 0x280000
    s_mov_b32 s27, 0x20000
    s_cmp_eq_u32 s30, 1
    s_cselect_b64 s[64:65], s[60:61], s[62:63]
    s_cselect_b64 s[66:67], s[62:63], s[60:61]
    s_mov_b32 s16, s64
    s_mov_b32 s17, s65
    s_mov_b32 s18, 0x780000
    s_mov_b32 s19, 0x20000
    s_mov_b32 s20, s66
    s_mov_b32 s21, s67
    s_mov_b32 s22, 0x780000
    s_mov_b32 s23, 0x20000
    v_add_u32 v26, 0, v0
    v_mul_u32_u24 v27, 0xaaab, v26
    v_lshrrev_b32 v27, 20, v27
    v_mul_u32_u24 v28, 24, v27
    v_sub_u32 v28, v26, v28
    v_bfe_u32 v29, v27, 1, 1
    v_lshlrev_b32 v29, 2, v29
    v_xor_b32 v28, v28, v29
    v_mul_u32_u24 v27, 12288, v27
    v_lshl_add_u32 v1, v28, 4, v27
    v_add_u32 v26, 64, v0
    v_mul_u32_u24 v27, 0xaaab, v26
    v_lshrrev_b32 v27, 20, v27
    v_mul_u32_u24 v28, 24, v27
    v_sub_u32 v28, v26, v28
    v_bfe_u32 v29, v27, 1, 1
    v_lshlrev_b32 v29, 2, v29
    v_xor_b32 v28, v28, v29
    v_mul_u32_u24 v27, 12288, v27
    v_lshl_add_u32 v2, v28, 4, v27
    v_add_u32 v26, 128, v0
    v_mul_u32_u24 v27, 0xaaab, v26
    v_lshrrev_b32 v27, 20, v27
    v_mul_u32_u24 v28, 24, v27
    v_sub_u32 v28, v26, v28
    v_bfe_u32 v29, v27, 1, 1
    v_lshlrev_b32 v29, 2, v29
    v_xor_b32 v28, v28, v29
    v_mul_u32_u24 v27, 12288, v27
    v_lshl_add_u32 v3, v28, 4, v27
    v_lshrrev_b32 v27, 3, v0
    v_and_b32 v28, 7, v0
    v_bfe_u32 v29, v27, 1, 1
    v_lshlrev_b32 v29, 2, v29
    v_xor_b32 v28, v28, v29
    v_mul_u32_u24 v27, 1280, v27
    v_lshl_add_u32 v4, v28, 4, v27
    v_lshrrev_b32 v27, 3, v0
    v_add_u32 v27, 0, v27
    v_bfe_u32 v29, v27, 1, 3
    v_and_b32 v28, 7, v0
    v_xor_b32 v28, v28, v29
    v_mul_u32_u24 v27, 1280, v27
    v_lshl_add_u32 v5, v28, 4, v27
    v_lshrrev_b32 v27, 3, v0
    v_add_u32 v27, 8, v27
    v_bfe_u32 v29, v27, 1, 3
    v_and_b32 v28, 7, v0
    v_xor_b32 v28, v28, v29
    v_mul_u32_u24 v27, 1280, v27
    v_lshl_add_u32 v6, v28, 4, v27
    v_lshrrev_b32 v27, 3, v0
    v_add_u32 v27, 16, v27
    v_bfe_u32 v29, v27, 1, 3
    v_and_b32 v28, 7, v0
    v_xor_b32 v28, v28, v29
    v_mul_u32_u24 v27, 1280, v27
    v_lshl_add_u32 v7, v28, 4, v27
    v_lshrrev_b32 v27, 3, v0
    v_add_u32 v27, 24, v27
    v_bfe_u32 v29, v27, 1, 3
    v_and_b32 v28, 7, v0
    v_xor_b32 v28, v28, v29
    v_mul_u32_u24 v27, 1280, v27
    v_lshl_add_u32 v8, v28, 4, v27
    v_lshrrev_b32 v26, 5, v0
    v_bfe_u32 v27, v0, 2, 2
    v_bfe_u32 v28, v0, 4, 1
    v_and_b32 v29, 3, v0
    v_lshl_add_u32 v30, v26, 3, v27
    v_mul_u32_u24 v30, 384, v30
    v_and_b32 v31, 1, v29
    v_lshl_add_u32 v30, v31, 5, v30
    v_lshl_add_u32 v30, v28, 4, v30
    v_lshrrev_b32 v31, 1, v29
    v_lshl_add_u32 v30, v31, 3, v30
    v_lshrrev_b32 v31, 1, v27
    v_lshlrev_b32 v31, 6, v31
    v_add_u32 v9, v30, v31
    v_sub_u32 v30, v30, v31
    v_add_u32 v10, 64, v30
    v_add_u32 v11, 81920, v9
    v_add_u32 v12, 81920, v10
    v_lshl_add_u32 v30, v26, 4, v27
    v_lshlrev_b32 v30, 7, v30
    v_lshl_add_u32 v30, v28, 5, v30
    v_lshl_add_u32 v30, v29, 3, v30
    v_add_u32 v21, v30, v31
    v_sub_u32 v30, v30, v31
    v_add_u32 v22, 64, v30
    v_add_u32 v23, 81920, v21
    v_add_u32 v24, 81920, v22
    s_lshl_b32 s36, s28, 12
    s_add_u32 s36, s36, 24576
    s_mul_i32 s35, s28, 6144
    v_and_b32 v27, 31, v0
    v_bfe_u32 v28, v0, 1, 3
    v_xor_b32 v28, v28, v26
    v_lshlrev_b32 v27, 7, v27
    v_add_u32 v27, s36, v27
    v_xor_b32 v29, 0, v28
    v_lshl_add_u32 v13, v29, 4, v27
    v_add_u32 v17, 81920, v13
    v_xor_b32 v29, 2, v28
    v_lshl_add_u32 v14, v29, 4, v27
    v_add_u32 v18, 81920, v14
    v_xor_b32 v29, 4, v28
    v_lshl_add_u32 v15, v29, 4, v27
    v_add_u32 v19, 81920, v15
    v_xor_b32 v29, 6, v28
    v_lshl_add_u32 v16, v29, 4, v27
    v_add_u32 v20, 81920, v16
    v_bfe_u32 v28, v0, 4, 1
    v_lshlrev_b32 v25, 10, v28
    v_and_b32 v28, 15, v0
    v_lshl_add_u32 v25, v28, 4, v25
    v_lshl_add_u32 v25, v26, 9, v25
    s_mul_i32 s37, s28, 196608
    s_mul_i32 s32, s29, 384
    s_add_u32 s37, s37, s32
    s_mul_i32 s38, s28, 61440
    s_mul_i32 s32, s29, 245760
    s_add_u32 s38, s38, s32
    s_lshl_b32 s42, 1, s29
    s_mov_b32 s31, s30
    s_add_u32 s34, s31, 0
    s_lshr_b32 s33, s34, 1
    s_lshl_b32 s32, s33, 2
    s_add_u32 s32, s32, s28
    s_mul_i32 s39, s32, 40960
    s_mul_i32 s41, s32, 786432
    s_mul_i32 s33, s29, 24576
    s_add_u32 s41, s41, s33
    s_and_b32 s33, s34, 1
    s_mul_i32 s33, s33, 12288
    s_add_u32 s41, s41, s33
    s_add_u32 s34, s31, 3
    s_lshr_b32 s33, s34, 1
    s_lshl_b32 s32, s33, 2
    s_add_u32 s32, s32, s28
    s_mul_i32 s46, s32, 40960
    s_mul_i32 s47, s32, 786432
    s_mul_i32 s33, s29, 24576
    s_add_u32 s47, s47, s33
    s_and_b32 s33, s34, 1
    s_mul_i32 s33, s33, 12288
    s_add_u32 s47, s47, s33
    s_add_u32 s40, s39, 491520
wpro_3:
    s_add_u32 m0, s35, 0
    s_add_u32 s32, s37, 0
    buffer_load_dwordx4 v1, s[16:19], s32 offen lds
    s_add_u32 m0, s35, 1024
    s_add_u32 s32, s37, 0
    buffer_load_dwordx4 v2, s[16:19], s32 offen lds
    s_add_u32 m0, s35, 2048
    s_add_u32 s32, s37, 0
    buffer_load_dwordx4 v3, s[16:19], s32 offen lds
    s_add_u32 m0, s35, 3072
    s_add_u32 s32, s37, 98304
    buffer_load_dwordx4 v1, s[16:19], s32 offen lds
    s_add_u32 m0, s35, 4096
    s_add_u32 s32, s37, 98304
    buffer_load_dwordx4 v2, s[16:19], s32 offen lds
    s_add_u32 m0, s35, 5120
    s_add_u32 s32, s37, 98304
    buffer_load_dwordx4 v3, s[16:19], s32 offen lds
    s_add_u32 m0, s36, 0
    s_add_u32 s32, s39, 0
    buffer_load_dwordx4 v5, s[24:27], s32 offen lds
    s_add_u32 m0, s36, 1024
    s_add_u32 s32, s39, 0
    buffer_load_dwordx4 v6, s[24:27], s32 offen lds
    s_add_u32 m0, s36, 2048
    s_add_u32 s32, s39, 0
    buffer_load_dwordx4 v7, s[24:27], s32 offen lds
    s_add_u32 m0, s36, 3072
    s_add_u32 s32, s39, 0
    buffer_load_dwordx4 v8, s[24:27], s32 offen lds
    s_add_u32 m0, s35, 40960
    s_add_u32 s32, s37, 786432
    buffer_load_dwordx4 v1, s[16:19], s32 offen lds
    s_add_u32 m0, s35, 41984
    s_add_u32 s32, s37, 786432
    buffer_load_dwordx4 v2, s[16:19], s32 offen lds
    s_add_u32 m0, s35, 43008
    s_add_u32 s32, s37, 786432
    buffer_load_dwordx4 v3, s[16:19], s32 offen lds
    s_add_u32 m0, s35, 44032
    s_add_u32 s32, s37, 884736
    buffer_load_dwordx4 v1, s[16:19], s32 offen lds
    s_add_u32 m0, s35, 45056
    s_add_u32 s32, s37, 884736
    buffer_load_dwordx4 v2, s[16:19], s32 offen lds
    s_add_u32 m0, s35, 46080
    s_add_u32 s32, s37, 884736
    buffer_load_dwordx4 v3, s[16:19], s32 offen lds
    s_add_u32 m0, s36, 40960
    s_add_u32 s32, s39, 128
    buffer_load_dwordx4 v5, s[24:27], s32 offen lds
    s_add_u32 m0, s36, 41984
    s_add_u32 s32, s39, 128
    buffer_load_dwordx4 v6, s[24:27], s32 offen lds
    s_add_u32 m0, s36, 43008
    s_add_u32 s32, s39, 128
    buffer_load_dwordx4 v7, s[24:27], s32 offen lds
    s_add_u32 m0, s36, 44032
    s_add_u32 s32, s39, 128
    buffer_load_dwordx4 v8, s[24:27], s32 offen lds
    s_add_u32 m0, s35, 81920
    s_add_u32 s32, s37, 1572864
    buffer_load_dwordx4 v1, s[16:19], s32 offen lds
    s_add_u32 m0, s35, 82944
    s_add_u32 s32, s37, 1572864
    buffer_load_dwordx4 v2, s[16:19], s32 offen lds
    s_add_u32 m0, s35, 83968
    s_add_u32 s32, s37, 1572864
    buffer_load_dwordx4 v3, s[16:19], s32 offen lds
    s_add_u32 m0, s35, 84992
    s_add_u32 s32, s37, 1671168
    buffer_load_dwordx4 v1, s[16:19], s32 offen lds
    s_add_u32 m0, s35, 86016
    s_add_u32 s32, s37, 1671168
    buffer_load_dwordx4 v2, s[16:19], s32 offen lds
    s_add_u32 m0, s35, 87040
    s_add_u32 s32, s37, 1671168
    buffer_load_dwordx4 v3, s[16:19], s32 offen lds
    s_add_u32 m0, s36, 81920
    s_add_u32 s32, s39, 256
    buffer_load_dwordx4 v5, s[24:27], s32 offen lds
    s_add_u32 m0, s36, 82944
    s_add_u32 s32, s39, 256
    buffer_load_dwordx4 v6, s[24:27], s32 offen lds
    s_add_u32 m0, s36, 83968
    s_add_u32 s32, s39, 256
    buffer_load_dwordx4 v7, s[24:27], s32 offen lds
    s_add_u32 m0, s36, 84992
    s_add_u32 s32, s39, 256
    buffer_load_dwordx4 v8, s[24:27], s32 offen lds
    s_add_u32 m0, s35, 122880
    s_add_u32 s32, s37, 2359296
    buffer_load_dwordx4 v1, s[16:19], s32 offen lds
    s_add_u32 m0, s35, 123904
    s_add_u32 s32, s37, 2359296
    buffer_load_dwordx4 v2, s[16:19], s32 offen lds
    s_add_u32 m0, s35, 124928
    s_add_u32 s32, s37, 2359296
    buffer_load_dwordx4 v3, s[16:19], s32 offen lds
    s_add_u32 m0, s35, 125952
    s_add_u32 s32, s37, 2457600
    buffer_load_dwordx4 v1, s[16:19], s32 offen lds
    s_add_u32 m0, s35, 126976
    s_add_u32 s32, s37, 2457600
    buffer_load_dwordx4 v2, s[16:19], s32 offen lds
    s_add_u32 m0, s35, 128000
    s_add_u32 s32, s37, 2457600
    buffer_load_dwordx4 v3, s[16:19], s32 offen lds
    s_add_u32 m0, s36, 122880
    s_add_u32 s32, s39, 384
    buffer_load_dwordx4 v5, s[24:27], s32 offen lds
    s_add_u32 m0, s36, 123904
    s_add_u32 s32, s39, 384
    buffer_load_dwordx4 v6, s[24:27], s32 offen lds
    s_add_u32 m0, s36, 124928
    s_add_u32 s32, s39, 384
    buffer_load_dwordx4 v7, s[24:27], s32 offen lds
    s_add_u32 m0, s36, 125952
    s_add_u32 s32, s39, 384
    buffer_load_dwordx4 v8, s[24:27], s32 offen lds
    s_waitcnt vmcnt(30)
    s_barrier
    ds_read_b128 a[24:27], v13 offset:0
    ds_read_b64_tr_b16 a[0:1], v9 offset:0
    ds_read_b64_tr_b16 a[2:3], v9 offset:1536
    ds_read_b64_tr_b16 a[4:5], v10 offset:0
    ds_read_b64_tr_b16 a[6:7], v10 offset:1536
    ds_read_b64_tr_b16 a[8:9], v9 offset:128
    ds_read_b64_tr_b16 a[10:11], v9 offset:1664
    ds_read_b64_tr_b16 a[12:13], v10 offset:128
    ds_read_b64_tr_b16 a[14:15], v10 offset:1664
    ds_read_b64_tr_b16 a[16:17], v9 offset:256
    ds_read_b64_tr_b16 a[18:19], v9 offset:1792
    ds_read_b64_tr_b16 a[20:21], v10 offset:256
    ds_read_b64_tr_b16 a[22:23], v10 offset:1792
wtop_4:
    s_waitcnt lgkmcnt(10)
    v_mfma_f32_32x32x16_bf16 v[32:47], a[0:3], a[24:27], 0
    ds_read_b128 a[52:55], v14 offset:0
    ds_read_b64_tr_b16 a[28:29], v9 offset:6144
    ds_read_b64_tr_b16 a[30:31], v9 offset:7680
    s_waitcnt lgkmcnt(11)
    v_mfma_f32_32x32x16_bf16 v[48:63], a[4:7], a[24:27], 0
    ds_read_b64_tr_b16 a[32:33], v10 offset:6144
    ds_read_b64_tr_b16 a[34:35], v10 offset:7680
    ds_read_b64_tr_b16 a[36:37], v9 offset:6272
    s_waitcnt lgkmcnt(12)
    v_mfma_f32_32x32x16_bf16 v[64:79], a[8:11], a[24:27], 0
    ds_read_b64_tr_b16 a[38:39], v9 offset:7808
    ds_read_b64_tr_b16 a[40:41], v10 offset:6272
    ds_read_b64_tr_b16 a[42:43], v10 offset:7808
    s_waitcnt lgkmcnt(13)
    v_mfma_f32_32x32x16_bf16 v[80:95], a[12:15], a[24:27], 0
    ds_read_b64_tr_b16 a[44:45], v9 offset:6400
    ds_read_b64_tr_b16 a[46:47], v9 offset:7936
    ds_read_b64_tr_b16 a[48:49], v10 offset:6400
    s_waitcnt lgkmcnt(14)
    v_mfma_f32_32x32x16_bf16 v[96:111], a[16:19], a[24:27], 0
    ds_read_b64_tr_b16 a[50:51], v10 offset:7936
    s_waitcnt lgkmcnt(13)
    v_mfma_f32_32x32x16_bf16 v[112:127], a[20:23], a[24:27], 0
    s_waitcnt lgkmcnt(10)
    v_mfma_f32_32x32x16_bf16 v[32:47], a[28:31], a[52:55], v[32:47]
    ds_read_b128 a[24:27], v15 offset:0
    ds_read_b64_tr_b16 a[0:1], v9 offset:12288
    ds_read_b64_tr_b16 a[2:3], v9 offset:13824
    s_waitcnt lgkmcnt(11)
    v_mfma_f32_32x32x16_bf16 v[48:63], a[32:35], a[52:55], v[48:63]
    ds_read_b64_tr_b16 a[4:5], v10 offset:12288
    ds_read_b64_tr_b16 a[6:7], v10 offset:13824
    ds_read_b64_tr_b16 a[8:9], v9 offset:12416
    s_waitcnt lgkmcnt(12)
    v_mfma_f32_32x32x16_bf16 v[64:79], a[36:39], a[52:55], v[64:79]
    ds_read_b64_tr_b16 a[10:11], v9 offset:13952
    ds_read_b64_tr_b16 a[12:13], v10 offset:12416
    ds_read_b64_tr_b16 a[14:15], v10 offset:13952
    s_waitcnt lgkmcnt(13)
    v_mfma_f32_32x32x16_bf16 v[80:95], a[40:43], a[52:55], v[80:95]
    ds_read_b64_tr_b16 a[16:17], v9 offset:12544
    ds_read_b64_tr_b16 a[18:19], v9 offset:14080
    ds_read_b64_tr_b16 a[20:21], v10 offset:12544
    s_waitcnt lgkmcnt(14)
    v_mfma_f32_32x32x16_bf16 v[96:111], a[44:47], a[52:55], v[96:111]
    ds_read_b64_tr_b16 a[22:23], v10 offset:14080
    s_waitcnt lgkmcnt(13)
    v_mfma_f32_32x32x16_bf16 v[112:127], a[48:51], a[52:55], v[112:127]
    s_waitcnt lgkmcnt(10)
    v_mfma_f32_32x32x16_bf16 v[32:47], a[0:3], a[24:27], v[32:47]
    ds_read_b128 a[52:55], v16 offset:0
    ds_read_b64_tr_b16 a[28:29], v9 offset:18432
    ds_read_b64_tr_b16 a[30:31], v9 offset:19968
    s_waitcnt lgkmcnt(11)
    v_mfma_f32_32x32x16_bf16 v[48:63], a[4:7], a[24:27], v[48:63]
    ds_read_b64_tr_b16 a[32:33], v10 offset:18432
    ds_read_b64_tr_b16 a[34:35], v10 offset:19968
    ds_read_b64_tr_b16 a[36:37], v9 offset:18560
    s_waitcnt lgkmcnt(12)
    v_mfma_f32_32x32x16_bf16 v[64:79], a[8:11], a[24:27], v[64:79]
    ds_read_b64_tr_b16 a[38:39], v9 offset:20096
    ds_read_b64_tr_b16 a[40:41], v10 offset:18560
    ds_read_b64_tr_b16 a[42:43], v10 offset:20096
    s_waitcnt lgkmcnt(13)
    v_mfma_f32_32x32x16_bf16 v[80:95], a[12:15], a[24:27], v[80:95]
    ds_read_b64_tr_b16 a[44:45], v9 offset:18688
    ds_read_b64_tr_b16 a[46:47], v9 offset:20224
    ds_read_b64_tr_b16 a[48:49], v10 offset:18688
    s_waitcnt lgkmcnt(14)
    v_mfma_f32_32x32x16_bf16 v[96:111], a[16:19], a[24:27], v[96:111]
    ds_read_b64_tr_b16 a[50:51], v10 offset:20224
    s_waitcnt lgkmcnt(13)
    v_mfma_f32_32x32x16_bf16 v[112:127], a[20:23], a[24:27], v[112:127]
    s_waitcnt lgkmcnt(0)
    s_waitcnt vmcnt(20)
    s_barrier
    v_mfma_f32_32x32x16_bf16 v[32:47], a[28:31], a[52:55], v[32:47]
    ds_read_b128 a[24:27], v13 offset:40960
    ds_read_b64_tr_b16 a[0:1], v9 offset:40960
    ds_read_b64_tr_b16 a[2:3], v9 offset:42496
    v_mfma_f32_32x32x16_bf16 v[48:63], a[32:35], a[52:55], v[48:63]
    ds_read_b64_tr_b16 a[4:5], v10 offset:40960
    ds_read_b64_tr_b16 a[6:7], v10 offset:42496
    ds_read_b64_tr_b16 a[8:9], v9 offset:41088
    s_add_u32 m0, s35, 0
    s_add_u32 s32, s37, 3145728
    buffer_load_dwordx4 v1, s[16:19], s32 offen lds
    v_mfma_f32_32x32x16_bf16 v[64:79], a[36:39], a[52:55], v[64:79]
    ds_read_b64_tr_b16 a[10:11], v9 offset:42624
    ds_read_b64_tr_b16 a[12:13], v10 offset:41088
    ds_read_b64_tr_b16 a[14:15], v10 offset:42624
    v_mfma_f32_32x32x16_bf16 v[80:95], a[40:43], a[52:55], v[80:95]
    ds_read_b64_tr_b16 a[16:17], v9 offset:41216
    ds_read_b64_tr_b16 a[18:19], v9 offset:42752
    ds_read_b64_tr_b16 a[20:21], v10 offset:41216
    s_add_u32 m0, s35, 1024
    s_add_u32 s32, s37, 3145728
    buffer_load_dwordx4 v2, s[16:19], s32 offen lds
    v_mfma_f32_32x32x16_bf16 v[96:111], a[44:47], a[52:55], v[96:111]
    ds_read_b64_tr_b16 a[22:23], v10 offset:42752
    v_mfma_f32_32x32x16_bf16 v[112:127], a[48:51], a[52:55], v[112:127]
    s_add_u32 m0, s35, 2048
    s_add_u32 s32, s37, 3145728
    buffer_load_dwordx4 v3, s[16:19], s32 offen lds
    s_waitcnt lgkmcnt(10)
    v_mfma_f32_32x32x16_bf16 v[32:47], a[0:3], a[24:27], v[32:47]
    ds_read_b128 a[52:55], v14 offset:40960
    ds_read_b64_tr_b16 a[28:29], v9 offset:47104
    ds_read_b64_tr_b16 a[30:31], v9 offset:48640
    s_waitcnt lgkmcnt(11)
    v_mfma_f32_32x32x16_bf16 v[48:63], a[4:7], a[24:27], v[48:63]
    ds_read_b64_tr_b16 a[32:33], v10 offset:47104
    ds_read_b64_tr_b16 a[34:35], v10 offset:48640
    ds_read_b64_tr_b16 a[36:37], v9 offset:47232
    s_add_u32 m0, s35, 3072
    s_add_u32 s32, s37, 3244032
    buffer_load_dwordx4 v1, s[16:19], s32 offen lds
    s_waitcnt lgkmcnt(12)
    v_mfma_f32_32x32x16_bf16 v[64:79], a[8:11], a[24:27], v[64:79]
    ds_read_b64_tr_b16 a[38:39], v9 offset:48768
    ds_read_b64_tr_b16 a[40:41], v10 offset:47232
    ds_read_b64_tr_b16 a[42:43], v10 offset:48768
    s_waitcnt lgkmcnt(13)
    v_mfma_f32_32x32x16_bf16 v[80:95], a[12:15], a[24:27], v[80:95]
    ds_read_b64_tr_b16 a[44:45], v9 offset:47360
    ds_read_b64_tr_b16 a[46:47], v9 offset:48896
    ds_read_b64_tr_b16 a[48:49], v10 offset:47360
    s_add_u32 m0, s35, 4096
    s_add_u32 s32, s37, 3244032
    buffer_load_dwordx4 v2, s[16:19], s32 offen lds
    s_waitcnt lgkmcnt(14)
    v_mfma_f32_32x32x16_bf16 v[96:111], a[16:19], a[24:27], v[96:111]
    ds_read_b64_tr_b16 a[50:51], v10 offset:48896
    s_waitcnt lgkmcnt(13)
    v_mfma_f32_32x32x16_bf16 v[112:127], a[20:23], a[24:27], v[112:127]
    s_add_u32 m0, s35, 5120
    s_add_u32 s32, s37, 3244032
    buffer_load_dwordx4 v3, s[16:19], s32 offen lds
    s_waitcnt lgkmcnt(10)
    v_mfma_f32_32x32x16_bf16 v[32:47], a[28:31], a[52:55], v[32:47]
    ds_read_b128 a[24:27], v15 offset:40960
    ds_read_b64_tr_b16 a[0:1], v9 offset:53248
    ds_read_b64_tr_b16 a[2:3], v9 offset:54784
    s_waitcnt lgkmcnt(11)
    v_mfma_f32_32x32x16_bf16 v[48:63], a[32:35], a[52:55], v[48:63]
    ds_read_b64_tr_b16 a[4:5], v10 offset:53248
    ds_read_b64_tr_b16 a[6:7], v10 offset:54784
    ds_read_b64_tr_b16 a[8:9], v9 offset:53376
    s_add_u32 m0, s36, 0
    s_add_u32 s32, s39, 512
    buffer_load_dwordx4 v5, s[24:27], s32 offen lds
    s_waitcnt lgkmcnt(12)
    v_mfma_f32_32x32x16_bf16 v[64:79], a[36:39], a[52:55], v[64:79]
    ds_read_b64_tr_b16 a[10:11], v9 offset:54912
    ds_read_b64_tr_b16 a[12:13], v10 offset:53376
    ds_read_b64_tr_b16 a[14:15], v10 offset:54912
    s_waitcnt lgkmcnt(13)
    v_mfma_f32_32x32x16_bf16 v[80:95], a[40:43], a[52:55], v[80:95]
    ds_read_b64_tr_b16 a[16:17], v9 offset:53504
    ds_read_b64_tr_b16 a[18:19], v9 offset:55040
    ds_read_b64_tr_b16 a[20:21], v10 offset:53504
    s_add_u32 m0, s36, 1024
    s_add_u32 s32, s39, 512
    buffer_load_dwordx4 v6, s[24:27], s32 offen lds
    s_waitcnt lgkmcnt(14)
    v_mfma_f32_32x32x16_bf16 v[96:111], a[44:47], a[52:55], v[96:111]
    ds_read_b64_tr_b16 a[22:23], v10 offset:55040
    s_waitcnt lgkmcnt(13)
    v_mfma_f32_32x32x16_bf16 v[112:127], a[48:51], a[52:55], v[112:127]
    s_add_u32 m0, s36, 2048
    s_add_u32 s32, s39, 512
    buffer_load_dwordx4 v7, s[24:27], s32 offen lds
    s_waitcnt lgkmcnt(10)
    v_mfma_f32_32x32x16_bf16 v[32:47], a[0:3], a[24:27], v[32:47]
    ds_read_b128 a[52:55], v16 offset:40960
    ds_read_b64_tr_b16 a[28:29], v9 offset:59392
    ds_read_b64_tr_b16 a[30:31], v9 offset:60928
    s_waitcnt lgkmcnt(11)
    v_mfma_f32_32x32x16_bf16 v[48:63], a[4:7], a[24:27], v[48:63]
    ds_read_b64_tr_b16 a[32:33], v10 offset:59392
    ds_read_b64_tr_b16 a[34:35], v10 offset:60928
    ds_read_b64_tr_b16 a[36:37], v9 offset:59520
    s_add_u32 m0, s36, 3072
    s_add_u32 s32, s39, 512
    buffer_load_dwordx4 v8, s[24:27], s32 offen lds
    s_waitcnt lgkmcnt(12)
    v_mfma_f32_32x32x16_bf16 v[64:79], a[8:11], a[24:27], v[64:79]
    ds_read_b64_tr_b16 a[38:39], v9 offset:61056
    ds_read_b64_tr_b16 a[40:41], v10 offset:59520
    ds_read_b64_tr_b16 a[42:43], v10 offset:61056
    s_waitcnt lgkmcnt(13)
    v_mfma_f32_32x32x16_bf16 v[80:95], a[12:15], a[24:27], v[80:95]
    ds_read_b64_tr_b16 a[44:45], v9 offset:59648
    ds_read_b64_tr_b16 a[46:47], v9 offset:61184
    ds_read_b64_tr_b16 a[48:49], v10 offset:59648
    s_waitcnt lgkmcnt(14)
    v_mfma_f32_32x32x16_bf16 v[96:111], a[16:19], a[24:27], v[96:111]
    ds_read_b64_tr_b16 a[50:51], v10 offset:61184
    s_waitcnt lgkmcnt(13)
    v_mfma_f32_32x32x16_bf16 v[112:127], a[20:23], a[24:27], v[112:127]
    s_waitcnt lgkmcnt(0)
    s_waitcnt vmcnt(20)
    s_barrier
    v_mfma_f32_32x32x16_bf16 v[32:47], a[28:31], a[52:55], v[32:47]
    ds_read_b128 a[24:27], v17 offset:0
    ds_read_b64_tr_b16 a[0:1], v11 offset:0
    ds_read_b64_tr_b16 a[2:3], v11 offset:1536
    v_mfma_f32_32x32x16_bf16 v[48:63], a[32:35], a[52:55], v[48:63]
    ds_read_b64_tr_b16 a[4:5], v12 offset:0
    ds_read_b64_tr_b16 a[6:7], v12 offset:1536
    ds_read_b64_tr_b16 a[8:9], v11 offset:128
    s_add_u32 m0, s35, 40960
    s_add_u32 s32, s37, 3932160
    buffer_load_dwordx4 v1, s[16:19], s32 offen lds
    v_mfma_f32_32x32x16_bf16 v[64:79], a[36:39], a[52:55], v[64:79]
    ds_read_b64_tr_b16 a[10:11], v11 offset:1664
    ds_read_b64_tr_b16 a[12:13], v12 offset:128
    ds_read_b64_tr_b16 a[14:15], v12 offset:1664
    v_mfma_f32_32x32x16_bf16 v[80:95], a[40:43], a[52:55], v[80:95]
    ds_read_b64_tr_b16 a[16:17], v11 offset:256
    ds_read_b64_tr_b16 a[18:19], v11 offset:1792
    ds_read_b64_tr_b16 a[20:21], v12 offset:256
    s_add_u32 m0, s35, 41984
    s_add_u32 s32, s37, 3932160
    buffer_load_dwordx4 v2, s[16:19], s32 offen lds
    v_mfma_f32_32x32x16_bf16 v[96:111], a[44:47], a[52:55], v[96:111]
    ds_read_b64_tr_b16 a[22:23], v12 offset:1792
    v_mfma_f32_32x32x16_bf16 v[112:127], a[48:51], a[52:55], v[112:127]
    s_add_u32 m0, s35, 43008
    s_add_u32 s32, s37, 3932160
    buffer_load_dwordx4 v3, s[16:19], s32 offen lds
    s_waitcnt lgkmcnt(10)
    v_mfma_f32_32x32x16_bf16 v[32:47], a[0:3], a[24:27], v[32:47]
    ds_read_b128 a[52:55], v18 offset:0
    ds_read_b64_tr_b16 a[28:29], v11 offset:6144
    ds_read_b64_tr_b16 a[30:31], v11 offset:7680
    s_waitcnt lgkmcnt(11)
    v_mfma_f32_32x32x16_bf16 v[48:63], a[4:7], a[24:27], v[48:63]
    ds_read_b64_tr_b16 a[32:33], v12 offset:6144
    ds_read_b64_tr_b16 a[34:35], v12 offset:7680
    ds_read_b64_tr_b16 a[36:37], v11 offset:6272
    s_add_u32 m0, s35, 44032
    s_add_u32 s32, s37, 4030464
    buffer_load_dwordx4 v1, s[16:19], s32 offen lds
    s_waitcnt lgkmcnt(12)
    v_mfma_f32_32x32x16_bf16 v[64:79], a[8:11], a[24:27], v[64:79]
    ds_read_b64_tr_b16 a[38:39], v11 offset:7808
    ds_read_b64_tr_b16 a[40:41], v12 offset:6272
    ds_read_b64_tr_b16 a[42:43], v12 offset:7808
    s_waitcnt lgkmcnt(13)
    v_mfma_f32_32x32x16_bf16 v[80:95], a[12:15], a[24:27], v[80:95]
    ds_read_b64_tr_b16 a[44:45], v11 offset:6400
    ds_read_b64_tr_b16 a[46:47], v11 offset:7936
    ds_read_b64_tr_b16 a[48:49], v12 offset:6400
    s_add_u32 m0, s35, 45056
    s_add_u32 s32, s37, 4030464
    buffer_load_dwordx4 v2, s[16:19], s32 offen lds
    s_waitcnt lgkmcnt(14)
    v_mfma_f32_32x32x16_bf16 v[96:111], a[16:19], a[24:27], v[96:111]
    ds_read_b64_tr_b16 a[50:51], v12 offset:7936
    s_waitcnt lgkmcnt(13)
    v_mfma_f32_32x32x16_bf16 v[112:127], a[20:23], a[24:27], v[112:127]
    s_add_u32 m0, s35, 46080
    s_add_u32 s32, s37, 4030464
    buffer_load_dwordx4 v3, s[16:19], s32 offen lds
    s_waitcnt lgkmcnt(10)
    v_mfma_f32_32x32x16_bf16 v[32:47], a[28:31], a[52:55], v[32:47]
    ds_read_b128 a[24:27], v19 offset:0
    ds_read_b64_tr_b16 a[0:1], v11 offset:12288
    ds_read_b64_tr_b16 a[2:3], v11 offset:13824
    s_waitcnt lgkmcnt(11)
    v_mfma_f32_32x32x16_bf16 v[48:63], a[32:35], a[52:55], v[48:63]
    ds_read_b64_tr_b16 a[4:5], v12 offset:12288
    ds_read_b64_tr_b16 a[6:7], v12 offset:13824
    ds_read_b64_tr_b16 a[8:9], v11 offset:12416
    s_add_u32 m0, s36, 40960
    s_add_u32 s32, s39, 640
    buffer_load_dwordx4 v5, s[24:27], s32 offen lds
    s_waitcnt lgkmcnt(12)
    v_mfma_f32_32x32x16_bf16 v[64:79], a[36:39], a[52:55], v[64:79]
    ds_read_b64_tr_b16 a[10:11], v11 offset:13952
    ds_read_b64_tr_b16 a[12:13], v12 offset:12416
    ds_read_b64_tr_b16 a[14:15], v12 offset:13952
    s_waitcnt lgkmcnt(13)
    v_mfma_f32_32x32x16_bf16 v[80:95], a[40:43], a[52:55], v[80:95]
    ds_read_b64_tr_b16 a[16:17], v11 offset:12544
    ds_read_b64_tr_b16 a[18:19], v11 offset:14080
    ds_read_b64_tr_b16 a[20:21], v12 offset:12544
    s_add_u32 m0, s36, 41984
    s_add_u32 s32, s39, 640
    buffer_load_dwordx4 v6, s[24:27], s32 offen lds
    s_waitcnt lgkmcnt(14)
    v_mfma_f32_32x32x16_bf16 v[96:111], a[44:47], a[52:55], v[96:111]
    ds_read_b64_tr_b16 a[22:23], v12 offset:14080
    s_waitcnt lgkmcnt(13)
    v_mfma_f32_32x32x16_bf16 v[112:127], a[48:51], a[52:55], v[112:127]
    s_add_u32 m0, s36, 43008
    s_add_u32 s32, s39, 640
    buffer_load_dwordx4 v7, s[24:27], s32 offen lds
    s_waitcnt lgkmcnt(10)
    v_mfma_f32_32x32x16_bf16 v[32:47], a[0:3], a[24:27], v[32:47]
    ds_read_b128 a[52:55], v20 offset:0
    ds_read_b64_tr_b16 a[28:29], v11 offset:18432
    ds_read_b64_tr_b16 a[30:31], v11 offset:19968
    s_waitcnt lgkmcnt(11)
    v_mfma_f32_32x32x16_bf16 v[48:63], a[4:7], a[24:27], v[48:63]
    ds_read_b64_tr_b16 a[32:33], v12 offset:18432
    ds_read_b64_tr_b16 a[34:35], v12 offset:19968
    ds_read_b64_tr_b16 a[36:37], v11 offset:18560
    s_add_u32 m0, s36, 44032
    s_add_u32 s32, s39, 640
    buffer_load_dwordx4 v8, s[24:27], s32 offen lds
    s_waitcnt lgkmcnt(12)
    v_mfma_f32_32x32x16_bf16 v[64:79], a[8:11], a[24:27], v[64:79]
    ds_read_b64_tr_b16 a[38:39], v11 offset:20096
    ds_read_b64_tr_b16 a[40:41], v12 offset:18560
    ds_read_b64_tr_b16 a[42:43], v12 offset:20096
    s_waitcnt lgkmcnt(13)
    v_mfma_f32_32x32x16_bf16 v[80:95], a[12:15], a[24:27], v[80:95]
    ds_read_b64_tr_b16 a[44:45], v11 offset:18688
    ds_read_b64_tr_b16 a[46:47], v11 offset:20224
    ds_read_b64_tr_b16 a[48:49], v12 offset:18688
    s_waitcnt lgkmcnt(14)
    v_mfma_f32_32x32x16_bf16 v[96:111], a[16:19], a[24:27], v[96:111]
    ds_read_b64_tr_b16 a[50:51], v12 offset:20224
    s_waitcnt lgkmcnt(13)
    v_mfma_f32_32x32x16_bf16 v[112:127], a[20:23], a[24:27], v[112:127]
    s_waitcnt lgkmcnt(0)
    s_waitcnt vmcnt(20)
    s_barrier
    v_mfma_f32_32x32x16_bf16 v[32:47], a[28:31], a[52:55], v[32:47]
    ds_read_b128 a[24:27], v17 offset:40960
    ds_read_b64_tr_b16 a[0:1], v11 offset:40960
    ds_read_b64_tr_b16 a[2:3], v11 offset:42496
    v_mfma_f32_32x32x16_bf16 v[48:63], a[32:35], a[52:55], v[48:63]
    ds_read_b64_tr_b16 a[4:5], v12 offset:40960
    ds_read_b64_tr_b16 a[6:7], v12 offset:42496
    ds_read_b64_tr_b16 a[8:9], v11 offset:41088
    s_add_u32 m0, s35, 81920
    s_add_u32 s32, s37, 4718592
    buffer_load_dwordx4 v1, s[16:19], s32 offen lds
    v_mfma_f32_32x32x16_bf16 v[64:79], a[36:39], a[52:55], v[64:79]
    ds_read_b64_tr_b16 a[10:11], v11 offset:42624
    ds_read_b64_tr_b16 a[12:13], v12 offset:41088
    ds_read_b64_tr_b16 a[14:15], v12 offset:42624
    v_mfma_f32_32x32x16_bf16 v[80:95], a[40:43], a[52:55], v[80:95]
    ds_read_b64_tr_b16 a[16:17], v11 offset:41216
    ds_read_b64_tr_b16 a[18:19], v11 offset:42752
    ds_read_b64_tr_b16 a[20:21], v12 offset:41216
    s_add_u32 m0, s35, 82944
    s_add_u32 s32, s37, 4718592
    buffer_load_dwordx4 v2, s[16:19], s32 offen lds
    v_mfma_f32_32x32x16_bf16 v[96:111], a[44:47], a[52:55], v[96:111]
    ds_read_b64_tr_b16 a[22:23], v12 offset:42752
    v_mfma_f32_32x32x16_bf16 v[112:127], a[48:51], a[52:55], v[112:127]
    s_add_u32 m0, s35, 83968
    s_add_u32 s32, s37, 4718592
    buffer_load_dwordx4 v3, s[16:19], s32 offen lds
    s_waitcnt lgkmcnt(10)
    v_mfma_f32_32x32x16_bf16 v[32:47], a[0:3], a[24:27], v[32:47]
    ds_read_b128 a[52:55], v18 offset:40960
    ds_read_b64_tr_b16 a[28:29], v11 offset:47104
    ds_read_b64_tr_b16 a[30:31], v11 offset:48640
    s_waitcnt lgkmcnt(11)
    v_mfma_f32_32x32x16_bf16 v[48:63], a[4:7], a[24:27], v[48:63]
    ds_read_b64_tr_b16 a[32:33], v12 offset:47104
    ds_read_b64_tr_b16 a[34:35], v12 offset:48640
    ds_read_b64_tr_b16 a[36:37], v11 offset:47232
    s_add_u32 m0, s35, 84992
    s_add_u32 s32, s37, 4816896
    buffer_load_dwordx4 v1, s[16:19], s32 offen lds
    s_waitcnt lgkmcnt(12)
    v_mfma_f32_32x32x16_bf16 v[64:79], a[8:11], a[24:27], v[64:79]
    ds_read_b64_tr_b16 a[38:39], v11 offset:48768
    ds_read_b64_tr_b16 a[40:41], v12 offset:47232
    ds_read_b64_tr_b16 a[42:43], v12 offset:48768
    s_waitcnt lgkmcnt(13)
    v_mfma_f32_32x32x16_bf16 v[80:95], a[12:15], a[24:27], v[80:95]
    ds_read_b64_tr_b16 a[44:45], v11 offset:47360
    ds_read_b64_tr_b16 a[46:47], v11 offset:48896
    ds_read_b64_tr_b16 a[48:49], v12 offset:47360
    s_add_u32 m0, s35, 86016
    s_add_u32 s32, s37, 4816896
    buffer_load_dwordx4 v2, s[16:19], s32 offen lds
    s_waitcnt lgkmcnt(14)
    v_mfma_f32_32x32x16_bf16 v[96:111], a[16:19], a[24:27], v[96:111]
    ds_read_b64_tr_b16 a[50:51], v12 offset:48896
    s_waitcnt lgkmcnt(13)
    v_mfma_f32_32x32x16_bf16 v[112:127], a[20:23], a[24:27], v[112:127]
    s_add_u32 m0, s35, 87040
    s_add_u32 s32, s37, 4816896
    buffer_load_dwordx4 v3, s[16:19], s32 offen lds
    s_waitcnt lgkmcnt(10)
    v_mfma_f32_32x32x16_bf16 v[32:47], a[28:31], a[52:55], v[32:47]
    ds_read_b128 a[24:27], v19 offset:40960
    ds_read_b64_tr_b16 a[0:1], v11 offset:53248
    ds_read_b64_tr_b16 a[2:3], v11 offset:54784
    s_waitcnt lgkmcnt(11)
    v_mfma_f32_32x32x16_bf16 v[48:63], a[32:35], a[52:55], v[48:63]
    ds_read_b64_tr_b16 a[4:5], v12 offset:53248
    ds_read_b64_tr_b16 a[6:7], v12 offset:54784
    ds_read_b64_tr_b16 a[8:9], v11 offset:53376
    s_add_u32 m0, s36, 81920
    s_add_u32 s32, s39, 768
    buffer_load_dwordx4 v5, s[24:27], s32 offen lds
    s_waitcnt lgkmcnt(12)
    v_mfma_f32_32x32x16_bf16 v[64:79], a[36:39], a[52:55], v[64:79]
    ds_read_b64_tr_b16 a[10:11], v11 offset:54912
    ds_read_b64_tr_b16 a[12:13], v12 offset:53376
    ds_read_b64_tr_b16 a[14:15], v12 offset:54912
    s_waitcnt lgkmcnt(13)
    v_mfma_f32_32x32x16_bf16 v[80:95], a[40:43], a[52:55], v[80:95]
    ds_read_b64_tr_b16 a[16:17], v11 offset:53504
    ds_read_b64_tr_b16 a[18:19], v11 offset:55040
    ds_read_b64_tr_b16 a[20:21], v12 offset:53504
    s_add_u32 m0, s36, 82944
    s_add_u32 s32, s39, 768
    buffer_load_dwordx4 v6, s[24:27], s32 offen lds
    s_waitcnt lgkmcnt(14)
    v_mfma_f32_32x32x16_bf16 v[96:111], a[44:47], a[52:55], v[96:111]
    ds_read_b64_tr_b16 a[22:23], v12 offset:55040
    s_waitcnt lgkmcnt(13)
    v_mfma_f32_32x32x16_bf16 v[112:127], a[48:51], a[52:55], v[112:127]
    s_add_u32 m0, s36, 83968
    s_add_u32 s32, s39, 768
    buffer_load_dwordx4 v7, s[24:27], s32 offen lds
    s_waitcnt lgkmcnt(10)
    v_mfma_f32_32x32x16_bf16 v[32:47], a[0:3], a[24:27], v[32:47]
    ds_read_b128 a[52:55], v20 offset:40960
    ds_read_b64_tr_b16 a[28:29], v11 offset:59392
    ds_read_b64_tr_b16 a[30:31], v11 offset:60928
    s_waitcnt lgkmcnt(11)
    v_mfma_f32_32x32x16_bf16 v[48:63], a[4:7], a[24:27], v[48:63]
    ds_read_b64_tr_b16 a[32:33], v12 offset:59392
    ds_read_b64_tr_b16 a[34:35], v12 offset:60928
    ds_read_b64_tr_b16 a[36:37], v11 offset:59520
    s_add_u32 m0, s36, 84992
    s_add_u32 s32, s39, 768
    buffer_load_dwordx4 v8, s[24:27], s32 offen lds
    s_waitcnt lgkmcnt(12)
    v_mfma_f32_32x32x16_bf16 v[64:79], a[8:11], a[24:27], v[64:79]
    ds_read_b64_tr_b16 a[38:39], v11 offset:61056
    ds_read_b64_tr_b16 a[40:41], v12 offset:59520
    ds_read_b64_tr_b16 a[42:43], v12 offset:61056
    s_waitcnt lgkmcnt(13)
    v_mfma_f32_32x32x16_bf16 v[80:95], a[12:15], a[24:27], v[80:95]
    ds_read_b64_tr_b16 a[44:45], v11 offset:59648
    ds_read_b64_tr_b16 a[46:47], v11 offset:61184
    ds_read_b64_tr_b16 a[48:49], v12 offset:59648
    s_waitcnt lgkmcnt(14)
    v_mfma_f32_32x32x16_bf16 v[96:111], a[16:19], a[24:27], v[96:111]
    ds_read_b64_tr_b16 a[50:51], v12 offset:61184
    s_waitcnt lgkmcnt(13)
    v_mfma_f32_32x32x16_bf16 v[112:127], a[20:23], a[24:27], v[112:127]
    s_waitcnt lgkmcnt(0)
    s_waitcnt vmcnt(20)
    s_barrier
    v_mfma_f32_32x32x16_bf16 v[32:47], a[28:31], a[52:55], v[32:47]
    ds_read_b128 a[24:27], v13 offset:0
    ds_read_b64_tr_b16 a[0:1], v9 offset:0
    ds_read_b64_tr_b16 a[2:3], v9 offset:1536
    v_mfma_f32_32x32x16_bf16 v[48:63], a[32:35], a[52:55], v[48:63]
    ds_read_b64_tr_b16 a[4:5], v10 offset:0
    ds_read_b64_tr_b16 a[6:7], v10 offset:1536
    ds_read_b64_tr_b16 a[8:9], v9 offset:128
    s_add_u32 m0, s35, 122880
    s_add_u32 s32, s37, 5505024
    buffer_load_dwordx4 v1, s[16:19], s32 offen lds
    v_mfma_f32_32x32x16_bf16 v[64:79], a[36:39], a[52:55], v[64:79]
    ds_read_b64_tr_b16 a[10:11], v9 offset:1664
    ds_read_b64_tr_b16 a[12:13], v10 offset:128
    ds_read_b64_tr_b16 a[14:15], v10 offset:1664
    v_mfma_f32_32x32x16_bf16 v[80:95], a[40:43], a[52:55], v[80:95]
    ds_read_b64_tr_b16 a[16:17], v9 offset:256
    ds_read_b64_tr_b16 a[18:19], v9 offset:1792
    ds_read_b64_tr_b16 a[20:21], v10 offset:256
    s_add_u32 m0, s35, 123904
    s_add_u32 s32, s37, 5505024
    buffer_load_dwordx4 v2, s[16:19], s32 offen lds
    v_mfma_f32_32x32x16_bf16 v[96:111], a[44:47], a[52:55], v[96:111]
    ds_read_b64_tr_b16 a[22:23], v10 offset:1792
    v_mfma_f32_32x32x16_bf16 v[112:127], a[48:51], a[52:55], v[112:127]
    s_add_u32 m0, s35, 124928
    s_add_u32 s32, s37, 5505024
    buffer_load_dwordx4 v3, s[16:19], s32 offen lds
    s_waitcnt lgkmcnt(10)
    v_mfma_f32_32x32x16_bf16 v[32:47], a[0:3], a[24:27], v[32:47]
    ds_read_b128 a[52:55], v14 offset:0
    ds_read_b64_tr_b16 a[28:29], v9 offset:6144
    ds_read_b64_tr_b16 a[30:31], v9 offset:7680
    s_waitcnt lgkmcnt(11)
    v_mfma_f32_32x32x16_bf16 v[48:63], a[4:7], a[24:27], v[48:63]
    ds_read_b64_tr_b16 a[32:33], v10 offset:6144
    ds_read_b64_tr_b16 a[34:35], v10 offset:7680
    ds_read_b64_tr_b16 a[36:37], v9 offset:6272
    s_add_u32 m0, s35, 125952
    s_add_u32 s32, s37, 5603328
    buffer_load_dwordx4 v1, s[16:19], s32 offen lds
    s_waitcnt lgkmcnt(12)
    v_mfma_f32_32x32x16_bf16 v[64:79], a[8:11], a[24:27], v[64:79]
    ds_read_b64_tr_b16 a[38:39], v9 offset:7808
    ds_read_b64_tr_b16 a[40:41], v10 offset:6272
    ds_read_b64_tr_b16 a[42:43], v10 offset:7808
    s_waitcnt lgkmcnt(13)
    v_mfma_f32_32x32x16_bf16 v[80:95], a[12:15], a[24:27], v[80:95]
    ds_read_b64_tr_b16 a[44:45], v9 offset:6400
    ds_read_b64_tr_b16 a[46:47], v9 offset:7936
    ds_read_b64_tr_b16 a[48:49], v10 offset:6400
    s_add_u32 m0, s35, 126976
    s_add_u32 s32, s37, 5603328
    buffer_load_dwordx4 v2, s[16:19], s32 offen lds
    s_waitcnt lgkmcnt(14)
    v_mfma_f32_32x32x16_bf16 v[96:111], a[16:19], a[24:27], v[96:111]
    ds_read_b64_tr_b16 a[50:51], v10 offset:7936
    s_waitcnt lgkmcnt(13)
    v_mfma_f32_32x32x16_bf16 v[112:127], a[20:23], a[24:27], v[112:127]
    s_add_u32 m0, s35, 128000
    s_add_u32 s32, s37, 5603328
    buffer_load_dwordx4 v3, s[16:19], s32 offen lds
    s_waitcnt lgkmcnt(10)
    v_mfma_f32_32x32x16_bf16 v[32:47], a[28:31], a[52:55], v[32:47]
    ds_read_b128 a[24:27], v15 offset:0
    ds_read_b64_tr_b16 a[0:1], v9 offset:12288
    ds_read_b64_tr_b16 a[2:3], v9 offset:13824
    s_waitcnt lgkmcnt(11)
    v_mfma_f32_32x32x16_bf16 v[48:63], a[32:35], a[52:55], v[48:63]
    ds_read_b64_tr_b16 a[4:5], v10 offset:12288
    ds_read_b64_tr_b16 a[6:7], v10 offset:13824
    ds_read_b64_tr_b16 a[8:9], v9 offset:12416
    s_add_u32 m0, s36, 122880
    s_add_u32 s32, s39, 896
    buffer_load_dwordx4 v5, s[24:27], s32 offen lds
    s_waitcnt lgkmcnt(12)
    v_mfma_f32_32x32x16_bf16 v[64:79], a[36:39], a[52:55], v[64:79]
    ds_read_b64_tr_b16 a[10:11], v9 offset:13952
    ds_read_b64_tr_b16 a[12:13], v10 offset:12416
    ds_read_b64_tr_b16 a[14:15], v10 offset:13952
    s_waitcnt lgkmcnt(13)
    v_mfma_f32_32x32x16_bf16 v[80:95], a[40:43], a[52:55], v[80:95]
    ds_read_b64_tr_b16 a[16:17], v9 offset:12544
    ds_read_b64_tr_b16 a[18:19], v9 offset:14080
    ds_read_b64_tr_b16 a[20:21], v10 offset:12544
    s_add_u32 m0, s36, 123904
    s_add_u32 s32, s39, 896
    buffer_load_dwordx4 v6, s[24:27], s32 offen lds
    s_waitcnt lgkmcnt(14)
    v_mfma_f32_32x32x16_bf16 v[96:111], a[44:47], a[52:55], v[96:111]
    ds_read_b64_tr_b16 a[22:23], v10 offset:14080
    s_waitcnt lgkmcnt(13)
    v_mfma_f32_32x32x16_bf16 v[112:127], a[48:51], a[52:55], v[112:127]
    s_add_u32 m0, s36, 124928
    s_add_u32 s32, s39, 896
    buffer_load_dwordx4 v7, s[24:27], s32 offen lds
    s_waitcnt lgkmcnt(10)
    v_mfma_f32_32x32x16_bf16 v[32:47], a[0:3], a[24:27], v[32:47]
    ds_read_b128 a[52:55], v16 offset:0
    ds_read_b64_tr_b16 a[28:29], v9 offset:18432
    ds_read_b64_tr_b16 a[30:31], v9 offset:19968
    s_waitcnt lgkmcnt(11)
    v_mfma_f32_32x32x16_bf16 v[48:63], a[4:7], a[24:27], v[48:63]
    ds_read_b64_tr_b16 a[32:33], v10 offset:18432
    ds_read_b64_tr_b16 a[34:35], v10 offset:19968
    ds_read_b64_tr_b16 a[36:37], v9 offset:18560
    s_add_u32 m0, s36, 125952
    s_add_u32 s32, s39, 896
    buffer_load_dwordx4 v8, s[24:27], s32 offen lds
    s_waitcnt lgkmcnt(12)
    v_mfma_f32_32x32x16_bf16 v[64:79], a[8:11], a[24:27], v[64:79]
    ds_read_b64_tr_b16 a[38:39], v9 offset:20096
    ds_read_b64_tr_b16 a[40:41], v10 offset:18560
    ds_read_b64_tr_b16 a[42:43], v10 offset:20096
    s_waitcnt lgkmcnt(13)
    v_mfma_f32_32x32x16_bf16 v[80:95], a[12:15], a[24:27], v[80:95]
    ds_read_b64_tr_b16 a[44:45], v9 offset:18688
    ds_read_b64_tr_b16 a[46:47], v9 offset:20224
    ds_read_b64_tr_b16 a[48:49], v10 offset:18688
    s_waitcnt lgkmcnt(14)
    v_mfma_f32_32x32x16_bf16 v[96:111], a[16:19], a[24:27], v[96:111]
    ds_read_b64_tr_b16 a[50:51], v10 offset:20224
    s_waitcnt lgkmcnt(13)
    v_mfma_f32_32x32x16_bf16 v[112:127], a[20:23], a[24:27], v[112:127]
    s_waitcnt lgkmcnt(0)
    s_waitcnt vmcnt(20)
    s_barrier
    v_mfma_f32_32x32x16_bf16 v[32:47], a[28:31], a[52:55], v[32:47]
    ds_read_b128 a[24:27], v13 offset:40960
    ds_read_b64_tr_b16 a[0:1], v9 offset:40960
    ds_read_b64_tr_b16 a[2:3], v9 offset:42496
    v_mfma_f32_32x32x16_bf16 v[48:63], a[32:35], a[52:55], v[48:63]
    ds_read_b64_tr_b16 a[4:5], v10 offset:40960
    ds_read_b64_tr_b16 a[6:7], v10 offset:42496
    ds_read_b64_tr_b16 a[8:9], v9 offset:41088
    s_add_u32 m0, s35, 0
    s_add_u32 s32, s37, 6291456
    buffer_load_dwordx4 v1, s[16:19], s32 offen lds
    v_mfma_f32_32x32x16_bf16 v[64:79], a[36:39], a[52:55], v[64:79]
    ds_read_b64_tr_b16 a[10:11], v9 offset:42624
    ds_read_b64_tr_b16 a[12:13], v10 offset:41088
    ds_read_b64_tr_b16 a[14:15], v10 offset:42624
    v_mfma_f32_32x32x16_bf16 v[80:95], a[40:43], a[52:55], v[80:95]
    ds_read_b64_tr_b16 a[16:17], v9 offset:41216
    ds_read_b64_tr_b16 a[18:19], v9 offset:42752
    ds_read_b64_tr_b16 a[20:21], v10 offset:41216
    s_add_u32 m0, s35, 1024
    s_add_u32 s32, s37, 6291456
    buffer_load_dwordx4 v2, s[16:19], s32 offen lds
    v_mfma_f32_32x32x16_bf16 v[96:111], a[44:47], a[52:55], v[96:111]
    ds_read_b64_tr_b16 a[22:23], v10 offset:42752
    v_mfma_f32_32x32x16_bf16 v[112:127], a[48:51], a[52:55], v[112:127]
    s_add_u32 m0, s35, 2048
    s_add_u32 s32, s37, 6291456
    buffer_load_dwordx4 v3, s[16:19], s32 offen lds
    s_waitcnt lgkmcnt(10)
    v_mfma_f32_32x32x16_bf16 v[32:47], a[0:3], a[24:27], v[32:47]
    ds_read_b128 a[52:55], v14 offset:40960
    ds_read_b64_tr_b16 a[28:29], v9 offset:47104
    ds_read_b64_tr_b16 a[30:31], v9 offset:48640
    s_waitcnt lgkmcnt(11)
    v_mfma_f32_32x32x16_bf16 v[48:63], a[4:7], a[24:27], v[48:63]
    ds_read_b64_tr_b16 a[32:33], v10 offset:47104
    ds_read_b64_tr_b16 a[34:35], v10 offset:48640
    ds_read_b64_tr_b16 a[36:37], v9 offset:47232
    s_add_u32 m0, s35, 3072
    s_add_u32 s32, s37, 6389760
    buffer_load_dwordx4 v1, s[16:19], s32 offen lds
    s_waitcnt lgkmcnt(12)
    v_mfma_f32_32x32x16_bf16 v[64:79], a[8:11], a[24:27], v[64:79]
    ds_read_b64_tr_b16 a[38:39], v9 offset:48768
    ds_read_b64_tr_b16 a[40:41], v10 offset:47232
    ds_read_b64_tr_b16 a[42:43], v10 offset:48768
    s_waitcnt lgkmcnt(13)
    v_mfma_f32_32x32x16_bf16 v[80:95], a[12:15], a[24:27], v[80:95]
    ds_read_b64_tr_b16 a[44:45], v9 offset:47360
    ds_read_b64_tr_b16 a[46:47], v9 offset:48896
    ds_read_b64_tr_b16 a[48:49], v10 offset:47360
    s_add_u32 m0, s35, 4096
    s_add_u32 s32, s37, 6389760
    buffer_load_dwordx4 v2, s[16:19], s32 offen lds
    s_waitcnt lgkmcnt(14)
    v_mfma_f32_32x32x16_bf16 v[96:111], a[16:19], a[24:27], v[96:111]
    ds_read_b64_tr_b16 a[50:51], v10 offset:48896
    s_waitcnt lgkmcnt(13)
    v_mfma_f32_32x32x16_bf16 v[112:127], a[20:23], a[24:27], v[112:127]
    s_add_u32 m0, s35, 5120
    s_add_u32 s32, s37, 6389760
    buffer_load_dwordx4 v3, s[16:19], s32 offen lds
    s_waitcnt lgkmcnt(10)
    v_mfma_f32_32x32x16_bf16 v[32:47], a[28:31], a[52:55], v[32:47]
    ds_read_b128 a[24:27], v15 offset:40960
    ds_read_b64_tr_b16 a[0:1], v9 offset:53248
    ds_read_b64_tr_b16 a[2:3], v9 offset:54784
    s_waitcnt lgkmcnt(11)
    v_mfma_f32_32x32x16_bf16 v[48:63], a[32:35], a[52:55], v[48:63]
    ds_read_b64_tr_b16 a[4:5], v10 offset:53248
    ds_read_b64_tr_b16 a[6:7], v10 offset:54784
    ds_read_b64_tr_b16 a[8:9], v9 offset:53376
    s_add_u32 m0, s36, 0
    s_add_u32 s32, s39, 1024
    buffer_load_dwordx4 v5, s[24:27], s32 offen lds
    s_waitcnt lgkmcnt(12)
    v_mfma_f32_32x32x16_bf16 v[64:79], a[36:39], a[52:55], v[64:79]
    ds_read_b64_tr_b16 a[10:11], v9 offset:54912
    ds_read_b64_tr_b16 a[12:13], v10 offset:53376
    ds_read_b64_tr_b16 a[14:15], v10 offset:54912
    s_waitcnt lgkmcnt(13)
    v_mfma_f32_32x32x16_bf16 v[80:95], a[40:43], a[52:55], v[80:95]
    ds_read_b64_tr_b16 a[16:17], v9 offset:53504
    ds_read_b64_tr_b16 a[18:19], v9 offset:55040
    ds_read_b64_tr_b16 a[20:21], v10 offset:53504
    s_add_u32 m0, s36, 1024
    s_add_u32 s32, s39, 1024
    buffer_load_dwordx4 v6, s[24:27], s32 offen lds
    s_waitcnt lgkmcnt(14)
    v_mfma_f32_32x32x16_bf16 v[96:111], a[44:47], a[52:55], v[96:111]
    ds_read_b64_tr_b16 a[22:23], v10 offset:55040
    s_waitcnt lgkmcnt(13)
    v_mfma_f32_32x32x16_bf16 v[112:127], a[48:51], a[52:55], v[112:127]
    s_add_u32 m0, s36, 2048
    s_add_u32 s32, s39, 1024
    buffer_load_dwordx4 v7, s[24:27], s32 offen lds
    s_waitcnt lgkmcnt(10)
    v_mfma_f32_32x32x16_bf16 v[32:47], a[0:3], a[24:27], v[32:47]
    ds_read_b128 a[52:55], v16 offset:40960
    ds_read_b64_tr_b16 a[28:29], v9 offset:59392
    ds_read_b64_tr_b16 a[30:31], v9 offset:60928
    s_waitcnt lgkmcnt(11)
    v_mfma_f32_32x32x16_bf16 v[48:63], a[4:7], a[24:27], v[48:63]
    ds_read_b64_tr_b16 a[32:33], v10 offset:59392
    ds_read_b64_tr_b16 a[34:35], v10 offset:60928
    ds_read_b64_tr_b16 a[36:37], v9 offset:59520
    s_add_u32 m0, s36, 3072
    s_add_u32 s32, s39, 1024
    buffer_load_dwordx4 v8, s[24:27], s32 offen lds
    s_waitcnt lgkmcnt(12)
    v_mfma_f32_32x32x16_bf16 v[64:79], a[8:11], a[24:27], v[64:79]
    ds_read_b64_tr_b16 a[38:39], v9 offset:61056
    ds_read_b64_tr_b16 a[40:41], v10 offset:59520
    ds_read_b64_tr_b16 a[42:43], v10 offset:61056
    s_waitcnt lgkmcnt(13)
    v_mfma_f32_32x32x16_bf16 v[80:95], a[12:15], a[24:27], v[80:95]
    ds_read_b64_tr_b16 a[44:45], v9 offset:59648
    ds_read_b64_tr_b16 a[46:47], v9 offset:61184
    ds_read_b64_tr_b16 a[48:49], v10 offset:59648
    s_waitcnt lgkmcnt(14)
    v_mfma_f32_32x32x16_bf16 v[96:111], a[16:19], a[24:27], v[96:111]
    ds_read_b64_tr_b16 a[50:51], v10 offset:61184
    s_waitcnt lgkmcnt(13)
    v_mfma_f32_32x32x16_bf16 v[112:127], a[20:23], a[24:27], v[112:127]
    s_waitcnt lgkmcnt(0)
    s_waitcnt vmcnt(20)
    s_barrier
    v_mfma_f32_32x32x16_bf16 v[32:47], a[28:31], a[52:55], v[32:47]
    ds_read_b128 a[24:27], v17 offset:0
    ds_read_b64_tr_b16 a[0:1], v11 offset:0
    ds_read_b64_tr_b16 a[2:3], v11 offset:1536
    v_mfma_f32_32x32x16_bf16 v[48:63], a[32:35], a[52:55], v[48:63]
    ds_read_b64_tr_b16 a[4:5], v12 offset:0
    ds_read_b64_tr_b16 a[6:7], v12 offset:1536
    ds_read_b64_tr_b16 a[8:9], v11 offset:128
    s_add_u32 m0, s35, 40960
    s_add_u32 s32, s37, 7077888
    buffer_load_dwordx4 v1, s[16:19], s32 offen lds
    v_mfma_f32_32x32x16_bf16 v[64:79], a[36:39], a[52:55], v[64:79]
    ds_read_b64_tr_b16 a[10:11], v11 offset:1664
    ds_read_b64_tr_b16 a[12:13], v12 offset:128
    ds_read_b64_tr_b16 a[14:15], v12 offset:1664
    v_mfma_f32_32x32x16_bf16 v[80:95], a[40:43], a[52:55], v[80:95]
    ds_read_b64_tr_b16 a[16:17], v11 offset:256
    ds_read_b64_tr_b16 a[18:19], v11 offset:1792
    ds_read_b64_tr_b16 a[20:21], v12 offset:256
    s_add_u32 m0, s35, 41984
    s_add_u32 s32, s37, 7077888
    buffer_load_dwordx4 v2, s[16:19], s32 offen lds
    v_mfma_f32_32x32x16_bf16 v[96:111], a[44:47], a[52:55], v[96:111]
    ds_read_b64_tr_b16 a[22:23], v12 offset:1792
    v_mfma_f32_32x32x16_bf16 v[112:127], a[48:51], a[52:55], v[112:127]
    s_add_u32 m0, s35, 43008
    s_add_u32 s32, s37, 7077888
    buffer_load_dwordx4 v3, s[16:19], s32 offen lds
    s_waitcnt lgkmcnt(10)
    v_mfma_f32_32x32x16_bf16 v[32:47], a[0:3], a[24:27], v[32:47]
    ds_read_b128 a[52:55], v18 offset:0
    ds_read_b64_tr_b16 a[28:29], v11 offset:6144
    ds_read_b64_tr_b16 a[30:31], v11 offset:7680
    s_waitcnt lgkmcnt(11)
    v_mfma_f32_32x32x16_bf16 v[48:63], a[4:7], a[24:27], v[48:63]
    ds_read_b64_tr_b16 a[32:33], v12 offset:6144
    ds_read_b64_tr_b16 a[34:35], v12 offset:7680
    ds_read_b64_tr_b16 a[36:37], v11 offset:6272
    s_add_u32 m0, s35, 44032
    s_add_u32 s32, s37, 7176192
    buffer_load_dwordx4 v1, s[16:19], s32 offen lds
    s_waitcnt lgkmcnt(12)
    v_mfma_f32_32x32x16_bf16 v[64:79], a[8:11], a[24:27], v[64:79]
    ds_read_b64_tr_b16 a[38:39], v11 offset:7808
    ds_read_b64_tr_b16 a[40:41], v12 offset:6272
    ds_read_b64_tr_b16 a[42:43], v12 offset:7808
    s_waitcnt lgkmcnt(13)
    v_mfma_f32_32x32x16_bf16 v[80:95], a[12:15], a[24:27], v[80:95]
    ds_read_b64_tr_b16 a[44:45], v11 offset:6400
    ds_read_b64_tr_b16 a[46:47], v11 offset:7936
    ds_read_b64_tr_b16 a[48:49], v12 offset:6400
    s_add_u32 m0, s35, 45056
    s_add_u32 s32, s37, 7176192
    buffer_load_dwordx4 v2, s[16:19], s32 offen lds
    s_waitcnt lgkmcnt(14)
    v_mfma_f32_32x32x16_bf16 v[96:111], a[16:19], a[24:27], v[96:111]
    ds_read_b64_tr_b16 a[50:51], v12 offset:7936
    s_waitcnt lgkmcnt(13)
    v_mfma_f32_32x32x16_bf16 v[112:127], a[20:23], a[24:27], v[112:127]
    s_add_u32 m0, s35, 46080
    s_add_u32 s32, s37, 7176192
    buffer_load_dwordx4 v3, s[16:19], s32 offen lds
    s_waitcnt lgkmcnt(10)
    v_mfma_f32_32x32x16_bf16 v[32:47], a[28:31], a[52:55], v[32:47]
    ds_read_b128 a[24:27], v19 offset:0
    ds_read_b64_tr_b16 a[0:1], v11 offset:12288
    ds_read_b64_tr_b16 a[2:3], v11 offset:13824
    s_waitcnt lgkmcnt(11)
    v_mfma_f32_32x32x16_bf16 v[48:63], a[32:35], a[52:55], v[48:63]
    ds_read_b64_tr_b16 a[4:5], v12 offset:12288
    ds_read_b64_tr_b16 a[6:7], v12 offset:13824
    ds_read_b64_tr_b16 a[8:9], v11 offset:12416
    s_add_u32 m0, s36, 40960
    s_add_u32 s32, s39, 1152
    buffer_load_dwordx4 v5, s[24:27], s32 offen lds
    s_waitcnt lgkmcnt(12)
    v_mfma_f32_32x32x16_bf16 v[64:79], a[36:39], a[52:55], v[64:79]
    ds_read_b64_tr_b16 a[10:11], v11 offset:13952
    ds_read_b64_tr_b16 a[12:13], v12 offset:12416
    ds_read_b64_tr_b16 a[14:15], v12 offset:13952
    s_waitcnt lgkmcnt(13)
    v_mfma_f32_32x32x16_bf16 v[80:95], a[40:43], a[52:55], v[80:95]
    ds_read_b64_tr_b16 a[16:17], v11 offset:12544
    ds_read_b64_tr_b16 a[18:19], v11 offset:14080
    ds_read_b64_tr_b16 a[20:21], v12 offset:12544
    s_add_u32 m0, s36, 41984
    s_add_u32 s32, s39, 1152
    buffer_load_dwordx4 v6, s[24:27], s32 offen lds
    s_waitcnt lgkmcnt(14)
    v_mfma_f32_32x32x16_bf16 v[96:111], a[44:47], a[52:55], v[96:111]
    ds_read_b64_tr_b16 a[22:23], v12 offset:14080
    s_waitcnt lgkmcnt(13)
    v_mfma_f32_32x32x16_bf16 v[112:127], a[48:51], a[52:55], v[112:127]
    s_add_u32 m0, s36, 43008
    s_add_u32 s32, s39, 1152
    buffer_load_dwordx4 v7, s[24:27], s32 offen lds
    s_waitcnt lgkmcnt(10)
    v_mfma_f32_32x32x16_bf16 v[32:47], a[0:3], a[24:27], v[32:47]
    ds_read_b128 a[52:55], v20 offset:0
    ds_read_b64_tr_b16 a[28:29], v11 offset:18432
    ds_read_b64_tr_b16 a[30:31], v11 offset:19968
    s_waitcnt lgkmcnt(11)
    v_mfma_f32_32x32x16_bf16 v[48:63], a[4:7], a[24:27], v[48:63]
    ds_read_b64_tr_b16 a[32:33], v12 offset:18432
    ds_read_b64_tr_b16 a[34:35], v12 offset:19968
    ds_read_b64_tr_b16 a[36:37], v11 offset:18560
    s_add_u32 m0, s36, 44032
    s_add_u32 s32, s39, 1152
    buffer_load_dwordx4 v8, s[24:27], s32 offen lds
    s_waitcnt lgkmcnt(12)
    v_mfma_f32_32x32x16_bf16 v[64:79], a[8:11], a[24:27], v[64:79]
    ds_read_b64_tr_b16 a[38:39], v11 offset:20096
    ds_read_b64_tr_b16 a[40:41], v12 offset:18560
    ds_read_b64_tr_b16 a[42:43], v12 offset:20096
    s_waitcnt lgkmcnt(13)
    v_mfma_f32_32x32x16_bf16 v[80:95], a[12:15], a[24:27], v[80:95]
    ds_read_b64_tr_b16 a[44:45], v11 offset:18688
    ds_read_b64_tr_b16 a[46:47], v11 offset:20224
    ds_read_b64_tr_b16 a[48:49], v12 offset:18688
    s_waitcnt lgkmcnt(14)
    v_mfma_f32_32x32x16_bf16 v[96:111], a[16:19], a[24:27], v[96:111]
    ds_read_b64_tr_b16 a[50:51], v12 offset:20224
    s_waitcnt lgkmcnt(13)
    v_mfma_f32_32x32x16_bf16 v[112:127], a[20:23], a[24:27], v[112:127]
    s_waitcnt lgkmcnt(0)
    s_waitcnt vmcnt(20)
    s_barrier
    v_mfma_f32_32x32x16_bf16 v[32:47], a[28:31], a[52:55], v[32:47]
    ds_read_b128 a[24:27], v17 offset:40960
    ds_read_b64_tr_b16 a[0:1], v11 offset:40960
    ds_read_b64_tr_b16 a[2:3], v11 offset:42496
    v_mfma_f32_32x32x16_bf16 v[48:63], a[32:35], a[52:55], v[48:63]
    ds_read_b64_tr_b16 a[4:5], v12 offset:40960
    ds_read_b64_tr_b16 a[6:7], v12 offset:42496
    ds_read_b64_tr_b16 a[8:9], v11 offset:41088
    s_add_u32 m0, s35, 81920
    s_add_u32 s32, s37, 0
    buffer_load_dwordx4 v1, s[20:23], s32 offen lds
    v_mfma_f32_32x32x16_bf16 v[64:79], a[36:39], a[52:55], v[64:79]
    ds_read_b64_tr_b16 a[10:11], v11 offset:42624
    ds_read_b64_tr_b16 a[12:13], v12 offset:41088
    ds_read_b64_tr_b16 a[14:15], v12 offset:42624
    v_mfma_f32_32x32x16_bf16 v[80:95], a[40:43], a[52:55], v[80:95]
    ds_read_b64_tr_b16 a[16:17], v11 offset:41216
    ds_read_b64_tr_b16 a[18:19], v11 offset:42752
    ds_read_b64_tr_b16 a[20:21], v12 offset:41216
    s_add_u32 m0, s35, 82944
    s_add_u32 s32, s37, 0
    buffer_load_dwordx4 v2, s[20:23], s32 offen lds
    v_mfma_f32_32x32x16_bf16 v[96:111], a[44:47], a[52:55], v[96:111]
    ds_read_b64_tr_b16 a[22:23], v12 offset:42752
    v_mfma_f32_32x32x16_bf16 v[112:127], a[48:51], a[52:55], v[112:127]
    s_add_u32 m0, s35, 83968
    s_add_u32 s32, s37, 0
    buffer_load_dwordx4 v3, s[20:23], s32 offen lds
    s_waitcnt lgkmcnt(10)
    v_mfma_f32_32x32x16_bf16 v[32:47], a[0:3], a[24:27], v[32:47]
    ds_read_b128 a[52:55], v18 offset:40960
    ds_read_b64_tr_b16 a[28:29], v11 offset:47104
    ds_read_b64_tr_b16 a[30:31], v11 offset:48640
    s_waitcnt lgkmcnt(11)
    v_mfma_f32_32x32x16_bf16 v[48:63], a[4:7], a[24:27], v[48:63]
    ds_read_b64_tr_b16 a[32:33], v12 offset:47104
    ds_read_b64_tr_b16 a[34:35], v12 offset:48640
    ds_read_b64_tr_b16 a[36:37], v11 offset:47232
    s_add_u32 m0, s35, 84992
    s_add_u32 s32, s37, 98304
    buffer_load_dwordx4 v1, s[20:23], s32 offen lds
    s_waitcnt lgkmcnt(12)
    v_mfma_f32_32x32x16_bf16 v[64:79], a[8:11], a[24:27], v[64:79]
    ds_read_b64_tr_b16 a[38:39], v11 offset:48768
    ds_read_b64_tr_b16 a[40:41], v12 offset:47232
    ds_read_b64_tr_b16 a[42:43], v12 offset:48768
    s_waitcnt lgkmcnt(13)
    v_mfma_f32_32x32x16_bf16 v[80:95], a[12:15], a[24:27], v[80:95]
    ds_read_b64_tr_b16 a[44:45], v11 offset:47360
    ds_read_b64_tr_b16 a[46:47], v11 offset:48896
    ds_read_b64_tr_b16 a[48:49], v12 offset:47360
    s_add_u32 m0, s35, 86016
    s_add_u32 s32, s37, 98304
    buffer_load_dwordx4 v2, s[20:23], s32 offen lds
    s_waitcnt lgkmcnt(14)
    v_mfma_f32_32x32x16_bf16 v[96:111], a[16:19], a[24:27], v[96:111]
    ds_read_b64_tr_b16 a[50:51], v12 offset:48896
    s_waitcnt lgkmcnt(13)
    v_mfma_f32_32x32x16_bf16 v[112:127], a[20:23], a[24:27], v[112:127]
    s_add_u32 m0, s35, 87040
    s_add_u32 s32, s37, 98304
    buffer_load_dwordx4 v3, s[20:23], s32 offen lds
    s_waitcnt lgkmcnt(10)
    v_mfma_f32_32x32x16_bf16 v[32:47], a[28:31], a[52:55], v[32:47]
    ds_read_b128 a[24:27], v19 offset:40960
    ds_read_b64_tr_b16 a[0:1], v11 offset:53248
    ds_read_b64_tr_b16 a[2:3], v11 offset:54784
    s_waitcnt lgkmcnt(11)
    v_mfma_f32_32x32x16_bf16 v[48:63], a[32:35], a[52:55], v[48:63]
    ds_read_b64_tr_b16 a[4:5], v12 offset:53248
    ds_read_b64_tr_b16 a[6:7], v12 offset:54784
    ds_read_b64_tr_b16 a[8:9], v11 offset:53376
    s_add_u32 m0, s36, 81920
    s_add_u32 s32, s46, 0
    buffer_load_dwordx4 v5, s[24:27], s32 offen lds
    s_waitcnt lgkmcnt(12)
    v_mfma_f32_32x32x16_bf16 v[64:79], a[36:39], a[52:55], v[64:79]
    ds_read_b64_tr_b16 a[10:11], v11 offset:54912
    ds_read_b64_tr_b16 a[12:13], v12 offset:53376
    ds_read_b64_tr_b16 a[14:15], v12 offset:54912
    s_waitcnt lgkmcnt(13)
    v_mfma_f32_32x32x16_bf16 v[80:95], a[40:43], a[52:55], v[80:95]
    ds_read_b64_tr_b16 a[16:17], v11 offset:53504
    ds_read_b64_tr_b16 a[18:19], v11 offset:55040
    ds_read_b64_tr_b16 a[20:21], v12 offset:53504
    s_add_u32 m0, s36, 82944
    s_add_u32 s32, s46, 0
    buffer_load_dwordx4 v6, s[24:27], s32 offen lds
    s_waitcnt lgkmcnt(14)
    v_mfma_f32_32x32x16_bf16 v[96:111], a[44:47], a[52:55], v[96:111]
    ds_read_b64_tr_b16 a[22:23], v12 offset:55040
    s_waitcnt lgkmcnt(13)
    v_mfma_f32_32x32x16_bf16 v[112:127], a[48:51], a[52:55], v[112:127]
    s_add_u32 m0, s36, 83968
    s_add_u32 s32, s46, 0
    buffer_load_dwordx4 v7, s[24:27], s32 offen lds
    s_waitcnt lgkmcnt(10)
    v_mfma_f32_32x32x16_bf16 v[32:47], a[0:3], a[24:27], v[32:47]
    ds_read_b128 a[52:55], v20 offset:40960
    ds_read_b64_tr_b16 a[28:29], v11 offset:59392
    ds_read_b64_tr_b16 a[30:31], v11 offset:60928
    s_waitcnt lgkmcnt(11)
    v_mfma_f32_32x32x16_bf16 v[48:63], a[4:7], a[24:27], v[48:63]
    ds_read_b64_tr_b16 a[32:33], v12 offset:59392
    ds_read_b64_tr_b16 a[34:35], v12 offset:60928
    ds_read_b64_tr_b16 a[36:37], v11 offset:59520
    s_add_u32 m0, s36, 84992
    s_add_u32 s32, s46, 0
    buffer_load_dwordx4 v8, s[24:27], s32 offen lds
    s_waitcnt lgkmcnt(12)
    v_mfma_f32_32x32x16_bf16 v[64:79], a[8:11], a[24:27], v[64:79]
    ds_read_b64_tr_b16 a[38:39], v11 offset:61056
    ds_read_b64_tr_b16 a[40:41], v12 offset:59520
    ds_read_b64_tr_b16 a[42:43], v12 offset:61056
    s_waitcnt lgkmcnt(13)
    v_mfma_f32_32x32x16_bf16 v[80:95], a[12:15], a[24:27], v[80:95]
    ds_read_b64_tr_b16 a[44:45], v11 offset:59648
    ds_read_b64_tr_b16 a[46:47], v11 offset:61184
    ds_read_b64_tr_b16 a[48:49], v12 offset:59648
    s_waitcnt lgkmcnt(14)
    v_mfma_f32_32x32x16_bf16 v[96:111], a[16:19], a[24:27], v[96:111]
    ds_read_b64_tr_b16 a[50:51], v12 offset:61184
    s_waitcnt lgkmcnt(13)
    v_mfma_f32_32x32x16_bf16 v[112:127], a[20:23], a[24:27], v[112:127]
    s_waitcnt lgkmcnt(0)
    s_waitcnt vmcnt(20)
    s_barrier
    v_mfma_f32_32x32x16_bf16 v[32:47], a[28:31], a[52:55], v[32:47]
    ds_read_b128 a[24:27], v13 offset:0
    ds_read_b64_tr_b16 a[0:1], v9 offset:0
    ds_read_b64_tr_b16 a[2:3], v9 offset:1536
    v_mfma_f32_32x32x16_bf16 v[48:63], a[32:35], a[52:55], v[48:63]
    ds_read_b64_tr_b16 a[4:5], v10 offset:0
    ds_read_b64_tr_b16 a[6:7], v10 offset:1536
    ds_read_b64_tr_b16 a[8:9], v9 offset:128
    s_add_u32 m0, s35, 122880
    s_add_u32 s32, s37, 786432
    buffer_load_dwordx4 v1, s[20:23], s32 offen lds
    v_mfma_f32_32x32x16_bf16 v[64:79], a[36:39], a[52:55], v[64:79]
    ds_read_b64_tr_b16 a[10:11], v9 offset:1664
    ds_read_b64_tr_b16 a[12:13], v10 offset:128
    ds_read_b64_tr_b16 a[14:15], v10 offset:1664
    v_mfma_f32_32x32x16_bf16 v[80:95], a[40:43], a[52:55], v[80:95]
    ds_read_b64_tr_b16 a[16:17], v9 offset:256
    ds_read_b64_tr_b16 a[18:19], v9 offset:1792
    ds_read_b64_tr_b16 a[20:21], v10 offset:256
    s_add_u32 m0, s35, 123904
    s_add_u32 s32, s37, 786432
    buffer_load_dwordx4 v2, s[20:23], s32 offen lds
    v_mfma_f32_32x32x16_bf16 v[96:111], a[44:47], a[52:55], v[96:111]
    ds_read_b64_tr_b16 a[22:23], v10 offset:1792
    v_mfma_f32_32x32x16_bf16 v[112:127], a[48:51], a[52:55], v[112:127]
    s_add_u32 m0, s35, 124928
    s_add_u32 s32, s37, 786432
    buffer_load_dwordx4 v3, s[20:23], s32 offen lds
    s_waitcnt lgkmcnt(10)
    v_mfma_f32_32x32x16_bf16 v[32:47], a[0:3], a[24:27], v[32:47]
    ds_read_b128 a[52:55], v14 offset:0
    ds_read_b64_tr_b16 a[28:29], v9 offset:6144
    ds_read_b64_tr_b16 a[30:31], v9 offset:7680
    s_waitcnt lgkmcnt(11)
    v_mfma_f32_32x32x16_bf16 v[48:63], a[4:7], a[24:27], v[48:63]
    ds_read_b64_tr_b16 a[32:33], v10 offset:6144
    ds_read_b64_tr_b16 a[34:35], v10 offset:7680
    ds_read_b64_tr_b16 a[36:37], v9 offset:6272
    s_add_u32 m0, s35, 125952
    s_add_u32 s32, s37, 884736
    buffer_load_dwordx4 v1, s[20:23], s32 offen lds
    s_waitcnt lgkmcnt(12)
    v_mfma_f32_32x32x16_bf16 v[64:79], a[8:11], a[24:27], v[64:79]
    ds_read_b64_tr_b16 a[38:39], v9 offset:7808
    ds_read_b64_tr_b16 a[40:41], v10 offset:6272
    ds_read_b64_tr_b16 a[42:43], v10 offset:7808
    s_waitcnt lgkmcnt(13)
    v_mfma_f32_32x32x16_bf16 v[80:95], a[12:15], a[24:27], v[80:95]
    ds_read_b64_tr_b16 a[44:45], v9 offset:6400
    ds_read_b64_tr_b16 a[46:47], v9 offset:7936
    ds_read_b64_tr_b16 a[48:49], v10 offset:6400
    s_add_u32 m0, s35, 126976
    s_add_u32 s32, s37, 884736
    buffer_load_dwordx4 v2, s[20:23], s32 offen lds
    s_waitcnt lgkmcnt(14)
    v_mfma_f32_32x32x16_bf16 v[96:111], a[16:19], a[24:27], v[96:111]
    ds_read_b64_tr_b16 a[50:51], v10 offset:7936
    s_waitcnt lgkmcnt(13)
    v_mfma_f32_32x32x16_bf16 v[112:127], a[20:23], a[24:27], v[112:127]
    s_add_u32 m0, s35, 128000
    s_add_u32 s32, s37, 884736
    buffer_load_dwordx4 v3, s[20:23], s32 offen lds
    s_waitcnt lgkmcnt(10)
    v_mfma_f32_32x32x16_bf16 v[32:47], a[28:31], a[52:55], v[32:47]
    ds_read_b128 a[24:27], v15 offset:0
    ds_read_b64_tr_b16 a[0:1], v9 offset:12288
    ds_read_b64_tr_b16 a[2:3], v9 offset:13824
    s_waitcnt lgkmcnt(11)
    v_mfma_f32_32x32x16_bf16 v[48:63], a[32:35], a[52:55], v[48:63]
    ds_read_b64_tr_b16 a[4:5], v10 offset:12288
    ds_read_b64_tr_b16 a[6:7], v10 offset:13824
    ds_read_b64_tr_b16 a[8:9], v9 offset:12416
    s_add_u32 m0, s36, 122880
    s_add_u32 s32, s46, 128
    buffer_load_dwordx4 v5, s[24:27], s32 offen lds
    s_waitcnt lgkmcnt(12)
    v_mfma_f32_32x32x16_bf16 v[64:79], a[36:39], a[52:55], v[64:79]
    ds_read_b64_tr_b16 a[10:11], v9 offset:13952
    ds_read_b64_tr_b16 a[12:13], v10 offset:12416
    ds_read_b64_tr_b16 a[14:15], v10 offset:13952
    s_waitcnt lgkmcnt(13)
    v_mfma_f32_32x32x16_bf16 v[80:95], a[40:43], a[52:55], v[80:95]
    ds_read_b64_tr_b16 a[16:17], v9 offset:12544
    ds_read_b64_tr_b16 a[18:19], v9 offset:14080
    ds_read_b64_tr_b16 a[20:21], v10 offset:12544
    s_add_u32 m0, s36, 123904
    s_add_u32 s32, s46, 128
    buffer_load_dwordx4 v6, s[24:27], s32 offen lds
    s_waitcnt lgkmcnt(14)
    v_mfma_f32_32x32x16_bf16 v[96:111], a[44:47], a[52:55], v[96:111]
    ds_read_b64_tr_b16 a[22:23], v10 offset:14080
    s_waitcnt lgkmcnt(13)
    v_mfma_f32_32x32x16_bf16 v[112:127], a[48:51], a[52:55], v[112:127]
    s_add_u32 m0, s36, 124928
    s_add_u32 s32, s46, 128
    buffer_load_dwordx4 v7, s[24:27], s32 offen lds
    s_waitcnt lgkmcnt(10)
    v_mfma_f32_32x32x16_bf16 v[32:47], a[0:3], a[24:27], v[32:47]
    ds_read_b128 a[52:55], v16 offset:0
    ds_read_b64_tr_b16 a[28:29], v9 offset:18432
    ds_read_b64_tr_b16 a[30:31], v9 offset:19968
    s_waitcnt lgkmcnt(11)
    v_mfma_f32_32x32x16_bf16 v[48:63], a[4:7], a[24:27], v[48:63]
    ds_read_b64_tr_b16 a[32:33], v10 offset:18432
    ds_read_b64_tr_b16 a[34:35], v10 offset:19968
    ds_read_b64_tr_b16 a[36:37], v9 offset:18560
    s_add_u32 m0, s36, 125952
    s_add_u32 s32, s46, 128
    buffer_load_dwordx4 v8, s[24:27], s32 offen lds
    s_waitcnt lgkmcnt(12)
    v_mfma_f32_32x32x16_bf16 v[64:79], a[8:11], a[24:27], v[64:79]
    ds_read_b64_tr_b16 a[38:39], v9 offset:20096
    ds_read_b64_tr_b16 a[40:41], v10 offset:18560
    ds_read_b64_tr_b16 a[42:43], v10 offset:20096
    s_waitcnt lgkmcnt(13)
    v_mfma_f32_32x32x16_bf16 v[80:95], a[12:15], a[24:27], v[80:95]
    ds_read_b64_tr_b16 a[44:45], v9 offset:18688
    ds_read_b64_tr_b16 a[46:47], v9 offset:20224
    ds_read_b64_tr_b16 a[48:49], v10 offset:18688
    s_waitcnt lgkmcnt(14)
    v_mfma_f32_32x32x16_bf16 v[96:111], a[16:19], a[24:27], v[96:111]
    ds_read_b64_tr_b16 a[50:51], v10 offset:20224
    s_waitcnt lgkmcnt(13)
    v_mfma_f32_32x32x16_bf16 v[112:127], a[20:23], a[24:27], v[112:127]
    s_waitcnt lgkmcnt(0)
    s_waitcnt vmcnt(20)
    s_barrier
    v_mfma_f32_32x32x16_bf16 v[32:47], a[28:31], a[52:55], v[32:47]
    ds_read_b128 a[24:27], v13 offset:40960
    ds_read_b64_tr_b16 a[0:1], v9 offset:40960
    ds_read_b64_tr_b16 a[2:3], v9 offset:42496
    v_mfma_f32_32x32x16_bf16 v[48:63], a[32:35], a[52:55], v[48:63]
    ds_read_b64_tr_b16 a[4:5], v10 offset:40960
    ds_read_b64_tr_b16 a[6:7], v10 offset:42496
    ds_read_b64_tr_b16 a[8:9], v9 offset:41088
    s_add_u32 m0, s35, 0
    s_add_u32 s32, s37, 1572864
    buffer_load_dwordx4 v1, s[20:23], s32 offen lds
    v_mfma_f32_32x32x16_bf16 v[64:79], a[36:39], a[52:55], v[64:79]
    ds_read_b64_tr_b16 a[10:11], v9 offset:42624
    ds_read_b64_tr_b16 a[12:13], v10 offset:41088
    ds_read_b64_tr_b16 a[14:15], v10 offset:42624
    v_mfma_f32_32x32x16_bf16 v[80:95], a[40:43], a[52:55], v[80:95]
    ds_read_b64_tr_b16 a[16:17], v9 offset:41216
    ds_read_b64_tr_b16 a[18:19], v9 offset:42752
    ds_read_b64_tr_b16 a[20:21], v10 offset:41216
    s_add_u32 m0, s35, 1024
    s_add_u32 s32, s37, 1572864
    buffer_load_dwordx4 v2, s[20:23], s32 offen lds
    v_mfma_f32_32x32x16_bf16 v[96:111], a[44:47], a[52:55], v[96:111]
    ds_read_b64_tr_b16 a[22:23], v10 offset:42752
    v_mfma_f32_32x32x16_bf16 v[112:127], a[48:51], a[52:55], v[112:127]
    s_add_u32 m0, s35, 2048
    s_add_u32 s32, s37, 1572864
    buffer_load_dwordx4 v3, s[20:23], s32 offen lds
    s_waitcnt lgkmcnt(10)
    v_mfma_f32_32x32x16_bf16 v[32:47], a[0:3], a[24:27], v[32:47]
    ds_read_b128 a[52:55], v14 offset:40960
    ds_read_b64_tr_b16 a[28:29], v9 offset:47104
    ds_read_b64_tr_b16 a[30:31], v9 offset:48640
    s_waitcnt lgkmcnt(11)
    v_mfma_f32_32x32x16_bf16 v[48:63], a[4:7], a[24:27], v[48:63]
    ds_read_b64_tr_b16 a[32:33], v10 offset:47104
    ds_read_b64_tr_b16 a[34:35], v10 offset:48640
    ds_read_b64_tr_b16 a[36:37], v9 offset:47232
    s_add_u32 m0, s35, 3072
    s_add_u32 s32, s37, 1671168
    buffer_load_dwordx4 v1, s[20:23], s32 offen lds
    s_waitcnt lgkmcnt(12)
    v_mfma_f32_32x32x16_bf16 v[64:79], a[8:11], a[24:27], v[64:79]
    ds_read_b64_tr_b16 a[38:39], v9 offset:48768
    ds_read_b64_tr_b16 a[40:41], v10 offset:47232
    ds_read_b64_tr_b16 a[42:43], v10 offset:48768
    s_waitcnt lgkmcnt(13)
    v_mfma_f32_32x32x16_bf16 v[80:95], a[12:15], a[24:27], v[80:95]
    ds_read_b64_tr_b16 a[44:45], v9 offset:47360
    ds_read_b64_tr_b16 a[46:47], v9 offset:48896
    ds_read_b64_tr_b16 a[48:49], v10 offset:47360
    s_add_u32 m0, s35, 4096
    s_add_u32 s32, s37, 1671168
    buffer_load_dwordx4 v2, s[20:23], s32 offen lds
    s_waitcnt lgkmcnt(14)
    v_mfma_f32_32x32x16_bf16 v[96:111], a[16:19], a[24:27], v[96:111]
    ds_read_b64_tr_b16 a[50:51], v10 offset:48896
    s_waitcnt lgkmcnt(13)
    v_mfma_f32_32x32x16_bf16 v[112:127], a[20:23], a[24:27], v[112:127]
    s_add_u32 m0, s35, 5120
    s_add_u32 s32, s37, 1671168
    buffer_load_dwordx4 v3, s[20:23], s32 offen lds
    s_waitcnt lgkmcnt(10)
    v_mfma_f32_32x32x16_bf16 v[32:47], a[28:31], a[52:55], v[32:47]
    ds_read_b128 a[24:27], v15 offset:40960
    ds_read_b64_tr_b16 a[0:1], v9 offset:53248
    ds_read_b64_tr_b16 a[2:3], v9 offset:54784
    s_waitcnt lgkmcnt(11)
    v_mfma_f32_32x32x16_bf16 v[48:63], a[32:35], a[52:55], v[48:63]
    ds_read_b64_tr_b16 a[4:5], v10 offset:53248
    ds_read_b64_tr_b16 a[6:7], v10 offset:54784
    ds_read_b64_tr_b16 a[8:9], v9 offset:53376
    s_add_u32 m0, s36, 0
    s_add_u32 s32, s46, 256
    buffer_load_dwordx4 v5, s[24:27], s32 offen lds
    s_waitcnt lgkmcnt(12)
    v_mfma_f32_32x32x16_bf16 v[64:79], a[36:39], a[52:55], v[64:79]
    ds_read_b64_tr_b16 a[10:11], v9 offset:54912
    ds_read_b64_tr_b16 a[12:13], v10 offset:53376
    ds_read_b64_tr_b16 a[14:15], v10 offset:54912
    s_waitcnt lgkmcnt(13)
    v_mfma_f32_32x32x16_bf16 v[80:95], a[40:43], a[52:55], v[80:95]
    ds_read_b64_tr_b16 a[16:17], v9 offset:53504
    ds_read_b64_tr_b16 a[18:19], v9 offset:55040
    ds_read_b64_tr_b16 a[20:21], v10 offset:53504
    s_add_u32 m0, s36, 1024
    s_add_u32 s32, s46, 256
    buffer_load_dwordx4 v6, s[24:27], s32 offen lds
    s_waitcnt lgkmcnt(14)
    v_mfma_f32_32x32x16_bf16 v[96:111], a[44:47], a[52:55], v[96:111]
    ds_read_b64_tr_b16 a[22:23], v10 offset:55040
    s_waitcnt lgkmcnt(13)
    v_mfma_f32_32x32x16_bf16 v[112:127], a[48:51], a[52:55], v[112:127]
    s_add_u32 m0, s36, 2048
    s_add_u32 s32, s46, 256
    buffer_load_dwordx4 v7, s[24:27], s32 offen lds
    s_waitcnt lgkmcnt(10)
    v_mfma_f32_32x32x16_bf16 v[32:47], a[0:3], a[24:27], v[32:47]
    ds_read_b128 a[52:55], v16 offset:40960
    ds_read_b64_tr_b16 a[28:29], v9 offset:59392
    ds_read_b64_tr_b16 a[30:31], v9 offset:60928
    s_waitcnt lgkmcnt(11)
    v_mfma_f32_32x32x16_bf16 v[48:63], a[4:7], a[24:27], v[48:63]
    ds_read_b64_tr_b16 a[32:33], v10 offset:59392
    ds_read_b64_tr_b16 a[34:35], v10 offset:60928
    ds_read_b64_tr_b16 a[36:37], v9 offset:59520
    s_add_u32 m0, s36, 3072
    s_add_u32 s32, s46, 256
    buffer_load_dwordx4 v8, s[24:27], s32 offen lds
    s_waitcnt lgkmcnt(12)
    v_mfma_f32_32x32x16_bf16 v[64:79], a[8:11], a[24:27], v[64:79]
    ds_read_b64_tr_b16 a[38:39], v9 offset:61056
    ds_read_b64_tr_b16 a[40:41], v10 offset:59520
    ds_read_b64_tr_b16 a[42:43], v10 offset:61056
    s_waitcnt lgkmcnt(13)
    v_mfma_f32_32x32x16_bf16 v[80:95], a[12:15], a[24:27], v[80:95]
    ds_read_b64_tr_b16 a[44:45], v9 offset:59648
    ds_read_b64_tr_b16 a[46:47], v9 offset:61184
    ds_read_b64_tr_b16 a[48:49], v10 offset:59648
    s_waitcnt lgkmcnt(14)
    v_mfma_f32_32x32x16_bf16 v[96:111], a[16:19], a[24:27], v[96:111]
    ds_read_b64_tr_b16 a[50:51], v10 offset:61184
    s_waitcnt lgkmcnt(13)
    v_mfma_f32_32x32x16_bf16 v[112:127], a[20:23], a[24:27], v[112:127]
    s_waitcnt lgkmcnt(0)
    s_waitcnt vmcnt(20)
    s_barrier
    v_mfma_f32_32x32x16_bf16 v[32:47], a[28:31], a[52:55], v[32:47]
    ds_read_b128 a[24:27], v17 offset:0
    ds_read_b64_tr_b16 a[0:1], v11 offset:0
    ds_read_b64_tr_b16 a[2:3], v11 offset:1536
    v_mfma_f32_32x32x16_bf16 v[48:63], a[32:35], a[52:55], v[48:63]
    ds_read_b64_tr_b16 a[4:5], v12 offset:0
    ds_read_b64_tr_b16 a[6:7], v12 offset:1536
    ds_read_b64_tr_b16 a[8:9], v11 offset:128
    s_add_u32 m0, s35, 40960
    s_add_u32 s32, s37, 2359296
    buffer_load_dwordx4 v1, s[20:23], s32 offen lds
    v_mfma_f32_32x32x16_bf16 v[64:79], a[36:39], a[52:55], v[64:79]
    ds_read_b64_tr_b16 a[10:11], v11 offset:1664
    ds_read_b64_tr_b16 a[12:13], v12 offset:128
    ds_read_b64_tr_b16 a[14:15], v12 offset:1664
    v_mfma_f32_32x32x16_bf16 v[80:95], a[40:43], a[52:55], v[80:95]
    ds_read_b64_tr_b16 a[16:17], v11 offset:256
    ds_read_b64_tr_b16 a[18:19], v11 offset:1792
    ds_read_b64_tr_b16 a[20:21], v12 offset:256
    s_add_u32 m0, s35, 41984
    s_add_u32 s32, s37, 2359296
    buffer_load_dwordx4 v2, s[20:23], s32 offen lds
    v_mfma_f32_32x32x16_bf16 v[96:111], a[44:47], a[52:55], v[96:111]
    ds_read_b64_tr_b16 a[22:23], v12 offset:1792
    v_mfma_f32_32x32x16_bf16 v[112:127], a[48:51], a[52:55], v[112:127]
    s_add_u32 m0, s35, 43008
    s_add_u32 s32, s37, 2359296
    buffer_load_dwordx4 v3, s[20:23], s32 offen lds
    s_waitcnt lgkmcnt(10)
    v_mfma_f32_32x32x16_bf16 v[128:143], a[0:3], a[24:27], 0
    ds_read_b128 a[52:55], v18 offset:0
    ds_read_b64_tr_b16 a[28:29], v11 offset:6144
    ds_read_b64_tr_b16 a[30:31], v11 offset:7680
    s_waitcnt lgkmcnt(11)
    v_mfma_f32_32x32x16_bf16 v[144:159], a[4:7], a[24:27], 0
    ds_read_b64_tr_b16 a[32:33], v12 offset:6144
    ds_read_b64_tr_b16 a[34:35], v12 offset:7680
    ds_read_b64_tr_b16 a[36:37], v11 offset:6272
    s_add_u32 m0, s35, 44032
    s_add_u32 s32, s37, 2457600
    buffer_load_dwordx4 v1, s[20:23], s32 offen lds
    s_waitcnt lgkmcnt(12)
    v_mfma_f32_32x32x16_bf16 v[160:175], a[8:11], a[24:27], 0
    ds_read_b64_tr_b16 a[38:39], v11 offset:7808
    ds_read_b64_tr_b16 a[40:41], v12 offset:6272
    ds_read_b64_tr_b16 a[42:43], v12 offset:7808
    s_waitcnt lgkmcnt(13)
    v_mfma_f32_32x32x16_bf16 v[176:191], a[12:15], a[24:27], 0
    ds_read_b64_tr_b16 a[44:45], v11 offset:6400
    ds_read_b64_tr_b16 a[46:47], v11 offset:7936
    ds_read_b64_tr_b16 a[48:49], v12 offset:6400
    s_add_u32 m0, s35, 45056
    s_add_u32 s32, s37, 2457600
    buffer_load_dwordx4 v2, s[20:23], s32 offen lds
    s_waitcnt lgkmcnt(14)
    v_mfma_f32_32x32x16_bf16 v[192:207], a[16:19], a[24:27], 0
    ds_read_b64_tr_b16 a[50:51], v12 offset:7936
    s_waitcnt lgkmcnt(13)
    v_mfma_f32_32x32x16_bf16 v[208:223], a[20:23], a[24:27], 0
    s_add_u32 m0, s35, 46080
    s_add_u32 s32, s37, 2457600
    buffer_load_dwordx4 v3, s[20:23], s32 offen lds
    s_waitcnt lgkmcnt(10)
    v_mfma_f32_32x32x16_bf16 v[128:143], a[28:31], a[52:55], v[128:143]
    ds_read_b128 a[24:27], v19 offset:0
    ds_read_b64_tr_b16 a[0:1], v11 offset:12288
    ds_read_b64_tr_b16 a[2:3], v11 offset:13824
    s_add_u32 s34, s41, 0
    v_cvt_pk_bf16_f32 v224, v32, v33
    s_waitcnt lgkmcnt(11)
    v_mfma_f32_32x32x16_bf16 v[144:159], a[32:35], a[52:55], v[144:159]
    ds_read_b64_tr_b16 a[4:5], v12 offset:12288
    ds_read_b64_tr_b16 a[6:7], v12 offset:13824
    ds_read_b64_tr_b16 a[8:9], v11 offset:12416
    s_add_u32 m0, s36, 40960
    s_add_u32 s32, s46, 384
    buffer_load_dwordx4 v5, s[24:27], s32 offen lds
    v_cvt_pk_bf16_f32 v225, v34, v35
    v_cvt_pk_bf16_f32 v226, v36, v37
    s_waitcnt lgkmcnt(12)
    v_mfma_f32_32x32x16_bf16 v[160:175], a[36:39], a[52:55], v[160:175]
    ds_read_b64_tr_b16 a[10:11], v11 offset:13952
    ds_read_b64_tr_b16 a[12:13], v12 offset:12416
    ds_read_b64_tr_b16 a[14:15], v12 offset:13952
    v_cvt_pk_bf16_f32 v227, v38, v39
    buffer_store_dwordx4 v[224:227], v25, s[8:11], s34 offen offset:0 sc1
    s_waitcnt lgkmcnt(13)
    v_mfma_f32_32x32x16_bf16 v[176:191], a[40:43], a[52:55], v[176:191]
    ds_read_b64_tr_b16 a[16:17], v11 offset:12544
    ds_read_b64_tr_b16 a[18:19], v11 offset:14080
    ds_read_b64_tr_b16 a[20:21], v12 offset:12544
    s_add_u32 m0, s36, 41984
    s_add_u32 s32, s46, 384
    buffer_load_dwordx4 v6, s[24:27], s32 offen lds
    v_cvt_pk_bf16_f32 v228, v40, v41
    v_cvt_pk_bf16_f32 v229, v42, v43
    s_waitcnt lgkmcnt(14)
    v_mfma_f32_32x32x16_bf16 v[192:207], a[44:47], a[52:55], v[192:207]
    ds_read_b64_tr_b16 a[22:23], v12 offset:14080
    v_cvt_pk_bf16_f32 v230, v44, v45
    v_cvt_pk_bf16_f32 v231, v46, v47
    s_waitcnt lgkmcnt(13)
    v_mfma_f32_32x32x16_bf16 v[208:223], a[48:51], a[52:55], v[208:223]
    s_add_u32 m0, s36, 43008
    s_add_u32 s32, s46, 384
    buffer_load_dwordx4 v7, s[24:27], s32 offen lds
    buffer_store_dwordx4 v[228:231], v25, s[8:11], s34 offen offset:256 sc1
    s_waitcnt lgkmcnt(10)
    v_mfma_f32_32x32x16_bf16 v[128:143], a[0:3], a[24:27], v[128:143]
    ds_read_b128 a[52:55], v20 offset:0
    ds_read_b64_tr_b16 a[28:29], v11 offset:18432
    ds_read_b64_tr_b16 a[30:31], v11 offset:19968
    v_cvt_pk_bf16_f32 v232, v48, v49
    v_cvt_pk_bf16_f32 v233, v50, v51
    s_waitcnt lgkmcnt(11)
    v_mfma_f32_32x32x16_bf16 v[144:159], a[4:7], a[24:27], v[144:159]
    ds_read_b64_tr_b16 a[32:33], v12 offset:18432
    ds_read_b64_tr_b16 a[34:35], v12 offset:19968
    ds_read_b64_tr_b16 a[36:37], v11 offset:18560
    s_add_u32 m0, s36, 44032
    s_add_u32 s32, s46, 384
    buffer_load_dwordx4 v8, s[24:27], s32 offen lds
    v_cvt_pk_bf16_f32 v234, v52, v53
    v_cvt_pk_bf16_f32 v235, v54, v55
    s_waitcnt lgkmcnt(12)
    v_mfma_f32_32x32x16_bf16 v[160:175], a[8:11], a[24:27], v[160:175]
    ds_read_b64_tr_b16 a[38:39], v11 offset:20096
    ds_read_b64_tr_b16 a[40:41], v12 offset:18560
    ds_read_b64_tr_b16 a[42:43], v12 offset:20096
    buffer_store_dwordx4 v[232:235], v25, s[8:11], s34 offen offset:2048 sc1
    v_cvt_pk_bf16_f32 v236, v56, v57
    s_waitcnt lgkmcnt(13)
    v_mfma_f32_32x32x16_bf16 v[176:191], a[12:15], a[24:27], v[176:191]
    ds_read_b64_tr_b16 a[44:45], v11 offset:18688
    ds_read_b64_tr_b16 a[46:47], v11 offset:20224
    ds_read_b64_tr_b16 a[48:49], v12 offset:18688
    v_cvt_pk_bf16_f32 v237, v58, v59
    v_cvt_pk_bf16_f32 v238, v60, v61
    s_waitcnt lgkmcnt(14)
    v_mfma_f32_32x32x16_bf16 v[192:207], a[16:19], a[24:27], v[192:207]
    ds_read_b64_tr_b16 a[50:51], v12 offset:20224
    v_cvt_pk_bf16_f32 v239, v62, v63
    buffer_store_dwordx4 v[236:239], v25, s[8:11], s34 offen offset:2304 sc1
    s_waitcnt lgkmcnt(13)
    v_mfma_f32_32x32x16_bf16 v[208:223], a[20:23], a[24:27], v[208:223]
    s_waitcnt lgkmcnt(0)
    s_waitcnt vmcnt(24)
    s_barrier
    v_mfma_f32_32x32x16_bf16 v[128:143], a[28:31], a[52:55], v[128:143]
    ds_read_b128 a[24:27], v17 offset:40960
    ds_read_b64_tr_b16 a[0:1], v11 offset:40960
    ds_read_b64_tr_b16 a[2:3], v11 offset:42496
    s_add_u32 s34, s41, 4096
    v_cvt_pk_bf16_f32 v240, v64, v65
    v_mfma_f32_32x32x16_bf16 v[144:159], a[32:35], a[52:55], v[144:159]
    ds_read_b64_tr_b16 a[4:5], v12 offset:40960
    ds_read_b64_tr_b16 a[6:7], v12 offset:42496
    ds_read_b64_tr_b16 a[8:9], v11 offset:41088
    s_add_u32 m0, s35, 81920
    s_add_u32 s32, s37, 3145728
    buffer_load_dwordx4 v1, s[20:23], s32 offen lds
    v_cvt_pk_bf16_f32 v241, v66, v67
    v_cvt_pk_bf16_f32 v242, v68, v69
    v_mfma_f32_32x32x16_bf16 v[160:175], a[36:39], a[52:55], v[160:175]
    ds_read_b64_tr_b16 a[10:11], v11 offset:42624
    ds_read_b64_tr_b16 a[12:13], v12 offset:41088
    ds_read_b64_tr_b16 a[14:15], v12 offset:42624
    v_cvt_pk_bf16_f32 v243, v70, v71
    buffer_store_dwordx4 v[240:243], v25, s[8:11], s34 offen offset:0 sc1
    v_mfma_f32_32x32x16_bf16 v[176:191], a[40:43], a[52:55], v[176:191]
    ds_read_b64_tr_b16 a[16:17], v11 offset:41216
    ds_read_b64_tr_b16 a[18:19], v11 offset:42752
    ds_read_b64_tr_b16 a[20:21], v12 offset:41216
    s_add_u32 m0, s35, 82944
    s_add_u32 s32, s37, 3145728
    buffer_load_dwordx4 v2, s[20:23], s32 offen lds
    v_cvt_pk_bf16_f32 v244, v72, v73
    v_cvt_pk_bf16_f32 v245, v74, v75
    v_mfma_f32_32x32x16_bf16 v[192:207], a[44:47], a[52:55], v[192:207]
    ds_read_b64_tr_b16 a[22:23], v12 offset:42752
    v_cvt_pk_bf16_f32 v246, v76, v77
    v_cvt_pk_bf16_f32 v247, v78, v79
    v_mfma_f32_32x32x16_bf16 v[208:223], a[48:51], a[52:55], v[208:223]
    s_add_u32 m0, s35, 83968
    s_add_u32 s32, s37, 3145728
    buffer_load_dwordx4 v3, s[20:23], s32 offen lds
    buffer_store_dwordx4 v[244:247], v25, s[8:11], s34 offen offset:256 sc1
    s_waitcnt lgkmcnt(10)
    v_mfma_f32_32x32x16_bf16 v[128:143], a[0:3], a[24:27], v[128:143]
    ds_read_b128 a[52:55], v18 offset:40960
    ds_read_b64_tr_b16 a[28:29], v11 offset:47104
    ds_read_b64_tr_b16 a[30:31], v11 offset:48640
    v_cvt_pk_bf16_f32 v248, v80, v81
    v_cvt_pk_bf16_f32 v249, v82, v83
    s_waitcnt lgkmcnt(11)
    v_mfma_f32_32x32x16_bf16 v[144:159], a[4:7], a[24:27], v[144:159]
    ds_read_b64_tr_b16 a[32:33], v12 offset:47104
    ds_read_b64_tr_b16 a[34:35], v12 offset:48640
    ds_read_b64_tr_b16 a[36:37], v11 offset:47232
    s_add_u32 m0, s35, 84992
    s_add_u32 s32, s37, 3244032
    buffer_load_dwordx4 v1, s[20:23], s32 offen lds
    v_cvt_pk_bf16_f32 v250, v84, v85
    v_cvt_pk_bf16_f32 v251, v86, v87
    s_waitcnt lgkmcnt(12)
    v_mfma_f32_32x32x16_bf16 v[160:175], a[8:11], a[24:27], v[160:175]
    ds_read_b64_tr_b16 a[38:39], v11 offset:48768
    ds_read_b64_tr_b16 a[40:41], v12 offset:47232
    ds_read_b64_tr_b16 a[42:43], v12 offset:48768
    buffer_store_dwordx4 v[248:251], v25, s[8:11], s34 offen offset:2048 sc1
    v_cvt_pk_bf16_f32 v252, v88, v89
    s_waitcnt lgkmcnt(13)
    v_mfma_f32_32x32x16_bf16 v[176:191], a[12:15], a[24:27], v[176:191]
    ds_read_b64_tr_b16 a[44:45], v11 offset:47360
    ds_read_b64_tr_b16 a[46:47], v11 offset:48896
    ds_read_b64_tr_b16 a[48:49], v12 offset:47360
    s_add_u32 m0, s35, 86016
    s_add_u32 s32, s37, 3244032
    buffer_load_dwordx4 v2, s[20:23], s32 offen lds
    v_cvt_pk_bf16_f32 v253, v90, v91
    v_cvt_pk_bf16_f32 v254, v92, v93
    s_waitcnt lgkmcnt(14)
    v_mfma_f32_32x32x16_bf16 v[192:207], a[16:19], a[24:27], v[192:207]
    ds_read_b64_tr_b16 a[50:51], v12 offset:48896
    v_cvt_pk_bf16_f32 v255, v94, v95
    buffer_store_dwordx4 v[252:255], v25, s[8:11], s34 offen offset:2304 sc1
    s_waitcnt lgkmcnt(13)
    v_mfma_f32_32x32x16_bf16 v[208:223], a[20:23], a[24:27], v[208:223]
    s_add_u32 m0, s35, 87040
    s_add_u32 s32, s37, 3244032
    buffer_load_dwordx4 v3, s[20:23], s32 offen lds
    s_waitcnt lgkmcnt(10)
    v_mfma_f32_32x32x16_bf16 v[128:143], a[28:31], a[52:55], v[128:143]
    ds_read_b128 a[24:27], v19 offset:40960
    ds_read_b64_tr_b16 a[0:1], v11 offset:53248
    ds_read_b64_tr_b16 a[2:3], v11 offset:54784
    s_add_u32 s34, s41, 8192
    v_cvt_pk_bf16_f32 v224, v96, v97
    s_waitcnt lgkmcnt(11)
    v_mfma_f32_32x32x16_bf16 v[144:159], a[32:35], a[52:55], v[144:159]
    ds_read_b64_tr_b16 a[4:5], v12 offset:53248
    ds_read_b64_tr_b16 a[6:7], v12 offset:54784
    ds_read_b64_tr_b16 a[8:9], v11 offset:53376
    s_add_u32 m0, s36, 81920
    s_add_u32 s32, s46, 512
    buffer_load_dwordx4 v5, s[24:27], s32 offen lds
    v_cvt_pk_bf16_f32 v225, v98, v99
    v_cvt_pk_bf16_f32 v226, v100, v101
    s_waitcnt lgkmcnt(12)
    v_mfma_f32_32x32x16_bf16 v[160:175], a[36:39], a[52:55], v[160:175]
    ds_read_b64_tr_b16 a[10:11], v11 offset:54912
    ds_read_b64_tr_b16 a[12:13], v12 offset:53376
    ds_read_b64_tr_b16 a[14:15], v12 offset:54912
    v_cvt_pk_bf16_f32 v227, v102, v103
    buffer_store_dwordx4 v[224:227], v25, s[8:11], s34 offen offset:0 sc1
    s_waitcnt lgkmcnt(13)
    v_mfma_f32_32x32x16_bf16 v[176:191], a[40:43], a[52:55], v[176:191]
    ds_read_b64_tr_b16 a[16:17], v11 offset:53504
    ds_read_b64_tr_b16 a[18:19], v11 offset:55040
    ds_read_b64_tr_b16 a[20:21], v12 offset:53504
    s_add_u32 m0, s36, 82944
    s_add_u32 s32, s46, 512
    buffer_load_dwordx4 v6, s[24:27], s32 offen lds
    v_cvt_pk_bf16_f32 v228, v104, v105
    v_cvt_pk_bf16_f32 v229, v106, v107
    s_waitcnt lgkmcnt(14)
    v_mfma_f32_32x32x16_bf16 v[192:207], a[44:47], a[52:55], v[192:207]
    ds_read_b64_tr_b16 a[22:23], v12 offset:55040
    v_cvt_pk_bf16_f32 v230, v108, v109
    v_cvt_pk_bf16_f32 v231, v110, v111
    s_waitcnt lgkmcnt(13)
    v_mfma_f32_32x32x16_bf16 v[208:223], a[48:51], a[52:55], v[208:223]
    s_add_u32 m0, s36, 83968
    s_add_u32 s32, s46, 512
    buffer_load_dwordx4 v7, s[24:27], s32 offen lds
    buffer_store_dwordx4 v[228:231], v25, s[8:11], s34 offen offset:256 sc1
    s_waitcnt lgkmcnt(10)
    v_mfma_f32_32x32x16_bf16 v[128:143], a[0:3], a[24:27], v[128:143]
    ds_read_b128 a[52:55], v20 offset:40960
    ds_read_b64_tr_b16 a[28:29], v11 offset:59392
    ds_read_b64_tr_b16 a[30:31], v11 offset:60928
    v_cvt_pk_bf16_f32 v232, v112, v113
    v_cvt_pk_bf16_f32 v233, v114, v115
    s_waitcnt lgkmcnt(11)
    v_mfma_f32_32x32x16_bf16 v[144:159], a[4:7], a[24:27], v[144:159]
    ds_read_b64_tr_b16 a[32:33], v12 offset:59392
    ds_read_b64_tr_b16 a[34:35], v12 offset:60928
    ds_read_b64_tr_b16 a[36:37], v11 offset:59520
    s_add_u32 m0, s36, 84992
    s_add_u32 s32, s46, 512
    buffer_load_dwordx4 v8, s[24:27], s32 offen lds
    v_cvt_pk_bf16_f32 v234, v116, v117
    v_cvt_pk_bf16_f32 v235, v118, v119
    s_waitcnt lgkmcnt(12)
    v_mfma_f32_32x32x16_bf16 v[160:175], a[8:11], a[24:27], v[160:175]
    ds_read_b64_tr_b16 a[38:39], v11 offset:61056
    ds_read_b64_tr_b16 a[40:41], v12 offset:59520
    ds_read_b64_tr_b16 a[42:43], v12 offset:61056
    buffer_store_dwordx4 v[232:235], v25, s[8:11], s34 offen offset:2048 sc1
    v_cvt_pk_bf16_f32 v236, v120, v121
    s_waitcnt lgkmcnt(13)
    v_mfma_f32_32x32x16_bf16 v[176:191], a[12:15], a[24:27], v[176:191]
    ds_read_b64_tr_b16 a[44:45], v11 offset:59648
    ds_read_b64_tr_b16 a[46:47], v11 offset:61184
    ds_read_b64_tr_b16 a[48:49], v12 offset:59648
    v_cvt_pk_bf16_f32 v237, v122, v123
    v_cvt_pk_bf16_f32 v238, v124, v125
    s_waitcnt lgkmcnt(14)
    v_mfma_f32_32x32x16_bf16 v[192:207], a[16:19], a[24:27], v[192:207]
    ds_read_b64_tr_b16 a[50:51], v12 offset:61184
    v_cvt_pk_bf16_f32 v239, v126, v127
    buffer_store_dwordx4 v[236:239], v25, s[8:11], s34 offen offset:2304 sc1
    s_waitcnt lgkmcnt(13)
    v_mfma_f32_32x32x16_bf16 v[208:223], a[20:23], a[24:27], v[208:223]
    s_waitcnt lgkmcnt(0)
    s_waitcnt vmcnt(32)
    s_barrier
    v_mfma_f32_32x32x16_bf16 v[128:143], a[28:31], a[52:55], v[128:143]
    ds_read_b128 a[24:27], v13 offset:0
    ds_read_b64_tr_b16 a[0:1], v9 offset:0
    ds_read_b64_tr_b16 a[2:3], v9 offset:1536
    v_mfma_f32_32x32x16_bf16 v[144:159], a[32:35], a[52:55], v[144:159]
    ds_read_b64_tr_b16 a[4:5], v10 offset:0
    ds_read_b64_tr_b16 a[6:7], v10 offset:1536
    ds_read_b64_tr_b16 a[8:9], v9 offset:128
    s_add_u32 m0, s35, 122880
    s_add_u32 s32, s37, 3932160
    buffer_load_dwordx4 v1, s[20:23], s32 offen lds
    v_mfma_f32_32x32x16_bf16 v[160:175], a[36:39], a[52:55], v[160:175]
    ds_read_b64_tr_b16 a[10:11], v9 offset:1664
    ds_read_b64_tr_b16 a[12:13], v10 offset:128
    ds_read_b64_tr_b16 a[14:15], v10 offset:1664
    v_mfma_f32_32x32x16_bf16 v[176:191], a[40:43], a[52:55], v[176:191]
    ds_read_b64_tr_b16 a[16:17], v9 offset:256
    ds_read_b64_tr_b16 a[18:19], v9 offset:1792
    ds_read_b64_tr_b16 a[20:21], v10 offset:256
    s_add_u32 m0, s35, 123904
    s_add_u32 s32, s37, 3932160
    buffer_load_dwordx4 v2, s[20:23], s32 offen lds
    v_mfma_f32_32x32x16_bf16 v[192:207], a[44:47], a[52:55], v[192:207]
    ds_read_b64_tr_b16 a[22:23], v10 offset:1792
    v_mfma_f32_32x32x16_bf16 v[208:223], a[48:51], a[52:55], v[208:223]
    s_add_u32 m0, s35, 124928
    s_add_u32 s32, s37, 3932160
    buffer_load_dwordx4 v3, s[20:23], s32 offen lds
    s_waitcnt lgkmcnt(10)
    v_mfma_f32_32x32x16_bf16 v[128:143], a[0:3], a[24:27], v[128:143]
    ds_read_b128 a[52:55], v14 offset:0
    ds_read_b64_tr_b16 a[28:29], v9 offset:6144
    ds_read_b64_tr_b16 a[30:31], v9 offset:7680
    s_waitcnt lgkmcnt(11)
    v_mfma_f32_32x32x16_bf16 v[144:159], a[4:7], a[24:27], v[144:159]
    ds_read_b64_tr_b16 a[32:33], v10 offset:6144
    ds_read_b64_tr_b16 a[34:35], v10 offset:7680
    ds_read_b64_tr_b16 a[36:37], v9 offset:6272
    s_add_u32 m0, s35, 125952
    s_add_u32 s32, s37, 4030464
    buffer_load_dwordx4 v1, s[20:23], s32 offen lds
    s_waitcnt lgkmcnt(12)
    v_mfma_f32_32x32x16_bf16 v[160:175], a[8:11], a[24:27], v[160:175]
    ds_read_b64_tr_b16 a[38:39], v9 offset:7808
    ds_read_b64_tr_b16 a[40:41], v10 offset:6272
    ds_read_b64_tr_b16 a[42:43], v10 offset:7808
    s_waitcnt lgkmcnt(13)
    v_mfma_f32_32x32x16_bf16 v[176:191], a[12:15], a[24:27], v[176:191]
    ds_read_b64_tr_b16 a[44:45], v9 offset:6400
    ds_read_b64_tr_b16 a[46:47], v9 offset:7936
    ds_read_b64_tr_b16 a[48:49], v10 offset:6400
    s_add_u32 m0, s35, 126976
    s_add_u32 s32, s37, 4030464
    buffer_load_dwordx4 v2, s[20:23], s32 offen lds
    s_waitcnt lgkmcnt(14)
    v_mfma_f32_32x32x16_bf16 v[192:207], a[16:19], a[24:27], v[192:207]
    ds_read_b64_tr_b16 a[50:51], v10 offset:7936
    s_waitcnt lgkmcnt(13)
    v_mfma_f32_32x32x16_bf16 v[208:223], a[20:23], a[24:27], v[208:223]
    s_add_u32 m0, s35, 128000
    s_add_u32 s32, s37, 4030464
    buffer_load_dwordx4 v3, s[20:23], s32 offen lds
    s_waitcnt lgkmcnt(10)
    v_mfma_f32_32x32x16_bf16 v[128:143], a[28:31], a[52:55], v[128:143]
    ds_read_b128 a[24:27], v15 offset:0
    ds_read_b64_tr_b16 a[0:1], v9 offset:12288
    ds_read_b64_tr_b16 a[2:3], v9 offset:13824
    s_waitcnt lgkmcnt(11)
    v_mfma_f32_32x32x16_bf16 v[144:159], a[32:35], a[52:55], v[144:159]
    ds_read_b64_tr_b16 a[4:5], v10 offset:12288
    ds_read_b64_tr_b16 a[6:7], v10 offset:13824
    ds_read_b64_tr_b16 a[8:9], v9 offset:12416
    s_add_u32 m0, s36, 122880
    s_add_u32 s32, s46, 640
    buffer_load_dwordx4 v5, s[24:27], s32 offen lds
    s_waitcnt lgkmcnt(12)
    v_mfma_f32_32x32x16_bf16 v[160:175], a[36:39], a[52:55], v[160:175]
    ds_read_b64_tr_b16 a[10:11], v9 offset:13952
    ds_read_b64_tr_b16 a[12:13], v10 offset:12416
    ds_read_b64_tr_b16 a[14:15], v10 offset:13952
    s_waitcnt lgkmcnt(13)
    v_mfma_f32_32x32x16_bf16 v[176:191], a[40:43], a[52:55], v[176:191]
    ds_read_b64_tr_b16 a[16:17], v9 offset:12544
    ds_read_b64_tr_b16 a[18:19], v9 offset:14080
    ds_read_b64_tr_b16 a[20:21], v10 offset:12544
    s_add_u32 m0, s36, 123904
    s_add_u32 s32, s46, 640
    buffer_load_dwordx4 v6, s[24:27], s32 offen lds
    s_waitcnt lgkmcnt(14)
    v_mfma_f32_32x32x16_bf16 v[192:207], a[44:47], a[52:55], v[192:207]
    ds_read_b64_tr_b16 a[22:23], v10 offset:14080
    s_waitcnt lgkmcnt(13)
    v_mfma_f32_32x32x16_bf16 v[208:223], a[48:51], a[52:55], v[208:223]
    s_add_u32 m0, s36, 124928
    s_add_u32 s32, s46, 640
    buffer_load_dwordx4 v7, s[24:27], s32 offen lds
    s_waitcnt lgkmcnt(10)
    v_mfma_f32_32x32x16_bf16 v[128:143], a[0:3], a[24:27], v[128:143]
    ds_read_b128 a[52:55], v16 offset:0
    ds_read_b64_tr_b16 a[28:29], v9 offset:18432
    ds_read_b64_tr_b16 a[30:31], v9 offset:19968
    s_waitcnt lgkmcnt(11)
    v_mfma_f32_32x32x16_bf16 v[144:159], a[4:7], a[24:27], v[144:159]
    ds_read_b64_tr_b16 a[32:33], v10 offset:18432
    ds_read_b64_tr_b16 a[34:35], v10 offset:19968
    ds_read_b64_tr_b16 a[36:37], v9 offset:18560
    s_add_u32 m0, s36, 125952
    s_add_u32 s32, s46, 640
    buffer_load_dwordx4 v8, s[24:27], s32 offen lds
    s_waitcnt lgkmcnt(12)
    v_mfma_f32_32x32x16_bf16 v[160:175], a[8:11], a[24:27], v[160:175]
    ds_read_b64_tr_b16 a[38:39], v9 offset:20096
    ds_read_b64_tr_b16 a[40:41], v10 offset:18560
    ds_read_b64_tr_b16 a[42:43], v10 offset:20096
    s_waitcnt lgkmcnt(13)
    v_mfma_f32_32x32x16_bf16 v[176:191], a[12:15], a[24:27], v[176:191]
    ds_read_b64_tr_b16 a[44:45], v9 offset:18688
    ds_read_b64_tr_b16 a[46:47], v9 offset:20224
    ds_read_b64_tr_b16 a[48:49], v10 offset:18688
    s_waitcnt lgkmcnt(14)
    v_mfma_f32_32x32x16_bf16 v[192:207], a[16:19], a[24:27], v[192:207]
    ds_read_b64_tr_b16 a[50:51], v10 offset:20224
    s_waitcnt lgkmcnt(13)
    v_mfma_f32_32x32x16_bf16 v[208:223], a[20:23], a[24:27], v[208:223]
    s_waitcnt lgkmcnt(0)
    s_waitcnt vmcnt(10)
    s_barrier
    s_cmp_lg_u32 s28, 0
    s_cbranch_scc1 pub_5
    s_add_u32 s32, s31, 0
    s_lshl_b32 s32, s32, 2
    s_add_u32 s32, s32, 64
    v_mov_b32 v26, s42
    s_mov_b64 exec, 1
    buffer_atomic_add v26, off, s[12:15], s32 sc1
    s_mov_b64 exec, -1
pub_5:
    s_cmp_ge_u32 s31, 29
    s_cbranch_scc1 wexit_2
    v_mfma_f32_32x32x16_bf16 v[128:143], a[28:31], a[52:55], v[128:143]
    ds_read_b128 a[24:27], v13 offset:40960
    ds_read_b64_tr_b16 a[0:1], v9 offset:40960
    ds_read_b64_tr_b16 a[2:3], v9 offset:42496
    v_mfma_f32_32x32x16_bf16 v[144:159], a[32:35], a[52:55], v[144:159]
    ds_read_b64_tr_b16 a[4:5], v10 offset:40960
    ds_read_b64_tr_b16 a[6:7], v10 offset:42496
    ds_read_b64_tr_b16 a[8:9], v9 offset:41088
    s_add_u32 m0, s35, 0
    s_add_u32 s32, s37, 4718592
    buffer_load_dwordx4 v1, s[20:23], s32 offen lds
    v_mfma_f32_32x32x16_bf16 v[160:175], a[36:39], a[52:55], v[160:175]
    ds_read_b64_tr_b16 a[10:11], v9 offset:42624
    ds_read_b64_tr_b16 a[12:13], v10 offset:41088
    ds_read_b64_tr_b16 a[14:15], v10 offset:42624
    v_mfma_f32_32x32x16_bf16 v[176:191], a[40:43], a[52:55], v[176:191]
    ds_read_b64_tr_b16 a[16:17], v9 offset:41216
    ds_read_b64_tr_b16 a[18:19], v9 offset:42752
    ds_read_b64_tr_b16 a[20:21], v10 offset:41216
    s_add_u32 m0, s35, 1024
    s_add_u32 s32, s37, 4718592
    buffer_load_dwordx4 v2, s[20:23], s32 offen lds
    v_mfma_f32_32x32x16_bf16 v[192:207], a[44:47], a[52:55], v[192:207]
    ds_read_b64_tr_b16 a[22:23], v10 offset:42752
    v_mfma_f32_32x32x16_bf16 v[208:223], a[48:51], a[52:55], v[208:223]
    s_add_u32 m0, s35, 2048
    s_add_u32 s32, s37, 4718592
    buffer_load_dwordx4 v3, s[20:23], s32 offen lds
    s_waitcnt lgkmcnt(10)
    v_mfma_f32_32x32x16_bf16 v[128:143], a[0:3], a[24:27], v[128:143]
    ds_read_b128 a[52:55], v14 offset:40960
    ds_read_b64_tr_b16 a[28:29], v9 offset:47104
    ds_read_b64_tr_b16 a[30:31], v9 offset:48640
    s_waitcnt lgkmcnt(11)
    v_mfma_f32_32x32x16_bf16 v[144:159], a[4:7], a[24:27], v[144:159]
    ds_read_b64_tr_b16 a[32:33], v10 offset:47104
    ds_read_b64_tr_b16 a[34:35], v10 offset:48640
    ds_read_b64_tr_b16 a[36:37], v9 offset:47232
    s_add_u32 m0, s35, 3072
    s_add_u32 s32, s37, 4816896
    buffer_load_dwordx4 v1, s[20:23], s32 offen lds
    s_waitcnt lgkmcnt(12)
    v_mfma_f32_32x32x16_bf16 v[160:175], a[8:11], a[24:27], v[160:175]
    ds_read_b64_tr_b16 a[38:39], v9 offset:48768
    ds_read_b64_tr_b16 a[40:41], v10 offset:47232
    ds_read_b64_tr_b16 a[42:43], v10 offset:48768
    s_waitcnt lgkmcnt(13)
    v_mfma_f32_32x32x16_bf16 v[176:191], a[12:15], a[24:27], v[176:191]
    ds_read_b64_tr_b16 a[44:45], v9 offset:47360
    ds_read_b64_tr_b16 a[46:47], v9 offset:48896
    ds_read_b64_tr_b16 a[48:49], v10 offset:47360
    s_add_u32 m0, s35, 4096
    s_add_u32 s32, s37, 4816896
    buffer_load_dwordx4 v2, s[20:23], s32 offen lds
    s_waitcnt lgkmcnt(14)
    v_mfma_f32_32x32x16_bf16 v[192:207], a[16:19], a[24:27], v[192:207]
    ds_read_b64_tr_b16 a[50:51], v10 offset:48896
    s_waitcnt lgkmcnt(13)
    v_mfma_f32_32x32x16_bf16 v[208:223], a[20:23], a[24:27], v[208:223]
    s_add_u32 m0, s35, 5120
    s_add_u32 s32, s37, 4816896
    buffer_load_dwordx4 v3, s[20:23], s32 offen lds
    s_waitcnt lgkmcnt(10)
    v_mfma_f32_32x32x16_bf16 v[128:143], a[28:31], a[52:55], v[128:143]
    ds_read_b128 a[24:27], v15 offset:40960
    ds_read_b64_tr_b16 a[0:1], v9 offset:53248
    ds_read_b64_tr_b16 a[2:3], v9 offset:54784
    s_waitcnt lgkmcnt(11)
    v_mfma_f32_32x32x16_bf16 v[144:159], a[32:35], a[52:55], v[144:159]
    ds_read_b64_tr_b16 a[4:5], v10 offset:53248
    ds_read_b64_tr_b16 a[6:7], v10 offset:54784
    ds_read_b64_tr_b16 a[8:9], v9 offset:53376
    s_add_u32 m0, s36, 0
    s_add_u32 s32, s46, 768
    buffer_load_dwordx4 v5, s[24:27], s32 offen lds
    s_waitcnt lgkmcnt(12)
    v_mfma_f32_32x32x16_bf16 v[160:175], a[36:39], a[52:55], v[160:175]
    ds_read_b64_tr_b16 a[10:11], v9 offset:54912
    ds_read_b64_tr_b16 a[12:13], v10 offset:53376
    ds_read_b64_tr_b16 a[14:15], v10 offset:54912
    s_waitcnt lgkmcnt(13)
    v_mfma_f32_32x32x16_bf16 v[176:191], a[40:43], a[52:55], v[176:191]
    ds_read_b64_tr_b16 a[16:17], v9 offset:53504
    ds_read_b64_tr_b16 a[18:19], v9 offset:55040
    ds_read_b64_tr_b16 a[20:21], v10 offset:53504
    s_add_u32 m0, s36, 1024
    s_add_u32 s32, s46, 768
    buffer_load_dwordx4 v6, s[24:27], s32 offen lds
    s_waitcnt lgkmcnt(14)
    v_mfma_f32_32x32x16_bf16 v[192:207], a[44:47], a[52:55], v[192:207]
    ds_read_b64_tr_b16 a[22:23], v10 offset:55040
    s_waitcnt lgkmcnt(13)
    v_mfma_f32_32x32x16_bf16 v[208:223], a[48:51], a[52:55], v[208:223]
    s_add_u32 m0, s36, 2048
    s_add_u32 s32, s46, 768
    buffer_load_dwordx4 v7, s[24:27], s32 offen lds
    s_waitcnt lgkmcnt(10)
    v_mfma_f32_32x32x16_bf16 v[128:143], a[0:3], a[24:27], v[128:143]
    ds_read_b128 a[52:55], v16 offset:40960
    ds_read_b64_tr_b16 a[28:29], v9 offset:59392
    ds_read_b64_tr_b16 a[30:31], v9 offset:60928
    s_waitcnt lgkmcnt(11)
    v_mfma_f32_32x32x16_bf16 v[144:159], a[4:7], a[24:27], v[144:159]
    ds_read_b64_tr_b16 a[32:33], v10 offset:59392
    ds_read_b64_tr_b16 a[34:35], v10 offset:60928
    ds_read_b64_tr_b16 a[36:37], v9 offset:59520
    s_add_u32 m0, s36, 3072
    s_add_u32 s32, s46, 768
    buffer_load_dwordx4 v8, s[24:27], s32 offen lds
    s_waitcnt lgkmcnt(12)
    v_mfma_f32_32x32x16_bf16 v[160:175], a[8:11], a[24:27], v[160:175]
    ds_read_b64_tr_b16 a[38:39], v9 offset:61056
    ds_read_b64_tr_b16 a[40:41], v10 offset:59520
    ds_read_b64_tr_b16 a[42:43], v10 offset:61056
    s_waitcnt lgkmcnt(13)
    v_mfma_f32_32x32x16_bf16 v[176:191], a[12:15], a[24:27], v[176:191]
    ds_read_b64_tr_b16 a[44:45], v9 offset:59648
    ds_read_b64_tr_b16 a[46:47], v9 offset:61184
    ds_read_b64_tr_b16 a[48:49], v10 offset:59648
    s_waitcnt lgkmcnt(14)
    v_mfma_f32_32x32x16_bf16 v[192:207], a[16:19], a[24:27], v[192:207]
    ds_read_b64_tr_b16 a[50:51], v10 offset:61184
    s_waitcnt lgkmcnt(13)
    v_mfma_f32_32x32x16_bf16 v[208:223], a[20:23], a[24:27], v[208:223]
    s_waitcnt lgkmcnt(0)
    s_waitcnt vmcnt(20)
    s_barrier
    v_mfma_f32_32x32x16_bf16 v[128:143], a[28:31], a[52:55], v[128:143]
    ds_read_b128 a[24:27], v17 offset:0
    ds_read_b64_tr_b16 a[0:1], v11 offset:0
    ds_read_b64_tr_b16 a[2:3], v11 offset:1536
    v_mfma_f32_32x32x16_bf16 v[144:159], a[32:35], a[52:55], v[144:159]
    ds_read_b64_tr_b16 a[4:5], v12 offset:0
    ds_read_b64_tr_b16 a[6:7], v12 offset:1536
    ds_read_b64_tr_b16 a[8:9], v11 offset:128
    s_add_u32 m0, s35, 40960
    s_add_u32 s32, s37, 5505024
    buffer_load_dwordx4 v1, s[20:23], s32 offen lds
    v_mfma_f32_32x32x16_bf16 v[160:175], a[36:39], a[52:55], v[160:175]
    ds_read_b64_tr_b16 a[10:11], v11 offset:1664
    ds_read_b64_tr_b16 a[12:13], v12 offset:128
    ds_read_b64_tr_b16 a[14:15], v12 offset:1664
    v_mfma_f32_32x32x16_bf16 v[176:191], a[40:43], a[52:55], v[176:191]
    ds_read_b64_tr_b16 a[16:17], v11 offset:256
    ds_read_b64_tr_b16 a[18:19], v11 offset:1792
    ds_read_b64_tr_b16 a[20:21], v12 offset:256
    s_add_u32 m0, s35, 41984
    s_add_u32 s32, s37, 5505024
    buffer_load_dwordx4 v2, s[20:23], s32 offen lds
    v_mfma_f32_32x32x16_bf16 v[192:207], a[44:47], a[52:55], v[192:207]
    ds_read_b64_tr_b16 a[22:23], v12 offset:1792
    v_mfma_f32_32x32x16_bf16 v[208:223], a[48:51], a[52:55], v[208:223]
    s_add_u32 m0, s35, 43008
    s_add_u32 s32, s37, 5505024
    buffer_load_dwordx4 v3, s[20:23], s32 offen lds
    s_waitcnt lgkmcnt(10)
    v_mfma_f32_32x32x16_bf16 v[128:143], a[0:3], a[24:27], v[128:143]
    ds_read_b128 a[52:55], v18 offset:0
    ds_read_b64_tr_b16 a[28:29], v11 offset:6144
    ds_read_b64_tr_b16 a[30:31], v11 offset:7680
    s_waitcnt lgkmcnt(11)
    v_mfma_f32_32x32x16_bf16 v[144:159], a[4:7], a[24:27], v[144:159]
    ds_read_b64_tr_b16 a[32:33], v12 offset:6144
    ds_read_b64_tr_b16 a[34:35], v12 offset:7680
    ds_read_b64_tr_b16 a[36:37], v11 offset:6272
    s_add_u32 m0, s35, 44032
    s_add_u32 s32, s37, 5603328
    buffer_load_dwordx4 v1, s[20:23], s32 offen lds
    s_waitcnt lgkmcnt(12)
    v_mfma_f32_32x32x16_bf16 v[160:175], a[8:11], a[24:27], v[160:175]
    ds_read_b64_tr_b16 a[38:39], v11 offset:7808
    ds_read_b64_tr_b16 a[40:41], v12 offset:6272
    ds_read_b64_tr_b16 a[42:43], v12 offset:7808
    s_waitcnt lgkmcnt(13)
    v_mfma_f32_32x32x16_bf16 v[176:191], a[12:15], a[24:27], v[176:191]
    ds_read_b64_tr_b16 a[44:45], v11 offset:6400
    ds_read_b64_tr_b16 a[46:47], v11 offset:7936
    ds_read_b64_tr_b16 a[48:49], v12 offset:6400
    s_add_u32 m0, s35, 45056
    s_add_u32 s32, s37, 5603328
    buffer_load_dwordx4 v2, s[20:23], s32 offen lds
    s_waitcnt lgkmcnt(14)
    v_mfma_f32_32x32x16_bf16 v[192:207], a[16:19], a[24:27], v[192:207]
    ds_read_b64_tr_b16 a[50:51], v12 offset:7936
    s_waitcnt lgkmcnt(13)
    v_mfma_f32_32x32x16_bf16 v[208:223], a[20:23], a[24:27], v[208:223]
    s_add_u32 m0, s35, 46080
    s_add_u32 s32, s37, 5603328
    buffer_load_dwordx4 v3, s[20:23], s32 offen lds
    s_waitcnt lgkmcnt(10)
    v_mfma_f32_32x32x16_bf16 v[128:143], a[28:31], a[52:55], v[128:143]
    ds_read_b128 a[24:27], v19 offset:0
    ds_read_b64_tr_b16 a[0:1], v11 offset:12288
    ds_read_b64_tr_b16 a[2:3], v11 offset:13824
    s_waitcnt lgkmcnt(11)
    v_mfma_f32_32x32x16_bf16 v[144:159], a[32:35], a[52:55], v[144:159]
    ds_read_b64_tr_b16 a[4:5], v12 offset:12288
    ds_read_b64_tr_b16 a[6:7], v12 offset:13824
    ds_read_b64_tr_b16 a[8:9], v11 offset:12416
    s_add_u32 m0, s36, 40960
    s_add_u32 s32, s46, 896
    buffer_load_dwordx4 v5, s[24:27], s32 offen lds
    s_waitcnt lgkmcnt(12)
    v_mfma_f32_32x32x16_bf16 v[160:175], a[36:39], a[52:55], v[160:175]
    ds_read_b64_tr_b16 a[10:11], v11 offset:13952
    ds_read_b64_tr_b16 a[12:13], v12 offset:12416
    ds_read_b64_tr_b16 a[14:15], v12 offset:13952
    s_waitcnt lgkmcnt(13)
    v_mfma_f32_32x32x16_bf16 v[176:191], a[40:43], a[52:55], v[176:191]
    ds_read_b64_tr_b16 a[16:17], v11 offset:12544
    ds_read_b64_tr_b16 a[18:19], v11 offset:14080
    ds_read_b64_tr_b16 a[20:21], v12 offset:12544
    s_add_u32 m0, s36, 41984
    s_add_u32 s32, s46, 896
    buffer_load_dwordx4 v6, s[24:27], s32 offen lds
    s_waitcnt lgkmcnt(14)
    v_mfma_f32_32x32x16_bf16 v[192:207], a[44:47], a[52:55], v[192:207]
    ds_read_b64_tr_b16 a[22:23], v12 offset:14080
    s_waitcnt lgkmcnt(13)
    v_mfma_f32_32x32x16_bf16 v[208:223], a[48:51], a[52:55], v[208:223]
    s_add_u32 m0, s36, 43008
    s_add_u32 s32, s46, 896
    buffer_load_dwordx4 v7, s[24:27], s32 offen lds
    s_waitcnt lgkmcnt(10)
    v_mfma_f32_32x32x16_bf16 v[128:143], a[0:3], a[24:27], v[128:143]
    ds_read_b128 a[52:55], v20 offset:0
    ds_read_b64_tr_b16 a[28:29], v11 offset:18432
    ds_read_b64_tr_b16 a[30:31], v11 offset:19968
    s_waitcnt lgkmcnt(11)
    v_mfma_f32_32x32x16_bf16 v[144:159], a[4:7], a[24:27], v[144:159]
    ds_read_b64_tr_b16 a[32:33], v12 offset:18432
    ds_read_b64_tr_b16 a[34:35], v12 offset:19968
    ds_read_b64_tr_b16 a[36:37], v11 offset:18560
    s_add_u32 m0, s36, 44032
    s_add_u32 s32, s46, 896
    buffer_load_dwordx4 v8, s[24:27], s32 offen lds
    s_waitcnt lgkmcnt(12)
    v_mfma_f32_32x32x16_bf16 v[160:175], a[8:11], a[24:27], v[160:175]
    ds_read_b64_tr_b16 a[38:39], v11 offset:20096
    ds_read_b64_tr_b16 a[40:41], v12 offset:18560
    ds_read_b64_tr_b16 a[42:43], v12 offset:20096
    s_waitcnt lgkmcnt(13)
    v_mfma_f32_32x32x16_bf16 v[176:191], a[12:15], a[24:27], v[176:191]
    ds_read_b64_tr_b16 a[44:45], v11 offset:18688
    ds_read_b64_tr_b16 a[46:47], v11 offset:20224
    ds_read_b64_tr_b16 a[48:49], v12 offset:18688
    s_waitcnt lgkmcnt(14)
    v_mfma_f32_32x32x16_bf16 v[192:207], a[16:19], a[24:27], v[192:207]
    ds_read_b64_tr_b16 a[50:51], v12 offset:20224
    s_waitcnt lgkmcnt(13)
    v_mfma_f32_32x32x16_bf16 v[208:223], a[20:23], a[24:27], v[208:223]
    s_waitcnt lgkmcnt(0)
    s_waitcnt vmcnt(20)
    s_barrier
    v_mfma_f32_32x32x16_bf16 v[128:143], a[28:31], a[52:55], v[128:143]
    ds_read_b128 a[24:27], v17 offset:40960
    ds_read_b64_tr_b16 a[0:1], v11 offset:40960
    ds_read_b64_tr_b16 a[2:3], v11 offset:42496
    v_mfma_f32_32x32x16_bf16 v[144:159], a[32:35], a[52:55], v[144:159]
    ds_read_b64_tr_b16 a[4:5], v12 offset:40960
    ds_read_b64_tr_b16 a[6:7], v12 offset:42496
    ds_read_b64_tr_b16 a[8:9], v11 offset:41088
    s_add_u32 m0, s35, 81920
    s_add_u32 s32, s37, 6291456
    buffer_load_dwordx4 v1, s[20:23], s32 offen lds
    v_mfma_f32_32x32x16_bf16 v[160:175], a[36:39], a[52:55], v[160:175]
    ds_read_b64_tr_b16 a[10:11], v11 offset:42624
    ds_read_b64_tr_b16 a[12:13], v12 offset:41088
    ds_read_b64_tr_b16 a[14:15], v12 offset:42624
    v_mfma_f32_32x32x16_bf16 v[176:191], a[40:43], a[52:55], v[176:191]
    ds_read_b64_tr_b16 a[16:17], v11 offset:41216
    ds_read_b64_tr_b16 a[18:19], v11 offset:42752
    ds_read_b64_tr_b16 a[20:21], v12 offset:41216
    s_add_u32 m0, s35, 82944
    s_add_u32 s32, s37, 6291456
    buffer_load_dwordx4 v2, s[20:23], s32 offen lds
    v_mfma_f32_32x32x16_bf16 v[192:207], a[44:47], a[52:55], v[192:207]
    ds_read_b64_tr_b16 a[22:23], v12 offset:42752
    v_mfma_f32_32x32x16_bf16 v[208:223], a[48:51], a[52:55], v[208:223]
    s_add_u32 m0, s35, 83968
    s_add_u32 s32, s37, 6291456
    buffer_load_dwordx4 v3, s[20:23], s32 offen lds
    s_waitcnt lgkmcnt(10)
    v_mfma_f32_32x32x16_bf16 v[128:143], a[0:3], a[24:27], v[128:143]
    ds_read_b128 a[52:55], v18 offset:40960
    ds_read_b64_tr_b16 a[28:29], v11 offset:47104
    ds_read_b64_tr_b16 a[30:31], v11 offset:48640
    s_waitcnt lgkmcnt(11)
    v_mfma_f32_32x32x16_bf16 v[144:159], a[4:7], a[24:27], v[144:159]
    ds_read_b64_tr_b16 a[32:33], v12 offset:47104
    ds_read_b64_tr_b16 a[34:35], v12 offset:48640
    ds_read_b64_tr_b16 a[36:37], v11 offset:47232
    s_add_u32 m0, s35, 84992
    s_add_u32 s32, s37, 6389760
    buffer_load_dwordx4 v1, s[20:23], s32 offen lds
    s_waitcnt lgkmcnt(12)
    v_mfma_f32_32x32x16_bf16 v[160:175], a[8:11], a[24:27], v[160:175]
    ds_read_b64_tr_b16 a[38:39], v11 offset:48768
    ds_read_b64_tr_b16 a[40:41], v12 offset:47232
    ds_read_b64_tr_b16 a[42:43], v12 offset:48768
    s_waitcnt lgkmcnt(13)
    v_mfma_f32_32x32x16_bf16 v[176:191], a[12:15], a[24:27], v[176:191]
    ds_read_b64_tr_b16 a[44:45], v11 offset:47360
    ds_read_b64_tr_b16 a[46:47], v11 offset:48896
    ds_read_b64_tr_b16 a[48:49], v12 offset:47360
    s_add_u32 m0, s35, 86016
    s_add_u32 s32, s37, 6389760
    buffer_load_dwordx4 v2, s[20:23], s32 offen lds
    s_waitcnt lgkmcnt(14)
    v_mfma_f32_32x32x16_bf16 v[192:207], a[16:19], a[24:27], v[192:207]
    ds_read_b64_tr_b16 a[50:51], v12 offset:48896
    s_waitcnt lgkmcnt(13)
    v_mfma_f32_32x32x16_bf16 v[208:223], a[20:23], a[24:27], v[208:223]
    s_add_u32 m0, s35, 87040
    s_add_u32 s32, s37, 6389760
    buffer_load_dwordx4 v3, s[20:23], s32 offen lds
    s_waitcnt lgkmcnt(10)
    v_mfma_f32_32x32x16_bf16 v[128:143], a[28:31], a[52:55], v[128:143]
    ds_read_b128 a[24:27], v19 offset:40960
    ds_read_b64_tr_b16 a[0:1], v11 offset:53248
    ds_read_b64_tr_b16 a[2:3], v11 offset:54784
    s_waitcnt lgkmcnt(11)
    v_mfma_f32_32x32x16_bf16 v[144:159], a[32:35], a[52:55], v[144:159]
    ds_read_b64_tr_b16 a[4:5], v12 offset:53248
    ds_read_b64_tr_b16 a[6:7], v12 offset:54784
    ds_read_b64_tr_b16 a[8:9], v11 offset:53376
    s_add_u32 m0, s36, 81920
    s_add_u32 s32, s46, 1024
    buffer_load_dwordx4 v5, s[24:27], s32 offen lds
    s_waitcnt lgkmcnt(12)
    v_mfma_f32_32x32x16_bf16 v[160:175], a[36:39], a[52:55], v[160:175]
    ds_read_b64_tr_b16 a[10:11], v11 offset:54912
    ds_read_b64_tr_b16 a[12:13], v12 offset:53376
    ds_read_b64_tr_b16 a[14:15], v12 offset:54912
    s_waitcnt lgkmcnt(13)
    v_mfma_f32_32x32x16_bf16 v[176:191], a[40:43], a[52:55], v[176:191]
    ds_read_b64_tr_b16 a[16:17], v11 offset:53504
    ds_read_b64_tr_b16 a[18:19], v11 offset:55040
    ds_read_b64_tr_b16 a[20:21], v12 offset:53504
    s_add_u32 m0, s36, 82944
    s_add_u32 s32, s46, 1024
    buffer_load_dwordx4 v6, s[24:27], s32 offen lds
    s_waitcnt lgkmcnt(14)
    v_mfma_f32_32x32x16_bf16 v[192:207], a[44:47], a[52:55], v[192:207]
    ds_read_b64_tr_b16 a[22:23], v12 offset:55040
    s_waitcnt lgkmcnt(13)
    v_mfma_f32_32x32x16_bf16 v[208:223], a[48:51], a[52:55], v[208:223]
    s_add_u32 m0, s36, 83968
    s_add_u32 s32, s46, 1024
    buffer_load_dwordx4 v7, s[24:27], s32 offen lds
    s_waitcnt lgkmcnt(10)
    v_mfma_f32_32x32x16_bf16 v[128:143], a[0:3], a[24:27], v[128:143]
    ds_read_b128 a[52:55], v20 offset:40960
    ds_read_b64_tr_b16 a[28:29], v11 offset:59392
    ds_read_b64_tr_b16 a[30:31], v11 offset:60928
    s_waitcnt lgkmcnt(11)
    v_mfma_f32_32x32x16_bf16 v[144:159], a[4:7], a[24:27], v[144:159]
    ds_read_b64_tr_b16 a[32:33], v12 offset:59392
    ds_read_b64_tr_b16 a[34:35], v12 offset:60928
    ds_read_b64_tr_b16 a[36:37], v11 offset:59520
    s_add_u32 m0, s36, 84992
    s_add_u32 s32, s46, 1024
    buffer_load_dwordx4 v8, s[24:27], s32 offen lds
    s_waitcnt lgkmcnt(12)
    v_mfma_f32_32x32x16_bf16 v[160:175], a[8:11], a[24:27], v[160:175]
    ds_read_b64_tr_b16 a[38:39], v11 offset:61056
    ds_read_b64_tr_b16 a[40:41], v12 offset:59520
    ds_read_b64_tr_b16 a[42:43], v12 offset:61056
    s_waitcnt lgkmcnt(13)
    v_mfma_f32_32x32x16_bf16 v[176:191], a[12:15], a[24:27], v[176:191]
    ds_read_b64_tr_b16 a[44:45], v11 offset:59648
    ds_read_b64_tr_b16 a[46:47], v11 offset:61184
    ds_read_b64_tr_b16 a[48:49], v12 offset:59648
    s_waitcnt lgkmcnt(14)
    v_mfma_f32_32x32x16_bf16 v[192:207], a[16:19], a[24:27], v[192:207]
    ds_read_b64_tr_b16 a[50:51], v12 offset:61184
    s_waitcnt lgkmcnt(13)
    v_mfma_f32_32x32x16_bf16 v[208:223], a[20:23], a[24:27], v[208:223]
    s_waitcnt lgkmcnt(0)
    s_waitcnt vmcnt(20)
    s_barrier
    v_mfma_f32_32x32x16_bf16 v[128:143], a[28:31], a[52:55], v[128:143]
    ds_read_b128 a[24:27], v13 offset:0
    ds_read_b64_tr_b16 a[0:1], v9 offset:0
    ds_read_b64_tr_b16 a[2:3], v9 offset:1536
    v_mfma_f32_32x32x16_bf16 v[144:159], a[32:35], a[52:55], v[144:159]
    ds_read_b64_tr_b16 a[4:5], v10 offset:0
    ds_read_b64_tr_b16 a[6:7], v10 offset:1536
    ds_read_b64_tr_b16 a[8:9], v9 offset:128
    s_add_u32 m0, s35, 122880
    s_add_u32 s32, s37, 7077888
    buffer_load_dwordx4 v1, s[20:23], s32 offen lds
    v_mfma_f32_32x32x16_bf16 v[160:175], a[36:39], a[52:55], v[160:175]
    ds_read_b64_tr_b16 a[10:11], v9 offset:1664
    ds_read_b64_tr_b16 a[12:13], v10 offset:128
    ds_read_b64_tr_b16 a[14:15], v10 offset:1664
    v_mfma_f32_32x32x16_bf16 v[176:191], a[40:43], a[52:55], v[176:191]
    ds_read_b64_tr_b16 a[16:17], v9 offset:256
    ds_read_b64_tr_b16 a[18:19], v9 offset:1792
    ds_read_b64_tr_b16 a[20:21], v10 offset:256
    s_add_u32 m0, s35, 123904
    s_add_u32 s32, s37, 7077888
    buffer_load_dwordx4 v2, s[20:23], s32 offen lds
    v_mfma_f32_32x32x16_bf16 v[192:207], a[44:47], a[52:55], v[192:207]
    ds_read_b64_tr_b16 a[22:23], v10 offset:1792
    v_mfma_f32_32x32x16_bf16 v[208:223], a[48:51], a[52:55], v[208:223]
    s_add_u32 m0, s35, 124928
    s_add_u32 s32, s37, 7077888
    buffer_load_dwordx4 v3, s[20:23], s32 offen lds
    s_waitcnt lgkmcnt(10)
    v_mfma_f32_32x32x16_bf16 v[128:143], a[0:3], a[24:27], v[128:143]
    ds_read_b128 a[52:55], v14 offset:0
    ds_read_b64_tr_b16 a[28:29], v9 offset:6144
    ds_read_b64_tr_b16 a[30:31], v9 offset:7680
    s_waitcnt lgkmcnt(11)
    v_mfma_f32_32x32x16_bf16 v[144:159], a[4:7], a[24:27], v[144:159]
    ds_read_b64_tr_b16 a[32:33], v10 offset:6144
    ds_read_b64_tr_b16 a[34:35], v10 offset:7680
    ds_read_b64_tr_b16 a[36:37], v9 offset:6272
    s_add_u32 m0, s35, 125952
    s_add_u32 s32, s37, 7176192
    buffer_load_dwordx4 v1, s[20:23], s32 offen lds
    s_waitcnt lgkmcnt(12)
    v_mfma_f32_32x32x16_bf16 v[160:175], a[8:11], a[24:27], v[160:175]
    ds_read_b64_tr_b16 a[38:39], v9 offset:7808
    ds_read_b64_tr_b16 a[40:41], v10 offset:6272
    ds_read_b64_tr_b16 a[42:43], v10 offset:7808
    s_waitcnt lgkmcnt(13)
    v_mfma_f32_32x32x16_bf16 v[176:191], a[12:15], a[24:27], v[176:191]
    ds_read_b64_tr_b16 a[44:45], v9 offset:6400
    ds_read_b64_tr_b16 a[46:47], v9 offset:7936
    ds_read_b64_tr_b16 a[48:49], v10 offset:6400
    s_add_u32 m0, s35, 126976
    s_add_u32 s32, s37, 7176192
    buffer_load_dwordx4 v2, s[20:23], s32 offen lds
    s_waitcnt lgkmcnt(14)
    v_mfma_f32_32x32x16_bf16 v[192:207], a[16:19], a[24:27], v[192:207]
    ds_read_b64_tr_b16 a[50:51], v10 offset:7936
    s_waitcnt lgkmcnt(13)
    v_mfma_f32_32x32x16_bf16 v[208:223], a[20:23], a[24:27], v[208:223]
    s_add_u32 m0, s35, 128000
    s_add_u32 s32, s37, 7176192
    buffer_load_dwordx4 v3, s[20:23], s32 offen lds
    s_waitcnt lgkmcnt(10)
    v_mfma_f32_32x32x16_bf16 v[128:143], a[28:31], a[52:55], v[128:143]
    ds_read_b128 a[24:27], v15 offset:0
    ds_read_b64_tr_b16 a[0:1], v9 offset:12288
    ds_read_b64_tr_b16 a[2:3], v9 offset:13824
    s_waitcnt lgkmcnt(11)
    v_mfma_f32_32x32x16_bf16 v[144:159], a[32:35], a[52:55], v[144:159]
    ds_read_b64_tr_b16 a[4:5], v10 offset:12288
    ds_read_b64_tr_b16 a[6:7], v10 offset:13824
    ds_read_b64_tr_b16 a[8:9], v9 offset:12416
    s_add_u32 m0, s36, 122880
    s_add_u32 s32, s46, 1152
    buffer_load_dwordx4 v5, s[24:27], s32 offen lds
    s_waitcnt lgkmcnt(12)
    v_mfma_f32_32x32x16_bf16 v[160:175], a[36:39], a[52:55], v[160:175]
    ds_read_b64_tr_b16 a[10:11], v9 offset:13952
    ds_read_b64_tr_b16 a[12:13], v10 offset:12416
    ds_read_b64_tr_b16 a[14:15], v10 offset:13952
    s_waitcnt lgkmcnt(13)
    v_mfma_f32_32x32x16_bf16 v[176:191], a[40:43], a[52:55], v[176:191]
    ds_read_b64_tr_b16 a[16:17], v9 offset:12544
    ds_read_b64_tr_b16 a[18:19], v9 offset:14080
    ds_read_b64_tr_b16 a[20:21], v10 offset:12544
    s_add_u32 m0, s36, 123904
    s_add_u32 s32, s46, 1152
    buffer_load_dwordx4 v6, s[24:27], s32 offen lds
    s_waitcnt lgkmcnt(14)
    v_mfma_f32_32x32x16_bf16 v[192:207], a[44:47], a[52:55], v[192:207]
    ds_read_b64_tr_b16 a[22:23], v10 offset:14080
    s_waitcnt lgkmcnt(13)
    v_mfma_f32_32x32x16_bf16 v[208:223], a[48:51], a[52:55], v[208:223]
    s_add_u32 m0, s36, 124928
    s_add_u32 s32, s46, 1152
    buffer_load_dwordx4 v7, s[24:27], s32 offen lds
    s_waitcnt lgkmcnt(10)
    v_mfma_f32_32x32x16_bf16 v[128:143], a[0:3], a[24:27], v[128:143]
    ds_read_b128 a[52:55], v16 offset:0
    ds_read_b64_tr_b16 a[28:29], v9 offset:18432
    ds_read_b64_tr_b16 a[30:31], v9 offset:19968
    s_waitcnt lgkmcnt(11)
    v_mfma_f32_32x32x16_bf16 v[144:159], a[4:7], a[24:27], v[144:159]
    ds_read_b64_tr_b16 a[32:33], v10 offset:18432
    ds_read_b64_tr_b16 a[34:35], v10 offset:19968
    ds_read_b64_tr_b16 a[36:37], v9 offset:18560
    s_add_u32 m0, s36, 125952
    s_add_u32 s32, s46, 1152
    buffer_load_dwordx4 v8, s[24:27], s32 offen lds
    s_waitcnt lgkmcnt(12)
    v_mfma_f32_32x32x16_bf16 v[160:175], a[8:11], a[24:27], v[160:175]
    ds_read_b64_tr_b16 a[38:39], v9 offset:20096
    ds_read_b64_tr_b16 a[40:41], v10 offset:18560
    ds_read_b64_tr_b16 a[42:43], v10 offset:20096
    s_waitcnt lgkmcnt(13)
    v_mfma_f32_32x32x16_bf16 v[176:191], a[12:15], a[24:27], v[176:191]
    ds_read_b64_tr_b16 a[44:45], v9 offset:18688
    ds_read_b64_tr_b16 a[46:47], v9 offset:20224
    ds_read_b64_tr_b16 a[48:49], v10 offset:18688
    s_waitcnt lgkmcnt(14)
    v_mfma_f32_32x32x16_bf16 v[192:207], a[16:19], a[24:27], v[192:207]
    ds_read_b64_tr_b16 a[50:51], v10 offset:20224
    s_waitcnt lgkmcnt(13)
    v_mfma_f32_32x32x16_bf16 v[208:223], a[20:23], a[24:27], v[208:223]
    s_waitcnt lgkmcnt(0)
    s_waitcnt vmcnt(20)
    s_barrier
    v_mfma_f32_32x32x16_bf16 v[128:143], a[28:31], a[52:55], v[128:143]
    ds_read_b128 a[24:27], v13 offset:40960
    ds_read_b64_tr_b16 a[0:1], v9 offset:40960
    ds_read_b64_tr_b16 a[2:3], v9 offset:42496
    v_mfma_f32_32x32x16_bf16 v[144:159], a[32:35], a[52:55], v[144:159]
    ds_read_b64_tr_b16 a[4:5], v10 offset:40960
    ds_read_b64_tr_b16 a[6:7], v10 offset:42496
    ds_read_b64_tr_b16 a[8:9], v9 offset:41088
    s_add_u32 m0, s35, 0
    s_add_u32 s32, s37, 0
    buffer_load_dwordx4 v1, s[16:19], s32 offen lds
    v_mfma_f32_32x32x16_bf16 v[160:175], a[36:39], a[52:55], v[160:175]
    ds_read_b64_tr_b16 a[10:11], v9 offset:42624
    ds_read_b64_tr_b16 a[12:13], v10 offset:41088
    ds_read_b64_tr_b16 a[14:15], v10 offset:42624
    v_mfma_f32_32x32x16_bf16 v[176:191], a[40:43], a[52:55], v[176:191]
    ds_read_b64_tr_b16 a[16:17], v9 offset:41216
    ds_read_b64_tr_b16 a[18:19], v9 offset:42752
    ds_read_b64_tr_b16 a[20:21], v10 offset:41216
    s_add_u32 m0, s35, 1024
    s_add_u32 s32, s37, 0
    buffer_load_dwordx4 v2, s[16:19], s32 offen lds
    v_mfma_f32_32x32x16_bf16 v[192:207], a[44:47], a[52:55], v[192:207]
    ds_read_b64_tr_b16 a[22:23], v10 offset:42752
    v_mfma_f32_32x32x16_bf16 v[208:223], a[48:51], a[52:55], v[208:223]
    s_add_u32 m0, s35, 2048
    s_add_u32 s32, s37, 0
    buffer_load_dwordx4 v3, s[16:19], s32 offen lds
    s_waitcnt lgkmcnt(10)
    v_mfma_f32_32x32x16_bf16 v[128:143], a[0:3], a[24:27], v[128:143]
    ds_read_b128 a[52:55], v14 offset:40960
    ds_read_b64_tr_b16 a[28:29], v9 offset:47104
    ds_read_b64_tr_b16 a[30:31], v9 offset:48640
    s_waitcnt lgkmcnt(11)
    v_mfma_f32_32x32x16_bf16 v[144:159], a[4:7], a[24:27], v[144:159]
    ds_read_b64_tr_b16 a[32:33], v10 offset:47104
    ds_read_b64_tr_b16 a[34:35], v10 offset:48640
    ds_read_b64_tr_b16 a[36:37], v9 offset:47232
    s_add_u32 m0, s35, 3072
    s_add_u32 s32, s37, 98304
    buffer_load_dwordx4 v1, s[16:19], s32 offen lds
    s_waitcnt lgkmcnt(12)
    v_mfma_f32_32x32x16_bf16 v[160:175], a[8:11], a[24:27], v[160:175]
    ds_read_b64_tr_b16 a[38:39], v9 offset:48768
    ds_read_b64_tr_b16 a[40:41], v10 offset:47232
    ds_read_b64_tr_b16 a[42:43], v10 offset:48768
    s_waitcnt lgkmcnt(13)
    v_mfma_f32_32x32x16_bf16 v[176:191], a[12:15], a[24:27], v[176:191]
    ds_read_b64_tr_b16 a[44:45], v9 offset:47360
    ds_read_b64_tr_b16 a[46:47], v9 offset:48896
    ds_read_b64_tr_b16 a[48:49], v10 offset:47360
    s_add_u32 m0, s35, 4096
    s_add_u32 s32, s37, 98304
    buffer_load_dwordx4 v2, s[16:19], s32 offen lds
    s_waitcnt lgkmcnt(14)
    v_mfma_f32_32x32x16_bf16 v[192:207], a[16:19], a[24:27], v[192:207]
    ds_read_b64_tr_b16 a[50:51], v10 offset:48896
    s_waitcnt lgkmcnt(13)
    v_mfma_f32_32x32x16_bf16 v[208:223], a[20:23], a[24:27], v[208:223]
    s_add_u32 m0, s35, 5120
    s_add_u32 s32, s37, 98304
    buffer_load_dwordx4 v3, s[16:19], s32 offen lds
    s_waitcnt lgkmcnt(10)
    v_mfma_f32_32x32x16_bf16 v[128:143], a[28:31], a[52:55], v[128:143]
    ds_read_b128 a[24:27], v15 offset:40960
    ds_read_b64_tr_b16 a[0:1], v9 offset:53248
    ds_read_b64_tr_b16 a[2:3], v9 offset:54784
    s_waitcnt lgkmcnt(11)
    v_mfma_f32_32x32x16_bf16 v[144:159], a[32:35], a[52:55], v[144:159]
    ds_read_b64_tr_b16 a[4:5], v10 offset:53248
    ds_read_b64_tr_b16 a[6:7], v10 offset:54784
    ds_read_b64_tr_b16 a[8:9], v9 offset:53376
    s_add_u32 m0, s36, 0
    s_add_u32 s32, s40, 0
    buffer_load_dwordx4 v5, s[24:27], s32 offen lds
    s_waitcnt lgkmcnt(12)
    v_mfma_f32_32x32x16_bf16 v[160:175], a[36:39], a[52:55], v[160:175]
    ds_read_b64_tr_b16 a[10:11], v9 offset:54912
    ds_read_b64_tr_b16 a[12:13], v10 offset:53376
    ds_read_b64_tr_b16 a[14:15], v10 offset:54912
    s_waitcnt lgkmcnt(13)
    v_mfma_f32_32x32x16_bf16 v[176:191], a[40:43], a[52:55], v[176:191]
    ds_read_b64_tr_b16 a[16:17], v9 offset:53504
    ds_read_b64_tr_b16 a[18:19], v9 offset:55040
    ds_read_b64_tr_b16 a[20:21], v10 offset:53504
    s_add_u32 m0, s36, 1024
    s_add_u32 s32, s40, 0
    buffer_load_dwordx4 v6, s[24:27], s32 offen lds
    s_waitcnt lgkmcnt(14)
    v_mfma_f32_32x32x16_bf16 v[192:207], a[44:47], a[52:55], v[192:207]
    ds_read_b64_tr_b16 a[22:23], v10 offset:55040
    s_waitcnt lgkmcnt(13)
    v_mfma_f32_32x32x16_bf16 v[208:223], a[48:51], a[52:55], v[208:223]
    s_add_u32 m0, s36, 2048
    s_add_u32 s32, s40, 0
    buffer_load_dwordx4 v7, s[24:27], s32 offen lds
    s_waitcnt lgkmcnt(10)
    v_mfma_f32_32x32x16_bf16 v[128:143], a[0:3], a[24:27], v[128:143]
    ds_read_b128 a[52:55], v16 offset:40960
    ds_read_b64_tr_b16 a[28:29], v9 offset:59392
    ds_read_b64_tr_b16 a[30:31], v9 offset:60928
    s_waitcnt lgkmcnt(11)
    v_mfma_f32_32x32x16_bf16 v[144:159], a[4:7], a[24:27], v[144:159]
    ds_read_b64_tr_b16 a[32:33], v10 offset:59392
    ds_read_b64_tr_b16 a[34:35], v10 offset:60928
    ds_read_b64_tr_b16 a[36:37], v9 offset:59520
    s_add_u32 m0, s36, 3072
    s_add_u32 s32, s40, 0
    buffer_load_dwordx4 v8, s[24:27], s32 offen lds
    s_waitcnt lgkmcnt(12)
    v_mfma_f32_32x32x16_bf16 v[160:175], a[8:11], a[24:27], v[160:175]
    ds_read_b64_tr_b16 a[38:39], v9 offset:61056
    ds_read_b64_tr_b16 a[40:41], v10 offset:59520
    ds_read_b64_tr_b16 a[42:43], v10 offset:61056
    s_waitcnt lgkmcnt(13)
    v_mfma_f32_32x32x16_bf16 v[176:191], a[12:15], a[24:27], v[176:191]
    ds_read_b64_tr_b16 a[44:45], v9 offset:59648
    ds_read_b64_tr_b16 a[46:47], v9 offset:61184
    ds_read_b64_tr_b16 a[48:49], v10 offset:59648
    s_waitcnt lgkmcnt(14)
    v_mfma_f32_32x32x16_bf16 v[192:207], a[16:19], a[24:27], v[192:207]
    ds_read_b64_tr_b16 a[50:51], v10 offset:61184
    s_waitcnt lgkmcnt(13)
    v_mfma_f32_32x32x16_bf16 v[208:223], a[20:23], a[24:27], v[208:223]
    s_waitcnt lgkmcnt(0)
    s_waitcnt vmcnt(20)
    s_barrier
    v_mfma_f32_32x32x16_bf16 v[128:143], a[28:31], a[52:55], v[128:143]
    ds_read_b128 a[24:27], v17 offset:0
    ds_read_b64_tr_b16 a[0:1], v11 offset:0
    ds_read_b64_tr_b16 a[2:3], v11 offset:1536
    v_mfma_f32_32x32x16_bf16 v[144:159], a[32:35], a[52:55], v[144:159]
    ds_read_b64_tr_b16 a[4:5], v12 offset:0
    ds_read_b64_tr_b16 a[6:7], v12 offset:1536
    ds_read_b64_tr_b16 a[8:9], v11 offset:128
    s_add_u32 m0, s35, 40960
    s_add_u32 s32, s37, 786432
    buffer_load_dwordx4 v1, s[16:19], s32 offen lds
    v_mfma_f32_32x32x16_bf16 v[160:175], a[36:39], a[52:55], v[160:175]
    ds_read_b64_tr_b16 a[10:11], v11 offset:1664
    ds_read_b64_tr_b16 a[12:13], v12 offset:128
    ds_read_b64_tr_b16 a[14:15], v12 offset:1664
    v_mfma_f32_32x32x16_bf16 v[176:191], a[40:43], a[52:55], v[176:191]
    ds_read_b64_tr_b16 a[16:17], v11 offset:256
    ds_read_b64_tr_b16 a[18:19], v11 offset:1792
    ds_read_b64_tr_b16 a[20:21], v12 offset:256
    s_add_u32 m0, s35, 41984
    s_add_u32 s32, s37, 786432
    buffer_load_dwordx4 v2, s[16:19], s32 offen lds
    v_mfma_f32_32x32x16_bf16 v[192:207], a[44:47], a[52:55], v[192:207]
    ds_read_b64_tr_b16 a[22:23], v12 offset:1792
    v_mfma_f32_32x32x16_bf16 v[208:223], a[48:51], a[52:55], v[208:223]
    s_add_u32 m0, s35, 43008
    s_add_u32 s32, s37, 786432
    buffer_load_dwordx4 v3, s[16:19], s32 offen lds
    s_waitcnt lgkmcnt(10)
    v_mfma_f32_32x32x16_bf16 v[128:143], a[0:3], a[24:27], v[128:143]
    ds_read_b128 a[52:55], v18 offset:0
    ds_read_b64_tr_b16 a[28:29], v11 offset:6144
    ds_read_b64_tr_b16 a[30:31], v11 offset:7680
    s_waitcnt lgkmcnt(11)
    v_mfma_f32_32x32x16_bf16 v[144:159], a[4:7], a[24:27], v[144:159]
    ds_read_b64_tr_b16 a[32:33], v12 offset:6144
    ds_read_b64_tr_b16 a[34:35], v12 offset:7680
    ds_read_b64_tr_b16 a[36:37], v11 offset:6272
    s_add_u32 m0, s35, 44032
    s_add_u32 s32, s37, 884736
    buffer_load_dwordx4 v1, s[16:19], s32 offen lds
    s_waitcnt lgkmcnt(12)
    v_mfma_f32_32x32x16_bf16 v[160:175], a[8:11], a[24:27], v[160:175]
    ds_read_b64_tr_b16 a[38:39], v11 offset:7808
    ds_read_b64_tr_b16 a[40:41], v12 offset:6272
    ds_read_b64_tr_b16 a[42:43], v12 offset:7808
    s_waitcnt lgkmcnt(13)
    v_mfma_f32_32x32x16_bf16 v[176:191], a[12:15], a[24:27], v[176:191]
    ds_read_b64_tr_b16 a[44:45], v11 offset:6400
    ds_read_b64_tr_b16 a[46:47], v11 offset:7936
    ds_read_b64_tr_b16 a[48:49], v12 offset:6400
    s_add_u32 m0, s35, 45056
    s_add_u32 s32, s37, 884736
    buffer_load_dwordx4 v2, s[16:19], s32 offen lds
    s_waitcnt lgkmcnt(14)
    v_mfma_f32_32x32x16_bf16 v[192:207], a[16:19], a[24:27], v[192:207]
    ds_read_b64_tr_b16 a[50:51], v12 offset:7936
    s_waitcnt lgkmcnt(13)
    v_mfma_f32_32x32x16_bf16 v[208:223], a[20:23], a[24:27], v[208:223]
    s_add_u32 m0, s35, 46080
    s_add_u32 s32, s37, 884736
    buffer_load_dwordx4 v3, s[16:19], s32 offen lds
    s_waitcnt lgkmcnt(10)
    v_mfma_f32_32x32x16_bf16 v[128:143], a[28:31], a[52:55], v[128:143]
    ds_read_b128 a[24:27], v19 offset:0
    ds_read_b64_tr_b16 a[0:1], v11 offset:12288
    ds_read_b64_tr_b16 a[2:3], v11 offset:13824
    s_waitcnt lgkmcnt(11)
    v_mfma_f32_32x32x16_bf16 v[144:159], a[32:35], a[52:55], v[144:159]
    ds_read_b64_tr_b16 a[4:5], v12 offset:12288
    ds_read_b64_tr_b16 a[6:7], v12 offset:13824
    ds_read_b64_tr_b16 a[8:9], v11 offset:12416
    s_add_u32 m0, s36, 40960
    s_add_u32 s32, s40, 128
    buffer_load_dwordx4 v5, s[24:27], s32 offen lds
    s_waitcnt lgkmcnt(12)
    v_mfma_f32_32x32x16_bf16 v[160:175], a[36:39], a[52:55], v[160:175]
    ds_read_b64_tr_b16 a[10:11], v11 offset:13952
    ds_read_b64_tr_b16 a[12:13], v12 offset:12416
    ds_read_b64_tr_b16 a[14:15], v12 offset:13952
    s_waitcnt lgkmcnt(13)
    v_mfma_f32_32x32x16_bf16 v[176:191], a[40:43], a[52:55], v[176:191]
    ds_read_b64_tr_b16 a[16:17], v11 offset:12544
    ds_read_b64_tr_b16 a[18:19], v11 offset:14080
    ds_read_b64_tr_b16 a[20:21], v12 offset:12544
    s_add_u32 m0, s36, 41984
    s_add_u32 s32, s40, 128
    buffer_load_dwordx4 v6, s[24:27], s32 offen lds
    s_waitcnt lgkmcnt(14)
    v_mfma_f32_32x32x16_bf16 v[192:207], a[44:47], a[52:55], v[192:207]
    ds_read_b64_tr_b16 a[22:23], v12 offset:14080
    s_waitcnt lgkmcnt(13)
    v_mfma_f32_32x32x16_bf16 v[208:223], a[48:51], a[52:55], v[208:223]
    s_add_u32 m0, s36, 43008
    s_add_u32 s32, s40, 128
    buffer_load_dwordx4 v7, s[24:27], s32 offen lds
    s_waitcnt lgkmcnt(10)
    v_mfma_f32_32x32x16_bf16 v[128:143], a[0:3], a[24:27], v[128:143]
    ds_read_b128 a[52:55], v20 offset:0
    ds_read_b64_tr_b16 a[28:29], v11 offset:18432
    ds_read_b64_tr_b16 a[30:31], v11 offset:19968
    s_waitcnt lgkmcnt(11)
    v_mfma_f32_32x32x16_bf16 v[144:159], a[4:7], a[24:27], v[144:159]
    ds_read_b64_tr_b16 a[32:33], v12 offset:18432
    ds_read_b64_tr_b16 a[34:35], v12 offset:19968
    ds_read_b64_tr_b16 a[36:37], v11 offset:18560
    s_add_u32 m0, s36, 44032
    s_add_u32 s32, s40, 128
    buffer_load_dwordx4 v8, s[24:27], s32 offen lds
    s_waitcnt lgkmcnt(12)
    v_mfma_f32_32x32x16_bf16 v[160:175], a[8:11], a[24:27], v[160:175]
    ds_read_b64_tr_b16 a[38:39], v11 offset:20096
    ds_read_b64_tr_b16 a[40:41], v12 offset:18560
    ds_read_b64_tr_b16 a[42:43], v12 offset:20096
    s_waitcnt lgkmcnt(13)
    v_mfma_f32_32x32x16_bf16 v[176:191], a[12:15], a[24:27], v[176:191]
    ds_read_b64_tr_b16 a[44:45], v11 offset:18688
    ds_read_b64_tr_b16 a[46:47], v11 offset:20224
    ds_read_b64_tr_b16 a[48:49], v12 offset:18688
    s_waitcnt lgkmcnt(14)
    v_mfma_f32_32x32x16_bf16 v[192:207], a[16:19], a[24:27], v[192:207]
    ds_read_b64_tr_b16 a[50:51], v12 offset:20224
    s_waitcnt lgkmcnt(13)
    v_mfma_f32_32x32x16_bf16 v[208:223], a[20:23], a[24:27], v[208:223]
    s_waitcnt lgkmcnt(0)
    s_waitcnt vmcnt(20)
    s_barrier
    v_mfma_f32_32x32x16_bf16 v[128:143], a[28:31], a[52:55], v[128:143]
    ds_read_b128 a[24:27], v17 offset:40960
    ds_read_b64_tr_b16 a[0:1], v11 offset:40960
    ds_read_b64_tr_b16 a[2:3], v11 offset:42496
    v_mfma_f32_32x32x16_bf16 v[144:159], a[32:35], a[52:55], v[144:159]
    ds_read_b64_tr_b16 a[4:5], v12 offset:40960
    ds_read_b64_tr_b16 a[6:7], v12 offset:42496
    ds_read_b64_tr_b16 a[8:9], v11 offset:41088
    s_add_u32 m0, s35, 81920
    s_add_u32 s32, s37, 1572864
    buffer_load_dwordx4 v1, s[16:19], s32 offen lds
    v_mfma_f32_32x32x16_bf16 v[160:175], a[36:39], a[52:55], v[160:175]
    ds_read_b64_tr_b16 a[10:11], v11 offset:42624
    ds_read_b64_tr_b16 a[12:13], v12 offset:41088
    ds_read_b64_tr_b16 a[14:15], v12 offset:42624
    v_mfma_f32_32x32x16_bf16 v[176:191], a[40:43], a[52:55], v[176:191]
    ds_read_b64_tr_b16 a[16:17], v11 offset:41216
    ds_read_b64_tr_b16 a[18:19], v11 offset:42752
    ds_read_b64_tr_b16 a[20:21], v12 offset:41216
    s_add_u32 m0, s35, 82944
    s_add_u32 s32, s37, 1572864
    buffer_load_dwordx4 v2, s[16:19], s32 offen lds
    v_mfma_f32_32x32x16_bf16 v[192:207], a[44:47], a[52:55], v[192:207]
    ds_read_b64_tr_b16 a[22:23], v12 offset:42752
    v_mfma_f32_32x32x16_bf16 v[208:223], a[48:51], a[52:55], v[208:223]
    s_add_u32 m0, s35, 83968
    s_add_u32 s32, s37, 1572864
    buffer_load_dwordx4 v3, s[16:19], s32 offen lds
    s_waitcnt lgkmcnt(10)
    v_mfma_f32_32x32x16_bf16 v[128:143], a[0:3], a[24:27], v[128:143]
    ds_read_b128 a[52:55], v18 offset:40960
    ds_read_b64_tr_b16 a[28:29], v11 offset:47104
    ds_read_b64_tr_b16 a[30:31], v11 offset:48640
    s_waitcnt lgkmcnt(11)
    v_mfma_f32_32x32x16_bf16 v[144:159], a[4:7], a[24:27], v[144:159]
    ds_read_b64_tr_b16 a[32:33], v12 offset:47104
    ds_read_b64_tr_b16 a[34:35], v12 offset:48640
    ds_read_b64_tr_b16 a[36:37], v11 offset:47232
    s_add_u32 m0, s35, 84992
    s_add_u32 s32, s37, 1671168
    buffer_load_dwordx4 v1, s[16:19], s32 offen lds
    s_waitcnt lgkmcnt(12)
    v_mfma_f32_32x32x16_bf16 v[160:175], a[8:11], a[24:27], v[160:175]
    ds_read_b64_tr_b16 a[38:39], v11 offset:48768
    ds_read_b64_tr_b16 a[40:41], v12 offset:47232
    ds_read_b64_tr_b16 a[42:43], v12 offset:48768
    s_waitcnt lgkmcnt(13)
    v_mfma_f32_32x32x16_bf16 v[176:191], a[12:15], a[24:27], v[176:191]
    ds_read_b64_tr_b16 a[44:45], v11 offset:47360
    ds_read_b64_tr_b16 a[46:47], v11 offset:48896
    ds_read_b64_tr_b16 a[48:49], v12 offset:47360
    s_add_u32 m0, s35, 86016
    s_add_u32 s32, s37, 1671168
    buffer_load_dwordx4 v2, s[16:19], s32 offen lds
    s_waitcnt lgkmcnt(14)
    v_mfma_f32_32x32x16_bf16 v[192:207], a[16:19], a[24:27], v[192:207]
    ds_read_b64_tr_b16 a[50:51], v12 offset:48896
    s_waitcnt lgkmcnt(13)
    v_mfma_f32_32x32x16_bf16 v[208:223], a[20:23], a[24:27], v[208:223]
    s_add_u32 m0, s35, 87040
    s_add_u32 s32, s37, 1671168
    buffer_load_dwordx4 v3, s[16:19], s32 offen lds
    s_waitcnt lgkmcnt(10)
    v_mfma_f32_32x32x16_bf16 v[128:143], a[28:31], a[52:55], v[128:143]
    ds_read_b128 a[24:27], v19 offset:40960
    ds_read_b64_tr_b16 a[0:1], v11 offset:53248
    ds_read_b64_tr_b16 a[2:3], v11 offset:54784
    s_waitcnt lgkmcnt(11)
    v_mfma_f32_32x32x16_bf16 v[144:159], a[32:35], a[52:55], v[144:159]
    ds_read_b64_tr_b16 a[4:5], v12 offset:53248
    ds_read_b64_tr_b16 a[6:7], v12 offset:54784
    ds_read_b64_tr_b16 a[8:9], v11 offset:53376
    s_add_u32 m0, s36, 81920
    s_add_u32 s32, s40, 256
    buffer_load_dwordx4 v5, s[24:27], s32 offen lds
    s_waitcnt lgkmcnt(12)
    v_mfma_f32_32x32x16_bf16 v[160:175], a[36:39], a[52:55], v[160:175]
    ds_read_b64_tr_b16 a[10:11], v11 offset:54912
    ds_read_b64_tr_b16 a[12:13], v12 offset:53376
    ds_read_b64_tr_b16 a[14:15], v12 offset:54912
    s_waitcnt lgkmcnt(13)
    v_mfma_f32_32x32x16_bf16 v[176:191], a[40:43], a[52:55], v[176:191]
    ds_read_b64_tr_b16 a[16:17], v11 offset:53504
    ds_read_b64_tr_b16 a[18:19], v11 offset:55040
    ds_read_b64_tr_b16 a[20:21], v12 offset:53504
    s_add_u32 m0, s36, 82944
    s_add_u32 s32, s40, 256
    buffer_load_dwordx4 v6, s[24:27], s32 offen lds
    s_waitcnt lgkmcnt(14)
    v_mfma_f32_32x32x16_bf16 v[192:207], a[44:47], a[52:55], v[192:207]
    ds_read_b64_tr_b16 a[22:23], v12 offset:55040
    s_waitcnt lgkmcnt(13)
    v_mfma_f32_32x32x16_bf16 v[208:223], a[48:51], a[52:55], v[208:223]
    s_add_u32 m0, s36, 83968
    s_add_u32 s32, s40, 256
    buffer_load_dwordx4 v7, s[24:27], s32 offen lds
    s_waitcnt lgkmcnt(10)
    v_mfma_f32_32x32x16_bf16 v[128:143], a[0:3], a[24:27], v[128:143]
    ds_read_b128 a[52:55], v20 offset:40960
    ds_read_b64_tr_b16 a[28:29], v11 offset:59392
    ds_read_b64_tr_b16 a[30:31], v11 offset:60928
    s_waitcnt lgkmcnt(11)
    v_mfma_f32_32x32x16_bf16 v[144:159], a[4:7], a[24:27], v[144:159]
    ds_read_b64_tr_b16 a[32:33], v12 offset:59392
    ds_read_b64_tr_b16 a[34:35], v12 offset:60928
    ds_read_b64_tr_b16 a[36:37], v11 offset:59520
    s_add_u32 m0, s36, 84992
    s_add_u32 s32, s40, 256
    buffer_load_dwordx4 v8, s[24:27], s32 offen lds
    s_waitcnt lgkmcnt(12)
    v_mfma_f32_32x32x16_bf16 v[160:175], a[8:11], a[24:27], v[160:175]
    ds_read_b64_tr_b16 a[38:39], v11 offset:61056
    ds_read_b64_tr_b16 a[40:41], v12 offset:59520
    ds_read_b64_tr_b16 a[42:43], v12 offset:61056
    s_waitcnt lgkmcnt(13)
    v_mfma_f32_32x32x16_bf16 v[176:191], a[12:15], a[24:27], v[176:191]
    ds_read_b64_tr_b16 a[44:45], v11 offset:59648
    ds_read_b64_tr_b16 a[46:47], v11 offset:61184
    ds_read_b64_tr_b16 a[48:49], v12 offset:59648
    s_waitcnt lgkmcnt(14)
    v_mfma_f32_32x32x16_bf16 v[192:207], a[16:19], a[24:27], v[192:207]
    ds_read_b64_tr_b16 a[50:51], v12 offset:61184
    s_waitcnt lgkmcnt(13)
    v_mfma_f32_32x32x16_bf16 v[208:223], a[20:23], a[24:27], v[208:223]
    s_waitcnt lgkmcnt(0)
    s_waitcnt vmcnt(20)
    s_barrier
    v_mfma_f32_32x32x16_bf16 v[128:143], a[28:31], a[52:55], v[128:143]
    ds_read_b128 a[24:27], v13 offset:0
    ds_read_b64_tr_b16 a[0:1], v9 offset:0
    ds_read_b64_tr_b16 a[2:3], v9 offset:1536
    v_mfma_f32_32x32x16_bf16 v[144:159], a[32:35], a[52:55], v[144:159]
    ds_read_b64_tr_b16 a[4:5], v10 offset:0
    ds_read_b64_tr_b16 a[6:7], v10 offset:1536
    ds_read_b64_tr_b16 a[8:9], v9 offset:128
    s_add_u32 m0, s35, 122880
    s_add_u32 s32, s37, 2359296
    buffer_load_dwordx4 v1, s[16:19], s32 offen lds
    v_mfma_f32_32x32x16_bf16 v[160:175], a[36:39], a[52:55], v[160:175]
    ds_read_b64_tr_b16 a[10:11], v9 offset:1664
    ds_read_b64_tr_b16 a[12:13], v10 offset:128
    ds_read_b64_tr_b16 a[14:15], v10 offset:1664
    v_mfma_f32_32x32x16_bf16 v[176:191], a[40:43], a[52:55], v[176:191]
    ds_read_b64_tr_b16 a[16:17], v9 offset:256
    ds_read_b64_tr_b16 a[18:19], v9 offset:1792
    ds_read_b64_tr_b16 a[20:21], v10 offset:256
    s_add_u32 m0, s35, 123904
    s_add_u32 s32, s37, 2359296
    buffer_load_dwordx4 v2, s[16:19], s32 offen lds
    v_mfma_f32_32x32x16_bf16 v[192:207], a[44:47], a[52:55], v[192:207]
    ds_read_b64_tr_b16 a[22:23], v10 offset:1792
    v_mfma_f32_32x32x16_bf16 v[208:223], a[48:51], a[52:55], v[208:223]
    s_add_u32 m0, s35, 124928
    s_add_u32 s32, s37, 2359296
    buffer_load_dwordx4 v3, s[16:19], s32 offen lds
    s_add_u32 s34, s47, 0
    v_cvt_pk_bf16_f32 v224, v128, v129
    v_cvt_pk_bf16_f32 v225, v130, v131
    v_cvt_pk_bf16_f32 v226, v132, v133
    v_cvt_pk_bf16_f32 v227, v134, v135
    buffer_store_dwordx4 v[224:227], v25, s[8:11], s34 offen offset:0 sc1
    v_cvt_pk_bf16_f32 v228, v136, v137
    v_cvt_pk_bf16_f32 v229, v138, v139
    v_cvt_pk_bf16_f32 v230, v140, v141
    v_cvt_pk_bf16_f32 v231, v142, v143
    buffer_store_dwordx4 v[228:231], v25, s[8:11], s34 offen offset:256 sc1
    v_cvt_pk_bf16_f32 v232, v144, v145
    v_cvt_pk_bf16_f32 v233, v146, v147
    v_cvt_pk_bf16_f32 v234, v148, v149
    v_cvt_pk_bf16_f32 v235, v150, v151
    buffer_store_dwordx4 v[232:235], v25, s[8:11], s34 offen offset:2048 sc1
    v_cvt_pk_bf16_f32 v236, v152, v153
    v_cvt_pk_bf16_f32 v237, v154, v155
    v_cvt_pk_bf16_f32 v238, v156, v157
    v_cvt_pk_bf16_f32 v239, v158, v159
    buffer_store_dwordx4 v[236:239], v25, s[8:11], s34 offen offset:2304 sc1
    s_add_u32 s34, s47, 4096
    v_cvt_pk_bf16_f32 v240, v160, v161
    v_cvt_pk_bf16_f32 v241, v162, v163
    v_cvt_pk_bf16_f32 v242, v164, v165
    v_cvt_pk_bf16_f32 v243, v166, v167
    buffer_store_dwordx4 v[240:243], v25, s[8:11], s34 offen offset:0 sc1
    v_cvt_pk_bf16_f32 v244, v168, v169
    v_cvt_pk_bf16_f32 v245, v170, v171
    v_cvt_pk_bf16_f32 v246, v172, v173
    v_cvt_pk_bf16_f32 v247, v174, v175
    buffer_store_dwordx4 v[244:247], v25, s[8:11], s34 offen offset:256 sc1
    v_cvt_pk_bf16_f32 v248, v176, v177
    v_cvt_pk_bf16_f32 v249, v178, v179
    v_cvt_pk_bf16_f32 v250, v180, v181
    v_cvt_pk_bf16_f32 v251, v182, v183
    buffer_store_dwordx4 v[248:251], v25, s[8:11], s34 offen offset:2048 sc1
    v_cvt_pk_bf16_f32 v252, v184, v185
    v_cvt_pk_bf16_f32 v253, v186, v187
    v_cvt_pk_bf16_f32 v254, v188, v189
    v_cvt_pk_bf16_f32 v255, v190, v191
    buffer_store_dwordx4 v[252:255], v25, s[8:11], s34 offen offset:2304 sc1
    s_add_u32 s34, s47, 8192
    v_cvt_pk_bf16_f32 v224, v192, v193
    v_cvt_pk_bf16_f32 v225, v194, v195
    v_cvt_pk_bf16_f32 v226, v196, v197
    v_cvt_pk_bf16_f32 v227, v198, v199
    buffer_store_dwordx4 v[224:227], v25, s[8:11], s34 offen offset:0 sc1
    v_cvt_pk_bf16_f32 v228, v200, v201
    v_cvt_pk_bf16_f32 v229, v202, v203
    v_cvt_pk_bf16_f32 v230, v204, v205
    v_cvt_pk_bf16_f32 v231, v206, v207
    buffer_store_dwordx4 v[228:231], v25, s[8:11], s34 offen offset:256 sc1
    v_cvt_pk_bf16_f32 v232, v208, v209
    v_cvt_pk_bf16_f32 v233, v210, v211
    v_cvt_pk_bf16_f32 v234, v212, v213
    v_cvt_pk_bf16_f32 v235, v214, v215
    buffer_store_dwordx4 v[232:235], v25, s[8:11], s34 offen offset:2048 sc1
    v_cvt_pk_bf16_f32 v236, v216, v217
    v_cvt_pk_bf16_f32 v237, v218, v219
    v_cvt_pk_bf16_f32 v238, v220, v221
    v_cvt_pk_bf16_f32 v239, v222, v223
    buffer_store_dwordx4 v[236:239], v25, s[8:11], s34 offen offset:2304 sc1
    s_add_u32 m0, s35, 125952
    s_add_u32 s32, s37, 2457600
    buffer_load_dwordx4 v1, s[16:19], s32 offen lds
    s_add_u32 m0, s35, 126976
    s_add_u32 s32, s37, 2457600
    buffer_load_dwordx4 v2, s[16:19], s32 offen lds
    s_add_u32 m0, s35, 128000
    s_add_u32 s32, s37, 2457600
    buffer_load_dwordx4 v3, s[16:19], s32 offen lds
    s_add_u32 m0, s36, 122880
    s_add_u32 s32, s40, 384
    buffer_load_dwordx4 v5, s[24:27], s32 offen lds
    s_add_u32 m0, s36, 123904
    s_add_u32 s32, s40, 384
    buffer_load_dwordx4 v6, s[24:27], s32 offen lds
    s_add_u32 m0, s36, 124928
    s_add_u32 s32, s40, 384
    buffer_load_dwordx4 v7, s[24:27], s32 offen lds
    s_add_u32 m0, s36, 125952
    s_add_u32 s32, s40, 384
    buffer_load_dwordx4 v8, s[24:27], s32 offen lds
    s_waitcnt vmcnt(0)
    s_barrier
    s_cmp_lg_u32 s28, 0
    s_cbranch_scc1 pub_6
    s_add_u32 s32, s31, 3
    s_lshl_b32 s32, s32, 2
    s_add_u32 s32, s32, 64
    v_mov_b32 v26, s42
    s_mov_b64 exec, 1
    buffer_atomic_add v26, off, s[12:15], s32 sc1
    s_mov_b64 exec, -1
pub_6:
    s_add_u32 s31, s31, 6
    s_add_u32 s34, s31, 0
    s_lshr_b32 s33, s34, 1
    s_lshl_b32 s32, s33, 2
    s_add_u32 s32, s32, s28
    s_mul_i32 s39, s32, 40960
    s_mul_i32 s41, s32, 786432
    s_mul_i32 s33, s29, 24576
    s_add_u32 s41, s41, s33
    s_and_b32 s33, s34, 1
    s_mul_i32 s33, s33, 12288
    s_add_u32 s41, s41, s33
    s_add_u32 s34, s31, 3
    s_lshr_b32 s33, s34, 1
    s_lshl_b32 s32, s33, 2
    s_add_u32 s32, s32, s28
    s_mul_i32 s46, s32, 40960
    s_mul_i32 s47, s32, 786432
    s_mul_i32 s33, s29, 24576
    s_add_u32 s47, s47, s33
    s_and_b32 s33, s34, 1
    s_mul_i32 s33, s33, 12288
    s_add_u32 s47, s47, s33
    s_add_u32 s40, s39, 491520
    s_cmp_lt_u32 s31, 32
    s_cbranch_scc1 wtop_4
    s_waitcnt lgkmcnt(0)
    s_branch L_tail
wexit_2:
    s_waitcnt vmcnt(0) lgkmcnt(0)
    s_barrier
    s_branch L_tail
role_vw_1:
    s_load_dwordx2 s[4:5], s[0:1], 144
    s_load_dwordx2 s[6:7], s[0:1], 136
    s_load_dwordx2 s[56:57], s[0:1], 0
    s_load_dwordx8 s[60:67], s[0:1], 16
    v_lshrrev_b32 v30, 6, v0
    s_nop 0
    v_readfirstlane_b32 s28, v30
    v_and_b32 v0, 63, v0
    s_waitcnt lgkmcnt(0)
    s_mov_b32 s8, s4
    s_mov_b32 s9, s5
    s_mov_b32 s10, 0x10000000
    s_mov_b32 s11, 0x20000
    s_mov_b32 s12, s6
    s_mov_b32 s13, s7
    s_mov_b32 s14, 0x100
    s_mov_b32 s15, 0x20000
    s_mov_b32 s24, s56
    s_mov_b32 s25, s57
    s_mov_b32 s26, 0x280000
    s_mov_b32 s27, 0x20000
    s_mov_b32 s16, s64
    s_mov_b32 s17, s65
    s_mov_b32 s18, 0x780000
    s_mov_b32 s19, 0x20000
    s_mov_b32 s20, s66
    s_mov_b32 s21, s67
    s_mov_b32 s22, 0x780000
    s_mov_b32 s23, 0x20000
    v_add_u32 v26, 0, v0
    v_mul_u32_u24 v27, 0xaaab, v26
    v_lshrrev_b32 v27, 20, v27
    v_mul_u32_u24 v28, 24, v27
    v_sub_u32 v28, v26, v28
    v_bfe_u32 v29, v27, 1, 1
    v_lshlrev_b32 v29, 2, v29
    v_xor_b32 v28, v28, v29
    v_mul_u32_u24 v27, 12288, v27
    v_lshl_add_u32 v1, v28, 4, v27
    v_add_u32 v26, 64, v0
    v_mul_u32_u24 v27, 0xaaab, v26
    v_lshrrev_b32 v27, 20, v27
    v_mul_u32_u24 v28, 24, v27
    v_sub_u32 v28, v26, v28
    v_bfe_u32 v29, v27, 1, 1
    v_lshlrev_b32 v29, 2, v29
    v_xor_b32 v28, v28, v29
    v_mul_u32_u24 v27, 12288, v27
    v_lshl_add_u32 v2, v28, 4, v27
    v_add_u32 v26, 128, v0
    v_mul_u32_u24 v27, 0xaaab, v26
    v_lshrrev_b32 v27, 20, v27
    v_mul_u32_u24 v28, 24, v27
    v_sub_u32 v28, v26, v28
    v_bfe_u32 v29, v27, 1, 1
    v_lshlrev_b32 v29, 2, v29
    v_xor_b32 v28, v28, v29
    v_mul_u32_u24 v27, 12288, v27
    v_lshl_add_u32 v3, v28, 4, v27
    v_lshrrev_b32 v27, 3, v0
    v_and_b32 v28, 7, v0
    v_bfe_u32 v29, v27, 1, 1
    v_lshlrev_b32 v29, 2, v29
    v_xor_b32 v28, v28, v29
    v_mul_u32_u24 v27, 1280, v27
    v_lshl_add_u32 v4, v28, 4, v27
    v_lshrrev_b32 v27, 3, v0
    v_add_u32 v27, 0, v27
    v_bfe_u32 v29, v27, 1, 3
    v_and_b32 v28, 7, v0
    v_xor_b32 v28, v28, v29
    v_bfe_u32 v29, v27, 2, 1
    v_and_b32 v27, 3, v27
    v_lshl_add_u32 v27, v29, 4, v27
    v_add_u32 v27, 0, v27
    v_mul_u32_u24 v27, 1280, v27
    v_lshl_add_u32 v5, v28, 4, v27
    v_lshrrev_b32 v27, 3, v0
    v_add_u32 v27, 8, v27
    v_bfe_u32 v29, v27, 1, 3
    v_and_b32 v28, 7, v0
    v_xor_b32 v28, v28, v29
    v_bfe_u32 v29, v27, 2, 1
    v_and_b32 v27, 3, v27
    v_lshl_add_u32 v27, v29, 4, v27
    v_add_u32 v27, 4, v27
    v_mul_u32_u24 v27, 1280, v27
    v_lshl_add_u32 v6, v28, 4, v27
    v_lshrrev_b32 v27, 3, v0
    v_add_u32 v27, 16, v27
    v_bfe_u32 v29, v27, 1, 3
    v_and_b32 v28, 7, v0
    v_xor_b32 v28, v28, v29
    v_bfe_u32 v29, v27, 2, 1
    v_and_b32 v27, 3, v27
    v_lshl_add_u32 v27, v29, 4, v27
    v_add_u32 v27, 8, v27
    v_mul_u32_u24 v27, 1280, v27
    v_lshl_add_u32 v7, v28, 4, v27
    v_lshrrev_b32 v27, 3, v0
    v_add_u32 v27, 24, v27
    v_bfe_u32 v29, v27, 1, 3
    v_and_b32 v28, 7, v0
    v_xor_b32 v28, v28, v29
    v_bfe_u32 v29, v27, 2, 1
    v_and_b32 v27, 3, v27
    v_lshl_add_u32 v27, v29, 4, v27
    v_add_u32 v27, 12, v27
    v_mul_u32_u24 v27, 1280, v27
    v_lshl_add_u32 v8, v28, 4, v27
    v_lshrrev_b32 v26, 5, v0
    v_bfe_u32 v27, v0, 2, 2
    v_bfe_u32 v28, v0, 4, 1
    v_and_b32 v29, 3, v0
    v_lshl_add_u32 v30, v26, 3, v27
    v_mul_u32_u24 v30, 384, v30
    v_and_b32 v31, 1, v29
    v_lshl_add_u32 v30, v31, 5, v30
    v_lshl_add_u32 v30, v28, 4, v30
    v_lshrrev_b32 v31, 1, v29
    v_lshl_add_u32 v30, v31, 3, v30
    v_lshrrev_b32 v31, 1, v27
    v_lshlrev_b32 v31, 6, v31
    v_add_u32 v9, v30, v31
    v_sub_u32 v30, v30, v31
    v_add_u32 v10, 64, v30
    v_add_u32 v11, 81920, v9
    v_add_u32 v12, 81920, v10
    v_lshl_add_u32 v30, v26, 4, v27
    v_lshlrev_b32 v30, 7, v30
    v_lshl_add_u32 v30, v28, 5, v30
    v_lshl_add_u32 v30, v29, 3, v30
    v_add_u32 v21, v30, v31
    v_sub_u32 v30, v30, v31
    v_add_u32 v22, 64, v30
    v_add_u32 v23, 81920, v21
    v_add_u32 v24, 81920, v22
    s_lshl_b32 s36, s28, 12
    s_add_u32 s36, s36, 24576
    s_mul_i32 s35, s28, 6144
    v_and_b32 v27, 31, v0
    v_bfe_u32 v28, v0, 1, 3
    v_xor_b32 v28, v28, v26
    v_lshlrev_b32 v27, 7, v27
    v_add_u32 v27, s36, v27
    v_xor_b32 v29, 0, v28
    v_lshl_add_u32 v13, v29, 4, v27
    v_add_u32 v17, 81920, v13
    v_xor_b32 v29, 2, v28
    v_lshl_add_u32 v14, v29, 4, v27
    v_add_u32 v18, 81920, v14
    v_xor_b32 v29, 4, v28
    v_lshl_add_u32 v15, v29, 4, v27
    v_add_u32 v19, 81920, v15
    v_xor_b32 v29, 6, v28
    v_lshl_add_u32 v16, v29, 4, v27
    v_add_u32 v20, 81920, v16
    v_bfe_u32 v28, v0, 4, 1
    v_lshlrev_b32 v25, 14, v28
    v_and_b32 v28, 15, v0
    v_lshl_add_u32 v25, v28, 4, v25
    v_lshl_add_u32 v25, v26, 9, v25
    s_mul_i32 s37, s28, 196608
    s_mul_i32 s32, s29, 384
    s_add_u32 s37, s37, s32
    s_mul_i32 s38, s28, 61440
    s_mul_i32 s32, s29, 245760
    s_add_u32 s38, s38, s32
    s_lshl_b32 s42, 1, s29
    s_mov_b32 s31, s30
    s_lshr_b32 s31, s30, 1
    s_xor_b32 s58, s31, 1
    s_lshl_b32 s32, s31, 2
    s_add_u32 s32, s32, s28
    s_mul_i32 s39, s32, 40960
    s_add_u32 s40, s39, 491520
    s_mul_i32 s41, s32, 1310720
    s_lshr_b32 s33, s29, 4
    s_mul_i32 s33, s33, 655360
    s_add_u32 s41, s41, s33
    s_and_b32 s33, s29, 15
    s_lshl_b32 s33, s33, 10
    s_add_u32 s41, s41, s33
    s_add_u32 s41, s41, 50331648
    s_mov_b32 s59, s38
    s_and_b32 s33, s30, 1
    s_mul_i32 s32, s33, 640
    s_add_u32 s38, s38, s32
    s_mul_i32 s32, s33, 327680
    s_add_u32 s41, s41, s32
wpro_8:
    s_add_u32 m0, s35, 0
    s_add_u32 s32, s37, 0
    buffer_load_dwordx4 v1, s[16:19], s32 offen lds
    s_add_u32 m0, s35, 1024
    s_add_u32 s32, s37, 0
    buffer_load_dwordx4 v2, s[16:19], s32 offen lds
    s_add_u32 m0, s35, 2048
    s_add_u32 s32, s37, 0
    buffer_load_dwordx4 v3, s[16:19], s32 offen lds
    s_add_u32 m0, s35, 3072
    s_add_u32 s32, s37, 98304
    buffer_load_dwordx4 v1, s[16:19], s32 offen lds
    s_add_u32 m0, s35, 4096
    s_add_u32 s32, s37, 98304
    buffer_load_dwordx4 v2, s[16:19], s32 offen lds
    s_add_u32 m0, s35, 5120
    s_add_u32 s32, s37, 98304
    buffer_load_dwordx4 v3, s[16:19], s32 offen lds
    s_add_u32 m0, s36, 0
    s_add_u32 s32, s39, 0
    buffer_load_dwordx4 v5, s[24:27], s32 offen lds
    s_add_u32 m0, s36, 1024
    s_add_u32 s32, s39, 0
    buffer_load_dwordx4 v6, s[24:27], s32 offen lds
    s_add_u32 m0, s36, 2048
    s_add_u32 s32, s39, 0
    buffer_load_dwordx4 v7, s[24:27], s32 offen lds
    s_add_u32 m0, s36, 3072
    s_add_u32 s32, s39, 0
    buffer_load_dwordx4 v8, s[24:27], s32 offen lds
    s_add_u32 m0, s35, 40960
    s_add_u32 s32, s37, 786432
    buffer_load_dwordx4 v1, s[16:19], s32 offen lds
    s_add_u32 m0, s35, 41984
    s_add_u32 s32, s37, 786432
    buffer_load_dwordx4 v2, s[16:19], s32 offen lds
    s_add_u32 m0, s35, 43008
    s_add_u32 s32, s37, 786432
    buffer_load_dwordx4 v3, s[16:19], s32 offen lds
    s_add_u32 m0, s35, 44032
    s_add_u32 s32, s37, 884736
    buffer_load_dwordx4 v1, s[16:19], s32 offen lds
    s_add_u32 m0, s35, 45056
    s_add_u32 s32, s37, 884736
    buffer_load_dwordx4 v2, s[16:19], s32 offen lds
    s_add_u32 m0, s35, 46080
    s_add_u32 s32, s37, 884736
    buffer_load_dwordx4 v3, s[16:19], s32 offen lds
    s_add_u32 m0, s36, 40960
    s_add_u32 s32, s39, 128
    buffer_load_dwordx4 v5, s[24:27], s32 offen lds
    s_add_u32 m0, s36, 41984
    s_add_u32 s32, s39, 128
    buffer_load_dwordx4 v6, s[24:27], s32 offen lds
    s_add_u32 m0, s36, 43008
    s_add_u32 s32, s39, 128
    buffer_load_dwordx4 v7, s[24:27], s32 offen lds
    s_add_u32 m0, s36, 44032
    s_add_u32 s32, s39, 128
    buffer_load_dwordx4 v8, s[24:27], s32 offen lds
    s_add_u32 m0, s35, 81920
    s_add_u32 s32, s37, 1572864
    buffer_load_dwordx4 v1, s[16:19], s32 offen lds
    s_add_u32 m0, s35, 82944
    s_add_u32 s32, s37, 1572864
    buffer_load_dwordx4 v2, s[16:19], s32 offen lds
    s_add_u32 m0, s35, 83968
    s_add_u32 s32, s37, 1572864
    buffer_load_dwordx4 v3, s[16:19], s32 offen lds
    s_add_u32 m0, s35, 84992
    s_add_u32 s32, s37, 1671168
    buffer_load_dwordx4 v1, s[16:19], s32 offen lds
    s_add_u32 m0, s35, 86016
    s_add_u32 s32, s37, 1671168
    buffer_load_dwordx4 v2, s[16:19], s32 offen lds
    s_add_u32 m0, s35, 87040
    s_add_u32 s32, s37, 1671168
    buffer_load_dwordx4 v3, s[16:19], s32 offen lds
    s_add_u32 m0, s36, 81920
    s_add_u32 s32, s39, 256
    buffer_load_dwordx4 v5, s[24:27], s32 offen lds
    s_add_u32 m0, s36, 82944
    s_add_u32 s32, s39, 256
    buffer_load_dwordx4 v6, s[24:27], s32 offen lds
    s_add_u32 m0, s36, 83968
    s_add_u32 s32, s39, 256
    buffer_load_dwordx4 v7, s[24:27], s32 offen lds
    s_add_u32 m0, s36, 84992
    s_add_u32 s32, s39, 256
    buffer_load_dwordx4 v8, s[24:27], s32 offen lds
    s_add_u32 m0, s35, 122880
    s_add_u32 s32, s37, 2359296
    buffer_load_dwordx4 v1, s[16:19], s32 offen lds
    s_add_u32 m0, s35, 123904
    s_add_u32 s32, s37, 2359296
    buffer_load_dwordx4 v2, s[16:19], s32 offen lds
    s_add_u32 m0, s35, 124928
    s_add_u32 s32, s37, 2359296
    buffer_load_dwordx4 v3, s[16:19], s32 offen lds
    s_add_u32 m0, s35, 125952
    s_add_u32 s32, s37, 2457600
    buffer_load_dwordx4 v1, s[16:19], s32 offen lds
    s_add_u32 m0, s35, 126976
    s_add_u32 s32, s37, 2457600
    buffer_load_dwordx4 v2, s[16:19], s32 offen lds
    s_add_u32 m0, s35, 128000
    s_add_u32 s32, s37, 2457600
    buffer_load_dwordx4 v3, s[16:19], s32 offen lds
    s_add_u32 m0, s36, 122880
    s_add_u32 s32, s39, 384
    buffer_load_dwordx4 v5, s[24:27], s32 offen lds
    s_add_u32 m0, s36, 123904
    s_add_u32 s32, s39, 384
    buffer_load_dwordx4 v6, s[24:27], s32 offen lds
    s_add_u32 m0, s36, 124928
    s_add_u32 s32, s39, 384
    buffer_load_dwordx4 v7, s[24:27], s32 offen lds
    s_add_u32 m0, s36, 125952
    s_add_u32 s32, s39, 384
    buffer_load_dwordx4 v8, s[24:27], s32 offen lds
    s_waitcnt vmcnt(30)
    s_barrier
    ds_read_b128 a[24:27], v13 offset:0
    ds_read_b64_tr_b16 a[0:1], v9 offset:0
    ds_read_b64_tr_b16 a[2:3], v9 offset:1536
    ds_read_b64_tr_b16 a[4:5], v10 offset:0
    ds_read_b64_tr_b16 a[6:7], v10 offset:1536
    ds_read_b64_tr_b16 a[8:9], v9 offset:128
    ds_read_b64_tr_b16 a[10:11], v9 offset:1664
    ds_read_b64_tr_b16 a[12:13], v10 offset:128
    ds_read_b64_tr_b16 a[14:15], v10 offset:1664
    ds_read_b64_tr_b16 a[16:17], v9 offset:256
    ds_read_b64_tr_b16 a[18:19], v9 offset:1792
    ds_read_b64_tr_b16 a[20:21], v10 offset:256
    ds_read_b64_tr_b16 a[22:23], v10 offset:1792
wtop_9:
    s_waitcnt lgkmcnt(10)
    v_mfma_f32_32x32x16_bf16 v[32:47], a[0:3], a[24:27], 0
    ds_read_b128 a[52:55], v14 offset:0
    ds_read_b64_tr_b16 a[28:29], v9 offset:6144
    ds_read_b64_tr_b16 a[30:31], v9 offset:7680
    s_waitcnt lgkmcnt(11)
    v_mfma_f32_32x32x16_bf16 v[48:63], a[4:7], a[24:27], 0
    ds_read_b64_tr_b16 a[32:33], v10 offset:6144
    ds_read_b64_tr_b16 a[34:35], v10 offset:7680
    ds_read_b64_tr_b16 a[36:37], v9 offset:6272
    s_waitcnt lgkmcnt(12)
    v_mfma_f32_32x32x16_bf16 v[64:79], a[8:11], a[24:27], 0
    ds_read_b64_tr_b16 a[38:39], v9 offset:7808
    ds_read_b64_tr_b16 a[40:41], v10 offset:6272
    ds_read_b64_tr_b16 a[42:43], v10 offset:7808
    s_waitcnt lgkmcnt(13)
    v_mfma_f32_32x32x16_bf16 v[80:95], a[12:15], a[24:27], 0
    ds_read_b64_tr_b16 a[44:45], v9 offset:6400
    ds_read_b64_tr_b16 a[46:47], v9 offset:7936
    ds_read_b64_tr_b16 a[48:49], v10 offset:6400
    s_waitcnt lgkmcnt(14)
    v_mfma_f32_32x32x16_bf16 v[96:111], a[16:19], a[24:27], 0
    ds_read_b64_tr_b16 a[50:51], v10 offset:7936
    s_waitcnt lgkmcnt(13)
    v_mfma_f32_32x32x16_bf16 v[112:127], a[20:23], a[24:27], 0
    s_waitcnt lgkmcnt(10)
    v_mfma_f32_32x32x16_bf16 v[32:47], a[28:31], a[52:55], v[32:47]
    ds_read_b128 a[24:27], v15 offset:0
    ds_read_b64_tr_b16 a[0:1], v9 offset:12288
    ds_read_b64_tr_b16 a[2:3], v9 offset:13824
    s_waitcnt lgkmcnt(11)
    v_mfma_f32_32x32x16_bf16 v[48:63], a[32:35], a[52:55], v[48:63]
    ds_read_b64_tr_b16 a[4:5], v10 offset:12288
    ds_read_b64_tr_b16 a[6:7], v10 offset:13824
    ds_read_b64_tr_b16 a[8:9], v9 offset:12416
    s_waitcnt lgkmcnt(12)
    v_mfma_f32_32x32x16_bf16 v[64:79], a[36:39], a[52:55], v[64:79]
    ds_read_b64_tr_b16 a[10:11], v9 offset:13952
    ds_read_b64_tr_b16 a[12:13], v10 offset:12416
    ds_read_b64_tr_b16 a[14:15], v10 offset:13952
    s_waitcnt lgkmcnt(13)
    v_mfma_f32_32x32x16_bf16 v[80:95], a[40:43], a[52:55], v[80:95]
    ds_read_b64_tr_b16 a[16:17], v9 offset:12544
    ds_read_b64_tr_b16 a[18:19], v9 offset:14080
    ds_read_b64_tr_b16 a[20:21], v10 offset:12544
    s_waitcnt lgkmcnt(14)
    v_mfma_f32_32x32x16_bf16 v[96:111], a[44:47], a[52:55], v[96:111]
    ds_read_b64_tr_b16 a[22:23], v10 offset:14080
    s_waitcnt lgkmcnt(13)
    v_mfma_f32_32x32x16_bf16 v[112:127], a[48:51], a[52:55], v[112:127]
    s_waitcnt lgkmcnt(10)
    v_mfma_f32_32x32x16_bf16 v[32:47], a[0:3], a[24:27], v[32:47]
    ds_read_b128 a[52:55], v16 offset:0
    ds_read_b64_tr_b16 a[28:29], v9 offset:18432
    ds_read_b64_tr_b16 a[30:31], v9 offset:19968
    s_waitcnt lgkmcnt(11)
    v_mfma_f32_32x32x16_bf16 v[48:63], a[4:7], a[24:27], v[48:63]
    ds_read_b64_tr_b16 a[32:33], v10 offset:18432
    ds_read_b64_tr_b16 a[34:35], v10 offset:19968
    ds_read_b64_tr_b16 a[36:37], v9 offset:18560
    s_waitcnt lgkmcnt(12)
    v_mfma_f32_32x32x16_bf16 v[64:79], a[8:11], a[24:27], v[64:79]
    ds_read_b64_tr_b16 a[38:39], v9 offset:20096
    ds_read_b64_tr_b16 a[40:41], v10 offset:18560
    ds_read_b64_tr_b16 a[42:43], v10 offset:20096
    s_waitcnt lgkmcnt(13)
    v_mfma_f32_32x32x16_bf16 v[80:95], a[12:15], a[24:27], v[80:95]
    ds_read_b64_tr_b16 a[44:45], v9 offset:18688
    ds_read_b64_tr_b16 a[46:47], v9 offset:20224
    ds_read_b64_tr_b16 a[48:49], v10 offset:18688
    s_waitcnt lgkmcnt(14)
    v_mfma_f32_32x32x16_bf16 v[96:111], a[16:19], a[24:27], v[96:111]
    ds_read_b64_tr_b16 a[50:51], v10 offset:20224
    s_waitcnt lgkmcnt(13)
    v_mfma_f32_32x32x16_bf16 v[112:127], a[20:23], a[24:27], v[112:127]
    s_waitcnt lgkmcnt(0)
    s_waitcnt vmcnt(20)
    s_barrier
    v_mfma_f32_32x32x16_bf16 v[32:47], a[28:31], a[52:55], v[32:47]
    ds_read_b128 a[24:27], v13 offset:40960
    ds_read_b64_tr_b16 a[0:1], v9 offset:40960
    ds_read_b64_tr_b16 a[2:3], v9 offset:42496
    v_mfma_f32_32x32x16_bf16 v[48:63], a[32:35], a[52:55], v[48:63]
    ds_read_b64_tr_b16 a[4:5], v10 offset:40960
    ds_read_b64_tr_b16 a[6:7], v10 offset:42496
    ds_read_b64_tr_b16 a[8:9], v9 offset:41088
    s_add_u32 m0, s35, 0
    s_add_u32 s32, s37, 3145728
    buffer_load_dwordx4 v1, s[16:19], s32 offen lds
    v_mfma_f32_32x32x16_bf16 v[64:79], a[36:39], a[52:55], v[64:79]
    ds_read_b64_tr_b16 a[10:11], v9 offset:42624
    ds_read_b64_tr_b16 a[12:13], v10 offset:41088
    ds_read_b64_tr_b16 a[14:15], v10 offset:42624
    v_mfma_f32_32x32x16_bf16 v[80:95], a[40:43], a[52:55], v[80:95]
    ds_read_b64_tr_b16 a[16:17], v9 offset:41216
    ds_read_b64_tr_b16 a[18:19], v9 offset:42752
    ds_read_b64_tr_b16 a[20:21], v10 offset:41216
    s_add_u32 m0, s35, 1024
    s_add_u32 s32, s37, 3145728
    buffer_load_dwordx4 v2, s[16:19], s32 offen lds
    v_mfma_f32_32x32x16_bf16 v[96:111], a[44:47], a[52:55], v[96:111]
    ds_read_b64_tr_b16 a[22:23], v10 offset:42752
    v_mfma_f32_32x32x16_bf16 v[112:127], a[48:51], a[52:55], v[112:127]
    s_add_u32 m0, s35, 2048
    s_add_u32 s32, s37, 3145728
    buffer_load_dwordx4 v3, s[16:19], s32 offen lds
    s_waitcnt lgkmcnt(10)
    v_mfma_f32_32x32x16_bf16 v[32:47], a[0:3], a[24:27], v[32:47]
    ds_read_b128 a[52:55], v14 offset:40960
    ds_read_b64_tr_b16 a[28:29], v9 offset:47104
    ds_read_b64_tr_b16 a[30:31], v9 offset:48640
    s_waitcnt lgkmcnt(11)
    v_mfma_f32_32x32x16_bf16 v[48:63], a[4:7], a[24:27], v[48:63]
    ds_read_b64_tr_b16 a[32:33], v10 offset:47104
    ds_read_b64_tr_b16 a[34:35], v10 offset:48640
    ds_read_b64_tr_b16 a[36:37], v9 offset:47232
    s_add_u32 m0, s35, 3072
    s_add_u32 s32, s37, 3244032
    buffer_load_dwordx4 v1, s[16:19], s32 offen lds
    s_waitcnt lgkmcnt(12)
    v_mfma_f32_32x32x16_bf16 v[64:79], a[8:11], a[24:27], v[64:79]
    ds_read_b64_tr_b16 a[38:39], v9 offset:48768
    ds_read_b64_tr_b16 a[40:41], v10 offset:47232
    ds_read_b64_tr_b16 a[42:43], v10 offset:48768
    s_waitcnt lgkmcnt(13)
    v_mfma_f32_32x32x16_bf16 v[80:95], a[12:15], a[24:27], v[80:95]
    ds_read_b64_tr_b16 a[44:45], v9 offset:47360
    ds_read_b64_tr_b16 a[46:47], v9 offset:48896
    ds_read_b64_tr_b16 a[48:49], v10 offset:47360
    s_add_u32 m0, s35, 4096
    s_add_u32 s32, s37, 3244032
    buffer_load_dwordx4 v2, s[16:19], s32 offen lds
    s_waitcnt lgkmcnt(14)
    v_mfma_f32_32x32x16_bf16 v[96:111], a[16:19], a[24:27], v[96:111]
    ds_read_b64_tr_b16 a[50:51], v10 offset:48896
    s_waitcnt lgkmcnt(13)
    v_mfma_f32_32x32x16_bf16 v[112:127], a[20:23], a[24:27], v[112:127]
    s_add_u32 m0, s35, 5120
    s_add_u32 s32, s37, 3244032
    buffer_load_dwordx4 v3, s[16:19], s32 offen lds
    s_waitcnt lgkmcnt(10)
    v_mfma_f32_32x32x16_bf16 v[32:47], a[28:31], a[52:55], v[32:47]
    ds_read_b128 a[24:27], v15 offset:40960
    ds_read_b64_tr_b16 a[0:1], v9 offset:53248
    ds_read_b64_tr_b16 a[2:3], v9 offset:54784
    s_waitcnt lgkmcnt(11)
    v_mfma_f32_32x32x16_bf16 v[48:63], a[32:35], a[52:55], v[48:63]
    ds_read_b64_tr_b16 a[4:5], v10 offset:53248
    ds_read_b64_tr_b16 a[6:7], v10 offset:54784
    ds_read_b64_tr_b16 a[8:9], v9 offset:53376
    s_add_u32 m0, s36, 0
    s_add_u32 s32, s39, 512
    buffer_load_dwordx4 v5, s[24:27], s32 offen lds
    s_waitcnt lgkmcnt(12)
    v_mfma_f32_32x32x16_bf16 v[64:79], a[36:39], a[52:55], v[64:79]
    ds_read_b64_tr_b16 a[10:11], v9 offset:54912
    ds_read_b64_tr_b16 a[12:13], v10 offset:53376
    ds_read_b64_tr_b16 a[14:15], v10 offset:54912
    s_waitcnt lgkmcnt(13)
    v_mfma_f32_32x32x16_bf16 v[80:95], a[40:43], a[52:55], v[80:95]
    ds_read_b64_tr_b16 a[16:17], v9 offset:53504
    ds_read_b64_tr_b16 a[18:19], v9 offset:55040
    ds_read_b64_tr_b16 a[20:21], v10 offset:53504
    s_add_u32 m0, s36, 1024
    s_add_u32 s32, s39, 512
    buffer_load_dwordx4 v6, s[24:27], s32 offen lds
    s_waitcnt lgkmcnt(14)
    v_mfma_f32_32x32x16_bf16 v[96:111], a[44:47], a[52:55], v[96:111]
    ds_read_b64_tr_b16 a[22:23], v10 offset:55040
    s_waitcnt lgkmcnt(13)
    v_mfma_f32_32x32x16_bf16 v[112:127], a[48:51], a[52:55], v[112:127]
    s_add_u32 m0, s36, 2048
    s_add_u32 s32, s39, 512
    buffer_load_dwordx4 v7, s[24:27], s32 offen lds
    s_waitcnt lgkmcnt(10)
    v_mfma_f32_32x32x16_bf16 v[32:47], a[0:3], a[24:27], v[32:47]
    ds_read_b128 a[52:55], v16 offset:40960
    ds_read_b64_tr_b16 a[28:29], v9 offset:59392
    ds_read_b64_tr_b16 a[30:31], v9 offset:60928
    s_waitcnt lgkmcnt(11)
    v_mfma_f32_32x32x16_bf16 v[48:63], a[4:7], a[24:27], v[48:63]
    ds_read_b64_tr_b16 a[32:33], v10 offset:59392
    ds_read_b64_tr_b16 a[34:35], v10 offset:60928
    ds_read_b64_tr_b16 a[36:37], v9 offset:59520
    s_add_u32 m0, s36, 3072
    s_add_u32 s32, s39, 512
    buffer_load_dwordx4 v8, s[24:27], s32 offen lds
    s_waitcnt lgkmcnt(12)
    v_mfma_f32_32x32x16_bf16 v[64:79], a[8:11], a[24:27], v[64:79]
    ds_read_b64_tr_b16 a[38:39], v9 offset:61056
    ds_read_b64_tr_b16 a[40:41], v10 offset:59520
    ds_read_b64_tr_b16 a[42:43], v10 offset:61056
    s_waitcnt lgkmcnt(13)
    v_mfma_f32_32x32x16_bf16 v[80:95], a[12:15], a[24:27], v[80:95]
    ds_read_b64_tr_b16 a[44:45], v9 offset:59648
    ds_read_b64_tr_b16 a[46:47], v9 offset:61184
    ds_read_b64_tr_b16 a[48:49], v10 offset:59648
    s_waitcnt lgkmcnt(14)
    v_mfma_f32_32x32x16_bf16 v[96:111], a[16:19], a[24:27], v[96:111]
    ds_read_b64_tr_b16 a[50:51], v10 offset:61184
    s_waitcnt lgkmcnt(13)
    v_mfma_f32_32x32x16_bf16 v[112:127], a[20:23], a[24:27], v[112:127]
    s_waitcnt lgkmcnt(0)
    s_waitcnt vmcnt(20)
    s_barrier
    v_mfma_f32_32x32x16_bf16 v[32:47], a[28:31], a[52:55], v[32:47]
    ds_read_b128 a[24:27], v17 offset:0
    ds_read_b64_tr_b16 a[0:1], v11 offset:0
    ds_read_b64_tr_b16 a[2:3], v11 offset:1536
    v_mfma_f32_32x32x16_bf16 v[48:63], a[32:35], a[52:55], v[48:63]
    ds_read_b64_tr_b16 a[4:5], v12 offset:0
    ds_read_b64_tr_b16 a[6:7], v12 offset:1536
    ds_read_b64_tr_b16 a[8:9], v11 offset:128
    s_add_u32 m0, s35, 40960
    s_add_u32 s32, s37, 3932160
    buffer_load_dwordx4 v1, s[16:19], s32 offen lds
    v_mfma_f32_32x32x16_bf16 v[64:79], a[36:39], a[52:55], v[64:79]
    ds_read_b64_tr_b16 a[10:11], v11 offset:1664
    ds_read_b64_tr_b16 a[12:13], v12 offset:128
    ds_read_b64_tr_b16 a[14:15], v12 offset:1664
    v_mfma_f32_32x32x16_bf16 v[80:95], a[40:43], a[52:55], v[80:95]
    ds_read_b64_tr_b16 a[16:17], v11 offset:256
    ds_read_b64_tr_b16 a[18:19], v11 offset:1792
    ds_read_b64_tr_b16 a[20:21], v12 offset:256
    s_add_u32 m0, s35, 41984
    s_add_u32 s32, s37, 3932160
    buffer_load_dwordx4 v2, s[16:19], s32 offen lds
    v_mfma_f32_32x32x16_bf16 v[96:111], a[44:47], a[52:55], v[96:111]
    ds_read_b64_tr_b16 a[22:23], v12 offset:1792
    v_mfma_f32_32x32x16_bf16 v[112:127], a[48:51], a[52:55], v[112:127]
    s_add_u32 m0, s35, 43008
    s_add_u32 s32, s37, 3932160
    buffer_load_dwordx4 v3, s[16:19], s32 offen lds
    s_waitcnt lgkmcnt(10)
    v_mfma_f32_32x32x16_bf16 v[32:47], a[0:3], a[24:27], v[32:47]
    ds_read_b128 a[52:55], v18 offset:0
    ds_read_b64_tr_b16 a[28:29], v11 offset:6144
    ds_read_b64_tr_b16 a[30:31], v11 offset:7680
    s_waitcnt lgkmcnt(11)
    v_mfma_f32_32x32x16_bf16 v[48:63], a[4:7], a[24:27], v[48:63]
    ds_read_b64_tr_b16 a[32:33], v12 offset:6144
    ds_read_b64_tr_b16 a[34:35], v12 offset:7680
    ds_read_b64_tr_b16 a[36:37], v11 offset:6272
    s_add_u32 m0, s35, 44032
    s_add_u32 s32, s37, 4030464
    buffer_load_dwordx4 v1, s[16:19], s32 offen lds
    s_waitcnt lgkmcnt(12)
    v_mfma_f32_32x32x16_bf16 v[64:79], a[8:11], a[24:27], v[64:79]
    ds_read_b64_tr_b16 a[38:39], v11 offset:7808
    ds_read_b64_tr_b16 a[40:41], v12 offset:6272
    ds_read_b64_tr_b16 a[42:43], v12 offset:7808
    s_waitcnt lgkmcnt(13)
    v_mfma_f32_32x32x16_bf16 v[80:95], a[12:15], a[24:27], v[80:95]
    ds_read_b64_tr_b16 a[44:45], v11 offset:6400
    ds_read_b64_tr_b16 a[46:47], v11 offset:7936
    ds_read_b64_tr_b16 a[48:49], v12 offset:6400
    s_add_u32 m0, s35, 45056
    s_add_u32 s32, s37, 4030464
    buffer_load_dwordx4 v2, s[16:19], s32 offen lds
    s_waitcnt lgkmcnt(14)
    v_mfma_f32_32x32x16_bf16 v[96:111], a[16:19], a[24:27], v[96:111]
    ds_read_b64_tr_b16 a[50:51], v12 offset:7936
    s_waitcnt lgkmcnt(13)
    v_mfma_f32_32x32x16_bf16 v[112:127], a[20:23], a[24:27], v[112:127]
    s_add_u32 m0, s35, 46080
    s_add_u32 s32, s37, 4030464
    buffer_load_dwordx4 v3, s[16:19], s32 offen lds
    s_waitcnt lgkmcnt(10)
    v_mfma_f32_32x32x16_bf16 v[32:47], a[28:31], a[52:55], v[32:47]
    ds_read_b128 a[24:27], v19 offset:0
    ds_read_b64_tr_b16 a[0:1], v11 offset:12288
    ds_read_b64_tr_b16 a[2:3], v11 offset:13824
    s_waitcnt lgkmcnt(11)
    v_mfma_f32_32x32x16_bf16 v[48:63], a[32:35], a[52:55], v[48:63]
    ds_read_b64_tr_b16 a[4:5], v12 offset:12288
    ds_read_b64_tr_b16 a[6:7], v12 offset:13824
    ds_read_b64_tr_b16 a[8:9], v11 offset:12416
    s_add_u32 m0, s36, 40960
    s_add_u32 s32, s39, 640
    buffer_load_dwordx4 v5, s[24:27], s32 offen lds
    s_waitcnt lgkmcnt(12)
    v_mfma_f32_32x32x16_bf16 v[64:79], a[36:39], a[52:55], v[64:79]
    ds_read_b64_tr_b16 a[10:11], v11 offset:13952
    ds_read_b64_tr_b16 a[12:13], v12 offset:12416
    ds_read_b64_tr_b16 a[14:15], v12 offset:13952
    s_waitcnt lgkmcnt(13)
    v_mfma_f32_32x32x16_bf16 v[80:95], a[40:43], a[52:55], v[80:95]
    ds_read_b64_tr_b16 a[16:17], v11 offset:12544
    ds_read_b64_tr_b16 a[18:19], v11 offset:14080
    ds_read_b64_tr_b16 a[20:21], v12 offset:12544
    s_add_u32 m0, s36, 41984
    s_add_u32 s32, s39, 640
    buffer_load_dwordx4 v6, s[24:27], s32 offen lds
    s_waitcnt lgkmcnt(14)
    v_mfma_f32_32x32x16_bf16 v[96:111], a[44:47], a[52:55], v[96:111]
    ds_read_b64_tr_b16 a[22:23], v12 offset:14080
    s_waitcnt lgkmcnt(13)
    v_mfma_f32_32x32x16_bf16 v[112:127], a[48:51], a[52:55], v[112:127]
    s_add_u32 m0, s36, 43008
    s_add_u32 s32, s39, 640
    buffer_load_dwordx4 v7, s[24:27], s32 offen lds
    s_waitcnt lgkmcnt(10)
    v_mfma_f32_32x32x16_bf16 v[32:47], a[0:3], a[24:27], v[32:47]
    ds_read_b128 a[52:55], v20 offset:0
    ds_read_b64_tr_b16 a[28:29], v11 offset:18432
    ds_read_b64_tr_b16 a[30:31], v11 offset:19968
    s_waitcnt lgkmcnt(11)
    v_mfma_f32_32x32x16_bf16 v[48:63], a[4:7], a[24:27], v[48:63]
    ds_read_b64_tr_b16 a[32:33], v12 offset:18432
    ds_read_b64_tr_b16 a[34:35], v12 offset:19968
    ds_read_b64_tr_b16 a[36:37], v11 offset:18560
    s_add_u32 m0, s36, 44032
    s_add_u32 s32, s39, 640
    buffer_load_dwordx4 v8, s[24:27], s32 offen lds
    s_waitcnt lgkmcnt(12)
    v_mfma_f32_32x32x16_bf16 v[64:79], a[8:11], a[24:27], v[64:79]
    ds_read_b64_tr_b16 a[38:39], v11 offset:20096
    ds_read_b64_tr_b16 a[40:41], v12 offset:18560
    ds_read_b64_tr_b16 a[42:43], v12 offset:20096
    s_waitcnt lgkmcnt(13)
    v_mfma_f32_32x32x16_bf16 v[80:95], a[12:15], a[24:27], v[80:95]
    ds_read_b64_tr_b16 a[44:45], v11 offset:18688
    ds_read_b64_tr_b16 a[46:47], v11 offset:20224
    ds_read_b64_tr_b16 a[48:49], v12 offset:18688
    s_waitcnt lgkmcnt(14)
    v_mfma_f32_32x32x16_bf16 v[96:111], a[16:19], a[24:27], v[96:111]
    ds_read_b64_tr_b16 a[50:51], v12 offset:20224
    s_waitcnt lgkmcnt(13)
    v_mfma_f32_32x32x16_bf16 v[112:127], a[20:23], a[24:27], v[112:127]
    s_waitcnt lgkmcnt(0)
    s_waitcnt vmcnt(20)
    s_barrier
    v_mfma_f32_32x32x16_bf16 v[32:47], a[28:31], a[52:55], v[32:47]
    ds_read_b128 a[24:27], v17 offset:40960
    ds_read_b64_tr_b16 a[0:1], v11 offset:40960
    ds_read_b64_tr_b16 a[2:3], v11 offset:42496
    v_mfma_f32_32x32x16_bf16 v[48:63], a[32:35], a[52:55], v[48:63]
    ds_read_b64_tr_b16 a[4:5], v12 offset:40960
    ds_read_b64_tr_b16 a[6:7], v12 offset:42496
    ds_read_b64_tr_b16 a[8:9], v11 offset:41088
    s_add_u32 m0, s35, 81920
    s_add_u32 s32, s37, 4718592
    buffer_load_dwordx4 v1, s[16:19], s32 offen lds
    v_mfma_f32_32x32x16_bf16 v[64:79], a[36:39], a[52:55], v[64:79]
    ds_read_b64_tr_b16 a[10:11], v11 offset:42624
    ds_read_b64_tr_b16 a[12:13], v12 offset:41088
    ds_read_b64_tr_b16 a[14:15], v12 offset:42624
    v_mfma_f32_32x32x16_bf16 v[80:95], a[40:43], a[52:55], v[80:95]
    ds_read_b64_tr_b16 a[16:17], v11 offset:41216
    ds_read_b64_tr_b16 a[18:19], v11 offset:42752
    ds_read_b64_tr_b16 a[20:21], v12 offset:41216
    s_add_u32 m0, s35, 82944
    s_add_u32 s32, s37, 4718592
    buffer_load_dwordx4 v2, s[16:19], s32 offen lds
    v_mfma_f32_32x32x16_bf16 v[96:111], a[44:47], a[52:55], v[96:111]
    ds_read_b64_tr_b16 a[22:23], v12 offset:42752
    v_mfma_f32_32x32x16_bf16 v[112:127], a[48:51], a[52:55], v[112:127]
    s_add_u32 m0, s35, 83968
    s_add_u32 s32, s37, 4718592
    buffer_load_dwordx4 v3, s[16:19], s32 offen lds
    s_waitcnt lgkmcnt(10)
    v_mfma_f32_32x32x16_bf16 v[32:47], a[0:3], a[24:27], v[32:47]
    ds_read_b128 a[52:55], v18 offset:40960
    ds_read_b64_tr_b16 a[28:29], v11 offset:47104
    ds_read_b64_tr_b16 a[30:31], v11 offset:48640
    s_waitcnt lgkmcnt(11)
    v_mfma_f32_32x32x16_bf16 v[48:63], a[4:7], a[24:27], v[48:63]
    ds_read_b64_tr_b16 a[32:33], v12 offset:47104
    ds_read_b64_tr_b16 a[34:35], v12 offset:48640
    ds_read_b64_tr_b16 a[36:37], v11 offset:47232
    s_add_u32 m0, s35, 84992
    s_add_u32 s32, s37, 4816896
    buffer_load_dwordx4 v1, s[16:19], s32 offen lds
    s_waitcnt lgkmcnt(12)
    v_mfma_f32_32x32x16_bf16 v[64:79], a[8:11], a[24:27], v[64:79]
    ds_read_b64_tr_b16 a[38:39], v11 offset:48768
    ds_read_b64_tr_b16 a[40:41], v12 offset:47232
    ds_read_b64_tr_b16 a[42:43], v12 offset:48768
    s_waitcnt lgkmcnt(13)
    v_mfma_f32_32x32x16_bf16 v[80:95], a[12:15], a[24:27], v[80:95]
    ds_read_b64_tr_b16 a[44:45], v11 offset:47360
    ds_read_b64_tr_b16 a[46:47], v11 offset:48896
    ds_read_b64_tr_b16 a[48:49], v12 offset:47360
    s_add_u32 m0, s35, 86016
    s_add_u32 s32, s37, 4816896
    buffer_load_dwordx4 v2, s[16:19], s32 offen lds
    s_waitcnt lgkmcnt(14)
    v_mfma_f32_32x32x16_bf16 v[96:111], a[16:19], a[24:27], v[96:111]
    ds_read_b64_tr_b16 a[50:51], v12 offset:48896
    s_waitcnt lgkmcnt(13)
    v_mfma_f32_32x32x16_bf16 v[112:127], a[20:23], a[24:27], v[112:127]
    s_add_u32 m0, s35, 87040
    s_add_u32 s32, s37, 4816896
    buffer_load_dwordx4 v3, s[16:19], s32 offen lds
    s_waitcnt lgkmcnt(10)
    v_mfma_f32_32x32x16_bf16 v[32:47], a[28:31], a[52:55], v[32:47]
    ds_read_b128 a[24:27], v19 offset:40960
    ds_read_b64_tr_b16 a[0:1], v11 offset:53248
    ds_read_b64_tr_b16 a[2:3], v11 offset:54784
    s_waitcnt lgkmcnt(11)
    v_mfma_f32_32x32x16_bf16 v[48:63], a[32:35], a[52:55], v[48:63]
    ds_read_b64_tr_b16 a[4:5], v12 offset:53248
    ds_read_b64_tr_b16 a[6:7], v12 offset:54784
    ds_read_b64_tr_b16 a[8:9], v11 offset:53376
    s_add_u32 m0, s36, 81920
    s_add_u32 s32, s39, 768
    buffer_load_dwordx4 v5, s[24:27], s32 offen lds
    s_waitcnt lgkmcnt(12)
    v_mfma_f32_32x32x16_bf16 v[64:79], a[36:39], a[52:55], v[64:79]
    ds_read_b64_tr_b16 a[10:11], v11 offset:54912
    ds_read_b64_tr_b16 a[12:13], v12 offset:53376
    ds_read_b64_tr_b16 a[14:15], v12 offset:54912
    s_waitcnt lgkmcnt(13)
    v_mfma_f32_32x32x16_bf16 v[80:95], a[40:43], a[52:55], v[80:95]
    ds_read_b64_tr_b16 a[16:17], v11 offset:53504
    ds_read_b64_tr_b16 a[18:19], v11 offset:55040
    ds_read_b64_tr_b16 a[20:21], v12 offset:53504
    s_add_u32 m0, s36, 82944
    s_add_u32 s32, s39, 768
    buffer_load_dwordx4 v6, s[24:27], s32 offen lds
    s_waitcnt lgkmcnt(14)
    v_mfma_f32_32x32x16_bf16 v[96:111], a[44:47], a[52:55], v[96:111]
    ds_read_b64_tr_b16 a[22:23], v12 offset:55040
    s_waitcnt lgkmcnt(13)
    v_mfma_f32_32x32x16_bf16 v[112:127], a[48:51], a[52:55], v[112:127]
    s_add_u32 m0, s36, 83968
    s_add_u32 s32, s39, 768
    buffer_load_dwordx4 v7, s[24:27], s32 offen lds
    s_waitcnt lgkmcnt(10)
    v_mfma_f32_32x32x16_bf16 v[32:47], a[0:3], a[24:27], v[32:47]
    ds_read_b128 a[52:55], v20 offset:40960
    ds_read_b64_tr_b16 a[28:29], v11 offset:59392
    ds_read_b64_tr_b16 a[30:31], v11 offset:60928
    s_waitcnt lgkmcnt(11)
    v_mfma_f32_32x32x16_bf16 v[48:63], a[4:7], a[24:27], v[48:63]
    ds_read_b64_tr_b16 a[32:33], v12 offset:59392
    ds_read_b64_tr_b16 a[34:35], v12 offset:60928
    ds_read_b64_tr_b16 a[36:37], v11 offset:59520
    s_add_u32 m0, s36, 84992
    s_add_u32 s32, s39, 768
    buffer_load_dwordx4 v8, s[24:27], s32 offen lds
    s_waitcnt lgkmcnt(12)
    v_mfma_f32_32x32x16_bf16 v[64:79], a[8:11], a[24:27], v[64:79]
    ds_read_b64_tr_b16 a[38:39], v11 offset:61056
    ds_read_b64_tr_b16 a[40:41], v12 offset:59520
    ds_read_b64_tr_b16 a[42:43], v12 offset:61056
    s_waitcnt lgkmcnt(13)
    v_mfma_f32_32x32x16_bf16 v[80:95], a[12:15], a[24:27], v[80:95]
    ds_read_b64_tr_b16 a[44:45], v11 offset:59648
    ds_read_b64_tr_b16 a[46:47], v11 offset:61184
    ds_read_b64_tr_b16 a[48:49], v12 offset:59648
    s_waitcnt lgkmcnt(14)
    v_mfma_f32_32x32x16_bf16 v[96:111], a[16:19], a[24:27], v[96:111]
    ds_read_b64_tr_b16 a[50:51], v12 offset:61184
    s_waitcnt lgkmcnt(13)
    v_mfma_f32_32x32x16_bf16 v[112:127], a[20:23], a[24:27], v[112:127]
    s_waitcnt lgkmcnt(0)
    s_waitcnt vmcnt(20)
    s_barrier
    v_mfma_f32_32x32x16_bf16 v[32:47], a[28:31], a[52:55], v[32:47]
    ds_read_b128 a[24:27], v13 offset:0
    ds_read_b64_tr_b16 a[0:1], v9 offset:0
    ds_read_b64_tr_b16 a[2:3], v9 offset:1536
    v_mfma_f32_32x32x16_bf16 v[48:63], a[32:35], a[52:55], v[48:63]
    ds_read_b64_tr_b16 a[4:5], v10 offset:0
    ds_read_b64_tr_b16 a[6:7], v10 offset:1536
    ds_read_b64_tr_b16 a[8:9], v9 offset:128
    s_add_u32 m0, s35, 122880
    s_add_u32 s32, s37, 5505024
    buffer_load_dwordx4 v1, s[16:19], s32 offen lds
    v_mfma_f32_32x32x16_bf16 v[64:79], a[36:39], a[52:55], v[64:79]
    ds_read_b64_tr_b16 a[10:11], v9 offset:1664
    ds_read_b64_tr_b16 a[12:13], v10 offset:128
    ds_read_b64_tr_b16 a[14:15], v10 offset:1664
    v_mfma_f32_32x32x16_bf16 v[80:95], a[40:43], a[52:55], v[80:95]
    ds_read_b64_tr_b16 a[16:17], v9 offset:256
    ds_read_b64_tr_b16 a[18:19], v9 offset:1792
    ds_read_b64_tr_b16 a[20:21], v10 offset:256
    s_add_u32 m0, s35, 123904
    s_add_u32 s32, s37, 5505024
    buffer_load_dwordx4 v2, s[16:19], s32 offen lds
    v_mfma_f32_32x32x16_bf16 v[96:111], a[44:47], a[52:55], v[96:111]
    ds_read_b64_tr_b16 a[22:23], v10 offset:1792
    v_mfma_f32_32x32x16_bf16 v[112:127], a[48:51], a[52:55], v[112:127]
    s_add_u32 m0, s35, 124928
    s_add_u32 s32, s37, 5505024
    buffer_load_dwordx4 v3, s[16:19], s32 offen lds
    s_waitcnt lgkmcnt(10)
    v_mfma_f32_32x32x16_bf16 v[32:47], a[0:3], a[24:27], v[32:47]
    ds_read_b128 a[52:55], v14 offset:0
    ds_read_b64_tr_b16 a[28:29], v9 offset:6144
    ds_read_b64_tr_b16 a[30:31], v9 offset:7680
    s_waitcnt lgkmcnt(11)
    v_mfma_f32_32x32x16_bf16 v[48:63], a[4:7], a[24:27], v[48:63]
    ds_read_b64_tr_b16 a[32:33], v10 offset:6144
    ds_read_b64_tr_b16 a[34:35], v10 offset:7680
    ds_read_b64_tr_b16 a[36:37], v9 offset:6272
    s_add_u32 m0, s35, 125952
    s_add_u32 s32, s37, 5603328
    buffer_load_dwordx4 v1, s[16:19], s32 offen lds
    s_waitcnt lgkmcnt(12)
    v_mfma_f32_32x32x16_bf16 v[64:79], a[8:11], a[24:27], v[64:79]
    ds_read_b64_tr_b16 a[38:39], v9 offset:7808
    ds_read_b64_tr_b16 a[40:41], v10 offset:6272
    ds_read_b64_tr_b16 a[42:43], v10 offset:7808
    s_waitcnt lgkmcnt(13)
    v_mfma_f32_32x32x16_bf16 v[80:95], a[12:15], a[24:27], v[80:95]
    ds_read_b64_tr_b16 a[44:45], v9 offset:6400
    ds_read_b64_tr_b16 a[46:47], v9 offset:7936
    ds_read_b64_tr_b16 a[48:49], v10 offset:6400
    s_add_u32 m0, s35, 126976
    s_add_u32 s32, s37, 5603328
    buffer_load_dwordx4 v2, s[16:19], s32 offen lds
    s_waitcnt lgkmcnt(14)
    v_mfma_f32_32x32x16_bf16 v[96:111], a[16:19], a[24:27], v[96:111]
    ds_read_b64_tr_b16 a[50:51], v10 offset:7936
    s_waitcnt lgkmcnt(13)
    v_mfma_f32_32x32x16_bf16 v[112:127], a[20:23], a[24:27], v[112:127]
    s_add_u32 m0, s35, 128000
    s_add_u32 s32, s37, 5603328
    buffer_load_dwordx4 v3, s[16:19], s32 offen lds
    s_waitcnt lgkmcnt(10)
    v_mfma_f32_32x32x16_bf16 v[32:47], a[28:31], a[52:55], v[32:47]
    ds_read_b128 a[24:27], v15 offset:0
    ds_read_b64_tr_b16 a[0:1], v9 offset:12288
    ds_read_b64_tr_b16 a[2:3], v9 offset:13824
    s_waitcnt lgkmcnt(11)
    v_mfma_f32_32x32x16_bf16 v[48:63], a[32:35], a[52:55], v[48:63]
    ds_read_b64_tr_b16 a[4:5], v10 offset:12288
    ds_read_b64_tr_b16 a[6:7], v10 offset:13824
    ds_read_b64_tr_b16 a[8:9], v9 offset:12416
    s_add_u32 m0, s36, 122880
    s_add_u32 s32, s39, 896
    buffer_load_dwordx4 v5, s[24:27], s32 offen lds
    s_waitcnt lgkmcnt(12)
    v_mfma_f32_32x32x16_bf16 v[64:79], a[36:39], a[52:55], v[64:79]
    ds_read_b64_tr_b16 a[10:11], v9 offset:13952
    ds_read_b64_tr_b16 a[12:13], v10 offset:12416
    ds_read_b64_tr_b16 a[14:15], v10 offset:13952
    s_waitcnt lgkmcnt(13)
    v_mfma_f32_32x32x16_bf16 v[80:95], a[40:43], a[52:55], v[80:95]
    ds_read_b64_tr_b16 a[16:17], v9 offset:12544
    ds_read_b64_tr_b16 a[18:19], v9 offset:14080
    ds_read_b64_tr_b16 a[20:21], v10 offset:12544
    s_add_u32 m0, s36, 123904
    s_add_u32 s32, s39, 896
    buffer_load_dwordx4 v6, s[24:27], s32 offen lds
    s_waitcnt lgkmcnt(14)
    v_mfma_f32_32x32x16_bf16 v[96:111], a[44:47], a[52:55], v[96:111]
    ds_read_b64_tr_b16 a[22:23], v10 offset:14080
    s_waitcnt lgkmcnt(13)
    v_mfma_f32_32x32x16_bf16 v[112:127], a[48:51], a[52:55], v[112:127]
    s_add_u32 m0, s36, 124928
    s_add_u32 s32, s39, 896
    buffer_load_dwordx4 v7, s[24:27], s32 offen lds
    s_waitcnt lgkmcnt(10)
    v_mfma_f32_32x32x16_bf16 v[32:47], a[0:3], a[24:27], v[32:47]
    ds_read_b128 a[52:55], v16 offset:0
    ds_read_b64_tr_b16 a[28:29], v9 offset:18432
    ds_read_b64_tr_b16 a[30:31], v9 offset:19968
    s_waitcnt lgkmcnt(11)
    v_mfma_f32_32x32x16_bf16 v[48:63], a[4:7], a[24:27], v[48:63]
    ds_read_b64_tr_b16 a[32:33], v10 offset:18432
    ds_read_b64_tr_b16 a[34:35], v10 offset:19968
    ds_read_b64_tr_b16 a[36:37], v9 offset:18560
    s_add_u32 m0, s36, 125952
    s_add_u32 s32, s39, 896
    buffer_load_dwordx4 v8, s[24:27], s32 offen lds
    s_waitcnt lgkmcnt(12)
    v_mfma_f32_32x32x16_bf16 v[64:79], a[8:11], a[24:27], v[64:79]
    ds_read_b64_tr_b16 a[38:39], v9 offset:20096
    ds_read_b64_tr_b16 a[40:41], v10 offset:18560
    ds_read_b64_tr_b16 a[42:43], v10 offset:20096
    s_waitcnt lgkmcnt(13)
    v_mfma_f32_32x32x16_bf16 v[80:95], a[12:15], a[24:27], v[80:95]
    ds_read_b64_tr_b16 a[44:45], v9 offset:18688
    ds_read_b64_tr_b16 a[46:47], v9 offset:20224
    ds_read_b64_tr_b16 a[48:49], v10 offset:18688
    s_waitcnt lgkmcnt(14)
    v_mfma_f32_32x32x16_bf16 v[96:111], a[16:19], a[24:27], v[96:111]
    ds_read_b64_tr_b16 a[50:51], v10 offset:20224
    s_waitcnt lgkmcnt(13)
    v_mfma_f32_32x32x16_bf16 v[112:127], a[20:23], a[24:27], v[112:127]
    s_waitcnt lgkmcnt(0)
    s_waitcnt vmcnt(20)
    s_barrier
    v_mfma_f32_32x32x16_bf16 v[32:47], a[28:31], a[52:55], v[32:47]
    ds_read_b128 a[24:27], v13 offset:40960
    ds_read_b64_tr_b16 a[0:1], v9 offset:40960
    ds_read_b64_tr_b16 a[2:3], v9 offset:42496
    v_mfma_f32_32x32x16_bf16 v[48:63], a[32:35], a[52:55], v[48:63]
    ds_read_b64_tr_b16 a[4:5], v10 offset:40960
    ds_read_b64_tr_b16 a[6:7], v10 offset:42496
    ds_read_b64_tr_b16 a[8:9], v9 offset:41088
    s_add_u32 m0, s35, 0
    s_add_u32 s32, s37, 6291456
    buffer_load_dwordx4 v1, s[16:19], s32 offen lds
    v_mfma_f32_32x32x16_bf16 v[64:79], a[36:39], a[52:55], v[64:79]
    ds_read_b64_tr_b16 a[10:11], v9 offset:42624
    ds_read_b64_tr_b16 a[12:13], v10 offset:41088
    ds_read_b64_tr_b16 a[14:15], v10 offset:42624
    v_mfma_f32_32x32x16_bf16 v[80:95], a[40:43], a[52:55], v[80:95]
    ds_read_b64_tr_b16 a[16:17], v9 offset:41216
    ds_read_b64_tr_b16 a[18:19], v9 offset:42752
    ds_read_b64_tr_b16 a[20:21], v10 offset:41216
    s_add_u32 m0, s35, 1024
    s_add_u32 s32, s37, 6291456
    buffer_load_dwordx4 v2, s[16:19], s32 offen lds
    v_mfma_f32_32x32x16_bf16 v[96:111], a[44:47], a[52:55], v[96:111]
    ds_read_b64_tr_b16 a[22:23], v10 offset:42752
    v_mfma_f32_32x32x16_bf16 v[112:127], a[48:51], a[52:55], v[112:127]
    s_add_u32 m0, s35, 2048
    s_add_u32 s32, s37, 6291456
    buffer_load_dwordx4 v3, s[16:19], s32 offen lds
    s_waitcnt lgkmcnt(10)
    v_mfma_f32_32x32x16_bf16 v[32:47], a[0:3], a[24:27], v[32:47]
    ds_read_b128 a[52:55], v14 offset:40960
    ds_read_b64_tr_b16 a[28:29], v9 offset:47104
    ds_read_b64_tr_b16 a[30:31], v9 offset:48640
    s_waitcnt lgkmcnt(11)
    v_mfma_f32_32x32x16_bf16 v[48:63], a[4:7], a[24:27], v[48:63]
    ds_read_b64_tr_b16 a[32:33], v10 offset:47104
    ds_read_b64_tr_b16 a[34:35], v10 offset:48640
    ds_read_b64_tr_b16 a[36:37], v9 offset:47232
    s_add_u32 m0, s35, 3072
    s_add_u32 s32, s37, 6389760
    buffer_load_dwordx4 v1, s[16:19], s32 offen lds
    s_waitcnt lgkmcnt(12)
    v_mfma_f32_32x32x16_bf16 v[64:79], a[8:11], a[24:27], v[64:79]
    ds_read_b64_tr_b16 a[38:39], v9 offset:48768
    ds_read_b64_tr_b16 a[40:41], v10 offset:47232
    ds_read_b64_tr_b16 a[42:43], v10 offset:48768
    s_waitcnt lgkmcnt(13)
    v_mfma_f32_32x32x16_bf16 v[80:95], a[12:15], a[24:27], v[80:95]
    ds_read_b64_tr_b16 a[44:45], v9 offset:47360
    ds_read_b64_tr_b16 a[46:47], v9 offset:48896
    ds_read_b64_tr_b16 a[48:49], v10 offset:47360
    s_add_u32 m0, s35, 4096
    s_add_u32 s32, s37, 6389760
    buffer_load_dwordx4 v2, s[16:19], s32 offen lds
    s_waitcnt lgkmcnt(14)
    v_mfma_f32_32x32x16_bf16 v[96:111], a[16:19], a[24:27], v[96:111]
    ds_read_b64_tr_b16 a[50:51], v10 offset:48896
    s_waitcnt lgkmcnt(13)
    v_mfma_f32_32x32x16_bf16 v[112:127], a[20:23], a[24:27], v[112:127]
    s_add_u32 m0, s35, 5120
    s_add_u32 s32, s37, 6389760
    buffer_load_dwordx4 v3, s[16:19], s32 offen lds
    s_waitcnt lgkmcnt(10)
    v_mfma_f32_32x32x16_bf16 v[32:47], a[28:31], a[52:55], v[32:47]
    ds_read_b128 a[24:27], v15 offset:40960
    ds_read_b64_tr_b16 a[0:1], v9 offset:53248
    ds_read_b64_tr_b16 a[2:3], v9 offset:54784
    s_waitcnt lgkmcnt(11)
    v_mfma_f32_32x32x16_bf16 v[48:63], a[32:35], a[52:55], v[48:63]
    ds_read_b64_tr_b16 a[4:5], v10 offset:53248
    ds_read_b64_tr_b16 a[6:7], v10 offset:54784
    ds_read_b64_tr_b16 a[8:9], v9 offset:53376
    s_add_u32 m0, s36, 0
    s_add_u32 s32, s39, 1024
    buffer_load_dwordx4 v5, s[24:27], s32 offen lds
    s_waitcnt lgkmcnt(12)
    v_mfma_f32_32x32x16_bf16 v[64:79], a[36:39], a[52:55], v[64:79]
    ds_read_b64_tr_b16 a[10:11], v9 offset:54912
    ds_read_b64_tr_b16 a[12:13], v10 offset:53376
    ds_read_b64_tr_b16 a[14:15], v10 offset:54912
    s_waitcnt lgkmcnt(13)
    v_mfma_f32_32x32x16_bf16 v[80:95], a[40:43], a[52:55], v[80:95]
    ds_read_b64_tr_b16 a[16:17], v9 offset:53504
    ds_read_b64_tr_b16 a[18:19], v9 offset:55040
    ds_read_b64_tr_b16 a[20:21], v10 offset:53504
    s_add_u32 m0, s36, 1024
    s_add_u32 s32, s39, 1024
    buffer_load_dwordx4 v6, s[24:27], s32 offen lds
    s_waitcnt lgkmcnt(14)
    v_mfma_f32_32x32x16_bf16 v[96:111], a[44:47], a[52:55], v[96:111]
    ds_read_b64_tr_b16 a[22:23], v10 offset:55040
    s_waitcnt lgkmcnt(13)
    v_mfma_f32_32x32x16_bf16 v[112:127], a[48:51], a[52:55], v[112:127]
    s_add_u32 m0, s36, 2048
    s_add_u32 s32, s39, 1024
    buffer_load_dwordx4 v7, s[24:27], s32 offen lds
    s_waitcnt lgkmcnt(10)
    v_mfma_f32_32x32x16_bf16 v[32:47], a[0:3], a[24:27], v[32:47]
    ds_read_b128 a[52:55], v16 offset:40960
    ds_read_b64_tr_b16 a[28:29], v9 offset:59392
    ds_read_b64_tr_b16 a[30:31], v9 offset:60928
    s_waitcnt lgkmcnt(11)
    v_mfma_f32_32x32x16_bf16 v[48:63], a[4:7], a[24:27], v[48:63]
    ds_read_b64_tr_b16 a[32:33], v10 offset:59392
    ds_read_b64_tr_b16 a[34:35], v10 offset:60928
    ds_read_b64_tr_b16 a[36:37], v9 offset:59520
    s_add_u32 m0, s36, 3072
    s_add_u32 s32, s39, 1024
    buffer_load_dwordx4 v8, s[24:27], s32 offen lds
    s_waitcnt lgkmcnt(12)
    v_mfma_f32_32x32x16_bf16 v[64:79], a[8:11], a[24:27], v[64:79]
    ds_read_b64_tr_b16 a[38:39], v9 offset:61056
    ds_read_b64_tr_b16 a[40:41], v10 offset:59520
    ds_read_b64_tr_b16 a[42:43], v10 offset:61056
    s_waitcnt lgkmcnt(13)
    v_mfma_f32_32x32x16_bf16 v[80:95], a[12:15], a[24:27], v[80:95]
    ds_read_b64_tr_b16 a[44:45], v9 offset:59648
    ds_read_b64_tr_b16 a[46:47], v9 offset:61184
    ds_read_b64_tr_b16 a[48:49], v10 offset:59648
    s_waitcnt lgkmcnt(14)
    v_mfma_f32_32x32x16_bf16 v[96:111], a[16:19], a[24:27], v[96:111]
    ds_read_b64_tr_b16 a[50:51], v10 offset:61184
    s_waitcnt lgkmcnt(13)
    v_mfma_f32_32x32x16_bf16 v[112:127], a[20:23], a[24:27], v[112:127]
    s_waitcnt lgkmcnt(0)
    s_waitcnt vmcnt(20)
    s_barrier
    v_mfma_f32_32x32x16_bf16 v[32:47], a[28:31], a[52:55], v[32:47]
    ds_read_b128 a[24:27], v17 offset:0
    ds_read_b64_tr_b16 a[0:1], v11 offset:0
    ds_read_b64_tr_b16 a[2:3], v11 offset:1536
    v_mfma_f32_32x32x16_bf16 v[48:63], a[32:35], a[52:55], v[48:63]
    ds_read_b64_tr_b16 a[4:5], v12 offset:0
    ds_read_b64_tr_b16 a[6:7], v12 offset:1536
    ds_read_b64_tr_b16 a[8:9], v11 offset:128
    s_add_u32 m0, s35, 40960
    s_add_u32 s32, s37, 7077888
    buffer_load_dwordx4 v1, s[16:19], s32 offen lds
    v_mfma_f32_32x32x16_bf16 v[64:79], a[36:39], a[52:55], v[64:79]
    ds_read_b64_tr_b16 a[10:11], v11 offset:1664
    ds_read_b64_tr_b16 a[12:13], v12 offset:128
    ds_read_b64_tr_b16 a[14:15], v12 offset:1664
    v_mfma_f32_32x32x16_bf16 v[80:95], a[40:43], a[52:55], v[80:95]
    ds_read_b64_tr_b16 a[16:17], v11 offset:256
    ds_read_b64_tr_b16 a[18:19], v11 offset:1792
    ds_read_b64_tr_b16 a[20:21], v12 offset:256
    s_add_u32 m0, s35, 41984
    s_add_u32 s32, s37, 7077888
    buffer_load_dwordx4 v2, s[16:19], s32 offen lds
    v_mfma_f32_32x32x16_bf16 v[96:111], a[44:47], a[52:55], v[96:111]
    ds_read_b64_tr_b16 a[22:23], v12 offset:1792
    v_mfma_f32_32x32x16_bf16 v[112:127], a[48:51], a[52:55], v[112:127]
    s_add_u32 m0, s35, 43008
    s_add_u32 s32, s37, 7077888
    buffer_load_dwordx4 v3, s[16:19], s32 offen lds
    s_waitcnt lgkmcnt(10)
    v_mfma_f32_32x32x16_bf16 v[32:47], a[0:3], a[24:27], v[32:47]
    ds_read_b128 a[52:55], v18 offset:0
    ds_read_b64_tr_b16 a[28:29], v11 offset:6144
    ds_read_b64_tr_b16 a[30:31], v11 offset:7680
    s_waitcnt lgkmcnt(11)
    v_mfma_f32_32x32x16_bf16 v[48:63], a[4:7], a[24:27], v[48:63]
    ds_read_b64_tr_b16 a[32:33], v12 offset:6144
    ds_read_b64_tr_b16 a[34:35], v12 offset:7680
    ds_read_b64_tr_b16 a[36:37], v11 offset:6272
    s_add_u32 m0, s35, 44032
    s_add_u32 s32, s37, 7176192
    buffer_load_dwordx4 v1, s[16:19], s32 offen lds
    s_waitcnt lgkmcnt(12)
    v_mfma_f32_32x32x16_bf16 v[64:79], a[8:11], a[24:27], v[64:79]
    ds_read_b64_tr_b16 a[38:39], v11 offset:7808
    ds_read_b64_tr_b16 a[40:41], v12 offset:6272
    ds_read_b64_tr_b16 a[42:43], v12 offset:7808
    s_waitcnt lgkmcnt(13)
    v_mfma_f32_32x32x16_bf16 v[80:95], a[12:15], a[24:27], v[80:95]
    ds_read_b64_tr_b16 a[44:45], v11 offset:6400
    ds_read_b64_tr_b16 a[46:47], v11 offset:7936
    ds_read_b64_tr_b16 a[48:49], v12 offset:6400
    s_add_u32 m0, s35, 45056
    s_add_u32 s32, s37, 7176192
    buffer_load_dwordx4 v2, s[16:19], s32 offen lds
    s_waitcnt lgkmcnt(14)
    v_mfma_f32_32x32x16_bf16 v[96:111], a[16:19], a[24:27], v[96:111]
    ds_read_b64_tr_b16 a[50:51], v12 offset:7936
    s_waitcnt lgkmcnt(13)
    v_mfma_f32_32x32x16_bf16 v[112:127], a[20:23], a[24:27], v[112:127]
    s_add_u32 m0, s35, 46080
    s_add_u32 s32, s37, 7176192
    buffer_load_dwordx4 v3, s[16:19], s32 offen lds
    s_waitcnt lgkmcnt(10)
    v_mfma_f32_32x32x16_bf16 v[32:47], a[28:31], a[52:55], v[32:47]
    ds_read_b128 a[24:27], v19 offset:0
    ds_read_b64_tr_b16 a[0:1], v11 offset:12288
    ds_read_b64_tr_b16 a[2:3], v11 offset:13824
    s_waitcnt lgkmcnt(11)
    v_mfma_f32_32x32x16_bf16 v[48:63], a[32:35], a[52:55], v[48:63]
    ds_read_b64_tr_b16 a[4:5], v12 offset:12288
    ds_read_b64_tr_b16 a[6:7], v12 offset:13824
    ds_read_b64_tr_b16 a[8:9], v11 offset:12416
    s_add_u32 m0, s36, 40960
    s_add_u32 s32, s39, 1152
    buffer_load_dwordx4 v5, s[24:27], s32 offen lds
    s_waitcnt lgkmcnt(12)
    v_mfma_f32_32x32x16_bf16 v[64:79], a[36:39], a[52:55], v[64:79]
    ds_read_b64_tr_b16 a[10:11], v11 offset:13952
    ds_read_b64_tr_b16 a[12:13], v12 offset:12416
    ds_read_b64_tr_b16 a[14:15], v12 offset:13952
    s_waitcnt lgkmcnt(13)
    v_mfma_f32_32x32x16_bf16 v[80:95], a[40:43], a[52:55], v[80:95]
    ds_read_b64_tr_b16 a[16:17], v11 offset:12544
    ds_read_b64_tr_b16 a[18:19], v11 offset:14080
    ds_read_b64_tr_b16 a[20:21], v12 offset:12544
    s_add_u32 m0, s36, 41984
    s_add_u32 s32, s39, 1152
    buffer_load_dwordx4 v6, s[24:27], s32 offen lds
    s_waitcnt lgkmcnt(14)
    v_mfma_f32_32x32x16_bf16 v[96:111], a[44:47], a[52:55], v[96:111]
    ds_read_b64_tr_b16 a[22:23], v12 offset:14080
    s_waitcnt lgkmcnt(13)
    v_mfma_f32_32x32x16_bf16 v[112:127], a[48:51], a[52:55], v[112:127]
    s_add_u32 m0, s36, 43008
    s_add_u32 s32, s39, 1152
    buffer_load_dwordx4 v7, s[24:27], s32 offen lds
    s_waitcnt lgkmcnt(10)
    v_mfma_f32_32x32x16_bf16 v[32:47], a[0:3], a[24:27], v[32:47]
    ds_read_b128 a[52:55], v20 offset:0
    ds_read_b64_tr_b16 a[28:29], v11 offset:18432
    ds_read_b64_tr_b16 a[30:31], v11 offset:19968
    s_waitcnt lgkmcnt(11)
    v_mfma_f32_32x32x16_bf16 v[48:63], a[4:7], a[24:27], v[48:63]
    ds_read_b64_tr_b16 a[32:33], v12 offset:18432
    ds_read_b64_tr_b16 a[34:35], v12 offset:19968
    ds_read_b64_tr_b16 a[36:37], v11 offset:18560
    s_add_u32 m0, s36, 44032
    s_add_u32 s32, s39, 1152
    buffer_load_dwordx4 v8, s[24:27], s32 offen lds
    s_waitcnt lgkmcnt(12)
    v_mfma_f32_32x32x16_bf16 v[64:79], a[8:11], a[24:27], v[64:79]
    ds_read_b64_tr_b16 a[38:39], v11 offset:20096
    ds_read_b64_tr_b16 a[40:41], v12 offset:18560
    ds_read_b64_tr_b16 a[42:43], v12 offset:20096
    s_waitcnt lgkmcnt(13)
    v_mfma_f32_32x32x16_bf16 v[80:95], a[12:15], a[24:27], v[80:95]
    ds_read_b64_tr_b16 a[44:45], v11 offset:18688
    ds_read_b64_tr_b16 a[46:47], v11 offset:20224
    ds_read_b64_tr_b16 a[48:49], v12 offset:18688
    s_waitcnt lgkmcnt(14)
    v_mfma_f32_32x32x16_bf16 v[96:111], a[16:19], a[24:27], v[96:111]
    ds_read_b64_tr_b16 a[50:51], v12 offset:20224
    s_waitcnt lgkmcnt(13)
    v_mfma_f32_32x32x16_bf16 v[112:127], a[20:23], a[24:27], v[112:127]
    s_waitcnt lgkmcnt(0)
    s_waitcnt vmcnt(20)
    s_barrier
    v_mfma_f32_32x32x16_bf16 v[32:47], a[28:31], a[52:55], v[32:47]
    ds_read_b128 a[24:27], v17 offset:40960
    ds_read_b64_tr_b16 a[0:1], v11 offset:40960
    ds_read_b64_tr_b16 a[2:3], v11 offset:42496
    v_mfma_f32_32x32x16_bf16 v[48:63], a[32:35], a[52:55], v[48:63]
    ds_read_b64_tr_b16 a[4:5], v12 offset:40960
    ds_read_b64_tr_b16 a[6:7], v12 offset:42496
    ds_read_b64_tr_b16 a[8:9], v11 offset:41088
    v_mfma_f32_32x32x16_bf16 v[64:79], a[36:39], a[52:55], v[64:79]
    ds_read_b64_tr_b16 a[10:11], v11 offset:42624
    ds_read_b64_tr_b16 a[12:13], v12 offset:41088
    ds_read_b64_tr_b16 a[14:15], v12 offset:42624
    v_mfma_f32_32x32x16_bf16 v[80:95], a[40:43], a[52:55], v[80:95]
    ds_read_b64_tr_b16 a[16:17], v11 offset:41216
    ds_read_b64_tr_b16 a[18:19], v11 offset:42752
    ds_read_b64_tr_b16 a[20:21], v12 offset:41216
    s_add_u32 m0, s35, 81920
    s_add_u32 s32, s38, 0
    buffer_load_dwordx4 v4, s[20:23], s32 offen lds
    v_mfma_f32_32x32x16_bf16 v[96:111], a[44:47], a[52:55], v[96:111]
    ds_read_b64_tr_b16 a[22:23], v12 offset:42752
    v_mfma_f32_32x32x16_bf16 v[112:127], a[48:51], a[52:55], v[112:127]
    s_waitcnt lgkmcnt(10)
    v_mfma_f32_32x32x16_bf16 v[32:47], a[0:3], a[24:27], v[32:47]
    ds_read_b128 a[52:55], v18 offset:40960
    ds_read_b64_tr_b16 a[28:29], v11 offset:47104
    ds_read_b64_tr_b16 a[30:31], v11 offset:48640
    s_waitcnt lgkmcnt(11)
    v_mfma_f32_32x32x16_bf16 v[48:63], a[4:7], a[24:27], v[48:63]
    ds_read_b64_tr_b16 a[32:33], v12 offset:47104
    ds_read_b64_tr_b16 a[34:35], v12 offset:48640
    ds_read_b64_tr_b16 a[36:37], v11 offset:47232
    s_add_u32 m0, s35, 82944
    s_add_u32 s32, s38, 10240
    buffer_load_dwordx4 v4, s[20:23], s32 offen lds
    s_waitcnt lgkmcnt(12)
    v_mfma_f32_32x32x16_bf16 v[64:79], a[8:11], a[24:27], v[64:79]
    ds_read_b64_tr_b16 a[38:39], v11 offset:48768
    ds_read_b64_tr_b16 a[40:41], v12 offset:47232
    ds_read_b64_tr_b16 a[42:43], v12 offset:48768
    s_waitcnt lgkmcnt(13)
    v_mfma_f32_32x32x16_bf16 v[80:95], a[12:15], a[24:27], v[80:95]
    ds_read_b64_tr_b16 a[44:45], v11 offset:47360
    ds_read_b64_tr_b16 a[46:47], v11 offset:48896
    ds_read_b64_tr_b16 a[48:49], v12 offset:47360
    s_waitcnt lgkmcnt(14)
    v_mfma_f32_32x32x16_bf16 v[96:111], a[16:19], a[24:27], v[96:111]
    ds_read_b64_tr_b16 a[50:51], v12 offset:48896
    s_waitcnt lgkmcnt(13)
    v_mfma_f32_32x32x16_bf16 v[112:127], a[20:23], a[24:27], v[112:127]
    s_add_u32 m0, s35, 83968
    s_add_u32 s32, s38, 20480
    buffer_load_dwordx4 v4, s[20:23], s32 offen lds
    s_waitcnt lgkmcnt(10)
    v_mfma_f32_32x32x16_bf16 v[32:47], a[28:31], a[52:55], v[32:47]
    ds_read_b128 a[24:27], v19 offset:40960
    ds_read_b64_tr_b16 a[0:1], v11 offset:53248
    ds_read_b64_tr_b16 a[2:3], v11 offset:54784
    s_waitcnt lgkmcnt(11)
    v_mfma_f32_32x32x16_bf16 v[48:63], a[32:35], a[52:55], v[48:63]
    ds_read_b64_tr_b16 a[4:5], v12 offset:53248
    ds_read_b64_tr_b16 a[6:7], v12 offset:54784
    ds_read_b64_tr_b16 a[8:9], v11 offset:53376
    s_waitcnt lgkmcnt(12)
    v_mfma_f32_32x32x16_bf16 v[64:79], a[36:39], a[52:55], v[64:79]
    ds_read_b64_tr_b16 a[10:11], v11 offset:54912
    ds_read_b64_tr_b16 a[12:13], v12 offset:53376
    ds_read_b64_tr_b16 a[14:15], v12 offset:54912
    s_waitcnt lgkmcnt(13)
    v_mfma_f32_32x32x16_bf16 v[80:95], a[40:43], a[52:55], v[80:95]
    ds_read_b64_tr_b16 a[16:17], v11 offset:53504
    ds_read_b64_tr_b16 a[18:19], v11 offset:55040
    ds_read_b64_tr_b16 a[20:21], v12 offset:53504
    s_add_u32 m0, s35, 84992
    s_add_u32 s32, s38, 30720
    buffer_load_dwordx4 v4, s[20:23], s32 offen lds
    s_waitcnt lgkmcnt(14)
    v_mfma_f32_32x32x16_bf16 v[96:111], a[44:47], a[52:55], v[96:111]
    ds_read_b64_tr_b16 a[22:23], v12 offset:55040
    s_waitcnt lgkmcnt(13)
    v_mfma_f32_32x32x16_bf16 v[112:127], a[48:51], a[52:55], v[112:127]
    s_waitcnt lgkmcnt(10)
    v_mfma_f32_32x32x16_bf16 v[32:47], a[0:3], a[24:27], v[32:47]
    ds_read_b128 a[52:55], v20 offset:40960
    ds_read_b64_tr_b16 a[28:29], v11 offset:59392
    ds_read_b64_tr_b16 a[30:31], v11 offset:60928
    s_waitcnt lgkmcnt(11)
    v_mfma_f32_32x32x16_bf16 v[48:63], a[4:7], a[24:27], v[48:63]
    ds_read_b64_tr_b16 a[32:33], v12 offset:59392
    ds_read_b64_tr_b16 a[34:35], v12 offset:60928
    ds_read_b64_tr_b16 a[36:37], v11 offset:59520
    s_add_u32 m0, s35, 86016
    s_add_u32 s32, s38, 40960
    buffer_load_dwordx4 v4, s[20:23], s32 offen lds
    s_waitcnt lgkmcnt(12)
    v_mfma_f32_32x32x16_bf16 v[64:79], a[8:11], a[24:27], v[64:79]
    ds_read_b64_tr_b16 a[38:39], v11 offset:61056
    ds_read_b64_tr_b16 a[40:41], v12 offset:59520
    ds_read_b64_tr_b16 a[42:43], v12 offset:61056
    s_waitcnt lgkmcnt(13)
    v_mfma_f32_32x32x16_bf16 v[80:95], a[12:15], a[24:27], v[80:95]
    ds_read_b64_tr_b16 a[44:45], v11 offset:59648
    ds_read_b64_tr_b16 a[46:47], v11 offset:61184
    ds_read_b64_tr_b16 a[48:49], v12 offset:59648
    s_waitcnt lgkmcnt(14)
    v_mfma_f32_32x32x16_bf16 v[96:111], a[16:19], a[24:27], v[96:111]
    ds_read_b64_tr_b16 a[50:51], v12 offset:61184
    s_waitcnt lgkmcnt(13)
    v_mfma_f32_32x32x16_bf16 v[112:127], a[20:23], a[24:27], v[112:127]
    s_add_u32 m0, s35, 87040
    s_add_u32 s32, s38, 51200
    buffer_load_dwordx4 v4, s[20:23], s32 offen lds
    s_waitcnt lgkmcnt(0)
    s_waitcnt vmcnt(16)
    s_barrier
    v_mfma_f32_32x32x16_bf16 v[32:47], a[28:31], a[52:55], v[32:47]
    ds_read_b128 a[24:27], v13 offset:0
    ds_read_b64_tr_b16 a[0:1], v9 offset:0
    ds_read_b64_tr_b16 a[2:3], v9 offset:1536
    v_mfma_f32_32x32x16_bf16 v[48:63], a[32:35], a[52:55], v[48:63]
    ds_read_b64_tr_b16 a[4:5], v10 offset:0
    ds_read_b64_tr_b16 a[6:7], v10 offset:1536
    ds_read_b64_tr_b16 a[8:9], v9 offset:128
    v_mfma_f32_32x32x16_bf16 v[64:79], a[36:39], a[52:55], v[64:79]
    ds_read_b64_tr_b16 a[10:11], v9 offset:1664
    ds_read_b64_tr_b16 a[12:13], v10 offset:128
    ds_read_b64_tr_b16 a[14:15], v10 offset:1664
    v_mfma_f32_32x32x16_bf16 v[80:95], a[40:43], a[52:55], v[80:95]
    ds_read_b64_tr_b16 a[16:17], v9 offset:256
    ds_read_b64_tr_b16 a[18:19], v9 offset:1792
    ds_read_b64_tr_b16 a[20:21], v10 offset:256
    s_add_u32 m0, s35, 122880
    s_add_u32 s32, s38, 128
    buffer_load_dwordx4 v4, s[20:23], s32 offen lds
    v_mfma_f32_32x32x16_bf16 v[96:111], a[44:47], a[52:55], v[96:111]
    ds_read_b64_tr_b16 a[22:23], v10 offset:1792
    v_mfma_f32_32x32x16_bf16 v[112:127], a[48:51], a[52:55], v[112:127]
    s_waitcnt lgkmcnt(10)
    v_mfma_f32_32x32x16_bf16 v[32:47], a[0:3], a[24:27], v[32:47]
    ds_read_b128 a[52:55], v14 offset:0
    ds_read_b64_tr_b16 a[28:29], v9 offset:6144
    ds_read_b64_tr_b16 a[30:31], v9 offset:7680
    s_waitcnt lgkmcnt(11)
    v_mfma_f32_32x32x16_bf16 v[48:63], a[4:7], a[24:27], v[48:63]
    ds_read_b64_tr_b16 a[32:33], v10 offset:6144
    ds_read_b64_tr_b16 a[34:35], v10 offset:7680
    ds_read_b64_tr_b16 a[36:37], v9 offset:6272
    s_add_u32 m0, s35, 123904
    s_add_u32 s32, s38, 10368
    buffer_load_dwordx4 v4, s[20:23], s32 offen lds
    s_waitcnt lgkmcnt(12)
    v_mfma_f32_32x32x16_bf16 v[64:79], a[8:11], a[24:27], v[64:79]
    ds_read_b64_tr_b16 a[38:39], v9 offset:7808
    ds_read_b64_tr_b16 a[40:41], v10 offset:6272
    ds_read_b64_tr_b16 a[42:43], v10 offset:7808
    s_waitcnt lgkmcnt(13)
    v_mfma_f32_32x32x16_bf16 v[80:95], a[12:15], a[24:27], v[80:95]
    ds_read_b64_tr_b16 a[44:45], v9 offset:6400
    ds_read_b64_tr_b16 a[46:47], v9 offset:7936
    ds_read_b64_tr_b16 a[48:49], v10 offset:6400
    s_waitcnt lgkmcnt(14)
    v_mfma_f32_32x32x16_bf16 v[96:111], a[16:19], a[24:27], v[96:111]
    ds_read_b64_tr_b16 a[50:51], v10 offset:7936
    s_waitcnt lgkmcnt(13)
    v_mfma_f32_32x32x16_bf16 v[112:127], a[20:23], a[24:27], v[112:127]
    s_add_u32 m0, s35, 124928
    s_add_u32 s32, s38, 20608
    buffer_load_dwordx4 v4, s[20:23], s32 offen lds
    s_waitcnt lgkmcnt(10)
    v_mfma_f32_32x32x16_bf16 v[32:47], a[28:31], a[52:55], v[32:47]
    ds_read_b128 a[24:27], v15 offset:0
    ds_read_b64_tr_b16 a[0:1], v9 offset:12288
    ds_read_b64_tr_b16 a[2:3], v9 offset:13824
    s_waitcnt lgkmcnt(11)
    v_mfma_f32_32x32x16_bf16 v[48:63], a[32:35], a[52:55], v[48:63]
    ds_read_b64_tr_b16 a[4:5], v10 offset:12288
    ds_read_b64_tr_b16 a[6:7], v10 offset:13824
    ds_read_b64_tr_b16 a[8:9], v9 offset:12416
    s_waitcnt lgkmcnt(12)
    v_mfma_f32_32x32x16_bf16 v[64:79], a[36:39], a[52:55], v[64:79]
    ds_read_b64_tr_b16 a[10:11], v9 offset:13952
    ds_read_b64_tr_b16 a[12:13], v10 offset:12416
    ds_read_b64_tr_b16 a[14:15], v10 offset:13952
    s_waitcnt lgkmcnt(13)
    v_mfma_f32_32x32x16_bf16 v[80:95], a[40:43], a[52:55], v[80:95]
    ds_read_b64_tr_b16 a[16:17], v9 offset:12544
    ds_read_b64_tr_b16 a[18:19], v9 offset:14080
    ds_read_b64_tr_b16 a[20:21], v10 offset:12544
    s_add_u32 m0, s35, 125952
    s_add_u32 s32, s38, 30848
    buffer_load_dwordx4 v4, s[20:23], s32 offen lds
    s_waitcnt lgkmcnt(14)
    v_mfma_f32_32x32x16_bf16 v[96:111], a[44:47], a[52:55], v[96:111]
    ds_read_b64_tr_b16 a[22:23], v10 offset:14080
    s_waitcnt lgkmcnt(13)
    v_mfma_f32_32x32x16_bf16 v[112:127], a[48:51], a[52:55], v[112:127]
    s_waitcnt lgkmcnt(10)
    v_mfma_f32_32x32x16_bf16 v[32:47], a[0:3], a[24:27], v[32:47]
    ds_read_b128 a[52:55], v16 offset:0
    ds_read_b64_tr_b16 a[28:29], v9 offset:18432
    ds_read_b64_tr_b16 a[30:31], v9 offset:19968
    s_waitcnt lgkmcnt(11)
    v_mfma_f32_32x32x16_bf16 v[48:63], a[4:7], a[24:27], v[48:63]
    ds_read_b64_tr_b16 a[32:33], v10 offset:18432
    ds_read_b64_tr_b16 a[34:35], v10 offset:19968
    ds_read_b64_tr_b16 a[36:37], v9 offset:18560
    s_add_u32 m0, s35, 126976
    s_add_u32 s32, s38, 41088
    buffer_load_dwordx4 v4, s[20:23], s32 offen lds
    s_waitcnt lgkmcnt(12)
    v_mfma_f32_32x32x16_bf16 v[64:79], a[8:11], a[24:27], v[64:79]
    ds_read_b64_tr_b16 a[38:39], v9 offset:20096
    ds_read_b64_tr_b16 a[40:41], v10 offset:18560
    ds_read_b64_tr_b16 a[42:43], v10 offset:20096
    s_waitcnt lgkmcnt(13)
    v_mfma_f32_32x32x16_bf16 v[80:95], a[12:15], a[24:27], v[80:95]
    ds_read_b64_tr_b16 a[44:45], v9 offset:18688
    ds_read_b64_tr_b16 a[46:47], v9 offset:20224
    ds_read_b64_tr_b16 a[48:49], v10 offset:18688
    s_waitcnt lgkmcnt(14)
    v_mfma_f32_32x32x16_bf16 v[96:111], a[16:19], a[24:27], v[96:111]
    ds_read_b64_tr_b16 a[50:51], v10 offset:20224
    s_waitcnt lgkmcnt(13)
    v_mfma_f32_32x32x16_bf16 v[112:127], a[20:23], a[24:27], v[112:127]
    s_add_u32 m0, s35, 128000
    s_add_u32 s32, s38, 51328
    buffer_load_dwordx4 v4, s[20:23], s32 offen lds
    s_waitcnt lgkmcnt(0)
    s_waitcnt vmcnt(12)
    s_barrier
    v_mfma_f32_32x32x16_bf16 v[32:47], a[28:31], a[52:55], v[32:47]
    ds_read_b128 a[24:27], v13 offset:40960
    ds_read_b64_tr_b16 a[0:1], v9 offset:40960
    ds_read_b64_tr_b16 a[2:3], v9 offset:42496
    v_mfma_f32_32x32x16_bf16 v[48:63], a[32:35], a[52:55], v[48:63]
    ds_read_b64_tr_b16 a[4:5], v10 offset:40960
    ds_read_b64_tr_b16 a[6:7], v10 offset:42496
    ds_read_b64_tr_b16 a[8:9], v9 offset:41088
    v_mfma_f32_32x32x16_bf16 v[64:79], a[36:39], a[52:55], v[64:79]
    ds_read_b64_tr_b16 a[10:11], v9 offset:42624
    ds_read_b64_tr_b16 a[12:13], v10 offset:41088
    ds_read_b64_tr_b16 a[14:15], v10 offset:42624
    v_mfma_f32_32x32x16_bf16 v[80:95], a[40:43], a[52:55], v[80:95]
    ds_read_b64_tr_b16 a[16:17], v9 offset:41216
    ds_read_b64_tr_b16 a[18:19], v9 offset:42752
    ds_read_b64_tr_b16 a[20:21], v10 offset:41216
    s_add_u32 m0, s35, 0
    s_add_u32 s32, s38, 256
    buffer_load_dwordx4 v4, s[20:23], s32 offen lds
    v_mfma_f32_32x32x16_bf16 v[96:111], a[44:47], a[52:55], v[96:111]
    ds_read_b64_tr_b16 a[22:23], v10 offset:42752
    v_mfma_f32_32x32x16_bf16 v[112:127], a[48:51], a[52:55], v[112:127]
    s_waitcnt lgkmcnt(10)
    v_mfma_f32_32x32x16_bf16 v[32:47], a[0:3], a[24:27], v[32:47]
    ds_read_b128 a[52:55], v14 offset:40960
    ds_read_b64_tr_b16 a[28:29], v9 offset:47104
    ds_read_b64_tr_b16 a[30:31], v9 offset:48640
    s_waitcnt lgkmcnt(11)
    v_mfma_f32_32x32x16_bf16 v[48:63], a[4:7], a[24:27], v[48:63]
    ds_read_b64_tr_b16 a[32:33], v10 offset:47104
    ds_read_b64_tr_b16 a[34:35], v10 offset:48640
    ds_read_b64_tr_b16 a[36:37], v9 offset:47232
    s_add_u32 m0, s35, 1024
    s_add_u32 s32, s38, 10496
    buffer_load_dwordx4 v4, s[20:23], s32 offen lds
    s_waitcnt lgkmcnt(12)
    v_mfma_f32_32x32x16_bf16 v[64:79], a[8:11], a[24:27], v[64:79]
    ds_read_b64_tr_b16 a[38:39], v9 offset:48768
    ds_read_b64_tr_b16 a[40:41], v10 offset:47232
    ds_read_b64_tr_b16 a[42:43], v10 offset:48768
    s_waitcnt lgkmcnt(13)
    v_mfma_f32_32x32x16_bf16 v[80:95], a[12:15], a[24:27], v[80:95]
    ds_read_b64_tr_b16 a[44:45], v9 offset:47360
    ds_read_b64_tr_b16 a[46:47], v9 offset:48896
    ds_read_b64_tr_b16 a[48:49], v10 offset:47360
    s_waitcnt lgkmcnt(14)
    v_mfma_f32_32x32x16_bf16 v[96:111], a[16:19], a[24:27], v[96:111]
    ds_read_b64_tr_b16 a[50:51], v10 offset:48896
    s_waitcnt lgkmcnt(13)
    v_mfma_f32_32x32x16_bf16 v[112:127], a[20:23], a[24:27], v[112:127]
    s_add_u32 m0, s35, 2048
    s_add_u32 s32, s38, 20736
    buffer_load_dwordx4 v4, s[20:23], s32 offen lds
    s_waitcnt lgkmcnt(10)
    v_mfma_f32_32x32x16_bf16 v[32:47], a[28:31], a[52:55], v[32:47]
    ds_read_b128 a[24:27], v15 offset:40960
    ds_read_b64_tr_b16 a[0:1], v9 offset:53248
    ds_read_b64_tr_b16 a[2:3], v9 offset:54784
    s_waitcnt lgkmcnt(11)
    v_mfma_f32_32x32x16_bf16 v[48:63], a[32:35], a[52:55], v[48:63]
    ds_read_b64_tr_b16 a[4:5], v10 offset:53248
    ds_read_b64_tr_b16 a[6:7], v10 offset:54784
    ds_read_b64_tr_b16 a[8:9], v9 offset:53376
    s_waitcnt lgkmcnt(12)
    v_mfma_f32_32x32x16_bf16 v[64:79], a[36:39], a[52:55], v[64:79]
    ds_read_b64_tr_b16 a[10:11], v9 offset:54912
    ds_read_b64_tr_b16 a[12:13], v10 offset:53376
    ds_read_b64_tr_b16 a[14:15], v10 offset:54912
    s_waitcnt lgkmcnt(13)
    v_mfma_f32_32x32x16_bf16 v[80:95], a[40:43], a[52:55], v[80:95]
    ds_read_b64_tr_b16 a[16:17], v9 offset:53504
    ds_read_b64_tr_b16 a[18:19], v9 offset:55040
    ds_read_b64_tr_b16 a[20:21], v10 offset:53504
    s_add_u32 m0, s35, 3072
    s_add_u32 s32, s38, 30976
    buffer_load_dwordx4 v4, s[20:23], s32 offen lds
    s_waitcnt lgkmcnt(14)
    v_mfma_f32_32x32x16_bf16 v[96:111], a[44:47], a[52:55], v[96:111]
    ds_read_b64_tr_b16 a[22:23], v10 offset:55040
    s_waitcnt lgkmcnt(13)
    v_mfma_f32_32x32x16_bf16 v[112:127], a[48:51], a[52:55], v[112:127]
    s_waitcnt lgkmcnt(10)
    v_mfma_f32_32x32x16_bf16 v[32:47], a[0:3], a[24:27], v[32:47]
    ds_read_b128 a[52:55], v16 offset:40960
    ds_read_b64_tr_b16 a[28:29], v9 offset:59392
    ds_read_b64_tr_b16 a[30:31], v9 offset:60928
    s_waitcnt lgkmcnt(11)
    v_mfma_f32_32x32x16_bf16 v[48:63], a[4:7], a[24:27], v[48:63]
    ds_read_b64_tr_b16 a[32:33], v10 offset:59392
    ds_read_b64_tr_b16 a[34:35], v10 offset:60928
    ds_read_b64_tr_b16 a[36:37], v9 offset:59520
    s_add_u32 m0, s35, 4096
    s_add_u32 s32, s38, 41216
    buffer_load_dwordx4 v4, s[20:23], s32 offen lds
    s_waitcnt lgkmcnt(12)
    v_mfma_f32_32x32x16_bf16 v[64:79], a[8:11], a[24:27], v[64:79]
    ds_read_b64_tr_b16 a[38:39], v9 offset:61056
    ds_read_b64_tr_b16 a[40:41], v10 offset:59520
    ds_read_b64_tr_b16 a[42:43], v10 offset:61056
    s_waitcnt lgkmcnt(13)
    v_mfma_f32_32x32x16_bf16 v[80:95], a[12:15], a[24:27], v[80:95]
    ds_read_b64_tr_b16 a[44:45], v9 offset:59648
    ds_read_b64_tr_b16 a[46:47], v9 offset:61184
    ds_read_b64_tr_b16 a[48:49], v10 offset:59648
    s_waitcnt lgkmcnt(14)
    v_mfma_f32_32x32x16_bf16 v[96:111], a[16:19], a[24:27], v[96:111]
    ds_read_b64_tr_b16 a[50:51], v10 offset:61184
    s_waitcnt lgkmcnt(13)
    v_mfma_f32_32x32x16_bf16 v[112:127], a[20:23], a[24:27], v[112:127]
    s_add_u32 m0, s35, 5120
    s_add_u32 s32, s38, 51456
    buffer_load_dwordx4 v4, s[20:23], s32 offen lds
    s_waitcnt lgkmcnt(0)
    s_waitcnt vmcnt(12)
    s_barrier
    v_mfma_f32_32x32x16_bf16 v[32:47], a[28:31], a[52:55], v[32:47]
    ds_read_b64_tr_b16 a[0:1], v23 offset:0
    ds_read_b64_tr_b16 a[2:3], v23 offset:512
    ds_read_b64_tr_b16 a[4:5], v23 offset:1024
    v_mfma_f32_32x32x16_bf16 v[48:63], a[32:35], a[52:55], v[48:63]
    ds_read_b64_tr_b16 a[6:7], v23 offset:1536
    ds_read_b64_tr_b16 a[8:9], v23 offset:4096
    ds_read_b64_tr_b16 a[10:11], v23 offset:4608
    v_mfma_f32_32x32x16_bf16 v[64:79], a[36:39], a[52:55], v[64:79]
    ds_read_b64_tr_b16 a[12:13], v23 offset:5120
    ds_read_b64_tr_b16 a[14:15], v23 offset:5632
    ds_read_b64_tr_b16 a[16:17], v23 offset:8192
    v_mfma_f32_32x32x16_bf16 v[80:95], a[40:43], a[52:55], v[80:95]
    ds_read_b64_tr_b16 a[18:19], v23 offset:8704
    ds_read_b64_tr_b16 a[20:21], v23 offset:9216
    ds_read_b64_tr_b16 a[22:23], v23 offset:9728
    s_add_u32 m0, s35, 40960
    s_add_u32 s32, s38, 384
    buffer_load_dwordx4 v4, s[20:23], s32 offen lds
    v_mfma_f32_32x32x16_bf16 v[96:111], a[44:47], a[52:55], v[96:111]
    v_mfma_f32_32x32x16_bf16 v[112:127], a[48:51], a[52:55], v[112:127]
    v_cvt_pk_bf16_f32 v128, v32, v33
    v_cvt_pk_bf16_f32 v129, v34, v35
    v_cvt_pk_bf16_f32 v130, v36, v37
    v_cvt_pk_bf16_f32 v131, v38, v39
    v_cvt_pk_bf16_f32 v132, v40, v41
    v_cvt_pk_bf16_f32 v133, v42, v43
    v_cvt_pk_bf16_f32 v134, v44, v45
    v_cvt_pk_bf16_f32 v135, v46, v47
    v_cvt_pk_bf16_f32 v136, v48, v49
    v_cvt_pk_bf16_f32 v137, v50, v51
    v_cvt_pk_bf16_f32 v138, v52, v53
    v_cvt_pk_bf16_f32 v139, v54, v55
    v_cvt_pk_bf16_f32 v140, v56, v57
    v_cvt_pk_bf16_f32 v141, v58, v59
    v_cvt_pk_bf16_f32 v142, v60, v61
    v_cvt_pk_bf16_f32 v143, v62, v63
    v_cvt_pk_bf16_f32 v144, v64, v65
    v_cvt_pk_bf16_f32 v145, v66, v67
    v_cvt_pk_bf16_f32 v146, v68, v69
    v_cvt_pk_bf16_f32 v147, v70, v71
    v_cvt_pk_bf16_f32 v148, v72, v73
    v_cvt_pk_bf16_f32 v149, v74, v75
    v_cvt_pk_bf16_f32 v150, v76, v77
    v_cvt_pk_bf16_f32 v151, v78, v79
    v_cvt_pk_bf16_f32 v152, v80, v81
    v_cvt_pk_bf16_f32 v153, v82, v83
    v_cvt_pk_bf16_f32 v154, v84, v85
    v_cvt_pk_bf16_f32 v155, v86, v87
    v_cvt_pk_bf16_f32 v156, v88, v89
    v_cvt_pk_bf16_f32 v157, v90, v91
    v_cvt_pk_bf16_f32 v158, v92, v93
    v_cvt_pk_bf16_f32 v159, v94, v95
    v_cvt_pk_bf16_f32 v160, v96, v97
    v_cvt_pk_bf16_f32 v161, v98, v99
    v_cvt_pk_bf16_f32 v162, v100, v101
    v_cvt_pk_bf16_f32 v163, v102, v103
    v_cvt_pk_bf16_f32 v164, v104, v105
    v_cvt_pk_bf16_f32 v165, v106, v107
    v_cvt_pk_bf16_f32 v166, v108, v109
    v_cvt_pk_bf16_f32 v167, v110, v111
    v_cvt_pk_bf16_f32 v168, v112, v113
    v_cvt_pk_bf16_f32 v169, v114, v115
    v_cvt_pk_bf16_f32 v170, v116, v117
    v_cvt_pk_bf16_f32 v171, v118, v119
    v_cvt_pk_bf16_f32 v172, v120, v121
    v_cvt_pk_bf16_f32 v173, v122, v123
    v_cvt_pk_bf16_f32 v174, v124, v125
    v_cvt_pk_bf16_f32 v175, v126, v127
    s_waitcnt lgkmcnt(10)
    v_mfma_f32_32x32x16_bf16 v[176:191], v[128:131], a[0:3], 0
    ds_read_b64_tr_b16 a[28:29], v23 offset:12288
    ds_read_b64_tr_b16 a[30:31], v23 offset:12800
    ds_read_b64_tr_b16 a[32:33], v23 offset:13312
    s_waitcnt lgkmcnt(11)
    v_mfma_f32_32x32x16_bf16 v[176:191], v[132:135], a[4:7], v[176:191]
    ds_read_b64_tr_b16 a[34:35], v23 offset:13824
    ds_read_b64_tr_b16 a[36:37], v23 offset:16384
    ds_read_b64_tr_b16 a[38:39], v23 offset:16896
    s_add_u32 m0, s35, 41984
    s_add_u32 s32, s38, 10624
    buffer_load_dwordx4 v4, s[20:23], s32 offen lds
    s_waitcnt lgkmcnt(12)
    v_mfma_f32_32x32x16_bf16 v[176:191], v[136:139], a[8:11], v[176:191]
    ds_read_b64_tr_b16 a[40:41], v23 offset:17408
    ds_read_b64_tr_b16 a[42:43], v23 offset:17920
    ds_read_b64_tr_b16 a[44:45], v23 offset:20480
    s_waitcnt lgkmcnt(13)
    v_mfma_f32_32x32x16_bf16 v[176:191], v[140:143], a[12:15], v[176:191]
    ds_read_b64_tr_b16 a[46:47], v23 offset:20992
    ds_read_b64_tr_b16 a[48:49], v23 offset:21504
    ds_read_b64_tr_b16 a[50:51], v23 offset:22016
    s_waitcnt lgkmcnt(14)
    v_mfma_f32_32x32x16_bf16 v[176:191], v[144:147], a[16:19], v[176:191]
    s_waitcnt lgkmcnt(12)
    v_mfma_f32_32x32x16_bf16 v[176:191], v[148:151], a[20:23], v[176:191]
    s_add_u32 m0, s35, 43008
    s_add_u32 s32, s38, 20864
    buffer_load_dwordx4 v4, s[20:23], s32 offen lds
    s_waitcnt lgkmcnt(10)
    v_mfma_f32_32x32x16_bf16 v[176:191], v[152:155], a[28:31], v[176:191]
    ds_read_b64_tr_b16 a[0:1], v24 offset:0
    ds_read_b64_tr_b16 a[2:3], v24 offset:512
    ds_read_b64_tr_b16 a[4:5], v24 offset:1024
    s_waitcnt lgkmcnt(11)
    v_mfma_f32_32x32x16_bf16 v[176:191], v[156:159], a[32:35], v[176:191]
    ds_read_b64_tr_b16 a[6:7], v24 offset:1536
    ds_read_b64_tr_b16 a[8:9], v24 offset:4096
    ds_read_b64_tr_b16 a[10:11], v24 offset:4608
    s_waitcnt lgkmcnt(12)
    v_mfma_f32_32x32x16_bf16 v[176:191], v[160:163], a[36:39], v[176:191]
    ds_read_b64_tr_b16 a[12:13], v24 offset:5120
    ds_read_b64_tr_b16 a[14:15], v24 offset:5632
    ds_read_b64_tr_b16 a[16:17], v24 offset:8192
    s_waitcnt lgkmcnt(13)
    v_mfma_f32_32x32x16_bf16 v[176:191], v[164:167], a[40:43], v[176:191]
    ds_read_b64_tr_b16 a[18:19], v24 offset:8704
    ds_read_b64_tr_b16 a[20:21], v24 offset:9216
    ds_read_b64_tr_b16 a[22:23], v24 offset:9728
    s_add_u32 m0, s35, 44032
    s_add_u32 s32, s38, 31104
    buffer_load_dwordx4 v4, s[20:23], s32 offen lds
    s_waitcnt lgkmcnt(14)
    v_mfma_f32_32x32x16_bf16 v[176:191], v[168:171], a[44:47], v[176:191]
    s_waitcnt lgkmcnt(12)
    v_mfma_f32_32x32x16_bf16 v[176:191], v[172:175], a[48:51], v[176:191]
    s_waitcnt lgkmcnt(10)
    v_mfma_f32_32x32x16_bf16 v[192:207], v[128:131], a[0:3], 0
    ds_read_b64_tr_b16 a[28:29], v24 offset:12288
    ds_read_b64_tr_b16 a[30:31], v24 offset:12800
    ds_read_b64_tr_b16 a[32:33], v24 offset:13312
    s_waitcnt lgkmcnt(11)
    v_mfma_f32_32x32x16_bf16 v[192:207], v[132:135], a[4:7], v[192:207]
    ds_read_b64_tr_b16 a[34:35], v24 offset:13824
    ds_read_b64_tr_b16 a[36:37], v24 offset:16384
    ds_read_b64_tr_b16 a[38:39], v24 offset:16896
    s_add_u32 m0, s35, 45056
    s_add_u32 s32, s38, 41344
    buffer_load_dwordx4 v4, s[20:23], s32 offen lds
    s_waitcnt lgkmcnt(12)
    v_mfma_f32_32x32x16_bf16 v[192:207], v[136:139], a[8:11], v[192:207]
    ds_read_b64_tr_b16 a[40:41], v24 offset:17408
    ds_read_b64_tr_b16 a[42:43], v24 offset:17920
    ds_read_b64_tr_b16 a[44:45], v24 offset:20480
    s_waitcnt lgkmcnt(13)
    v_mfma_f32_32x32x16_bf16 v[192:207], v[140:143], a[12:15], v[192:207]
    ds_read_b64_tr_b16 a[46:47], v24 offset:20992
    ds_read_b64_tr_b16 a[48:49], v24 offset:21504
    ds_read_b64_tr_b16 a[50:51], v24 offset:22016
    s_waitcnt lgkmcnt(14)
    v_mfma_f32_32x32x16_bf16 v[192:207], v[144:147], a[16:19], v[192:207]
    s_waitcnt lgkmcnt(12)
    v_mfma_f32_32x32x16_bf16 v[192:207], v[148:151], a[20:23], v[192:207]
    s_add_u32 m0, s35, 46080
    s_add_u32 s32, s38, 51584
    buffer_load_dwordx4 v4, s[20:23], s32 offen lds
    s_waitcnt lgkmcnt(0)
    s_waitcnt vmcnt(12)
    s_barrier
    v_mfma_f32_32x32x16_bf16 v[192:207], v[152:155], a[28:31], v[192:207]
    ds_read_b64_tr_b16 a[0:1], v23 offset:40960
    ds_read_b64_tr_b16 a[2:3], v23 offset:41472
    ds_read_b64_tr_b16 a[4:5], v23 offset:41984
    s_add_u32 s34, s41, 0
    v_cvt_pk_bf16_f32 v224, v176, v177
    v_mfma_f32_32x32x16_bf16 v[192:207], v[156:159], a[32:35], v[192:207]
    ds_read_b64_tr_b16 a[6:7], v23 offset:42496
    ds_read_b64_tr_b16 a[8:9], v23 offset:45056
    ds_read_b64_tr_b16 a[10:11], v23 offset:45568
    v_cvt_pk_bf16_f32 v225, v178, v179
    v_cvt_pk_bf16_f32 v226, v180, v181
    v_mfma_f32_32x32x16_bf16 v[192:207], v[160:163], a[36:39], v[192:207]
    ds_read_b64_tr_b16 a[12:13], v23 offset:46080
    ds_read_b64_tr_b16 a[14:15], v23 offset:46592
    ds_read_b64_tr_b16 a[16:17], v23 offset:49152
    v_cvt_pk_bf16_f32 v227, v182, v183
    buffer_store_dwordx4 v[224:227], v25, s[8:11], s34 offen offset:0 sc1
    v_mfma_f32_32x32x16_bf16 v[192:207], v[164:167], a[40:43], v[192:207]
    ds_read_b64_tr_b16 a[18:19], v23 offset:49664
    ds_read_b64_tr_b16 a[20:21], v23 offset:50176
    ds_read_b64_tr_b16 a[22:23], v23 offset:50688
    s_add_u32 m0, s35, 81920
    s_add_u32 s32, s38, 512
    buffer_load_dwordx4 v4, s[20:23], s32 offen lds
    v_cvt_pk_bf16_f32 v228, v184, v185
    v_cvt_pk_bf16_f32 v229, v186, v187
    v_mfma_f32_32x32x16_bf16 v[192:207], v[168:171], a[44:47], v[192:207]
    v_cvt_pk_bf16_f32 v230, v188, v189
    v_cvt_pk_bf16_f32 v231, v190, v191
    v_mfma_f32_32x32x16_bf16 v[192:207], v[172:175], a[48:51], v[192:207]
    buffer_store_dwordx4 v[228:231], v25, s[8:11], s34 offen offset:256 sc1
    s_waitcnt lgkmcnt(10)
    v_mfma_f32_32x32x16_bf16 v[176:191], v[128:131], a[0:3], 0
    ds_read_b64_tr_b16 a[28:29], v23 offset:53248
    ds_read_b64_tr_b16 a[30:31], v23 offset:53760
    ds_read_b64_tr_b16 a[32:33], v23 offset:54272
    s_waitcnt lgkmcnt(11)
    v_mfma_f32_32x32x16_bf16 v[176:191], v[132:135], a[4:7], v[176:191]
    ds_read_b64_tr_b16 a[34:35], v23 offset:54784
    ds_read_b64_tr_b16 a[36:37], v23 offset:57344
    ds_read_b64_tr_b16 a[38:39], v23 offset:57856
    s_add_u32 m0, s35, 82944
    s_add_u32 s32, s38, 10752
    buffer_load_dwordx4 v4, s[20:23], s32 offen lds
    s_waitcnt lgkmcnt(12)
    v_mfma_f32_32x32x16_bf16 v[176:191], v[136:139], a[8:11], v[176:191]
    ds_read_b64_tr_b16 a[40:41], v23 offset:58368
    ds_read_b64_tr_b16 a[42:43], v23 offset:58880
    ds_read_b64_tr_b16 a[44:45], v23 offset:61440
    s_waitcnt lgkmcnt(13)
    v_mfma_f32_32x32x16_bf16 v[176:191], v[140:143], a[12:15], v[176:191]
    ds_read_b64_tr_b16 a[46:47], v23 offset:61952
    ds_read_b64_tr_b16 a[48:49], v23 offset:62464
    ds_read_b64_tr_b16 a[50:51], v23 offset:62976
    s_waitcnt lgkmcnt(14)
    v_mfma_f32_32x32x16_bf16 v[176:191], v[144:147], a[16:19], v[176:191]
    s_waitcnt lgkmcnt(12)
    v_mfma_f32_32x32x16_bf16 v[176:191], v[148:151], a[20:23], v[176:191]
    s_add_u32 m0, s35, 83968
    s_add_u32 s32, s38, 20992
    buffer_load_dwordx4 v4, s[20:23], s32 offen lds
    s_waitcnt lgkmcnt(10)
    v_mfma_f32_32x32x16_bf16 v[176:191], v[152:155], a[28:31], v[176:191]
    ds_read_b64_tr_b16 a[0:1], v24 offset:40960
    ds_read_b64_tr_b16 a[2:3], v24 offset:41472
    ds_read_b64_tr_b16 a[4:5], v24 offset:41984
    s_add_u32 s34, s41, 32768
    v_cvt_pk_bf16_f32 v232, v192, v193
    s_waitcnt lgkmcnt(11)
    v_mfma_f32_32x32x16_bf16 v[176:191], v[156:159], a[32:35], v[176:191]
    ds_read_b64_tr_b16 a[6:7], v24 offset:42496
    ds_read_b64_tr_b16 a[8:9], v24 offset:45056
    ds_read_b64_tr_b16 a[10:11], v24 offset:45568
    v_cvt_pk_bf16_f32 v233, v194, v195
    v_cvt_pk_bf16_f32 v234, v196, v197
    s_waitcnt lgkmcnt(12)
    v_mfma_f32_32x32x16_bf16 v[176:191], v[160:163], a[36:39], v[176:191]
    ds_read_b64_tr_b16 a[12:13], v24 offset:46080
    ds_read_b64_tr_b16 a[14:15], v24 offset:46592
    ds_read_b64_tr_b16 a[16:17], v24 offset:49152
    v_cvt_pk_bf16_f32 v235, v198, v199
    buffer_store_dwordx4 v[232:235], v25, s[8:11], s34 offen offset:0 sc1
    s_waitcnt lgkmcnt(13)
    v_mfma_f32_32x32x16_bf16 v[176:191], v[164:167], a[40:43], v[176:191]
    ds_read_b64_tr_b16 a[18:19], v24 offset:49664
    ds_read_b64_tr_b16 a[20:21], v24 offset:50176
    ds_read_b64_tr_b16 a[22:23], v24 offset:50688
    s_add_u32 m0, s35, 84992
    s_add_u32 s32, s38, 31232
    buffer_load_dwordx4 v4, s[20:23], s32 offen lds
    v_cvt_pk_bf16_f32 v236, v200, v201
    v_cvt_pk_bf16_f32 v237, v202, v203
    s_waitcnt lgkmcnt(14)
    v_mfma_f32_32x32x16_bf16 v[176:191], v[168:171], a[44:47], v[176:191]
    v_cvt_pk_bf16_f32 v238, v204, v205
    v_cvt_pk_bf16_f32 v239, v206, v207
    s_waitcnt lgkmcnt(12)
    v_mfma_f32_32x32x16_bf16 v[176:191], v[172:175], a[48:51], v[176:191]
    buffer_store_dwordx4 v[236:239], v25, s[8:11], s34 offen offset:256 sc1
    s_waitcnt lgkmcnt(10)
    v_mfma_f32_32x32x16_bf16 v[192:207], v[128:131], a[0:3], 0
    ds_read_b64_tr_b16 a[28:29], v24 offset:53248
    ds_read_b64_tr_b16 a[30:31], v24 offset:53760
    ds_read_b64_tr_b16 a[32:33], v24 offset:54272
    s_waitcnt lgkmcnt(11)
    v_mfma_f32_32x32x16_bf16 v[192:207], v[132:135], a[4:7], v[192:207]
    ds_read_b64_tr_b16 a[34:35], v24 offset:54784
    ds_read_b64_tr_b16 a[36:37], v24 offset:57344
    ds_read_b64_tr_b16 a[38:39], v24 offset:57856
    s_add_u32 m0, s35, 86016
    s_add_u32 s32, s38, 41472
    buffer_load_dwordx4 v4, s[20:23], s32 offen lds
    s_waitcnt lgkmcnt(12)
    v_mfma_f32_32x32x16_bf16 v[192:207], v[136:139], a[8:11], v[192:207]
    ds_read_b64_tr_b16 a[40:41], v24 offset:58368
    ds_read_b64_tr_b16 a[42:43], v24 offset:58880
    ds_read_b64_tr_b16 a[44:45], v24 offset:61440
    s_waitcnt lgkmcnt(13)
    v_mfma_f32_32x32x16_bf16 v[192:207], v[140:143], a[12:15], v[192:207]
    ds_read_b64_tr_b16 a[46:47], v24 offset:61952
    ds_read_b64_tr_b16 a[48:49], v24 offset:62464
    ds_read_b64_tr_b16 a[50:51], v24 offset:62976
    s_waitcnt lgkmcnt(14)
    v_mfma_f32_32x32x16_bf16 v[192:207], v[144:147], a[16:19], v[192:207]
    s_waitcnt lgkmcnt(12)
    v_mfma_f32_32x32x16_bf16 v[192:207], v[148:151], a[20:23], v[192:207]
    s_add_u32 m0, s35, 87040
    s_add_u32 s32, s38, 51712
    buffer_load_dwordx4 v4, s[20:23], s32 offen lds
    s_waitcnt lgkmcnt(0)
    s_waitcnt vmcnt(16)
    s_barrier
    v_mfma_f32_32x32x16_bf16 v[192:207], v[152:155], a[28:31], v[192:207]
    ds_read_b64_tr_b16 a[0:1], v21 offset:0
    ds_read_b64_tr_b16 a[2:3], v21 offset:512
    ds_read_b64_tr_b16 a[4:5], v21 offset:1024
    s_add_u32 s34, s41, 65536
    v_cvt_pk_bf16_f32 v240, v176, v177
    v_mfma_f32_32x32x16_bf16 v[192:207], v[156:159], a[32:35], v[192:207]
    ds_read_b64_tr_b16 a[6:7], v21 offset:1536
    ds_read_b64_tr_b16 a[8:9], v21 offset:4096
    ds_read_b64_tr_b16 a[10:11], v21 offset:4608
    v_cvt_pk_bf16_f32 v241, v178, v179
    v_cvt_pk_bf16_f32 v242, v180, v181
    v_mfma_f32_32x32x16_bf16 v[192:207], v[160:163], a[36:39], v[192:207]
    ds_read_b64_tr_b16 a[12:13], v21 offset:5120
    ds_read_b64_tr_b16 a[14:15], v21 offset:5632
    ds_read_b64_tr_b16 a[16:17], v21 offset:8192
    v_cvt_pk_bf16_f32 v243, v182, v183
    buffer_store_dwordx4 v[240:243], v25, s[8:11], s34 offen offset:0 sc1
    v_mfma_f32_32x32x16_bf16 v[192:207], v[164:167], a[40:43], v[192:207]
    ds_read_b64_tr_b16 a[18:19], v21 offset:8704
    ds_read_b64_tr_b16 a[20:21], v21 offset:9216
    ds_read_b64_tr_b16 a[22:23], v21 offset:9728
    s_add_u32 m0, s35, 122880
    s_add_u32 s32, s38, 640
    buffer_load_dwordx4 v4, s[20:23], s32 offen lds
    v_cvt_pk_bf16_f32 v244, v184, v185
    v_cvt_pk_bf16_f32 v245, v186, v187
    v_mfma_f32_32x32x16_bf16 v[192:207], v[168:171], a[44:47], v[192:207]
    v_cvt_pk_bf16_f32 v246, v188, v189
    v_cvt_pk_bf16_f32 v247, v190, v191
    v_mfma_f32_32x32x16_bf16 v[192:207], v[172:175], a[48:51], v[192:207]
    buffer_store_dwordx4 v[244:247], v25, s[8:11], s34 offen offset:256 sc1
    s_waitcnt lgkmcnt(10)
    v_mfma_f32_32x32x16_bf16 v[176:191], v[128:131], a[0:3], 0
    ds_read_b64_tr_b16 a[28:29], v21 offset:12288
    ds_read_b64_tr_b16 a[30:31], v21 offset:12800
    ds_read_b64_tr_b16 a[32:33], v21 offset:13312
    s_waitcnt lgkmcnt(11)
    v_mfma_f32_32x32x16_bf16 v[176:191], v[132:135], a[4:7], v[176:191]
    ds_read_b64_tr_b16 a[34:35], v21 offset:13824
    ds_read_b64_tr_b16 a[36:37], v21 offset:16384
    ds_read_b64_tr_b16 a[38:39], v21 offset:16896
    s_add_u32 m0, s35, 123904
    s_add_u32 s32, s38, 10880
    buffer_load_dwordx4 v4, s[20:23], s32 offen lds
    s_waitcnt lgkmcnt(12)
    v_mfma_f32_32x32x16_bf16 v[176:191], v[136:139], a[8:11], v[176:191]
    ds_read_b64_tr_b16 a[40:41], v21 offset:17408
    ds_read_b64_tr_b16 a[42:43], v21 offset:17920
    ds_read_b64_tr_b16 a[44:45], v21 offset:20480
    s_waitcnt lgkmcnt(13)
    v_mfma_f32_32x32x16_bf16 v[176:191], v[140:143], a[12:15], v[176:191]
    ds_read_b64_tr_b16 a[46:47], v21 offset:20992
    ds_read_b64_tr_b16 a[48:49], v21 offset:21504
    ds_read_b64_tr_b16 a[50:51], v21 offset:22016
    s_waitcnt lgkmcnt(14)
    v_mfma_f32_32x32x16_bf16 v[176:191], v[144:147], a[16:19], v[176:191]
    s_waitcnt lgkmcnt(12)
    v_mfma_f32_32x32x16_bf16 v[176:191], v[148:151], a[20:23], v[176:191]
    s_add_u32 m0, s35, 124928
    s_add_u32 s32, s38, 21120
    buffer_load_dwordx4 v4, s[20:23], s32 offen lds
    s_waitcnt lgkmcnt(10)
    v_mfma_f32_32x32x16_bf16 v[176:191], v[152:155], a[28:31], v[176:191]
    ds_read_b64_tr_b16 a[0:1], v22 offset:0
    ds_read_b64_tr_b16 a[2:3], v22 offset:512
    ds_read_b64_tr_b16 a[4:5], v22 offset:1024
    s_add_u32 s34, s41, 98304
    v_cvt_pk_bf16_f32 v248, v192, v193
    s_waitcnt lgkmcnt(11)
    v_mfma_f32_32x32x16_bf16 v[176:191], v[156:159], a[32:35], v[176:191]
    ds_read_b64_tr_b16 a[6:7], v22 offset:1536
    ds_read_b64_tr_b16 a[8:9], v22 offset:4096
    ds_read_b64_tr_b16 a[10:11], v22 offset:4608
    v_cvt_pk_bf16_f32 v249, v194, v195
    v_cvt_pk_bf16_f32 v250, v196, v197
    s_waitcnt lgkmcnt(12)
    v_mfma_f32_32x32x16_bf16 v[176:191], v[160:163], a[36:39], v[176:191]
    ds_read_b64_tr_b16 a[12:13], v22 offset:5120
    ds_read_b64_tr_b16 a[14:15], v22 offset:5632
    ds_read_b64_tr_b16 a[16:17], v22 offset:8192
    v_cvt_pk_bf16_f32 v251, v198, v199
    buffer_store_dwordx4 v[248:251], v25, s[8:11], s34 offen offset:0 sc1
    s_waitcnt lgkmcnt(13)
    v_mfma_f32_32x32x16_bf16 v[176:191], v[164:167], a[40:43], v[176:191]
    ds_read_b64_tr_b16 a[18:19], v22 offset:8704
    ds_read_b64_tr_b16 a[20:21], v22 offset:9216
    ds_read_b64_tr_b16 a[22:23], v22 offset:9728
    s_add_u32 m0, s35, 125952
    s_add_u32 s32, s38, 31360
    buffer_load_dwordx4 v4, s[20:23], s32 offen lds
    v_cvt_pk_bf16_f32 v252, v200, v201
    v_cvt_pk_bf16_f32 v253, v202, v203
    s_waitcnt lgkmcnt(14)
    v_mfma_f32_32x32x16_bf16 v[176:191], v[168:171], a[44:47], v[176:191]
    v_cvt_pk_bf16_f32 v254, v204, v205
    v_cvt_pk_bf16_f32 v255, v206, v207
    s_waitcnt lgkmcnt(12)
    v_mfma_f32_32x32x16_bf16 v[176:191], v[172:175], a[48:51], v[176:191]
    buffer_store_dwordx4 v[252:255], v25, s[8:11], s34 offen offset:256 sc1
    s_waitcnt lgkmcnt(10)
    v_mfma_f32_32x32x16_bf16 v[192:207], v[128:131], a[0:3], 0
    ds_read_b64_tr_b16 a[28:29], v22 offset:12288
    ds_read_b64_tr_b16 a[30:31], v22 offset:12800
    ds_read_b64_tr_b16 a[32:33], v22 offset:13312
    s_waitcnt lgkmcnt(11)
    v_mfma_f32_32x32x16_bf16 v[192:207], v[132:135], a[4:7], v[192:207]
    ds_read_b64_tr_b16 a[34:35], v22 offset:13824
    ds_read_b64_tr_b16 a[36:37], v22 offset:16384
    ds_read_b64_tr_b16 a[38:39], v22 offset:16896
    s_add_u32 m0, s35, 126976
    s_add_u32 s32, s38, 41600
    buffer_load_dwordx4 v4, s[20:23], s32 offen lds
    s_waitcnt lgkmcnt(12)
    v_mfma_f32_32x32x16_bf16 v[192:207], v[136:139], a[8:11], v[192:207]
    ds_read_b64_tr_b16 a[40:41], v22 offset:17408
    ds_read_b64_tr_b16 a[42:43], v22 offset:17920
    ds_read_b64_tr_b16 a[44:45], v22 offset:20480
    s_waitcnt lgkmcnt(13)
    v_mfma_f32_32x32x16_bf16 v[192:207], v[140:143], a[12:15], v[192:207]
    ds_read_b64_tr_b16 a[46:47], v22 offset:20992
    ds_read_b64_tr_b16 a[48:49], v22 offset:21504
    ds_read_b64_tr_b16 a[50:51], v22 offset:22016
    s_waitcnt lgkmcnt(14)
    v_mfma_f32_32x32x16_bf16 v[192:207], v[144:147], a[16:19], v[192:207]
    s_waitcnt lgkmcnt(12)
    v_mfma_f32_32x32x16_bf16 v[192:207], v[148:151], a[20:23], v[192:207]
    s_add_u32 m0, s35, 128000
    s_add_u32 s32, s38, 51840
    buffer_load_dwordx4 v4, s[20:23], s32 offen lds
    s_waitcnt lgkmcnt(0)
    s_waitcnt vmcnt(20)
    s_barrier
    v_mfma_f32_32x32x16_bf16 v[192:207], v[152:155], a[28:31], v[192:207]
    ds_read_b64_tr_b16 a[0:1], v21 offset:40960
    ds_read_b64_tr_b16 a[2:3], v21 offset:41472
    ds_read_b64_tr_b16 a[4:5], v21 offset:41984
    s_add_u32 s34, s41, 131072
    v_cvt_pk_bf16_f32 v224, v176, v177
    v_mfma_f32_32x32x16_bf16 v[192:207], v[156:159], a[32:35], v[192:207]
    ds_read_b64_tr_b16 a[6:7], v21 offset:42496
    ds_read_b64_tr_b16 a[8:9], v21 offset:45056
    ds_read_b64_tr_b16 a[10:11], v21 offset:45568
    v_cvt_pk_bf16_f32 v225, v178, v179
    v_cvt_pk_bf16_f32 v226, v180, v181
    v_mfma_f32_32x32x16_bf16 v[192:207], v[160:163], a[36:39], v[192:207]
    ds_read_b64_tr_b16 a[12:13], v21 offset:46080
    ds_read_b64_tr_b16 a[14:15], v21 offset:46592
    ds_read_b64_tr_b16 a[16:17], v21 offset:49152
    v_cvt_pk_bf16_f32 v227, v182, v183
    buffer_store_dwordx4 v[224:227], v25, s[8:11], s34 offen offset:0 sc1
    v_mfma_f32_32x32x16_bf16 v[192:207], v[164:167], a[40:43], v[192:207]
    ds_read_b64_tr_b16 a[18:19], v21 offset:49664
    ds_read_b64_tr_b16 a[20:21], v21 offset:50176
    ds_read_b64_tr_b16 a[22:23], v21 offset:50688
    s_add_u32 m0, s35, 0
    s_add_u32 s32, s38, 768
    buffer_load_dwordx4 v4, s[20:23], s32 offen lds
    v_cvt_pk_bf16_f32 v228, v184, v185
    v_cvt_pk_bf16_f32 v229, v186, v187
    v_mfma_f32_32x32x16_bf16 v[192:207], v[168:171], a[44:47], v[192:207]
    v_cvt_pk_bf16_f32 v230, v188, v189
    v_cvt_pk_bf16_f32 v231, v190, v191
    v_mfma_f32_32x32x16_bf16 v[192:207], v[172:175], a[48:51], v[192:207]
    buffer_store_dwordx4 v[228:231], v25, s[8:11], s34 offen offset:256 sc1
    s_waitcnt lgkmcnt(10)
    v_mfma_f32_32x32x16_bf16 v[176:191], v[128:131], a[0:3], 0
    ds_read_b64_tr_b16 a[28:29], v21 offset:53248
    ds_read_b64_tr_b16 a[30:31], v21 offset:53760
    ds_read_b64_tr_b16 a[32:33], v21 offset:54272
    s_waitcnt lgkmcnt(11)
    v_mfma_f32_32x32x16_bf16 v[176:191], v[132:135], a[4:7], v[176:191]
    ds_read_b64_tr_b16 a[34:35], v21 offset:54784
    ds_read_b64_tr_b16 a[36:37], v21 offset:57344
    ds_read_b64_tr_b16 a[38:39], v21 offset:57856
    s_add_u32 m0, s35, 1024
    s_add_u32 s32, s38, 11008
    buffer_load_dwordx4 v4, s[20:23], s32 offen lds
    s_waitcnt lgkmcnt(12)
    v_mfma_f32_32x32x16_bf16 v[176:191], v[136:139], a[8:11], v[176:191]
    ds_read_b64_tr_b16 a[40:41], v21 offset:58368
    ds_read_b64_tr_b16 a[42:43], v21 offset:58880
    ds_read_b64_tr_b16 a[44:45], v21 offset:61440
    s_waitcnt lgkmcnt(13)
    v_mfma_f32_32x32x16_bf16 v[176:191], v[140:143], a[12:15], v[176:191]
    ds_read_b64_tr_b16 a[46:47], v21 offset:61952
    ds_read_b64_tr_b16 a[48:49], v21 offset:62464
    ds_read_b64_tr_b16 a[50:51], v21 offset:62976
    s_waitcnt lgkmcnt(14)
    v_mfma_f32_32x32x16_bf16 v[176:191], v[144:147], a[16:19], v[176:191]
    s_waitcnt lgkmcnt(12)
    v_mfma_f32_32x32x16_bf16 v[176:191], v[148:151], a[20:23], v[176:191]
    s_add_u32 m0, s35, 2048
    s_add_u32 s32, s38, 21248
    buffer_load_dwordx4 v4, s[20:23], s32 offen lds
    s_waitcnt lgkmcnt(10)
    v_mfma_f32_32x32x16_bf16 v[176:191], v[152:155], a[28:31], v[176:191]
    ds_read_b64_tr_b16 a[0:1], v22 offset:40960
    ds_read_b64_tr_b16 a[2:3], v22 offset:41472
    ds_read_b64_tr_b16 a[4:5], v22 offset:41984
    s_add_u32 s34, s41, 163840
    v_cvt_pk_bf16_f32 v232, v192, v193
    s_waitcnt lgkmcnt(11)
    v_mfma_f32_32x32x16_bf16 v[176:191], v[156:159], a[32:35], v[176:191]
    ds_read_b64_tr_b16 a[6:7], v22 offset:42496
    ds_read_b64_tr_b16 a[8:9], v22 offset:45056
    ds_read_b64_tr_b16 a[10:11], v22 offset:45568
    v_cvt_pk_bf16_f32 v233, v194, v195
    v_cvt_pk_bf16_f32 v234, v196, v197
    s_waitcnt lgkmcnt(12)
    v_mfma_f32_32x32x16_bf16 v[176:191], v[160:163], a[36:39], v[176:191]
    ds_read_b64_tr_b16 a[12:13], v22 offset:46080
    ds_read_b64_tr_b16 a[14:15], v22 offset:46592
    ds_read_b64_tr_b16 a[16:17], v22 offset:49152
    v_cvt_pk_bf16_f32 v235, v198, v199
    buffer_store_dwordx4 v[232:235], v25, s[8:11], s34 offen offset:0 sc1
    s_waitcnt lgkmcnt(13)
    v_mfma_f32_32x32x16_bf16 v[176:191], v[164:167], a[40:43], v[176:191]
    ds_read_b64_tr_b16 a[18:19], v22 offset:49664
    ds_read_b64_tr_b16 a[20:21], v22 offset:50176
    ds_read_b64_tr_b16 a[22:23], v22 offset:50688
    s_add_u32 m0, s35, 3072
    s_add_u32 s32, s38, 31488
    buffer_load_dwordx4 v4, s[20:23], s32 offen lds
    v_cvt_pk_bf16_f32 v236, v200, v201
    v_cvt_pk_bf16_f32 v237, v202, v203
    s_waitcnt lgkmcnt(14)
    v_mfma_f32_32x32x16_bf16 v[176:191], v[168:171], a[44:47], v[176:191]
    v_cvt_pk_bf16_f32 v238, v204, v205
    v_cvt_pk_bf16_f32 v239, v206, v207
    s_waitcnt lgkmcnt(12)
    v_mfma_f32_32x32x16_bf16 v[176:191], v[172:175], a[48:51], v[176:191]
    buffer_store_dwordx4 v[236:239], v25, s[8:11], s34 offen offset:256 sc1
    s_waitcnt lgkmcnt(10)
    v_mfma_f32_32x32x16_bf16 v[192:207], v[128:131], a[0:3], 0
    ds_read_b64_tr_b16 a[28:29], v22 offset:53248
    ds_read_b64_tr_b16 a[30:31], v22 offset:53760
    ds_read_b64_tr_b16 a[32:33], v22 offset:54272
    s_waitcnt lgkmcnt(11)
    v_mfma_f32_32x32x16_bf16 v[192:207], v[132:135], a[4:7], v[192:207]
    ds_read_b64_tr_b16 a[34:35], v22 offset:54784
    ds_read_b64_tr_b16 a[36:37], v22 offset:57344
    ds_read_b64_tr_b16 a[38:39], v22 offset:57856
    s_add_u32 m0, s35, 4096
    s_add_u32 s32, s38, 41728
    buffer_load_dwordx4 v4, s[20:23], s32 offen lds
    s_waitcnt lgkmcnt(12)
    v_mfma_f32_32x32x16_bf16 v[192:207], v[136:139], a[8:11], v[192:207]
    ds_read_b64_tr_b16 a[40:41], v22 offset:58368
    ds_read_b64_tr_b16 a[42:43], v22 offset:58880
    ds_read_b64_tr_b16 a[44:45], v22 offset:61440
    s_waitcnt lgkmcnt(13)
    v_mfma_f32_32x32x16_bf16 v[192:207], v[140:143], a[12:15], v[192:207]
    ds_read_b64_tr_b16 a[46:47], v22 offset:61952
    ds_read_b64_tr_b16 a[48:49], v22 offset:62464
    ds_read_b64_tr_b16 a[50:51], v22 offset:62976
    s_waitcnt lgkmcnt(14)
    v_mfma_f32_32x32x16_bf16 v[192:207], v[144:147], a[16:19], v[192:207]
    s_waitcnt lgkmcnt(12)
    v_mfma_f32_32x32x16_bf16 v[192:207], v[148:151], a[20:23], v[192:207]
    s_add_u32 m0, s35, 5120
    s_add_u32 s32, s38, 51968
    buffer_load_dwordx4 v4, s[20:23], s32 offen lds
    s_waitcnt lgkmcnt(0)
    s_waitcnt vmcnt(20)
    s_barrier
    v_mfma_f32_32x32x16_bf16 v[192:207], v[152:155], a[28:31], v[192:207]
    ds_read_b64_tr_b16 a[0:1], v23 offset:0
    ds_read_b64_tr_b16 a[2:3], v23 offset:512
    ds_read_b64_tr_b16 a[4:5], v23 offset:1024
    s_add_u32 s34, s41, 196608
    v_cvt_pk_bf16_f32 v240, v176, v177
    v_mfma_f32_32x32x16_bf16 v[192:207], v[156:159], a[32:35], v[192:207]
    ds_read_b64_tr_b16 a[6:7], v23 offset:1536
    ds_read_b64_tr_b16 a[8:9], v23 offset:4096
    ds_read_b64_tr_b16 a[10:11], v23 offset:4608
    v_cvt_pk_bf16_f32 v241, v178, v179
    v_cvt_pk_bf16_f32 v242, v180, v181
    v_mfma_f32_32x32x16_bf16 v[192:207], v[160:163], a[36:39], v[192:207]
    ds_read_b64_tr_b16 a[12:13], v23 offset:5120
    ds_read_b64_tr_b16 a[14:15], v23 offset:5632
    ds_read_b64_tr_b16 a[16:17], v23 offset:8192
    v_cvt_pk_bf16_f32 v243, v182, v183
    buffer_store_dwordx4 v[240:243], v25, s[8:11], s34 offen offset:0 sc1
    v_mfma_f32_32x32x16_bf16 v[192:207], v[164:167], a[40:43], v[192:207]
    ds_read_b64_tr_b16 a[18:19], v23 offset:8704
    ds_read_b64_tr_b16 a[20:21], v23 offset:9216
    ds_read_b64_tr_b16 a[22:23], v23 offset:9728
    s_add_u32 m0, s35, 40960
    s_add_u32 s32, s38, 896
    buffer_load_dwordx4 v4, s[20:23], s32 offen lds
    v_cvt_pk_bf16_f32 v244, v184, v185
    v_cvt_pk_bf16_f32 v245, v186, v187
    v_mfma_f32_32x32x16_bf16 v[192:207], v[168:171], a[44:47], v[192:207]
    v_cvt_pk_bf16_f32 v246, v188, v189
    v_cvt_pk_bf16_f32 v247, v190, v191
    v_mfma_f32_32x32x16_bf16 v[192:207], v[172:175], a[48:51], v[192:207]
    buffer_store_dwordx4 v[244:247], v25, s[8:11], s34 offen offset:256 sc1
    s_waitcnt lgkmcnt(10)
    v_mfma_f32_32x32x16_bf16 v[176:191], v[128:131], a[0:3], 0
    ds_read_b64_tr_b16 a[28:29], v23 offset:12288
    ds_read_b64_tr_b16 a[30:31], v23 offset:12800
    ds_read_b64_tr_b16 a[32:33], v23 offset:13312
    s_waitcnt lgkmcnt(11)
    v_mfma_f32_32x32x16_bf16 v[176:191], v[132:135], a[4:7], v[176:191]
    ds_read_b64_tr_b16 a[34:35], v23 offset:13824
    ds_read_b64_tr_b16 a[36:37], v23 offset:16384
    ds_read_b64_tr_b16 a[38:39], v23 offset:16896
    s_add_u32 m0, s35, 41984
    s_add_u32 s32, s38, 11136
    buffer_load_dwordx4 v4, s[20:23], s32 offen lds
    s_waitcnt lgkmcnt(12)
    v_mfma_f32_32x32x16_bf16 v[176:191], v[136:139], a[8:11], v[176:191]
    ds_read_b64_tr_b16 a[40:41], v23 offset:17408
    ds_read_b64_tr_b16 a[42:43], v23 offset:17920
    ds_read_b64_tr_b16 a[44:45], v23 offset:20480
    s_waitcnt lgkmcnt(13)
    v_mfma_f32_32x32x16_bf16 v[176:191], v[140:143], a[12:15], v[176:191]
    ds_read_b64_tr_b16 a[46:47], v23 offset:20992
    ds_read_b64_tr_b16 a[48:49], v23 offset:21504
    ds_read_b64_tr_b16 a[50:51], v23 offset:22016
    s_waitcnt lgkmcnt(14)
    v_mfma_f32_32x32x16_bf16 v[176:191], v[144:147], a[16:19], v[176:191]
    s_waitcnt lgkmcnt(12)
    v_mfma_f32_32x32x16_bf16 v[176:191], v[148:151], a[20:23], v[176:191]
    s_add_u32 m0, s35, 43008
    s_add_u32 s32, s38, 21376
    buffer_load_dwordx4 v4, s[20:23], s32 offen lds
    s_waitcnt lgkmcnt(10)
    v_mfma_f32_32x32x16_bf16 v[176:191], v[152:155], a[28:31], v[176:191]
    ds_read_b64_tr_b16 a[0:1], v24 offset:0
    ds_read_b64_tr_b16 a[2:3], v24 offset:512
    ds_read_b64_tr_b16 a[4:5], v24 offset:1024
    s_add_u32 s34, s41, 229376
    v_cvt_pk_bf16_f32 v248, v192, v193
    s_waitcnt lgkmcnt(11)
    v_mfma_f32_32x32x16_bf16 v[176:191], v[156:159], a[32:35], v[176:191]
    ds_read_b64_tr_b16 a[6:7], v24 offset:1536
    ds_read_b64_tr_b16 a[8:9], v24 offset:4096
    ds_read_b64_tr_b16 a[10:11], v24 offset:4608
    v_cvt_pk_bf16_f32 v249, v194, v195
    v_cvt_pk_bf16_f32 v250, v196, v197
    s_waitcnt lgkmcnt(12)
    v_mfma_f32_32x32x16_bf16 v[176:191], v[160:163], a[36:39], v[176:191]
    ds_read_b64_tr_b16 a[12:13], v24 offset:5120
    ds_read_b64_tr_b16 a[14:15], v24 offset:5632
    ds_read_b64_tr_b16 a[16:17], v24 offset:8192
    v_cvt_pk_bf16_f32 v251, v198, v199
    buffer_store_dwordx4 v[248:251], v25, s[8:11], s34 offen offset:0 sc1
    s_waitcnt lgkmcnt(13)
    v_mfma_f32_32x32x16_bf16 v[176:191], v[164:167], a[40:43], v[176:191]
    ds_read_b64_tr_b16 a[18:19], v24 offset:8704
    ds_read_b64_tr_b16 a[20:21], v24 offset:9216
    ds_read_b64_tr_b16 a[22:23], v24 offset:9728
    s_add_u32 m0, s35, 44032
    s_add_u32 s32, s38, 31616
    buffer_load_dwordx4 v4, s[20:23], s32 offen lds
    v_cvt_pk_bf16_f32 v252, v200, v201
    v_cvt_pk_bf16_f32 v253, v202, v203
    s_waitcnt lgkmcnt(14)
    v_mfma_f32_32x32x16_bf16 v[176:191], v[168:171], a[44:47], v[176:191]
    v_cvt_pk_bf16_f32 v254, v204, v205
    v_cvt_pk_bf16_f32 v255, v206, v207
    s_waitcnt lgkmcnt(12)
    v_mfma_f32_32x32x16_bf16 v[176:191], v[172:175], a[48:51], v[176:191]
    buffer_store_dwordx4 v[252:255], v25, s[8:11], s34 offen offset:256 sc1
    s_waitcnt lgkmcnt(10)
    v_mfma_f32_32x32x16_bf16 v[192:207], v[128:131], a[0:3], 0
    ds_read_b64_tr_b16 a[28:29], v24 offset:12288
    ds_read_b64_tr_b16 a[30:31], v24 offset:12800
    ds_read_b64_tr_b16 a[32:33], v24 offset:13312
    s_waitcnt lgkmcnt(11)
    v_mfma_f32_32x32x16_bf16 v[192:207], v[132:135], a[4:7], v[192:207]
    ds_read_b64_tr_b16 a[34:35], v24 offset:13824
    ds_read_b64_tr_b16 a[36:37], v24 offset:16384
    ds_read_b64_tr_b16 a[38:39], v24 offset:16896
    s_add_u32 m0, s35, 45056
    s_add_u32 s32, s38, 41856
    buffer_load_dwordx4 v4, s[20:23], s32 offen lds
    s_waitcnt lgkmcnt(12)
    v_mfma_f32_32x32x16_bf16 v[192:207], v[136:139], a[8:11], v[192:207]
    ds_read_b64_tr_b16 a[40:41], v24 offset:17408
    ds_read_b64_tr_b16 a[42:43], v24 offset:17920
    ds_read_b64_tr_b16 a[44:45], v24 offset:20480
    s_waitcnt lgkmcnt(13)
    v_mfma_f32_32x32x16_bf16 v[192:207], v[140:143], a[12:15], v[192:207]
    ds_read_b64_tr_b16 a[46:47], v24 offset:20992
    ds_read_b64_tr_b16 a[48:49], v24 offset:21504
    ds_read_b64_tr_b16 a[50:51], v24 offset:22016
    s_waitcnt lgkmcnt(14)
    v_mfma_f32_32x32x16_bf16 v[192:207], v[144:147], a[16:19], v[192:207]
    s_waitcnt lgkmcnt(12)
    v_mfma_f32_32x32x16_bf16 v[192:207], v[148:151], a[20:23], v[192:207]
    s_add_u32 m0, s35, 46080
    s_add_u32 s32, s38, 52096
    buffer_load_dwordx4 v4, s[20:23], s32 offen lds
    s_waitcnt lgkmcnt(0)
    s_waitcnt vmcnt(20)
    s_barrier
    v_mfma_f32_32x32x16_bf16 v[192:207], v[152:155], a[28:31], v[192:207]
    ds_read_b64_tr_b16 a[0:1], v23 offset:40960
    ds_read_b64_tr_b16 a[2:3], v23 offset:41472
    ds_read_b64_tr_b16 a[4:5], v23 offset:41984
    s_add_u32 s34, s41, 262144
    v_cvt_pk_bf16_f32 v224, v176, v177
    v_mfma_f32_32x32x16_bf16 v[192:207], v[156:159], a[32:35], v[192:207]
    ds_read_b64_tr_b16 a[6:7], v23 offset:42496
    ds_read_b64_tr_b16 a[8:9], v23 offset:45056
    ds_read_b64_tr_b16 a[10:11], v23 offset:45568
    v_cvt_pk_bf16_f32 v225, v178, v179
    v_cvt_pk_bf16_f32 v226, v180, v181
    v_mfma_f32_32x32x16_bf16 v[192:207], v[160:163], a[36:39], v[192:207]
    ds_read_b64_tr_b16 a[12:13], v23 offset:46080
    ds_read_b64_tr_b16 a[14:15], v23 offset:46592
    ds_read_b64_tr_b16 a[16:17], v23 offset:49152
    v_cvt_pk_bf16_f32 v227, v182, v183
    buffer_store_dwordx4 v[224:227], v25, s[8:11], s34 offen offset:0 sc1
    v_mfma_f32_32x32x16_bf16 v[192:207], v[164:167], a[40:43], v[192:207]
    ds_read_b64_tr_b16 a[18:19], v23 offset:49664
    ds_read_b64_tr_b16 a[20:21], v23 offset:50176
    ds_read_b64_tr_b16 a[22:23], v23 offset:50688
    s_add_u32 m0, s35, 81920
    s_add_u32 s32, s38, 1024
    buffer_load_dwordx4 v4, s[20:23], s32 offen lds
    v_cvt_pk_bf16_f32 v228, v184, v185
    v_cvt_pk_bf16_f32 v229, v186, v187
    v_mfma_f32_32x32x16_bf16 v[192:207], v[168:171], a[44:47], v[192:207]
    v_cvt_pk_bf16_f32 v230, v188, v189
    v_cvt_pk_bf16_f32 v231, v190, v191
    v_mfma_f32_32x32x16_bf16 v[192:207], v[172:175], a[48:51], v[192:207]
    buffer_store_dwordx4 v[228:231], v25, s[8:11], s34 offen offset:256 sc1
    s_waitcnt lgkmcnt(10)
    v_mfma_f32_32x32x16_bf16 v[176:191], v[128:131], a[0:3], 0
    ds_read_b64_tr_b16 a[28:29], v23 offset:53248
    ds_read_b64_tr_b16 a[30:31], v23 offset:53760
    ds_read_b64_tr_b16 a[32:33], v23 offset:54272
    s_waitcnt lgkmcnt(11)
    v_mfma_f32_32x32x16_bf16 v[176:191], v[132:135], a[4:7], v[176:191]
    ds_read_b64_tr_b16 a[34:35], v23 offset:54784
    ds_read_b64_tr_b16 a[36:37], v23 offset:57344
    ds_read_b64_tr_b16 a[38:39], v23 offset:57856
    s_add_u32 m0, s35, 82944
    s_add_u32 s32, s38, 11264
    buffer_load_dwordx4 v4, s[20:23], s32 offen lds
    s_waitcnt lgkmcnt(12)
    v_mfma_f32_32x32x16_bf16 v[176:191], v[136:139], a[8:11], v[176:191]
    ds_read_b64_tr_b16 a[40:41], v23 offset:58368
    ds_read_b64_tr_b16 a[42:43], v23 offset:58880
    ds_read_b64_tr_b16 a[44:45], v23 offset:61440
    s_waitcnt lgkmcnt(13)
    v_mfma_f32_32x32x16_bf16 v[176:191], v[140:143], a[12:15], v[176:191]
    ds_read_b64_tr_b16 a[46:47], v23 offset:61952
    ds_read_b64_tr_b16 a[48:49], v23 offset:62464
    ds_read_b64_tr_b16 a[50:51], v23 offset:62976
    s_waitcnt lgkmcnt(14)
    v_mfma_f32_32x32x16_bf16 v[176:191], v[144:147], a[16:19], v[176:191]
    s_waitcnt lgkmcnt(12)
    v_mfma_f32_32x32x16_bf16 v[176:191], v[148:151], a[20:23], v[176:191]
    s_add_u32 m0, s35, 83968
    s_add_u32 s32, s38, 21504
    buffer_load_dwordx4 v4, s[20:23], s32 offen lds
    s_waitcnt lgkmcnt(10)
    v_mfma_f32_32x32x16_bf16 v[176:191], v[152:155], a[28:31], v[176:191]
    ds_read_b64_tr_b16 a[0:1], v24 offset:40960
    ds_read_b64_tr_b16 a[2:3], v24 offset:41472
    ds_read_b64_tr_b16 a[4:5], v24 offset:41984
    s_add_u32 s34, s41, 294912
    v_cvt_pk_bf16_f32 v232, v192, v193
    s_waitcnt lgkmcnt(11)
    v_mfma_f32_32x32x16_bf16 v[176:191], v[156:159], a[32:35], v[176:191]
    ds_read_b64_tr_b16 a[6:7], v24 offset:42496
    ds_read_b64_tr_b16 a[8:9], v24 offset:45056
    ds_read_b64_tr_b16 a[10:11], v24 offset:45568
    v_cvt_pk_bf16_f32 v233, v194, v195
    v_cvt_pk_bf16_f32 v234, v196, v197
    s_waitcnt lgkmcnt(12)
    v_mfma_f32_32x32x16_bf16 v[176:191], v[160:163], a[36:39], v[176:191]
    ds_read_b64_tr_b16 a[12:13], v24 offset:46080
    ds_read_b64_tr_b16 a[14:15], v24 offset:46592
    ds_read_b64_tr_b16 a[16:17], v24 offset:49152
    v_cvt_pk_bf16_f32 v235, v198, v199
    buffer_store_dwordx4 v[232:235], v25, s[8:11], s34 offen offset:0 sc1
    s_waitcnt lgkmcnt(13)
    v_mfma_f32_32x32x16_bf16 v[176:191], v[164:167], a[40:43], v[176:191]
    ds_read_b64_tr_b16 a[18:19], v24 offset:49664
    ds_read_b64_tr_b16 a[20:21], v24 offset:50176
    ds_read_b64_tr_b16 a[22:23], v24 offset:50688
    s_add_u32 m0, s35, 84992
    s_add_u32 s32, s38, 31744
    buffer_load_dwordx4 v4, s[20:23], s32 offen lds
    v_cvt_pk_bf16_f32 v236, v200, v201
    v_cvt_pk_bf16_f32 v237, v202, v203
    s_waitcnt lgkmcnt(14)
    v_mfma_f32_32x32x16_bf16 v[176:191], v[168:171], a[44:47], v[176:191]
    v_cvt_pk_bf16_f32 v238, v204, v205
    v_cvt_pk_bf16_f32 v239, v206, v207
    s_waitcnt lgkmcnt(12)
    v_mfma_f32_32x32x16_bf16 v[176:191], v[172:175], a[48:51], v[176:191]
    buffer_store_dwordx4 v[236:239], v25, s[8:11], s34 offen offset:256 sc1
    s_cmp_lg_u32 s58, 0
    s_cbranch_scc1 wexit_7
    s_waitcnt lgkmcnt(10)
    v_mfma_f32_32x32x16_bf16 v[192:207], v[128:131], a[0:3], 0
    ds_read_b64_tr_b16 a[28:29], v24 offset:53248
    ds_read_b64_tr_b16 a[30:31], v24 offset:53760
    ds_read_b64_tr_b16 a[32:33], v24 offset:54272
    s_waitcnt lgkmcnt(11)
    v_mfma_f32_32x32x16_bf16 v[192:207], v[132:135], a[4:7], v[192:207]
    ds_read_b64_tr_b16 a[34:35], v24 offset:54784
    ds_read_b64_tr_b16 a[36:37], v24 offset:57344
    ds_read_b64_tr_b16 a[38:39], v24 offset:57856
    s_add_u32 m0, s35, 86016
    s_add_u32 s32, s38, 41984
    buffer_load_dwordx4 v4, s[20:23], s32 offen lds
    s_waitcnt lgkmcnt(12)
    v_mfma_f32_32x32x16_bf16 v[192:207], v[136:139], a[8:11], v[192:207]
    ds_read_b64_tr_b16 a[40:41], v24 offset:58368
    ds_read_b64_tr_b16 a[42:43], v24 offset:58880
    ds_read_b64_tr_b16 a[44:45], v24 offset:61440
    s_waitcnt lgkmcnt(13)
    v_mfma_f32_32x32x16_bf16 v[192:207], v[140:143], a[12:15], v[192:207]
    ds_read_b64_tr_b16 a[46:47], v24 offset:61952
    ds_read_b64_tr_b16 a[48:49], v24 offset:62464
    ds_read_b64_tr_b16 a[50:51], v24 offset:62976
    s_waitcnt lgkmcnt(14)
    v_mfma_f32_32x32x16_bf16 v[192:207], v[144:147], a[16:19], v[192:207]
    s_waitcnt lgkmcnt(12)
    v_mfma_f32_32x32x16_bf16 v[192:207], v[148:151], a[20:23], v[192:207]
    s_add_u32 m0, s35, 87040
    s_add_u32 s32, s38, 52224
    buffer_load_dwordx4 v4, s[20:23], s32 offen lds
    s_waitcnt lgkmcnt(0)
    s_waitcnt vmcnt(20)
    s_barrier
    v_mfma_f32_32x32x16_bf16 v[192:207], v[152:155], a[28:31], v[192:207]
    ds_read_b64_tr_b16 a[0:1], v21 offset:0
    ds_read_b64_tr_b16 a[2:3], v21 offset:512
    ds_read_b64_tr_b16 a[4:5], v21 offset:1024
    s_add_u32 s34, s41, 327680
    v_cvt_pk_bf16_f32 v240, v176, v177
    v_mfma_f32_32x32x16_bf16 v[192:207], v[156:159], a[32:35], v[192:207]
    ds_read_b64_tr_b16 a[6:7], v21 offset:1536
    ds_read_b64_tr_b16 a[8:9], v21 offset:4096
    ds_read_b64_tr_b16 a[10:11], v21 offset:4608
    v_cvt_pk_bf16_f32 v241, v178, v179
    v_cvt_pk_bf16_f32 v242, v180, v181
    v_mfma_f32_32x32x16_bf16 v[192:207], v[160:163], a[36:39], v[192:207]
    ds_read_b64_tr_b16 a[12:13], v21 offset:5120
    ds_read_b64_tr_b16 a[14:15], v21 offset:5632
    ds_read_b64_tr_b16 a[16:17], v21 offset:8192
    v_cvt_pk_bf16_f32 v243, v182, v183
    buffer_store_dwordx4 v[240:243], v25, s[8:11], s34 offen offset:0 sc1
    v_mfma_f32_32x32x16_bf16 v[192:207], v[164:167], a[40:43], v[192:207]
    ds_read_b64_tr_b16 a[18:19], v21 offset:8704
    ds_read_b64_tr_b16 a[20:21], v21 offset:9216
    ds_read_b64_tr_b16 a[22:23], v21 offset:9728
    s_add_u32 m0, s35, 122880
    s_add_u32 s32, s38, 1152
    buffer_load_dwordx4 v4, s[20:23], s32 offen lds
    v_cvt_pk_bf16_f32 v244, v184, v185
    v_cvt_pk_bf16_f32 v245, v186, v187
    v_mfma_f32_32x32x16_bf16 v[192:207], v[168:171], a[44:47], v[192:207]
    v_cvt_pk_bf16_f32 v246, v188, v189
    v_cvt_pk_bf16_f32 v247, v190, v191
    v_mfma_f32_32x32x16_bf16 v[192:207], v[172:175], a[48:51], v[192:207]
    buffer_store_dwordx4 v[244:247], v25, s[8:11], s34 offen offset:256 sc1
    s_waitcnt lgkmcnt(10)
    v_mfma_f32_32x32x16_bf16 v[176:191], v[128:131], a[0:3], 0
    ds_read_b64_tr_b16 a[28:29], v21 offset:12288
    ds_read_b64_tr_b16 a[30:31], v21 offset:12800
    ds_read_b64_tr_b16 a[32:33], v21 offset:13312
    s_waitcnt lgkmcnt(11)
    v_mfma_f32_32x32x16_bf16 v[176:191], v[132:135], a[4:7], v[176:191]
    ds_read_b64_tr_b16 a[34:35], v21 offset:13824
    ds_read_b64_tr_b16 a[36:37], v21 offset:16384
    ds_read_b64_tr_b16 a[38:39], v21 offset:16896
    s_add_u32 m0, s35, 123904
    s_add_u32 s32, s38, 11392
    buffer_load_dwordx4 v4, s[20:23], s32 offen lds
    s_waitcnt lgkmcnt(12)
    v_mfma_f32_32x32x16_bf16 v[176:191], v[136:139], a[8:11], v[176:191]
    ds_read_b64_tr_b16 a[40:41], v21 offset:17408
    ds_read_b64_tr_b16 a[42:43], v21 offset:17920
    ds_read_b64_tr_b16 a[44:45], v21 offset:20480
    s_waitcnt lgkmcnt(13)
    v_mfma_f32_32x32x16_bf16 v[176:191], v[140:143], a[12:15], v[176:191]
    ds_read_b64_tr_b16 a[46:47], v21 offset:20992
    ds_read_b64_tr_b16 a[48:49], v21 offset:21504
    ds_read_b64_tr_b16 a[50:51], v21 offset:22016
    s_waitcnt lgkmcnt(14)
    v_mfma_f32_32x32x16_bf16 v[176:191], v[144:147], a[16:19], v[176:191]
    s_waitcnt lgkmcnt(12)
    v_mfma_f32_32x32x16_bf16 v[176:191], v[148:151], a[20:23], v[176:191]
    s_add_u32 m0, s35, 124928
    s_add_u32 s32, s38, 21632
    buffer_load_dwordx4 v4, s[20:23], s32 offen lds
    s_waitcnt lgkmcnt(10)
    v_mfma_f32_32x32x16_bf16 v[176:191], v[152:155], a[28:31], v[176:191]
    ds_read_b64_tr_b16 a[0:1], v22 offset:0
    ds_read_b64_tr_b16 a[2:3], v22 offset:512
    ds_read_b64_tr_b16 a[4:5], v22 offset:1024
    s_add_u32 s34, s41, 360448
    v_cvt_pk_bf16_f32 v248, v192, v193
    s_waitcnt lgkmcnt(11)
    v_mfma_f32_32x32x16_bf16 v[176:191], v[156:159], a[32:35], v[176:191]
    ds_read_b64_tr_b16 a[6:7], v22 offset:1536
    ds_read_b64_tr_b16 a[8:9], v22 offset:4096
    ds_read_b64_tr_b16 a[10:11], v22 offset:4608
    v_cvt_pk_bf16_f32 v249, v194, v195
    v_cvt_pk_bf16_f32 v250, v196, v197
    s_waitcnt lgkmcnt(12)
    v_mfma_f32_32x32x16_bf16 v[176:191], v[160:163], a[36:39], v[176:191]
    ds_read_b64_tr_b16 a[12:13], v22 offset:5120
    ds_read_b64_tr_b16 a[14:15], v22 offset:5632
    ds_read_b64_tr_b16 a[16:17], v22 offset:8192
    v_cvt_pk_bf16_f32 v251, v198, v199
    buffer_store_dwordx4 v[248:251], v25, s[8:11], s34 offen offset:0 sc1
    s_waitcnt lgkmcnt(13)
    v_mfma_f32_32x32x16_bf16 v[176:191], v[164:167], a[40:43], v[176:191]
    ds_read_b64_tr_b16 a[18:19], v22 offset:8704
    ds_read_b64_tr_b16 a[20:21], v22 offset:9216
    ds_read_b64_tr_b16 a[22:23], v22 offset:9728
    s_add_u32 m0, s35, 125952
    s_add_u32 s32, s38, 31872
    buffer_load_dwordx4 v4, s[20:23], s32 offen lds
    v_cvt_pk_bf16_f32 v252, v200, v201
    v_cvt_pk_bf16_f32 v253, v202, v203
    s_waitcnt lgkmcnt(14)
    v_mfma_f32_32x32x16_bf16 v[176:191], v[168:171], a[44:47], v[176:191]
    v_cvt_pk_bf16_f32 v254, v204, v205
    v_cvt_pk_bf16_f32 v255, v206, v207
    s_waitcnt lgkmcnt(12)
    v_mfma_f32_32x32x16_bf16 v[176:191], v[172:175], a[48:51], v[176:191]
    buffer_store_dwordx4 v[252:255], v25, s[8:11], s34 offen offset:256 sc1
    s_waitcnt lgkmcnt(10)
    v_mfma_f32_32x32x16_bf16 v[192:207], v[128:131], a[0:3], 0
    ds_read_b64_tr_b16 a[28:29], v22 offset:12288
    ds_read_b64_tr_b16 a[30:31], v22 offset:12800
    ds_read_b64_tr_b16 a[32:33], v22 offset:13312
    s_waitcnt lgkmcnt(11)
    v_mfma_f32_32x32x16_bf16 v[192:207], v[132:135], a[4:7], v[192:207]
    ds_read_b64_tr_b16 a[34:35], v22 offset:13824
    ds_read_b64_tr_b16 a[36:37], v22 offset:16384
    ds_read_b64_tr_b16 a[38:39], v22 offset:16896
    s_add_u32 m0, s35, 126976
    s_add_u32 s32, s38, 42112
    buffer_load_dwordx4 v4, s[20:23], s32 offen lds
    s_waitcnt lgkmcnt(12)
    v_mfma_f32_32x32x16_bf16 v[192:207], v[136:139], a[8:11], v[192:207]
    ds_read_b64_tr_b16 a[40:41], v22 offset:17408
    ds_read_b64_tr_b16 a[42:43], v22 offset:17920
    ds_read_b64_tr_b16 a[44:45], v22 offset:20480
    s_waitcnt lgkmcnt(13)
    v_mfma_f32_32x32x16_bf16 v[192:207], v[140:143], a[12:15], v[192:207]
    ds_read_b64_tr_b16 a[46:47], v22 offset:20992
    ds_read_b64_tr_b16 a[48:49], v22 offset:21504
    ds_read_b64_tr_b16 a[50:51], v22 offset:22016
    s_waitcnt lgkmcnt(14)
    v_mfma_f32_32x32x16_bf16 v[192:207], v[144:147], a[16:19], v[192:207]
    s_waitcnt lgkmcnt(12)
    v_mfma_f32_32x32x16_bf16 v[192:207], v[148:151], a[20:23], v[192:207]
    s_add_u32 m0, s35, 128000
    s_add_u32 s32, s38, 52352
    buffer_load_dwordx4 v4, s[20:23], s32 offen lds
    s_waitcnt lgkmcnt(0)
    s_waitcnt vmcnt(20)
    s_barrier
    v_mfma_f32_32x32x16_bf16 v[192:207], v[152:155], a[28:31], v[192:207]
    ds_read_b64_tr_b16 a[0:1], v21 offset:40960
    ds_read_b64_tr_b16 a[2:3], v21 offset:41472
    ds_read_b64_tr_b16 a[4:5], v21 offset:41984
    s_add_u32 s34, s41, 393216
    v_cvt_pk_bf16_f32 v224, v176, v177
    v_mfma_f32_32x32x16_bf16 v[192:207], v[156:159], a[32:35], v[192:207]
    ds_read_b64_tr_b16 a[6:7], v21 offset:42496
    ds_read_b64_tr_b16 a[8:9], v21 offset:45056
    ds_read_b64_tr_b16 a[10:11], v21 offset:45568
    s_add_u32 m0, s35, 0
    s_add_u32 s32, s37, 0
    buffer_load_dwordx4 v1, s[16:19], s32 offen lds
    v_cvt_pk_bf16_f32 v225, v178, v179
    v_cvt_pk_bf16_f32 v226, v180, v181
    v_mfma_f32_32x32x16_bf16 v[192:207], v[160:163], a[36:39], v[192:207]
    ds_read_b64_tr_b16 a[12:13], v21 offset:46080
    ds_read_b64_tr_b16 a[14:15], v21 offset:46592
    ds_read_b64_tr_b16 a[16:17], v21 offset:49152
    v_cvt_pk_bf16_f32 v227, v182, v183
    buffer_store_dwordx4 v[224:227], v25, s[8:11], s34 offen offset:0 sc1
    v_mfma_f32_32x32x16_bf16 v[192:207], v[164:167], a[40:43], v[192:207]
    ds_read_b64_tr_b16 a[18:19], v21 offset:49664
    ds_read_b64_tr_b16 a[20:21], v21 offset:50176
    ds_read_b64_tr_b16 a[22:23], v21 offset:50688
    s_add_u32 m0, s35, 1024
    s_add_u32 s32, s37, 0
    buffer_load_dwordx4 v2, s[16:19], s32 offen lds
    v_cvt_pk_bf16_f32 v228, v184, v185
    v_cvt_pk_bf16_f32 v229, v186, v187
    v_mfma_f32_32x32x16_bf16 v[192:207], v[168:171], a[44:47], v[192:207]
    v_cvt_pk_bf16_f32 v230, v188, v189
    v_cvt_pk_bf16_f32 v231, v190, v191
    v_mfma_f32_32x32x16_bf16 v[192:207], v[172:175], a[48:51], v[192:207]
    s_add_u32 m0, s35, 2048
    s_add_u32 s32, s37, 0
    buffer_load_dwordx4 v3, s[16:19], s32 offen lds
    buffer_store_dwordx4 v[228:231], v25, s[8:11], s34 offen offset:256 sc1
    s_waitcnt lgkmcnt(10)
    v_mfma_f32_32x32x16_bf16 v[176:191], v[128:131], a[0:3], 0
    ds_read_b64_tr_b16 a[28:29], v21 offset:53248
    ds_read_b64_tr_b16 a[30:31], v21 offset:53760
    ds_read_b64_tr_b16 a[32:33], v21 offset:54272
    s_waitcnt lgkmcnt(11)
    v_mfma_f32_32x32x16_bf16 v[176:191], v[132:135], a[4:7], v[176:191]
    ds_read_b64_tr_b16 a[34:35], v21 offset:54784
    ds_read_b64_tr_b16 a[36:37], v21 offset:57344
    ds_read_b64_tr_b16 a[38:39], v21 offset:57856
    s_add_u32 m0, s35, 3072
    s_add_u32 s32, s37, 98304
    buffer_load_dwordx4 v1, s[16:19], s32 offen lds
    s_waitcnt lgkmcnt(12)
    v_mfma_f32_32x32x16_bf16 v[176:191], v[136:139], a[8:11], v[176:191]
    ds_read_b64_tr_b16 a[40:41], v21 offset:58368
    ds_read_b64_tr_b16 a[42:43], v21 offset:58880
    ds_read_b64_tr_b16 a[44:45], v21 offset:61440
    s_waitcnt lgkmcnt(13)
    v_mfma_f32_32x32x16_bf16 v[176:191], v[140:143], a[12:15], v[176:191]
    ds_read_b64_tr_b16 a[46:47], v21 offset:61952
    ds_read_b64_tr_b16 a[48:49], v21 offset:62464
    ds_read_b64_tr_b16 a[50:51], v21 offset:62976
    s_add_u32 m0, s35, 4096
    s_add_u32 s32, s37, 98304
    buffer_load_dwordx4 v2, s[16:19], s32 offen lds
    s_waitcnt lgkmcnt(14)
    v_mfma_f32_32x32x16_bf16 v[176:191], v[144:147], a[16:19], v[176:191]
    s_waitcnt lgkmcnt(12)
    v_mfma_f32_32x32x16_bf16 v[176:191], v[148:151], a[20:23], v[176:191]
    s_add_u32 m0, s35, 5120
    s_add_u32 s32, s37, 98304
    buffer_load_dwordx4 v3, s[16:19], s32 offen lds
    s_waitcnt lgkmcnt(10)
    v_mfma_f32_32x32x16_bf16 v[176:191], v[152:155], a[28:31], v[176:191]
    ds_read_b64_tr_b16 a[0:1], v22 offset:40960
    ds_read_b64_tr_b16 a[2:3], v22 offset:41472
    ds_read_b64_tr_b16 a[4:5], v22 offset:41984
    s_add_u32 s34, s41, 425984
    v_cvt_pk_bf16_f32 v232, v192, v193
    s_waitcnt lgkmcnt(11)
    v_mfma_f32_32x32x16_bf16 v[176:191], v[156:159], a[32:35], v[176:191]
    ds_read_b64_tr_b16 a[6:7], v22 offset:42496
    ds_read_b64_tr_b16 a[8:9], v22 offset:45056
    ds_read_b64_tr_b16 a[10:11], v22 offset:45568
    s_add_u32 m0, s36, 0
    s_add_u32 s32, s40, 0
    buffer_load_dwordx4 v5, s[24:27], s32 offen lds
    v_cvt_pk_bf16_f32 v233, v194, v195
    v_cvt_pk_bf16_f32 v234, v196, v197
    s_waitcnt lgkmcnt(12)
    v_mfma_f32_32x32x16_bf16 v[176:191], v[160:163], a[36:39], v[176:191]
    ds_read_b64_tr_b16 a[12:13], v22 offset:46080
    ds_read_b64_tr_b16 a[14:15], v22 offset:46592
    ds_read_b64_tr_b16 a[16:17], v22 offset:49152
    v_cvt_pk_bf16_f32 v235, v198, v199
    buffer_store_dwordx4 v[232:235], v25, s[8:11], s34 offen offset:0 sc1
    s_waitcnt lgkmcnt(13)
    v_mfma_f32_32x32x16_bf16 v[176:191], v[164:167], a[40:43], v[176:191]
    ds_read_b64_tr_b16 a[18:19], v22 offset:49664
    ds_read_b64_tr_b16 a[20:21], v22 offset:50176
    ds_read_b64_tr_b16 a[22:23], v22 offset:50688
    s_add_u32 m0, s36, 1024
    s_add_u32 s32, s40, 0
    buffer_load_dwordx4 v6, s[24:27], s32 offen lds
    v_cvt_pk_bf16_f32 v236, v200, v201
    v_cvt_pk_bf16_f32 v237, v202, v203
    s_waitcnt lgkmcnt(14)
    v_mfma_f32_32x32x16_bf16 v[176:191], v[168:171], a[44:47], v[176:191]
    v_cvt_pk_bf16_f32 v238, v204, v205
    v_cvt_pk_bf16_f32 v239, v206, v207
    s_waitcnt lgkmcnt(12)
    v_mfma_f32_32x32x16_bf16 v[176:191], v[172:175], a[48:51], v[176:191]
    s_add_u32 m0, s36, 2048
    s_add_u32 s32, s40, 0
    buffer_load_dwordx4 v7, s[24:27], s32 offen lds
    buffer_store_dwordx4 v[236:239], v25, s[8:11], s34 offen offset:256 sc1
    s_waitcnt lgkmcnt(10)
    v_mfma_f32_32x32x16_bf16 v[192:207], v[128:131], a[0:3], 0
    ds_read_b64_tr_b16 a[28:29], v22 offset:53248
    ds_read_b64_tr_b16 a[30:31], v22 offset:53760
    ds_read_b64_tr_b16 a[32:33], v22 offset:54272
    s_waitcnt lgkmcnt(11)
    v_mfma_f32_32x32x16_bf16 v[192:207], v[132:135], a[4:7], v[192:207]
    ds_read_b64_tr_b16 a[34:35], v22 offset:54784
    ds_read_b64_tr_b16 a[36:37], v22 offset:57344
    ds_read_b64_tr_b16 a[38:39], v22 offset:57856
    s_add_u32 m0, s36, 3072
    s_add_u32 s32, s40, 0
    buffer_load_dwordx4 v8, s[24:27], s32 offen lds
    s_waitcnt lgkmcnt(12)
    v_mfma_f32_32x32x16_bf16 v[192:207], v[136:139], a[8:11], v[192:207]
    ds_read_b64_tr_b16 a[40:41], v22 offset:58368
    ds_read_b64_tr_b16 a[42:43], v22 offset:58880
    ds_read_b64_tr_b16 a[44:45], v22 offset:61440
    s_waitcnt lgkmcnt(13)
    v_mfma_f32_32x32x16_bf16 v[192:207], v[140:143], a[12:15], v[192:207]
    ds_read_b64_tr_b16 a[46:47], v22 offset:61952
    ds_read_b64_tr_b16 a[48:49], v22 offset:62464
    ds_read_b64_tr_b16 a[50:51], v22 offset:62976
    s_waitcnt lgkmcnt(14)
    v_mfma_f32_32x32x16_bf16 v[192:207], v[144:147], a[16:19], v[192:207]
    s_waitcnt lgkmcnt(12)
    v_mfma_f32_32x32x16_bf16 v[192:207], v[148:151], a[20:23], v[192:207]
    s_waitcnt lgkmcnt(0)
    s_waitcnt vmcnt(24)
    s_barrier
    v_mfma_f32_32x32x16_bf16 v[192:207], v[152:155], a[28:31], v[192:207]
    ds_read_b64_tr_b16 a[0:1], v23 offset:0
    ds_read_b64_tr_b16 a[2:3], v23 offset:512
    ds_read_b64_tr_b16 a[4:5], v23 offset:1024
    s_add_u32 s34, s41, 458752
    v_cvt_pk_bf16_f32 v240, v176, v177
    v_mfma_f32_32x32x16_bf16 v[192:207], v[156:159], a[32:35], v[192:207]
    ds_read_b64_tr_b16 a[6:7], v23 offset:1536
    ds_read_b64_tr_b16 a[8:9], v23 offset:4096
    ds_read_b64_tr_b16 a[10:11], v23 offset:4608
    s_add_u32 m0, s35, 40960
    s_add_u32 s32, s37, 786432
    buffer_load_dwordx4 v1, s[16:19], s32 offen lds
    v_cvt_pk_bf16_f32 v241, v178, v179
    v_cvt_pk_bf16_f32 v242, v180, v181
    v_mfma_f32_32x32x16_bf16 v[192:207], v[160:163], a[36:39], v[192:207]
    ds_read_b64_tr_b16 a[12:13], v23 offset:5120
    ds_read_b64_tr_b16 a[14:15], v23 offset:5632
    ds_read_b64_tr_b16 a[16:17], v23 offset:8192
    v_cvt_pk_bf16_f32 v243, v182, v183
    buffer_store_dwordx4 v[240:243], v25, s[8:11], s34 offen offset:0 sc1
    v_mfma_f32_32x32x16_bf16 v[192:207], v[164:167], a[40:43], v[192:207]
    ds_read_b64_tr_b16 a[18:19], v23 offset:8704
    ds_read_b64_tr_b16 a[20:21], v23 offset:9216
    ds_read_b64_tr_b16 a[22:23], v23 offset:9728
    s_add_u32 m0, s35, 41984
    s_add_u32 s32, s37, 786432
    buffer_load_dwordx4 v2, s[16:19], s32 offen lds
    v_cvt_pk_bf16_f32 v244, v184, v185
    v_cvt_pk_bf16_f32 v245, v186, v187
    v_mfma_f32_32x32x16_bf16 v[192:207], v[168:171], a[44:47], v[192:207]
    v_cvt_pk_bf16_f32 v246, v188, v189
    v_cvt_pk_bf16_f32 v247, v190, v191
    v_mfma_f32_32x32x16_bf16 v[192:207], v[172:175], a[48:51], v[192:207]
    s_add_u32 m0, s35, 43008
    s_add_u32 s32, s37, 786432
    buffer_load_dwordx4 v3, s[16:19], s32 offen lds
    buffer_store_dwordx4 v[244:247], v25, s[8:11], s34 offen offset:256 sc1
    s_waitcnt lgkmcnt(10)
    v_mfma_f32_32x32x16_bf16 v[176:191], v[128:131], a[0:3], 0
    ds_read_b64_tr_b16 a[28:29], v23 offset:12288
    ds_read_b64_tr_b16 a[30:31], v23 offset:12800
    ds_read_b64_tr_b16 a[32:33], v23 offset:13312
    s_waitcnt lgkmcnt(11)
    v_mfma_f32_32x32x16_bf16 v[176:191], v[132:135], a[4:7], v[176:191]
    ds_read_b64_tr_b16 a[34:35], v23 offset:13824
    ds_read_b64_tr_b16 a[36:37], v23 offset:16384
    ds_read_b64_tr_b16 a[38:39], v23 offset:16896
    s_add_u32 m0, s35, 44032
    s_add_u32 s32, s37, 884736
    buffer_load_dwordx4 v1, s[16:19], s32 offen lds
    s_waitcnt lgkmcnt(12)
    v_mfma_f32_32x32x16_bf16 v[176:191], v[136:139], a[8:11], v[176:191]
    ds_read_b64_tr_b16 a[40:41], v23 offset:17408
    ds_read_b64_tr_b16 a[42:43], v23 offset:17920
    ds_read_b64_tr_b16 a[44:45], v23 offset:20480
    s_waitcnt lgkmcnt(13)
    v_mfma_f32_32x32x16_bf16 v[176:191], v[140:143], a[12:15], v[176:191]
    ds_read_b64_tr_b16 a[46:47], v23 offset:20992
    ds_read_b64_tr_b16 a[48:49], v23 offset:21504
    ds_read_b64_tr_b16 a[50:51], v23 offset:22016
    s_add_u32 m0, s35, 45056
    s_add_u32 s32, s37, 884736
    buffer_load_dwordx4 v2, s[16:19], s32 offen lds
    s_waitcnt lgkmcnt(14)
    v_mfma_f32_32x32x16_bf16 v[176:191], v[144:147], a[16:19], v[176:191]
    s_waitcnt lgkmcnt(12)
    v_mfma_f32_32x32x16_bf16 v[176:191], v[148:151], a[20:23], v[176:191]
    s_add_u32 m0, s35, 46080
    s_add_u32 s32, s37, 884736
    buffer_load_dwordx4 v3, s[16:19], s32 offen lds
    s_waitcnt lgkmcnt(10)
    v_mfma_f32_32x32x16_bf16 v[176:191], v[152:155], a[28:31], v[176:191]
    ds_read_b64_tr_b16 a[0:1], v24 offset:0
    ds_read_b64_tr_b16 a[2:3], v24 offset:512
    ds_read_b64_tr_b16 a[4:5], v24 offset:1024
    s_add_u32 s34, s41, 491520
    v_cvt_pk_bf16_f32 v248, v192, v193
    s_waitcnt lgkmcnt(11)
    v_mfma_f32_32x32x16_bf16 v[176:191], v[156:159], a[32:35], v[176:191]
    ds_read_b64_tr_b16 a[6:7], v24 offset:1536
    ds_read_b64_tr_b16 a[8:9], v24 offset:4096
    ds_read_b64_tr_b16 a[10:11], v24 offset:4608
    s_add_u32 m0, s36, 40960
    s_add_u32 s32, s40, 128
    buffer_load_dwordx4 v5, s[24:27], s32 offen lds
    v_cvt_pk_bf16_f32 v249, v194, v195
    v_cvt_pk_bf16_f32 v250, v196, v197
    s_waitcnt lgkmcnt(12)
    v_mfma_f32_32x32x16_bf16 v[176:191], v[160:163], a[36:39], v[176:191]
    ds_read_b64_tr_b16 a[12:13], v24 offset:5120
    ds_read_b64_tr_b16 a[14:15], v24 offset:5632
    ds_read_b64_tr_b16 a[16:17], v24 offset:8192
    v_cvt_pk_bf16_f32 v251, v198, v199
    buffer_store_dwordx4 v[248:251], v25, s[8:11], s34 offen offset:0 sc1
    s_waitcnt lgkmcnt(13)
    v_mfma_f32_32x32x16_bf16 v[176:191], v[164:167], a[40:43], v[176:191]
    ds_read_b64_tr_b16 a[18:19], v24 offset:8704
    ds_read_b64_tr_b16 a[20:21], v24 offset:9216
    ds_read_b64_tr_b16 a[22:23], v24 offset:9728
    s_add_u32 m0, s36, 41984
    s_add_u32 s32, s40, 128
    buffer_load_dwordx4 v6, s[24:27], s32 offen lds
    v_cvt_pk_bf16_f32 v252, v200, v201
    v_cvt_pk_bf16_f32 v253, v202, v203
    s_waitcnt lgkmcnt(14)
    v_mfma_f32_32x32x16_bf16 v[176:191], v[168:171], a[44:47], v[176:191]
    v_cvt_pk_bf16_f32 v254, v204, v205
    v_cvt_pk_bf16_f32 v255, v206, v207
    s_waitcnt lgkmcnt(12)
    v_mfma_f32_32x32x16_bf16 v[176:191], v[172:175], a[48:51], v[176:191]
    s_add_u32 m0, s36, 43008
    s_add_u32 s32, s40, 128
    buffer_load_dwordx4 v7, s[24:27], s32 offen lds
    buffer_store_dwordx4 v[252:255], v25, s[8:11], s34 offen offset:256 sc1
    s_waitcnt lgkmcnt(10)
    v_mfma_f32_32x32x16_bf16 v[192:207], v[128:131], a[0:3], 0
    ds_read_b64_tr_b16 a[28:29], v24 offset:12288
    ds_read_b64_tr_b16 a[30:31], v24 offset:12800
    ds_read_b64_tr_b16 a[32:33], v24 offset:13312
    s_waitcnt lgkmcnt(11)
    v_mfma_f32_32x32x16_bf16 v[192:207], v[132:135], a[4:7], v[192:207]
    ds_read_b64_tr_b16 a[34:35], v24 offset:13824
    ds_read_b64_tr_b16 a[36:37], v24 offset:16384
    ds_read_b64_tr_b16 a[38:39], v24 offset:16896
    s_add_u32 m0, s36, 44032
    s_add_u32 s32, s40, 128
    buffer_load_dwordx4 v8, s[24:27], s32 offen lds
    s_waitcnt lgkmcnt(12)
    v_mfma_f32_32x32x16_bf16 v[192:207], v[136:139], a[8:11], v[192:207]
    ds_read_b64_tr_b16 a[40:41], v24 offset:17408
    ds_read_b64_tr_b16 a[42:43], v24 offset:17920
    ds_read_b64_tr_b16 a[44:45], v24 offset:20480
    s_waitcnt lgkmcnt(13)
    v_mfma_f32_32x32x16_bf16 v[192:207], v[140:143], a[12:15], v[192:207]
    ds_read_b64_tr_b16 a[46:47], v24 offset:20992
    ds_read_b64_tr_b16 a[48:49], v24 offset:21504
    ds_read_b64_tr_b16 a[50:51], v24 offset:22016
    s_waitcnt lgkmcnt(14)
    v_mfma_f32_32x32x16_bf16 v[192:207], v[144:147], a[16:19], v[192:207]
    s_waitcnt lgkmcnt(12)
    v_mfma_f32_32x32x16_bf16 v[192:207], v[148:151], a[20:23], v[192:207]
    s_waitcnt lgkmcnt(0)
    s_waitcnt vmcnt(28)
    s_barrier
    v_mfma_f32_32x32x16_bf16 v[192:207], v[152:155], a[28:31], v[192:207]
    ds_read_b64_tr_b16 a[0:1], v23 offset:40960
    ds_read_b64_tr_b16 a[2:3], v23 offset:41472
    ds_read_b64_tr_b16 a[4:5], v23 offset:41984
    s_add_u32 s34, s41, 524288
    v_cvt_pk_bf16_f32 v224, v176, v177
    v_mfma_f32_32x32x16_bf16 v[192:207], v[156:159], a[32:35], v[192:207]
    ds_read_b64_tr_b16 a[6:7], v23 offset:42496
    ds_read_b64_tr_b16 a[8:9], v23 offset:45056
    ds_read_b64_tr_b16 a[10:11], v23 offset:45568
    s_add_u32 m0, s35, 81920
    s_add_u32 s32, s37, 1572864
    buffer_load_dwordx4 v1, s[16:19], s32 offen lds
    v_cvt_pk_bf16_f32 v225, v178, v179
    v_cvt_pk_bf16_f32 v226, v180, v181
    v_mfma_f32_32x32x16_bf16 v[192:207], v[160:163], a[36:39], v[192:207]
    ds_read_b64_tr_b16 a[12:13], v23 offset:46080
    ds_read_b64_tr_b16 a[14:15], v23 offset:46592
    ds_read_b64_tr_b16 a[16:17], v23 offset:49152
    v_cvt_pk_bf16_f32 v227, v182, v183
    buffer_store_dwordx4 v[224:227], v25, s[8:11], s34 offen offset:0 sc1
    v_mfma_f32_32x32x16_bf16 v[192:207], v[164:167], a[40:43], v[192:207]
    ds_read_b64_tr_b16 a[18:19], v23 offset:49664
    ds_read_b64_tr_b16 a[20:21], v23 offset:50176
    ds_read_b64_tr_b16 a[22:23], v23 offset:50688
    s_add_u32 m0, s35, 82944
    s_add_u32 s32, s37, 1572864
    buffer_load_dwordx4 v2, s[16:19], s32 offen lds
    v_cvt_pk_bf16_f32 v228, v184, v185
    v_cvt_pk_bf16_f32 v229, v186, v187
    v_mfma_f32_32x32x16_bf16 v[192:207], v[168:171], a[44:47], v[192:207]
    v_cvt_pk_bf16_f32 v230, v188, v189
    v_cvt_pk_bf16_f32 v231, v190, v191
    v_mfma_f32_32x32x16_bf16 v[192:207], v[172:175], a[48:51], v[192:207]
    s_add_u32 m0, s35, 83968
    s_add_u32 s32, s37, 1572864
    buffer_load_dwordx4 v3, s[16:19], s32 offen lds
    buffer_store_dwordx4 v[228:231], v25, s[8:11], s34 offen offset:256 sc1
    s_waitcnt lgkmcnt(10)
    v_mfma_f32_32x32x16_bf16 v[176:191], v[128:131], a[0:3], 0
    ds_read_b64_tr_b16 a[28:29], v23 offset:53248
    ds_read_b64_tr_b16 a[30:31], v23 offset:53760
    ds_read_b64_tr_b16 a[32:33], v23 offset:54272
    s_waitcnt lgkmcnt(11)
    v_mfma_f32_32x32x16_bf16 v[176:191], v[132:135], a[4:7], v[176:191]
    ds_read_b64_tr_b16 a[34:35], v23 offset:54784
    ds_read_b64_tr_b16 a[36:37], v23 offset:57344
    ds_read_b64_tr_b16 a[38:39], v23 offset:57856
    s_add_u32 m0, s35, 84992
    s_add_u32 s32, s37, 1671168
    buffer_load_dwordx4 v1, s[16:19], s32 offen lds
    s_waitcnt lgkmcnt(12)
    v_mfma_f32_32x32x16_bf16 v[176:191], v[136:139], a[8:11], v[176:191]
    ds_read_b64_tr_b16 a[40:41], v23 offset:58368
    ds_read_b64_tr_b16 a[42:43], v23 offset:58880
    ds_read_b64_tr_b16 a[44:45], v23 offset:61440
    s_waitcnt lgkmcnt(13)
    v_mfma_f32_32x32x16_bf16 v[176:191], v[140:143], a[12:15], v[176:191]
    ds_read_b64_tr_b16 a[46:47], v23 offset:61952
    ds_read_b64_tr_b16 a[48:49], v23 offset:62464
    ds_read_b64_tr_b16 a[50:51], v23 offset:62976
    s_add_u32 m0, s35, 86016
    s_add_u32 s32, s37, 1671168
    buffer_load_dwordx4 v2, s[16:19], s32 offen lds
    s_waitcnt lgkmcnt(14)
    v_mfma_f32_32x32x16_bf16 v[176:191], v[144:147], a[16:19], v[176:191]
    s_waitcnt lgkmcnt(12)
    v_mfma_f32_32x32x16_bf16 v[176:191], v[148:151], a[20:23], v[176:191]
    s_add_u32 m0, s35, 87040
    s_add_u32 s32, s37, 1671168
    buffer_load_dwordx4 v3, s[16:19], s32 offen lds
    s_waitcnt lgkmcnt(10)
    v_mfma_f32_32x32x16_bf16 v[176:191], v[152:155], a[28:31], v[176:191]
    ds_read_b64_tr_b16 a[0:1], v24 offset:40960
    ds_read_b64_tr_b16 a[2:3], v24 offset:41472
    ds_read_b64_tr_b16 a[4:5], v24 offset:41984
    s_add_u32 s34, s41, 557056
    v_cvt_pk_bf16_f32 v232, v192, v193
    s_waitcnt lgkmcnt(11)
    v_mfma_f32_32x32x16_bf16 v[176:191], v[156:159], a[32:35], v[176:191]
    ds_read_b64_tr_b16 a[6:7], v24 offset:42496
    ds_read_b64_tr_b16 a[8:9], v24 offset:45056
    ds_read_b64_tr_b16 a[10:11], v24 offset:45568
    s_add_u32 m0, s36, 81920
    s_add_u32 s32, s40, 256
    buffer_load_dwordx4 v5, s[24:27], s32 offen lds
    v_cvt_pk_bf16_f32 v233, v194, v195
    v_cvt_pk_bf16_f32 v234, v196, v197
    s_waitcnt lgkmcnt(12)
    v_mfma_f32_32x32x16_bf16 v[176:191], v[160:163], a[36:39], v[176:191]
    ds_read_b64_tr_b16 a[12:13], v24 offset:46080
    ds_read_b64_tr_b16 a[14:15], v24 offset:46592
    ds_read_b64_tr_b16 a[16:17], v24 offset:49152
    v_cvt_pk_bf16_f32 v235, v198, v199
    buffer_store_dwordx4 v[232:235], v25, s[8:11], s34 offen offset:0 sc1
    s_waitcnt lgkmcnt(13)
    v_mfma_f32_32x32x16_bf16 v[176:191], v[164:167], a[40:43], v[176:191]
    ds_read_b64_tr_b16 a[18:19], v24 offset:49664
    ds_read_b64_tr_b16 a[20:21], v24 offset:50176
    ds_read_b64_tr_b16 a[22:23], v24 offset:50688
    s_add_u32 m0, s36, 82944
    s_add_u32 s32, s40, 256
    buffer_load_dwordx4 v6, s[24:27], s32 offen lds
    v_cvt_pk_bf16_f32 v236, v200, v201
    v_cvt_pk_bf16_f32 v237, v202, v203
    s_waitcnt lgkmcnt(14)
    v_mfma_f32_32x32x16_bf16 v[176:191], v[168:171], a[44:47], v[176:191]
    v_cvt_pk_bf16_f32 v238, v204, v205
    v_cvt_pk_bf16_f32 v239, v206, v207
    s_waitcnt lgkmcnt(12)
    v_mfma_f32_32x32x16_bf16 v[176:191], v[172:175], a[48:51], v[176:191]
    s_add_u32 m0, s36, 83968
    s_add_u32 s32, s40, 256
    buffer_load_dwordx4 v7, s[24:27], s32 offen lds
    buffer_store_dwordx4 v[236:239], v25, s[8:11], s34 offen offset:256 sc1
    s_waitcnt lgkmcnt(10)
    v_mfma_f32_32x32x16_bf16 v[192:207], v[128:131], a[0:3], 0
    ds_read_b64_tr_b16 a[28:29], v24 offset:53248
    ds_read_b64_tr_b16 a[30:31], v24 offset:53760
    ds_read_b64_tr_b16 a[32:33], v24 offset:54272
    s_waitcnt lgkmcnt(11)
    v_mfma_f32_32x32x16_bf16 v[192:207], v[132:135], a[4:7], v[192:207]
    ds_read_b64_tr_b16 a[34:35], v24 offset:54784
    ds_read_b64_tr_b16 a[36:37], v24 offset:57344
    ds_read_b64_tr_b16 a[38:39], v24 offset:57856
    s_add_u32 m0, s36, 84992
    s_add_u32 s32, s40, 256
    buffer_load_dwordx4 v8, s[24:27], s32 offen lds
    s_waitcnt lgkmcnt(12)
    v_mfma_f32_32x32x16_bf16 v[192:207], v[136:139], a[8:11], v[192:207]
    ds_read_b64_tr_b16 a[40:41], v24 offset:58368
    ds_read_b64_tr_b16 a[42:43], v24 offset:58880
    ds_read_b64_tr_b16 a[44:45], v24 offset:61440
    s_waitcnt lgkmcnt(13)
    v_mfma_f32_32x32x16_bf16 v[192:207], v[140:143], a[12:15], v[192:207]
    ds_read_b64_tr_b16 a[46:47], v24 offset:61952
    ds_read_b64_tr_b16 a[48:49], v24 offset:62464
    ds_read_b64_tr_b16 a[50:51], v24 offset:62976
    s_waitcnt lgkmcnt(14)
    v_mfma_f32_32x32x16_bf16 v[192:207], v[144:147], a[16:19], v[192:207]
    s_waitcnt lgkmcnt(12)
    v_mfma_f32_32x32x16_bf16 v[192:207], v[148:151], a[20:23], v[192:207]
    s_waitcnt lgkmcnt(0)
    s_waitcnt vmcnt(28)
    s_barrier
    v_mfma_f32_32x32x16_bf16 v[192:207], v[152:155], a[28:31], v[192:207]
    ds_read_b128 a[24:27], v13 offset:0
    ds_read_b64_tr_b16 a[0:1], v9 offset:0
    ds_read_b64_tr_b16 a[2:3], v9 offset:1536
    s_add_u32 s34, s41, 589824
    v_cvt_pk_bf16_f32 v240, v176, v177
    v_mfma_f32_32x32x16_bf16 v[192:207], v[156:159], a[32:35], v[192:207]
    ds_read_b64_tr_b16 a[4:5], v10 offset:0
    ds_read_b64_tr_b16 a[6:7], v10 offset:1536
    ds_read_b64_tr_b16 a[8:9], v9 offset:128
    s_add_u32 m0, s35, 122880
    s_add_u32 s32, s37, 2359296
    buffer_load_dwordx4 v1, s[16:19], s32 offen lds
    v_cvt_pk_bf16_f32 v241, v178, v179
    v_cvt_pk_bf16_f32 v242, v180, v181
    v_mfma_f32_32x32x16_bf16 v[192:207], v[160:163], a[36:39], v[192:207]
    ds_read_b64_tr_b16 a[10:11], v9 offset:1664
    ds_read_b64_tr_b16 a[12:13], v10 offset:128
    ds_read_b64_tr_b16 a[14:15], v10 offset:1664
    v_cvt_pk_bf16_f32 v243, v182, v183
    buffer_store_dwordx4 v[240:243], v25, s[8:11], s34 offen offset:0 sc1
    v_mfma_f32_32x32x16_bf16 v[192:207], v[164:167], a[40:43], v[192:207]
    ds_read_b64_tr_b16 a[16:17], v9 offset:256
    ds_read_b64_tr_b16 a[18:19], v9 offset:1792
    ds_read_b64_tr_b16 a[20:21], v10 offset:256
    s_add_u32 m0, s35, 123904
    s_add_u32 s32, s37, 2359296
    buffer_load_dwordx4 v2, s[16:19], s32 offen lds
    v_cvt_pk_bf16_f32 v244, v184, v185
    v_cvt_pk_bf16_f32 v245, v186, v187
    v_mfma_f32_32x32x16_bf16 v[192:207], v[168:171], a[44:47], v[192:207]
    ds_read_b64_tr_b16 a[22:23], v10 offset:1792
    v_cvt_pk_bf16_f32 v246, v188, v189
    v_cvt_pk_bf16_f32 v247, v190, v191
    v_mfma_f32_32x32x16_bf16 v[192:207], v[172:175], a[48:51], v[192:207]
    s_add_u32 m0, s35, 124928
    s_add_u32 s32, s37, 2359296
    buffer_load_dwordx4 v3, s[16:19], s32 offen lds
    buffer_store_dwordx4 v[244:247], v25, s[8:11], s34 offen offset:256 sc1
    s_add_u32 s34, s41, 622592
    s_nop 6
    v_cvt_pk_bf16_f32 v248, v192, v193
    v_cvt_pk_bf16_f32 v249, v194, v195
    v_cvt_pk_bf16_f32 v250, v196, v197
    v_cvt_pk_bf16_f32 v251, v198, v199
    buffer_store_dwordx4 v[248:251], v25, s[8:11], s34 offen offset:0 sc1
    v_cvt_pk_bf16_f32 v252, v200, v201
    v_cvt_pk_bf16_f32 v253, v202, v203
    v_cvt_pk_bf16_f32 v254, v204, v205
    v_cvt_pk_bf16_f32 v255, v206, v207
    buffer_store_dwordx4 v[252:255], v25, s[8:11], s34 offen offset:256 sc1
    s_add_u32 m0, s35, 125952
    s_add_u32 s32, s37, 2457600
    buffer_load_dwordx4 v1, s[16:19], s32 offen lds
    s_add_u32 m0, s35, 126976
    s_add_u32 s32, s37, 2457600
    buffer_load_dwordx4 v2, s[16:19], s32 offen lds
    s_add_u32 m0, s35, 128000
    s_add_u32 s32, s37, 2457600
    buffer_load_dwordx4 v3, s[16:19], s32 offen lds
    s_add_u32 m0, s36, 122880
    s_add_u32 s32, s40, 384
    buffer_load_dwordx4 v5, s[24:27], s32 offen lds
    s_add_u32 m0, s36, 123904
    s_add_u32 s32, s40, 384
    buffer_load_dwordx4 v6, s[24:27], s32 offen lds
    s_add_u32 m0, s36, 124928
    s_add_u32 s32, s40, 384
    buffer_load_dwordx4 v7, s[24:27], s32 offen lds
    s_add_u32 m0, s36, 125952
    s_add_u32 s32, s40, 384
    buffer_load_dwordx4 v8, s[24:27], s32 offen lds
    s_waitcnt vmcnt(0)
    s_barrier
    s_cmp_lg_u32 s28, 0
    s_cbranch_scc1 pub_10
    s_lshr_b32 s32, s29, 4
    s_lshl_b32 s33, s31, 1
    s_add_u32 s32, s32, s33
    s_and_b32 s33, s32, 3
    s_lshl_b32 s33, s33, 3
    s_lshl_b32 s33, 1, s33
    s_and_b32 s32, s32, 0xfc
    s_add_u32 s32, s32, 200
    v_mov_b32 v26, s33
    s_mov_b64 exec, 1
    buffer_atomic_add v26, off, s[12:15], s32 sc1
    s_mov_b64 exec, -1
pub_10:
    s_add_u32 s31, s31, 3
    s_lshl_b32 s32, s31, 2
    s_add_u32 s32, s32, s28
    s_mul_i32 s39, s32, 40960
    s_add_u32 s40, s39, 491520
    s_mul_i32 s41, s32, 1310720
    s_lshr_b32 s33, s29, 4
    s_mul_i32 s33, s33, 655360
    s_add_u32 s41, s41, s33
    s_and_b32 s33, s29, 15
    s_lshl_b32 s33, s33, 10
    s_add_u32 s41, s41, s33
    s_add_u32 s41, s41, 50331648
    s_cmp_lt_u32 s31, 16
    s_cbranch_scc1 wtop_9
    s_waitcnt lgkmcnt(0)
    s_branch L_tail
wexit_7:
    s_waitcnt vmcnt(0) lgkmcnt(0)
    s_barrier
    s_cmp_lg_u32 s28, 0
    s_cbranch_scc1 pub_11
    s_lshr_b32 s32, s29, 4
    s_lshl_b32 s33, s31, 1
    s_add_u32 s32, s32, s33
    s_and_b32 s33, s32, 3
    s_lshl_b32 s33, s33, 3
    s_lshl_b32 s33, 1, s33
    s_and_b32 s32, s32, 0xfc
    s_add_u32 s32, s32, 200
    v_mov_b32 v26, s33
    s_mov_b64 exec, 1
    buffer_atomic_add v26, off, s[12:15], s32 sc1
    s_mov_b64 exec, -1
pub_11:
    s_mov_b32 s58, 0
    s_mov_b32 s38, s59
    s_add_u32 s31, s30, 2
    s_lshl_b32 s32, s31, 2
    s_add_u32 s32, s32, s28
    s_mul_i32 s39, s32, 40960
    s_add_u32 s40, s39, 491520
    s_mul_i32 s41, s32, 1310720
    s_lshr_b32 s33, s29, 4
    s_mul_i32 s33, s33, 655360
    s_add_u32 s41, s41, s33
    s_and_b32 s33, s29, 15
    s_lshl_b32 s33, s33, 10
    s_add_u32 s41, s41, s33
    s_add_u32 s41, s41, 50331648
    s_branch wpro_8
L_tail:
    s_mul_i32 s32, s43, 0xaaab
    s_lshr_b32 s32, s32, 17
    s_bitcmp1_b32 s32, 0
    s_cbranch_scc1 L_post
    s_mul_i32 s41, s29, 3
    s_add_u32 s41, s41, s30
    s_cmp_ge_u32 s41, 80
    s_cbranch_scc1 L_post
    s_load_dwordx16 s[64:79], s[0:1], 56
    s_load_dwordx4 s[80:83], s[0:1], 120
    s_mul_i32 s35, s41, 0x3334
    s_lshr_b32 s35, s35, 16
    s_mul_i32 s32, s35, 5
    s_sub_u32 s36, s41, s32
    s_waitcnt lgkmcnt(0)
    s_barrier
    s_mov_b32 s24, s64
    s_mov_b32 s25, s65
    s_mov_b32 s26, 0x280000
    s_mov_b32 s27, 0x20000
    s_mov_b32 s16, s70
    s_mov_b32 s17, s71
    s_mov_b32 s18, 0xc8000
    s_mov_b32 s19, 0x20000
    s_mov_b32 s20, s72
    s_mov_b32 s21, s73
    s_mov_b32 s22, 0xc8000
    s_mov_b32 s23, 0x20000
    s_mov_b32 s48, s82
    s_mov_b32 s49, s83
    s_mov_b32 s50, 0xa00000
    s_mov_b32 s51, 0x20000
    v_lshrrev_b32 v27, 3, v0
    v_add_u32 v27, 0, v27
    v_bfe_u32 v29, v27, 1, 3
    v_and_b32 v28, 7, v0
    v_xor_b32 v28, v28, v29
    v_bfe_u32 v29, v27, 2, 1
    v_and_b32 v27, 3, v27
    v_lshl_add_u32 v27, v29, 6, v27
    v_add_u32 v27, 0, v27
    v_mul_u32_u24 v27, 1280, v27
    v_lshl_add_u32 v1, v28, 4, v27
    v_lshrrev_b32 v27, 3, v0
    v_add_u32 v27, 8, v27
    v_bfe_u32 v29, v27, 1, 3
    v_and_b32 v28, 7, v0
    v_xor_b32 v28, v28, v29
    v_bfe_u32 v29, v27, 2, 1
    v_and_b32 v27, 3, v27
    v_lshl_add_u32 v27, v29, 6, v27
    v_add_u32 v27, 4, v27
    v_mul_u32_u24 v27, 1280, v27
    v_lshl_add_u32 v2, v28, 4, v27
    v_lshrrev_b32 v27, 3, v0
    v_add_u32 v27, 16, v27
    v_bfe_u32 v29, v27, 1, 3
    v_and_b32 v28, 7, v0
    v_xor_b32 v28, v28, v29
    v_bfe_u32 v29, v27, 2, 1
    v_and_b32 v27, 3, v27
    v_lshl_add_u32 v27, v29, 6, v27
    v_add_u32 v27, 8, v27
    v_mul_u32_u24 v27, 1280, v27
    v_lshl_add_u32 v3, v28, 4, v27
    v_lshrrev_b32 v27, 3, v0
    v_add_u32 v27, 24, v27
    v_bfe_u32 v29, v27, 1, 3
    v_and_b32 v28, 7, v0
    v_xor_b32 v28, v28, v29
    v_bfe_u32 v29, v27, 2, 1
    v_and_b32 v27, 3, v27
    v_lshl_add_u32 v27, v29, 6, v27
    v_add_u32 v27, 12, v27
    v_mul_u32_u24 v27, 1280, v27
    v_lshl_add_u32 v4, v28, 4, v27
    v_lshrrev_b32 v27, 3, v0
    v_add_u32 v27, 0, v27
    v_bfe_u32 v29, v27, 1, 3
    v_and_b32 v28, 7, v0
    v_xor_b32 v28, v28, v29
    v_mul_u32_u24 v27, 1280, v27
    v_lshl_add_u32 v5, v28, 4, v27
    v_lshrrev_b32 v27, 3, v0
    v_add_u32 v27, 8, v27
    v_bfe_u32 v29, v27, 1, 3
    v_and_b32 v28, 7, v0
    v_xor_b32 v28, v28, v29
    v_mul_u32_u24 v27, 1280, v27
    v_lshl_add_u32 v6, v28, 4, v27
    v_lshrrev_b32 v27, 3, v0
    v_add_u32 v27, 16, v27
    v_bfe_u32 v29, v27, 1, 3
    v_and_b32 v28, 7, v0
    v_xor_b32 v28, v28, v29
    v_mul_u32_u24 v27, 1280, v27
    v_lshl_add_u32 v7, v28, 4, v27
    v_lshrrev_b32 v27, 3, v0
    v_add_u32 v27, 24, v27
    v_bfe_u32 v29, v27, 1, 3
    v_and_b32 v28, 7, v0
    v_xor_b32 v28, v28, v29
    v_mul_u32_u24 v27, 1280, v27
    v_lshl_add_u32 v8, v28, 4, v27
    v_lshrrev_b32 v26, 5, v0
    v_and_b32 v27, 31, v0
    v_bfe_u32 v28, v0, 1, 3
    v_xor_b32 v28, v28, v26
    v_lshlrev_b32 v27, 7, v27
    v_xor_b32 v29, 0, v28
    v_lshl_add_u32 v9, v29, 4, v27
    v_xor_b32 v29, 2, v28
    v_lshl_add_u32 v10, v29, 4, v27
    v_xor_b32 v29, 4, v28
    v_lshl_add_u32 v11, v29, 4, v27
    v_xor_b32 v29, 6, v28
    v_lshl_add_u32 v12, v29, 4, v27
    v_add_u32 v13, 49152, v9
    v_add_u32 v14, 49152, v10
    v_add_u32 v15, 49152, v11
    v_add_u32 v16, 49152, v12
    v_add_u32 v17, 98304, v9
    v_add_u32 v18, 98304, v10
    v_add_u32 v19, 98304, v11
    v_add_u32 v20, 98304, v12
    s_lshl_b32 s32, s28, 13
    s_add_u32 s40, s32, 16384
    s_lshl_b32 s37, s35, 7
    s_lshl_b32 s32, s28, 4
    s_add_u32 s37, s37, s32
    s_mul_i32 s37, s37, 1280
    s_lshl_b32 s39, s28, 12
    s_lshl_b32 s38, s36, 7
    s_lshl_b32 s32, s28, 5
    s_add_u32 s38, s38, s32
    v_and_b32 v26, 31, v0
    v_add_u32 v26, s38, v26
    v_lshlrev_b32 v26, 1, v26
    s_mov_b32 s52, s66
    s_mov_b32 s53, s67
    s_mov_b32 s54, 0x500
    s_mov_b32 s55, 0x20000
    buffer_load_ushort v232, v26, s[52:55], 0 offen
    s_mov_b32 s52, s68
    s_mov_b32 s53, s69
    s_mov_b32 s54, 0x500
    s_mov_b32 s55, 0x20000
    buffer_load_ushort v233, v26, s[52:55], 0 offen
    s_mov_b32 s52, s78
    s_mov_b32 s53, s79
    s_mov_b32 s54, 0x500
    s_mov_b32 s55, 0x20000
    buffer_load_ushort v234, v26, s[52:55], 0 offen
    s_mul_i32 s38, s38, 1280
    v_add_u32 v160, s40, v9
    v_add_u32 v161, s40, v10
    v_add_u32 v162, s40, v11
    v_add_u32 v163, s40, v12
    v_add_u32 v164, s40, v13
    v_add_u32 v165, s40, v14
    v_add_u32 v166, s40, v15
    v_add_u32 v167, s40, v16
    v_add_u32 v168, s40, v17
    v_add_u32 v169, s40, v18
    v_add_u32 v170, s40, v19
    v_add_u32 v171, s40, v20
    s_add_u32 m0, s39, 0
    s_add_u32 s32, s37, 0
    buffer_load_dwordx4 v1, s[24:27], s32 offen lds
    s_add_u32 m0, s39, 1024
    s_add_u32 s32, s37, 0
    buffer_load_dwordx4 v2, s[24:27], s32 offen lds
    s_add_u32 m0, s39, 2048
    s_add_u32 s32, s37, 0
    buffer_load_dwordx4 v3, s[24:27], s32 offen lds
    s_add_u32 m0, s39, 3072
    s_add_u32 s32, s37, 0
    buffer_load_dwordx4 v4, s[24:27], s32 offen lds
    s_add_u32 m0, s40, 0
    s_add_u32 s32, s38, 0
    buffer_load_dwordx4 v5, s[16:19], s32 offen lds
    s_add_u32 m0, s40, 1024
    s_add_u32 s32, s38, 0
    buffer_load_dwordx4 v6, s[16:19], s32 offen lds
    s_add_u32 m0, s40, 2048
    s_add_u32 s32, s38, 0
    buffer_load_dwordx4 v7, s[16:19], s32 offen lds
    s_add_u32 m0, s40, 3072
    s_add_u32 s32, s38, 0
    buffer_load_dwordx4 v8, s[16:19], s32 offen lds
    s_add_u32 m0, s40, 4096
    s_add_u32 s32, s38, 0
    buffer_load_dwordx4 v5, s[20:23], s32 offen lds
    s_add_u32 m0, s40, 5120
    s_add_u32 s32, s38, 0
    buffer_load_dwordx4 v6, s[20:23], s32 offen lds
    s_add_u32 m0, s40, 6144
    s_add_u32 s32, s38, 0
    buffer_load_dwordx4 v7, s[20:23], s32 offen lds
    s_add_u32 m0, s40, 7168
    s_add_u32 s32, s38, 0
    buffer_load_dwordx4 v8, s[20:23], s32 offen lds
    s_add_u32 m0, s39, 49152
    s_add_u32 s32, s37, 128
    buffer_load_dwordx4 v1, s[24:27], s32 offen lds
    s_add_u32 m0, s39, 50176
    s_add_u32 s32, s37, 128
    buffer_load_dwordx4 v2, s[24:27], s32 offen lds
    s_add_u32 m0, s39, 51200
    s_add_u32 s32, s37, 128
    buffer_load_dwordx4 v3, s[24:27], s32 offen lds
    s_add_u32 m0, s39, 52224
    s_add_u32 s32, s37, 128
    buffer_load_dwordx4 v4, s[24:27], s32 offen lds
    s_add_u32 m0, s40, 49152
    s_add_u32 s32, s38, 128
    buffer_load_dwordx4 v5, s[16:19], s32 offen lds
    s_add_u32 m0, s40, 50176
    s_add_u32 s32, s38, 128
    buffer_load_dwordx4 v6, s[16:19], s32 offen lds
    s_add_u32 m0, s40, 51200
    s_add_u32 s32, s38, 128
    buffer_load_dwordx4 v7, s[16:19], s32 offen lds
    s_add_u32 m0, s40, 52224
    s_add_u32 s32, s38, 128
    buffer_load_dwordx4 v8, s[16:19], s32 offen lds
    s_add_u32 m0, s40, 53248
    s_add_u32 s32, s38, 128
    buffer_load_dwordx4 v5, s[20:23], s32 offen lds
    s_add_u32 m0, s40, 54272
    s_add_u32 s32, s38, 128
    buffer_load_dwordx4 v6, s[20:23], s32 offen lds
    s_add_u32 m0, s40, 55296
    s_add_u32 s32, s38, 128
    buffer_load_dwordx4 v7, s[20:23], s32 offen lds
    s_add_u32 m0, s40, 56320
    s_add_u32 s32, s38, 128
    buffer_load_dwordx4 v8, s[20:23], s32 offen lds
    s_add_u32 m0, s39, 98304
    s_add_u32 s32, s37, 256
    buffer_load_dwordx4 v1, s[24:27], s32 offen lds
    s_add_u32 m0, s39, 99328
    s_add_u32 s32, s37, 256
    buffer_load_dwordx4 v2, s[24:27], s32 offen lds
    s_add_u32 m0, s39, 100352
    s_add_u32 s32, s37, 256
    buffer_load_dwordx4 v3, s[24:27], s32 offen lds
    s_add_u32 m0, s39, 101376
    s_add_u32 s32, s37, 256
    buffer_load_dwordx4 v4, s[24:27], s32 offen lds
    s_add_u32 m0, s40, 98304
    s_add_u32 s32, s38, 256
    buffer_load_dwordx4 v5, s[16:19], s32 offen lds
    s_add_u32 m0, s40, 99328
    s_add_u32 s32, s38, 256
    buffer_load_dwordx4 v6, s[16:19], s32 offen lds
    s_add_u32 m0, s40, 100352
    s_add_u32 s32, s38, 256
    buffer_load_dwordx4 v7, s[16:19], s32 offen lds
    s_add_u32 m0, s40, 101376
    s_add_u32 s32, s38, 256
    buffer_load_dwordx4 v8, s[16:19], s32 offen lds
    s_add_u32 m0, s40, 102400
    s_add_u32 s32, s38, 256
    buffer_load_dwordx4 v5, s[20:23], s32 offen lds
    s_add_u32 m0, s40, 103424
    s_add_u32 s32, s38, 256
    buffer_load_dwordx4 v6, s[20:23], s32 offen lds
    s_add_u32 m0, s40, 104448
    s_add_u32 s32, s38, 256
    buffer_load_dwordx4 v7, s[20:23], s32 offen lds
    s_add_u32 m0, s40, 105472
    s_add_u32 s32, s38, 256
    buffer_load_dwordx4 v8, s[20:23], s32 offen lds
    s_waitcnt vmcnt(24)
    s_barrier
    ds_read_b128 a[16:19], v160 offset:0
    ds_read_b128 a[20:23], v160 offset:4096
    ds_read_b128 a[0:3], v9 offset:0
    ds_read_b128 a[4:7], v9 offset:4096
    ds_read_b128 a[8:11], v9 offset:8192
    ds_read_b128 a[12:15], v9 offset:12288
    s_waitcnt lgkmcnt(3)
    v_mfma_f32_32x32x16_bf16 v[32:47], a[0:3], a[16:19], 0
    ds_read_b128 a[40:43], v161 offset:0
    v_mfma_f32_32x32x16_bf16 v[96:111], a[0:3], a[20:23], 0
    ds_read_b128 a[44:47], v161 offset:4096
    s_waitcnt lgkmcnt(4)
    v_mfma_f32_32x32x16_bf16 v[48:63], a[4:7], a[16:19], 0
    ds_read_b128 a[24:27], v10 offset:0
    v_mfma_f32_32x32x16_bf16 v[112:127], a[4:7], a[20:23], 0
    ds_read_b128 a[28:31], v10 offset:4096
    s_waitcnt lgkmcnt(5)
    v_mfma_f32_32x32x16_bf16 v[64:79], a[8:11], a[16:19], 0
    ds_read_b128 a[32:35], v10 offset:8192
    v_mfma_f32_32x32x16_bf16 v[128:143], a[8:11], a[20:23], 0
    ds_read_b128 a[36:39], v10 offset:12288
    s_waitcnt lgkmcnt(6)
    v_mfma_f32_32x32x16_bf16 v[80:95], a[12:15], a[16:19], 0
    v_mfma_f32_32x32x16_bf16 v[144:159], a[12:15], a[20:23], 0
    s_waitcnt lgkmcnt(3)
    v_mfma_f32_32x32x16_bf16 v[32:47], a[24:27], a[40:43], v[32:47]
    ds_read_b128 a[16:19], v162 offset:0
    v_mfma_f32_32x32x16_bf16 v[96:111], a[24:27], a[44:47], v[96:111]
    ds_read_b128 a[20:23], v162 offset:4096
    s_waitcnt lgkmcnt(4)
    v_mfma_f32_32x32x16_bf16 v[48:63], a[28:31], a[40:43], v[48:63]
    ds_read_b128 a[0:3], v11 offset:0
    v_mfma_f32_32x32x16_bf16 v[112:127], a[28:31], a[44:47], v[112:127]
    ds_read_b128 a[4:7], v11 offset:4096
    s_waitcnt lgkmcnt(5)
    v_mfma_f32_32x32x16_bf16 v[64:79], a[32:35], a[40:43], v[64:79]
    ds_read_b128 a[8:11], v11 offset:8192
    v_mfma_f32_32x32x16_bf16 v[128:143], a[32:35], a[44:47], v[128:143]
    ds_read_b128 a[12:15], v11 offset:12288
    s_waitcnt lgkmcnt(6)
    v_mfma_f32_32x32x16_bf16 v[80:95], a[36:39], a[40:43], v[80:95]
    v_mfma_f32_32x32x16_bf16 v[144:159], a[36:39], a[44:47], v[144:159]
    s_waitcnt lgkmcnt(3)
    v_mfma_f32_32x32x16_bf16 v[32:47], a[0:3], a[16:19], v[32:47]
    ds_read_b128 a[40:43], v163 offset:0
    v_mfma_f32_32x32x16_bf16 v[96:111], a[0:3], a[20:23], v[96:111]
    ds_read_b128 a[44:47], v163 offset:4096
    s_waitcnt lgkmcnt(4)
    v_mfma_f32_32x32x16_bf16 v[48:63], a[4:7], a[16:19], v[48:63]
    ds_read_b128 a[24:27], v12 offset:0
    v_mfma_f32_32x32x16_bf16 v[112:127], a[4:7], a[20:23], v[112:127]
    ds_read_b128 a[28:31], v12 offset:4096
    s_waitcnt lgkmcnt(5)
    v_mfma_f32_32x32x16_bf16 v[64:79], a[8:11], a[16:19], v[64:79]
    ds_read_b128 a[32:35], v12 offset:8192
    v_mfma_f32_32x32x16_bf16 v[128:143], a[8:11], a[20:23], v[128:143]
    ds_read_b128 a[36:39], v12 offset:12288
    s_waitcnt lgkmcnt(6)
    v_mfma_f32_32x32x16_bf16 v[80:95], a[12:15], a[16:19], v[80:95]
    v_mfma_f32_32x32x16_bf16 v[144:159], a[12:15], a[20:23], v[144:159]
    s_waitcnt lgkmcnt(0)
    s_waitcnt vmcnt(12)
    s_barrier
    v_mfma_f32_32x32x16_bf16 v[32:47], a[24:27], a[40:43], v[32:47]
    ds_read_b128 a[16:19], v164 offset:0
    v_mfma_f32_32x32x16_bf16 v[96:111], a[24:27], a[44:47], v[96:111]
    ds_read_b128 a[20:23], v164 offset:4096
    s_add_u32 m0, s39, 0
    s_add_u32 s32, s37, 384
    buffer_load_dwordx4 v1, s[24:27], s32 offen lds
    v_mfma_f32_32x32x16_bf16 v[48:63], a[28:31], a[40:43], v[48:63]
    ds_read_b128 a[0:3], v13 offset:0
    v_mfma_f32_32x32x16_bf16 v[112:127], a[28:31], a[44:47], v[112:127]
    ds_read_b128 a[4:7], v13 offset:4096
    s_add_u32 m0, s39, 1024
    s_add_u32 s32, s37, 384
    buffer_load_dwordx4 v2, s[24:27], s32 offen lds
    v_mfma_f32_32x32x16_bf16 v[64:79], a[32:35], a[40:43], v[64:79]
    ds_read_b128 a[8:11], v13 offset:8192
    v_mfma_f32_32x32x16_bf16 v[128:143], a[32:35], a[44:47], v[128:143]
    ds_read_b128 a[12:15], v13 offset:12288
    s_add_u32 m0, s39, 2048
    s_add_u32 s32, s37, 384
    buffer_load_dwordx4 v3, s[24:27], s32 offen lds
    v_mfma_f32_32x32x16_bf16 v[80:95], a[36:39], a[40:43], v[80:95]
    v_mfma_f32_32x32x16_bf16 v[144:159], a[36:39], a[44:47], v[144:159]
    s_add_u32 m0, s39, 3072
    s_add_u32 s32, s37, 384
    buffer_load_dwordx4 v4, s[24:27], s32 offen lds
    s_waitcnt lgkmcnt(3)
    v_mfma_f32_32x32x16_bf16 v[32:47], a[0:3], a[16:19], v[32:47]
    ds_read_b128 a[40:43], v165 offset:0
    v_mfma_f32_32x32x16_bf16 v[96:111], a[0:3], a[20:23], v[96:111]
    ds_read_b128 a[44:47], v165 offset:4096
    s_add_u32 m0, s40, 0
    s_add_u32 s32, s38, 384
    buffer_load_dwordx4 v5, s[16:19], s32 offen lds
    s_waitcnt lgkmcnt(4)
    v_mfma_f32_32x32x16_bf16 v[48:63], a[4:7], a[16:19], v[48:63]
    ds_read_b128 a[24:27], v14 offset:0
    v_mfma_f32_32x32x16_bf16 v[112:127], a[4:7], a[20:23], v[112:127]
    ds_read_b128 a[28:31], v14 offset:4096
    s_add_u32 m0, s40, 1024
    s_add_u32 s32, s38, 384
    buffer_load_dwordx4 v6, s[16:19], s32 offen lds
    s_waitcnt lgkmcnt(5)
    v_mfma_f32_32x32x16_bf16 v[64:79], a[8:11], a[16:19], v[64:79]
    ds_read_b128 a[32:35], v14 offset:8192
    v_mfma_f32_32x32x16_bf16 v[128:143], a[8:11], a[20:23], v[128:143]
    ds_read_b128 a[36:39], v14 offset:12288
    s_add_u32 m0, s40, 2048
    s_add_u32 s32, s38, 384
    buffer_load_dwordx4 v7, s[16:19], s32 offen lds
    s_waitcnt lgkmcnt(6)
    v_mfma_f32_32x32x16_bf16 v[80:95], a[12:15], a[16:19], v[80:95]
    v_mfma_f32_32x32x16_bf16 v[144:159], a[12:15], a[20:23], v[144:159]
    s_add_u32 m0, s40, 3072
    s_add_u32 s32, s38, 384
    buffer_load_dwordx4 v8, s[16:19], s32 offen lds
    s_waitcnt lgkmcnt(3)
    v_mfma_f32_32x32x16_bf16 v[32:47], a[24:27], a[40:43], v[32:47]
    ds_read_b128 a[16:19], v166 offset:0
    v_mfma_f32_32x32x16_bf16 v[96:111], a[24:27], a[44:47], v[96:111]
    ds_read_b128 a[20:23], v166 offset:4096
    s_add_u32 m0, s40, 4096
    s_add_u32 s32, s38, 384
    buffer_load_dwordx4 v5, s[20:23], s32 offen lds
    s_waitcnt lgkmcnt(4)
    v_mfma_f32_32x32x16_bf16 v[48:63], a[28:31], a[40:43], v[48:63]
    ds_read_b128 a[0:3], v15 offset:0
    v_mfma_f32_32x32x16_bf16 v[112:127], a[28:31], a[44:47], v[112:127]
    ds_read_b128 a[4:7], v15 offset:4096
    s_add_u32 m0, s40, 5120
    s_add_u32 s32, s38, 384
    buffer_load_dwordx4 v6, s[20:23], s32 offen lds
    s_waitcnt lgkmcnt(5)
    v_mfma_f32_32x32x16_bf16 v[64:79], a[32:35], a[40:43], v[64:79]
    ds_read_b128 a[8:11], v15 offset:8192
    v_mfma_f32_32x32x16_bf16 v[128:143], a[32:35], a[44:47], v[128:143]
    ds_read_b128 a[12:15], v15 offset:12288
    s_add_u32 m0, s40, 6144
    s_add_u32 s32, s38, 384
    buffer_load_dwordx4 v7, s[20:23], s32 offen lds
    s_waitcnt lgkmcnt(6)
    v_mfma_f32_32x32x16_bf16 v[80:95], a[36:39], a[40:43], v[80:95]
    v_mfma_f32_32x32x16_bf16 v[144:159], a[36:39], a[44:47], v[144:159]
    s_add_u32 m0, s40, 7168
    s_add_u32 s32, s38, 384
    buffer_load_dwordx4 v8, s[20:23], s32 offen lds
    s_waitcnt lgkmcnt(3)
    v_mfma_f32_32x32x16_bf16 v[32:47], a[0:3], a[16:19], v[32:47]
    ds_read_b128 a[40:43], v167 offset:0
    v_mfma_f32_32x32x16_bf16 v[96:111], a[0:3], a[20:23], v[96:111]
    ds_read_b128 a[44:47], v167 offset:4096
    s_waitcnt lgkmcnt(4)
    v_mfma_f32_32x32x16_bf16 v[48:63], a[4:7], a[16:19], v[48:63]
    ds_read_b128 a[24:27], v16 offset:0
    v_mfma_f32_32x32x16_bf16 v[112:127], a[4:7], a[20:23], v[112:127]
    ds_read_b128 a[28:31], v16 offset:4096
    s_waitcnt lgkmcnt(5)
    v_mfma_f32_32x32x16_bf16 v[64:79], a[8:11], a[16:19], v[64:79]
    ds_read_b128 a[32:35], v16 offset:8192
    v_mfma_f32_32x32x16_bf16 v[128:143], a[8:11], a[20:23], v[128:143]
    ds_read_b128 a[36:39], v16 offset:12288
    s_waitcnt lgkmcnt(6)
    v_mfma_f32_32x32x16_bf16 v[80:95], a[12:15], a[16:19], v[80:95]
    v_mfma_f32_32x32x16_bf16 v[144:159], a[12:15], a[20:23], v[144:159]
    s_waitcnt lgkmcnt(0)
    s_waitcnt vmcnt(12)
    s_barrier
    v_mfma_f32_32x32x16_bf16 v[32:47], a[24:27], a[40:43], v[32:47]
    ds_read_b128 a[16:19], v168 offset:0
    v_mfma_f32_32x32x16_bf16 v[96:111], a[24:27], a[44:47], v[96:111]
    ds_read_b128 a[20:23], v168 offset:4096
    s_add_u32 m0, s39, 49152
    s_add_u32 s32, s37, 512
    buffer_load_dwordx4 v1, s[24:27], s32 offen lds
    v_mfma_f32_32x32x16_bf16 v[48:63], a[28:31], a[40:43], v[48:63]
    ds_read_b128 a[0:3], v17 offset:0
    v_mfma_f32_32x32x16_bf16 v[112:127], a[28:31], a[44:47], v[112:127]
    ds_read_b128 a[4:7], v17 offset:4096
    s_add_u32 m0, s39, 50176
    s_add_u32 s32, s37, 512
    buffer_load_dwordx4 v2, s[24:27], s32 offen lds
    v_mfma_f32_32x32x16_bf16 v[64:79], a[32:35], a[40:43], v[64:79]
    ds_read_b128 a[8:11], v17 offset:8192
    v_mfma_f32_32x32x16_bf16 v[128:143], a[32:35], a[44:47], v[128:143]
    ds_read_b128 a[12:15], v17 offset:12288
    s_add_u32 m0, s39, 51200
    s_add_u32 s32, s37, 512
    buffer_load_dwordx4 v3, s[24:27], s32 offen lds
    v_mfma_f32_32x32x16_bf16 v[80:95], a[36:39], a[40:43], v[80:95]
    v_mfma_f32_32x32x16_bf16 v[144:159], a[36:39], a[44:47], v[144:159]
    s_add_u32 m0, s39, 52224
    s_add_u32 s32, s37, 512
    buffer_load_dwordx4 v4, s[24:27], s32 offen lds
    s_waitcnt lgkmcnt(3)
    v_mfma_f32_32x32x16_bf16 v[32:47], a[0:3], a[16:19], v[32:47]
    ds_read_b128 a[40:43], v169 offset:0
    v_mfma_f32_32x32x16_bf16 v[96:111], a[0:3], a[20:23], v[96:111]
    ds_read_b128 a[44:47], v169 offset:4096
    s_add_u32 m0, s40, 49152
    s_add_u32 s32, s38, 512
    buffer_load_dwordx4 v5, s[16:19], s32 offen lds
    s_waitcnt lgkmcnt(4)
    v_mfma_f32_32x32x16_bf16 v[48:63], a[4:7], a[16:19], v[48:63]
    ds_read_b128 a[24:27], v18 offset:0
    v_mfma_f32_32x32x16_bf16 v[112:127], a[4:7], a[20:23], v[112:127]
    ds_read_b128 a[28:31], v18 offset:4096
    s_add_u32 m0, s40, 50176
    s_add_u32 s32, s38, 512
    buffer_load_dwordx4 v6, s[16:19], s32 offen lds
    s_waitcnt lgkmcnt(5)
    v_mfma_f32_32x32x16_bf16 v[64:79], a[8:11], a[16:19], v[64:79]
    ds_read_b128 a[32:35], v18 offset:8192
    v_mfma_f32_32x32x16_bf16 v[128:143], a[8:11], a[20:23], v[128:143]
    ds_read_b128 a[36:39], v18 offset:12288
    s_add_u32 m0, s40, 51200
    s_add_u32 s32, s38, 512
    buffer_load_dwordx4 v7, s[16:19], s32 offen lds
    s_waitcnt lgkmcnt(6)
    v_mfma_f32_32x32x16_bf16 v[80:95], a[12:15], a[16:19], v[80:95]
    v_mfma_f32_32x32x16_bf16 v[144:159], a[12:15], a[20:23], v[144:159]
    s_add_u32 m0, s40, 52224
    s_add_u32 s32, s38, 512
    buffer_load_dwordx4 v8, s[16:19], s32 offen lds
    s_waitcnt lgkmcnt(3)
    v_mfma_f32_32x32x16_bf16 v[32:47], a[24:27], a[40:43], v[32:47]
    ds_read_b128 a[16:19], v170 offset:0
    v_mfma_f32_32x32x16_bf16 v[96:111], a[24:27], a[44:47], v[96:111]
    ds_read_b128 a[20:23], v170 offset:4096
    s_add_u32 m0, s40, 53248
    s_add_u32 s32, s38, 512
    buffer_load_dwordx4 v5, s[20:23], s32 offen lds
    s_waitcnt lgkmcnt(4)
    v_mfma_f32_32x32x16_bf16 v[48:63], a[28:31], a[40:43], v[48:63]
    ds_read_b128 a[0:3], v19 offset:0
    v_mfma_f32_32x32x16_bf16 v[112:127], a[28:31], a[44:47], v[112:127]
    ds_read_b128 a[4:7], v19 offset:4096
    s_add_u32 m0, s40, 54272
    s_add_u32 s32, s38, 512
    buffer_load_dwordx4 v6, s[20:23], s32 offen lds
    s_waitcnt lgkmcnt(5)
    v_mfma_f32_32x32x16_bf16 v[64:79], a[32:35], a[40:43], v[64:79]
    ds_read_b128 a[8:11], v19 offset:8192
    v_mfma_f32_32x32x16_bf16 v[128:143], a[32:35], a[44:47], v[128:143]
    ds_read_b128 a[12:15], v19 offset:12288
    s_add_u32 m0, s40, 55296
    s_add_u32 s32, s38, 512
    buffer_load_dwordx4 v7, s[20:23], s32 offen lds
    s_waitcnt lgkmcnt(6)
    v_mfma_f32_32x32x16_bf16 v[80:95], a[36:39], a[40:43], v[80:95]
    v_mfma_f32_32x32x16_bf16 v[144:159], a[36:39], a[44:47], v[144:159]
    s_add_u32 m0, s40, 56320
    s_add_u32 s32, s38, 512
    buffer_load_dwordx4 v8, s[20:23], s32 offen lds
    s_waitcnt lgkmcnt(3)
    v_mfma_f32_32x32x16_bf16 v[32:47], a[0:3], a[16:19], v[32:47]
    ds_read_b128 a[40:43], v171 offset:0
    v_mfma_f32_32x32x16_bf16 v[96:111], a[0:3], a[20:23], v[96:111]
    ds_read_b128 a[44:47], v171 offset:4096
    s_waitcnt lgkmcnt(4)
    v_mfma_f32_32x32x16_bf16 v[48:63], a[4:7], a[16:19], v[48:63]
    ds_read_b128 a[24:27], v20 offset:0
    v_mfma_f32_32x32x16_bf16 v[112:127], a[4:7], a[20:23], v[112:127]
    ds_read_b128 a[28:31], v20 offset:4096
    s_waitcnt lgkmcnt(5)
    v_mfma_f32_32x32x16_bf16 v[64:79], a[8:11], a[16:19], v[64:79]
    ds_read_b128 a[32:35], v20 offset:8192
    v_mfma_f32_32x32x16_bf16 v[128:143], a[8:11], a[20:23], v[128:143]
    ds_read_b128 a[36:39], v20 offset:12288
    s_waitcnt lgkmcnt(6)
    v_mfma_f32_32x32x16_bf16 v[80:95], a[12:15], a[16:19], v[80:95]
    v_mfma_f32_32x32x16_bf16 v[144:159], a[12:15], a[20:23], v[144:159]
    s_waitcnt lgkmcnt(0)
    s_waitcnt vmcnt(12)
    s_barrier
    v_mfma_f32_32x32x16_bf16 v[32:47], a[24:27], a[40:43], v[32:47]
    ds_read_b128 a[16:19], v160 offset:0
    v_mfma_f32_32x32x16_bf16 v[96:111], a[24:27], a[44:47], v[96:111]
    ds_read_b128 a[20:23], v160 offset:4096
    s_add_u32 m0, s39, 98304
    s_add_u32 s32, s37, 640
    buffer_load_dwordx4 v1, s[24:27], s32 offen lds
    v_mfma_f32_32x32x16_bf16 v[48:63], a[28:31], a[40:43], v[48:63]
    ds_read_b128 a[0:3], v9 offset:0
    v_mfma_f32_32x32x16_bf16 v[112:127], a[28:31], a[44:47], v[112:127]
    ds_read_b128 a[4:7], v9 offset:4096
    s_add_u32 m0, s39, 99328
    s_add_u32 s32, s37, 640
    buffer_load_dwordx4 v2, s[24:27], s32 offen lds
    v_mfma_f32_32x32x16_bf16 v[64:79], a[32:35], a[40:43], v[64:79]
    ds_read_b128 a[8:11], v9 offset:8192
    v_mfma_f32_32x32x16_bf16 v[128:143], a[32:35], a[44:47], v[128:143]
    ds_read_b128 a[12:15], v9 offset:12288
    s_add_u32 m0, s39, 100352
    s_add_u32 s32, s37, 640
    buffer_load_dwordx4 v3, s[24:27], s32 offen lds
    v_mfma_f32_32x32x16_bf16 v[80:95], a[36:39], a[40:43], v[80:95]
    v_mfma_f32_32x32x16_bf16 v[144:159], a[36:39], a[44:47], v[144:159]
    s_add_u32 m0, s39, 101376
    s_add_u32 s32, s37, 640
    buffer_load_dwordx4 v4, s[24:27], s32 offen lds
    s_waitcnt lgkmcnt(3)
    v_mfma_f32_32x32x16_bf16 v[32:47], a[0:3], a[16:19], v[32:47]
    ds_read_b128 a[40:43], v161 offset:0
    v_mfma_f32_32x32x16_bf16 v[96:111], a[0:3], a[20:23], v[96:111]
    ds_read_b128 a[44:47], v161 offset:4096
    s_add_u32 m0, s40, 98304
    s_add_u32 s32, s38, 640
    buffer_load_dwordx4 v5, s[16:19], s32 offen lds
    s_waitcnt lgkmcnt(4)
    v_mfma_f32_32x32x16_bf16 v[48:63], a[4:7], a[16:19], v[48:63]
    ds_read_b128 a[24:27], v10 offset:0
    v_mfma_f32_32x32x16_bf16 v[112:127], a[4:7], a[20:23], v[112:127]
    ds_read_b128 a[28:31], v10 offset:4096
    s_add_u32 m0, s40, 99328
    s_add_u32 s32, s38, 640
    buffer_load_dwordx4 v6, s[16:19], s32 offen lds
    s_waitcnt lgkmcnt(5)
    v_mfma_f32_32x32x16_bf16 v[64:79], a[8:11], a[16:19], v[64:79]
    ds_read_b128 a[32:35], v10 offset:8192
    v_mfma_f32_32x32x16_bf16 v[128:143], a[8:11], a[20:23], v[128:143]
    ds_read_b128 a[36:39], v10 offset:12288
    s_add_u32 m0, s40, 100352
    s_add_u32 s32, s38, 640
    buffer_load_dwordx4 v7, s[16:19], s32 offen lds
    s_waitcnt lgkmcnt(6)
    v_mfma_f32_32x32x16_bf16 v[80:95], a[12:15], a[16:19], v[80:95]
    v_mfma_f32_32x32x16_bf16 v[144:159], a[12:15], a[20:23], v[144:159]
    s_add_u32 m0, s40, 101376
    s_add_u32 s32, s38, 640
    buffer_load_dwordx4 v8, s[16:19], s32 offen lds
    s_waitcnt lgkmcnt(3)
    v_mfma_f32_32x32x16_bf16 v[32:47], a[24:27], a[40:43], v[32:47]
    ds_read_b128 a[16:19], v162 offset:0
    v_mfma_f32_32x32x16_bf16 v[96:111], a[24:27], a[44:47], v[96:111]
    ds_read_b128 a[20:23], v162 offset:4096
    s_add_u32 m0, s40, 102400
    s_add_u32 s32, s38, 640
    buffer_load_dwordx4 v5, s[20:23], s32 offen lds
    s_waitcnt lgkmcnt(4)
    v_mfma_f32_32x32x16_bf16 v[48:63], a[28:31], a[40:43], v[48:63]
    ds_read_b128 a[0:3], v11 offset:0
    v_mfma_f32_32x32x16_bf16 v[112:127], a[28:31], a[44:47], v[112:127]
    ds_read_b128 a[4:7], v11 offset:4096
    s_add_u32 m0, s40, 103424
    s_add_u32 s32, s38, 640
    buffer_load_dwordx4 v6, s[20:23], s32 offen lds
    s_waitcnt lgkmcnt(5)
    v_mfma_f32_32x32x16_bf16 v[64:79], a[32:35], a[40:43], v[64:79]
    ds_read_b128 a[8:11], v11 offset:8192
    v_mfma_f32_32x32x16_bf16 v[128:143], a[32:35], a[44:47], v[128:143]
    ds_read_b128 a[12:15], v11 offset:12288
    s_add_u32 m0, s40, 104448
    s_add_u32 s32, s38, 640
    buffer_load_dwordx4 v7, s[20:23], s32 offen lds
    s_waitcnt lgkmcnt(6)
    v_mfma_f32_32x32x16_bf16 v[80:95], a[36:39], a[40:43], v[80:95]
    v_mfma_f32_32x32x16_bf16 v[144:159], a[36:39], a[44:47], v[144:159]
    s_add_u32 m0, s40, 105472
    s_add_u32 s32, s38, 640
    buffer_load_dwordx4 v8, s[20:23], s32 offen lds
    s_waitcnt lgkmcnt(3)
    v_mfma_f32_32x32x16_bf16 v[32:47], a[0:3], a[16:19], v[32:47]
    ds_read_b128 a[40:43], v163 offset:0
    v_mfma_f32_32x32x16_bf16 v[96:111], a[0:3], a[20:23], v[96:111]
    ds_read_b128 a[44:47], v163 offset:4096
    s_waitcnt lgkmcnt(4)
    v_mfma_f32_32x32x16_bf16 v[48:63], a[4:7], a[16:19], v[48:63]
    ds_read_b128 a[24:27], v12 offset:0
    v_mfma_f32_32x32x16_bf16 v[112:127], a[4:7], a[20:23], v[112:127]
    ds_read_b128 a[28:31], v12 offset:4096
    s_waitcnt lgkmcnt(5)
    v_mfma_f32_32x32x16_bf16 v[64:79], a[8:11], a[16:19], v[64:79]
    ds_read_b128 a[32:35], v12 offset:8192
    v_mfma_f32_32x32x16_bf16 v[128:143], a[8:11], a[20:23], v[128:143]
    ds_read_b128 a[36:39], v12 offset:12288
    s_waitcnt lgkmcnt(6)
    v_mfma_f32_32x32x16_bf16 v[80:95], a[12:15], a[16:19], v[80:95]
    v_mfma_f32_32x32x16_bf16 v[144:159], a[12:15], a[20:23], v[144:159]
    s_waitcnt lgkmcnt(0)
    s_waitcnt vmcnt(12)
    s_barrier
    v_mfma_f32_32x32x16_bf16 v[32:47], a[24:27], a[40:43], v[32:47]
    ds_read_b128 a[16:19], v164 offset:0
    v_mfma_f32_32x32x16_bf16 v[96:111], a[24:27], a[44:47], v[96:111]
    ds_read_b128 a[20:23], v164 offset:4096
    s_add_u32 m0, s39, 0
    s_add_u32 s32, s37, 768
    buffer_load_dwordx4 v1, s[24:27], s32 offen lds
    v_mfma_f32_32x32x16_bf16 v[48:63], a[28:31], a[40:43], v[48:63]
    ds_read_b128 a[0:3], v13 offset:0
    v_mfma_f32_32x32x16_bf16 v[112:127], a[28:31], a[44:47], v[112:127]
    ds_read_b128 a[4:7], v13 offset:4096
    s_add_u32 m0, s39, 1024
    s_add_u32 s32, s37, 768
    buffer_load_dwordx4 v2, s[24:27], s32 offen lds
    v_mfma_f32_32x32x16_bf16 v[64:79], a[32:35], a[40:43], v[64:79]
    ds_read_b128 a[8:11], v13 offset:8192
    v_mfma_f32_32x32x16_bf16 v[128:143], a[32:35], a[44:47], v[128:143]
    ds_read_b128 a[12:15], v13 offset:12288
    s_add_u32 m0, s39, 2048
    s_add_u32 s32, s37, 768
    buffer_load_dwordx4 v3, s[24:27], s32 offen lds
    v_mfma_f32_32x32x16_bf16 v[80:95], a[36:39], a[40:43], v[80:95]
    v_mfma_f32_32x32x16_bf16 v[144:159], a[36:39], a[44:47], v[144:159]
    s_add_u32 m0, s39, 3072
    s_add_u32 s32, s37, 768
    buffer_load_dwordx4 v4, s[24:27], s32 offen lds
    s_waitcnt lgkmcnt(3)
    v_mfma_f32_32x32x16_bf16 v[32:47], a[0:3], a[16:19], v[32:47]
    ds_read_b128 a[40:43], v165 offset:0
    v_mfma_f32_32x32x16_bf16 v[96:111], a[0:3], a[20:23], v[96:111]
    ds_read_b128 a[44:47], v165 offset:4096
    s_add_u32 m0, s40, 0
    s_add_u32 s32, s38, 768
    buffer_load_dwordx4 v5, s[16:19], s32 offen lds
    s_waitcnt lgkmcnt(4)
    v_mfma_f32_32x32x16_bf16 v[48:63], a[4:7], a[16:19], v[48:63]
    ds_read_b128 a[24:27], v14 offset:0
    v_mfma_f32_32x32x16_bf16 v[112:127], a[4:7], a[20:23], v[112:127]
    ds_read_b128 a[28:31], v14 offset:4096
    s_add_u32 m0, s40, 1024
    s_add_u32 s32, s38, 768
    buffer_load_dwordx4 v6, s[16:19], s32 offen lds
    s_waitcnt lgkmcnt(5)
    v_mfma_f32_32x32x16_bf16 v[64:79], a[8:11], a[16:19], v[64:79]
    ds_read_b128 a[32:35], v14 offset:8192
    v_mfma_f32_32x32x16_bf16 v[128:143], a[8:11], a[20:23], v[128:143]
    ds_read_b128 a[36:39], v14 offset:12288
    s_add_u32 m0, s40, 2048
    s_add_u32 s32, s38, 768
    buffer_load_dwordx4 v7, s[16:19], s32 offen lds
    s_waitcnt lgkmcnt(6)
    v_mfma_f32_32x32x16_bf16 v[80:95], a[12:15], a[16:19], v[80:95]
    v_mfma_f32_32x32x16_bf16 v[144:159], a[12:15], a[20:23], v[144:159]
    s_add_u32 m0, s40, 3072
    s_add_u32 s32, s38, 768
    buffer_load_dwordx4 v8, s[16:19], s32 offen lds
    s_waitcnt lgkmcnt(3)
    v_mfma_f32_32x32x16_bf16 v[32:47], a[24:27], a[40:43], v[32:47]
    ds_read_b128 a[16:19], v166 offset:0
    v_mfma_f32_32x32x16_bf16 v[96:111], a[24:27], a[44:47], v[96:111]
    ds_read_b128 a[20:23], v166 offset:4096
    s_add_u32 m0, s40, 4096
    s_add_u32 s32, s38, 768
    buffer_load_dwordx4 v5, s[20:23], s32 offen lds
    s_waitcnt lgkmcnt(4)
    v_mfma_f32_32x32x16_bf16 v[48:63], a[28:31], a[40:43], v[48:63]
    ds_read_b128 a[0:3], v15 offset:0
    v_mfma_f32_32x32x16_bf16 v[112:127], a[28:31], a[44:47], v[112:127]
    ds_read_b128 a[4:7], v15 offset:4096
    s_add_u32 m0, s40, 5120
    s_add_u32 s32, s38, 768
    buffer_load_dwordx4 v6, s[20:23], s32 offen lds
    s_waitcnt lgkmcnt(5)
    v_mfma_f32_32x32x16_bf16 v[64:79], a[32:35], a[40:43], v[64:79]
    ds_read_b128 a[8:11], v15 offset:8192
    v_mfma_f32_32x32x16_bf16 v[128:143], a[32:35], a[44:47], v[128:143]
    ds_read_b128 a[12:15], v15 offset:12288
    s_add_u32 m0, s40, 6144
    s_add_u32 s32, s38, 768
    buffer_load_dwordx4 v7, s[20:23], s32 offen lds
    s_waitcnt lgkmcnt(6)
    v_mfma_f32_32x32x16_bf16 v[80:95], a[36:39], a[40:43], v[80:95]
    v_mfma_f32_32x32x16_bf16 v[144:159], a[36:39], a[44:47], v[144:159]
    s_add_u32 m0, s40, 7168
    s_add_u32 s32, s38, 768
    buffer_load_dwordx4 v8, s[20:23], s32 offen lds
    s_waitcnt lgkmcnt(3)
    v_mfma_f32_32x32x16_bf16 v[32:47], a[0:3], a[16:19], v[32:47]
    ds_read_b128 a[40:43], v167 offset:0
    v_mfma_f32_32x32x16_bf16 v[96:111], a[0:3], a[20:23], v[96:111]
    ds_read_b128 a[44:47], v167 offset:4096
    s_waitcnt lgkmcnt(4)
    v_mfma_f32_32x32x16_bf16 v[48:63], a[4:7], a[16:19], v[48:63]
    ds_read_b128 a[24:27], v16 offset:0
    v_mfma_f32_32x32x16_bf16 v[112:127], a[4:7], a[20:23], v[112:127]
    ds_read_b128 a[28:31], v16 offset:4096
    s_waitcnt lgkmcnt(5)
    v_mfma_f32_32x32x16_bf16 v[64:79], a[8:11], a[16:19], v[64:79]
    ds_read_b128 a[32:35], v16 offset:8192
    v_mfma_f32_32x32x16_bf16 v[128:143], a[8:11], a[20:23], v[128:143]
    ds_read_b128 a[36:39], v16 offset:12288
    s_waitcnt lgkmcnt(6)
    v_mfma_f32_32x32x16_bf16 v[80:95], a[12:15], a[16:19], v[80:95]
    v_mfma_f32_32x32x16_bf16 v[144:159], a[12:15], a[20:23], v[144:159]
    s_waitcnt lgkmcnt(0)
    s_waitcnt vmcnt(12)
    s_barrier
    v_mfma_f32_32x32x16_bf16 v[32:47], a[24:27], a[40:43], v[32:47]
    ds_read_b128 a[16:19], v168 offset:0
    v_mfma_f32_32x32x16_bf16 v[96:111], a[24:27], a[44:47], v[96:111]
    ds_read_b128 a[20:23], v168 offset:4096
    s_add_u32 m0, s39, 49152
    s_add_u32 s32, s37, 896
    buffer_load_dwordx4 v1, s[24:27], s32 offen lds
    v_mfma_f32_32x32x16_bf16 v[48:63], a[28:31], a[40:43], v[48:63]
    ds_read_b128 a[0:3], v17 offset:0
    v_mfma_f32_32x32x16_bf16 v[112:127], a[28:31], a[44:47], v[112:127]
    ds_read_b128 a[4:7], v17 offset:4096
    s_add_u32 m0, s39, 50176
    s_add_u32 s32, s37, 896
    buffer_load_dwordx4 v2, s[24:27], s32 offen lds
    v_mfma_f32_32x32x16_bf16 v[64:79], a[32:35], a[40:43], v[64:79]
    ds_read_b128 a[8:11], v17 offset:8192
    v_mfma_f32_32x32x16_bf16 v[128:143], a[32:35], a[44:47], v[128:143]
    ds_read_b128 a[12:15], v17 offset:12288
    s_add_u32 m0, s39, 51200
    s_add_u32 s32, s37, 896
    buffer_load_dwordx4 v3, s[24:27], s32 offen lds
    v_mfma_f32_32x32x16_bf16 v[80:95], a[36:39], a[40:43], v[80:95]
    v_mfma_f32_32x32x16_bf16 v[144:159], a[36:39], a[44:47], v[144:159]
    s_add_u32 m0, s39, 52224
    s_add_u32 s32, s37, 896
    buffer_load_dwordx4 v4, s[24:27], s32 offen lds
    s_waitcnt lgkmcnt(3)
    v_mfma_f32_32x32x16_bf16 v[32:47], a[0:3], a[16:19], v[32:47]
    ds_read_b128 a[40:43], v169 offset:0
    v_mfma_f32_32x32x16_bf16 v[96:111], a[0:3], a[20:23], v[96:111]
    ds_read_b128 a[44:47], v169 offset:4096
    s_add_u32 m0, s40, 49152
    s_add_u32 s32, s38, 896
    buffer_load_dwordx4 v5, s[16:19], s32 offen lds
    s_waitcnt lgkmcnt(4)
    v_mfma_f32_32x32x16_bf16 v[48:63], a[4:7], a[16:19], v[48:63]
    ds_read_b128 a[24:27], v18 offset:0
    v_mfma_f32_32x32x16_bf16 v[112:127], a[4:7], a[20:23], v[112:127]
    ds_read_b128 a[28:31], v18 offset:4096
    s_add_u32 m0, s40, 50176
    s_add_u32 s32, s38, 896
    buffer_load_dwordx4 v6, s[16:19], s32 offen lds
    s_waitcnt lgkmcnt(5)
    v_mfma_f32_32x32x16_bf16 v[64:79], a[8:11], a[16:19], v[64:79]
    ds_read_b128 a[32:35], v18 offset:8192
    v_mfma_f32_32x32x16_bf16 v[128:143], a[8:11], a[20:23], v[128:143]
    ds_read_b128 a[36:39], v18 offset:12288
    s_add_u32 m0, s40, 51200
    s_add_u32 s32, s38, 896
    buffer_load_dwordx4 v7, s[16:19], s32 offen lds
    s_waitcnt lgkmcnt(6)
    v_mfma_f32_32x32x16_bf16 v[80:95], a[12:15], a[16:19], v[80:95]
    v_mfma_f32_32x32x16_bf16 v[144:159], a[12:15], a[20:23], v[144:159]
    s_add_u32 m0, s40, 52224
    s_add_u32 s32, s38, 896
    buffer_load_dwordx4 v8, s[16:19], s32 offen lds
    s_waitcnt lgkmcnt(3)
    v_mfma_f32_32x32x16_bf16 v[32:47], a[24:27], a[40:43], v[32:47]
    ds_read_b128 a[16:19], v170 offset:0
    v_mfma_f32_32x32x16_bf16 v[96:111], a[24:27], a[44:47], v[96:111]
    ds_read_b128 a[20:23], v170 offset:4096
    s_add_u32 m0, s40, 53248
    s_add_u32 s32, s38, 896
    buffer_load_dwordx4 v5, s[20:23], s32 offen lds
    s_waitcnt lgkmcnt(4)
    v_mfma_f32_32x32x16_bf16 v[48:63], a[28:31], a[40:43], v[48:63]
    ds_read_b128 a[0:3], v19 offset:0
    v_mfma_f32_32x32x16_bf16 v[112:127], a[28:31], a[44:47], v[112:127]
    ds_read_b128 a[4:7], v19 offset:4096
    s_add_u32 m0, s40, 54272
    s_add_u32 s32, s38, 896
    buffer_load_dwordx4 v6, s[20:23], s32 offen lds
    s_waitcnt lgkmcnt(5)
    v_mfma_f32_32x32x16_bf16 v[64:79], a[32:35], a[40:43], v[64:79]
    ds_read_b128 a[8:11], v19 offset:8192
    v_mfma_f32_32x32x16_bf16 v[128:143], a[32:35], a[44:47], v[128:143]
    ds_read_b128 a[12:15], v19 offset:12288
    s_add_u32 m0, s40, 55296
    s_add_u32 s32, s38, 896
    buffer_load_dwordx4 v7, s[20:23], s32 offen lds
    s_waitcnt lgkmcnt(6)
    v_mfma_f32_32x32x16_bf16 v[80:95], a[36:39], a[40:43], v[80:95]
    v_mfma_f32_32x32x16_bf16 v[144:159], a[36:39], a[44:47], v[144:159]
    s_add_u32 m0, s40, 56320
    s_add_u32 s32, s38, 896
    buffer_load_dwordx4 v8, s[20:23], s32 offen lds
    s_waitcnt lgkmcnt(3)
    v_mfma_f32_32x32x16_bf16 v[32:47], a[0:3], a[16:19], v[32:47]
    ds_read_b128 a[40:43], v171 offset:0
    v_mfma_f32_32x32x16_bf16 v[96:111], a[0:3], a[20:23], v[96:111]
    ds_read_b128 a[44:47], v171 offset:4096
    s_waitcnt lgkmcnt(4)
    v_mfma_f32_32x32x16_bf16 v[48:63], a[4:7], a[16:19], v[48:63]
    ds_read_b128 a[24:27], v20 offset:0
    v_mfma_f32_32x32x16_bf16 v[112:127], a[4:7], a[20:23], v[112:127]
    ds_read_b128 a[28:31], v20 offset:4096
    s_waitcnt lgkmcnt(5)
    v_mfma_f32_32x32x16_bf16 v[64:79], a[8:11], a[16:19], v[64:79]
    ds_read_b128 a[32:35], v20 offset:8192
    v_mfma_f32_32x32x16_bf16 v[128:143], a[8:11], a[20:23], v[128:143]
    ds_read_b128 a[36:39], v20 offset:12288
    s_waitcnt lgkmcnt(6)
    v_mfma_f32_32x32x16_bf16 v[80:95], a[12:15], a[16:19], v[80:95]
    v_mfma_f32_32x32x16_bf16 v[144:159], a[12:15], a[20:23], v[144:159]
    s_waitcnt lgkmcnt(0)
    s_waitcnt vmcnt(12)
    s_barrier
    v_mfma_f32_32x32x16_bf16 v[32:47], a[24:27], a[40:43], v[32:47]
    ds_read_b128 a[16:19], v160 offset:0
    v_mfma_f32_32x32x16_bf16 v[96:111], a[24:27], a[44:47], v[96:111]
    ds_read_b128 a[20:23], v160 offset:4096
    s_add_u32 m0, s39, 98304
    s_add_u32 s32, s37, 1024
    buffer_load_dwordx4 v1, s[24:27], s32 offen lds
    v_mfma_f32_32x32x16_bf16 v[48:63], a[28:31], a[40:43], v[48:63]
    ds_read_b128 a[0:3], v9 offset:0
    v_mfma_f32_32x32x16_bf16 v[112:127], a[28:31], a[44:47], v[112:127]
    ds_read_b128 a[4:7], v9 offset:4096
    s_add_u32 m0, s39, 99328
    s_add_u32 s32, s37, 1024
    buffer_load_dwordx4 v2, s[24:27], s32 offen lds
    v_mfma_f32_32x32x16_bf16 v[64:79], a[32:35], a[40:43], v[64:79]
    ds_read_b128 a[8:11], v9 offset:8192
    v_mfma_f32_32x32x16_bf16 v[128:143], a[32:35], a[44:47], v[128:143]
    ds_read_b128 a[12:15], v9 offset:12288
    s_add_u32 m0, s39, 100352
    s_add_u32 s32, s37, 1024
    buffer_load_dwordx4 v3, s[24:27], s32 offen lds
    v_mfma_f32_32x32x16_bf16 v[80:95], a[36:39], a[40:43], v[80:95]
    v_mfma_f32_32x32x16_bf16 v[144:159], a[36:39], a[44:47], v[144:159]
    s_add_u32 m0, s39, 101376
    s_add_u32 s32, s37, 1024
    buffer_load_dwordx4 v4, s[24:27], s32 offen lds
    s_waitcnt lgkmcnt(3)
    v_mfma_f32_32x32x16_bf16 v[32:47], a[0:3], a[16:19], v[32:47]
    ds_read_b128 a[40:43], v161 offset:0
    v_mfma_f32_32x32x16_bf16 v[96:111], a[0:3], a[20:23], v[96:111]
    ds_read_b128 a[44:47], v161 offset:4096
    s_add_u32 m0, s40, 98304
    s_add_u32 s32, s38, 1024
    buffer_load_dwordx4 v5, s[16:19], s32 offen lds
    s_waitcnt lgkmcnt(4)
    v_mfma_f32_32x32x16_bf16 v[48:63], a[4:7], a[16:19], v[48:63]
    ds_read_b128 a[24:27], v10 offset:0
    v_mfma_f32_32x32x16_bf16 v[112:127], a[4:7], a[20:23], v[112:127]
    ds_read_b128 a[28:31], v10 offset:4096
    s_add_u32 m0, s40, 99328
    s_add_u32 s32, s38, 1024
    buffer_load_dwordx4 v6, s[16:19], s32 offen lds
    s_waitcnt lgkmcnt(5)
    v_mfma_f32_32x32x16_bf16 v[64:79], a[8:11], a[16:19], v[64:79]
    ds_read_b128 a[32:35], v10 offset:8192
    v_mfma_f32_32x32x16_bf16 v[128:143], a[8:11], a[20:23], v[128:143]
    ds_read_b128 a[36:39], v10 offset:12288
    s_add_u32 m0, s40, 100352
    s_add_u32 s32, s38, 1024
    buffer_load_dwordx4 v7, s[16:19], s32 offen lds
    s_waitcnt lgkmcnt(6)
    v_mfma_f32_32x32x16_bf16 v[80:95], a[12:15], a[16:19], v[80:95]
    v_mfma_f32_32x32x16_bf16 v[144:159], a[12:15], a[20:23], v[144:159]
    s_add_u32 m0, s40, 101376
    s_add_u32 s32, s38, 1024
    buffer_load_dwordx4 v8, s[16:19], s32 offen lds
    s_waitcnt lgkmcnt(3)
    v_mfma_f32_32x32x16_bf16 v[32:47], a[24:27], a[40:43], v[32:47]
    ds_read_b128 a[16:19], v162 offset:0
    v_mfma_f32_32x32x16_bf16 v[96:111], a[24:27], a[44:47], v[96:111]
    ds_read_b128 a[20:23], v162 offset:4096
    s_add_u32 m0, s40, 102400
    s_add_u32 s32, s38, 1024
    buffer_load_dwordx4 v5, s[20:23], s32 offen lds
    s_waitcnt lgkmcnt(4)
    v_mfma_f32_32x32x16_bf16 v[48:63], a[28:31], a[40:43], v[48:63]
    ds_read_b128 a[0:3], v11 offset:0
    v_mfma_f32_32x32x16_bf16 v[112:127], a[28:31], a[44:47], v[112:127]
    ds_read_b128 a[4:7], v11 offset:4096
    s_add_u32 m0, s40, 103424
    s_add_u32 s32, s38, 1024
    buffer_load_dwordx4 v6, s[20:23], s32 offen lds
    s_waitcnt lgkmcnt(5)
    v_mfma_f32_32x32x16_bf16 v[64:79], a[32:35], a[40:43], v[64:79]
    ds_read_b128 a[8:11], v11 offset:8192
    v_mfma_f32_32x32x16_bf16 v[128:143], a[32:35], a[44:47], v[128:143]
    ds_read_b128 a[12:15], v11 offset:12288
    s_add_u32 m0, s40, 104448
    s_add_u32 s32, s38, 1024
    buffer_load_dwordx4 v7, s[20:23], s32 offen lds
    s_waitcnt lgkmcnt(6)
    v_mfma_f32_32x32x16_bf16 v[80:95], a[36:39], a[40:43], v[80:95]
    v_mfma_f32_32x32x16_bf16 v[144:159], a[36:39], a[44:47], v[144:159]
    s_add_u32 m0, s40, 105472
    s_add_u32 s32, s38, 1024
    buffer_load_dwordx4 v8, s[20:23], s32 offen lds
    s_waitcnt lgkmcnt(3)
    v_mfma_f32_32x32x16_bf16 v[32:47], a[0:3], a[16:19], v[32:47]
    ds_read_b128 a[40:43], v163 offset:0
    v_mfma_f32_32x32x16_bf16 v[96:111], a[0:3], a[20:23], v[96:111]
    ds_read_b128 a[44:47], v163 offset:4096
    s_waitcnt lgkmcnt(4)
    v_mfma_f32_32x32x16_bf16 v[48:63], a[4:7], a[16:19], v[48:63]
    ds_read_b128 a[24:27], v12 offset:0
    v_mfma_f32_32x32x16_bf16 v[112:127], a[4:7], a[20:23], v[112:127]
    ds_read_b128 a[28:31], v12 offset:4096
    s_waitcnt lgkmcnt(5)
    v_mfma_f32_32x32x16_bf16 v[64:79], a[8:11], a[16:19], v[64:79]
    ds_read_b128 a[32:35], v12 offset:8192
    v_mfma_f32_32x32x16_bf16 v[128:143], a[8:11], a[20:23], v[128:143]
    ds_read_b128 a[36:39], v12 offset:12288
    s_waitcnt lgkmcnt(6)
    v_mfma_f32_32x32x16_bf16 v[80:95], a[12:15], a[16:19], v[80:95]
    v_mfma_f32_32x32x16_bf16 v[144:159], a[12:15], a[20:23], v[144:159]
    s_waitcnt lgkmcnt(0)
    s_waitcnt vmcnt(12)
    s_barrier
    v_mfma_f32_32x32x16_bf16 v[32:47], a[24:27], a[40:43], v[32:47]
    ds_read_b128 a[16:19], v164 offset:0
    v_mfma_f32_32x32x16_bf16 v[96:111], a[24:27], a[44:47], v[96:111]
    ds_read_b128 a[20:23], v164 offset:4096
    s_add_u32 m0, s39, 0
    s_add_u32 s32, s37, 1152
    buffer_load_dwordx4 v1, s[24:27], s32 offen lds
    v_mfma_f32_32x32x16_bf16 v[48:63], a[28:31], a[40:43], v[48:63]
    ds_read_b128 a[0:3], v13 offset:0
    v_mfma_f32_32x32x16_bf16 v[112:127], a[28:31], a[44:47], v[112:127]
    ds_read_b128 a[4:7], v13 offset:4096
    s_add_u32 m0, s39, 1024
    s_add_u32 s32, s37, 1152
    buffer_load_dwordx4 v2, s[24:27], s32 offen lds
    v_mfma_f32_32x32x16_bf16 v[64:79], a[32:35], a[40:43], v[64:79]
    ds_read_b128 a[8:11], v13 offset:8192
    v_mfma_f32_32x32x16_bf16 v[128:143], a[32:35], a[44:47], v[128:143]
    ds_read_b128 a[12:15], v13 offset:12288
    s_add_u32 m0, s39, 2048
    s_add_u32 s32, s37, 1152
    buffer_load_dwordx4 v3, s[24:27], s32 offen lds
    v_mfma_f32_32x32x16_bf16 v[80:95], a[36:39], a[40:43], v[80:95]
    v_mfma_f32_32x32x16_bf16 v[144:159], a[36:39], a[44:47], v[144:159]
    s_add_u32 m0, s39, 3072
    s_add_u32 s32, s37, 1152
    buffer_load_dwordx4 v4, s[24:27], s32 offen lds
    s_waitcnt lgkmcnt(3)
    v_mfma_f32_32x32x16_bf16 v[32:47], a[0:3], a[16:19], v[32:47]
    ds_read_b128 a[40:43], v165 offset:0
    v_mfma_f32_32x32x16_bf16 v[96:111], a[0:3], a[20:23], v[96:111]
    ds_read_b128 a[44:47], v165 offset:4096
    s_add_u32 m0, s40, 0
    s_add_u32 s32, s38, 1152
    buffer_load_dwordx4 v5, s[16:19], s32 offen lds
    s_waitcnt lgkmcnt(4)
    v_mfma_f32_32x32x16_bf16 v[48:63], a[4:7], a[16:19], v[48:63]
    ds_read_b128 a[24:27], v14 offset:0
    v_mfma_f32_32x32x16_bf16 v[112:127], a[4:7], a[20:23], v[112:127]
    ds_read_b128 a[28:31], v14 offset:4096
    s_add_u32 m0, s40, 1024
    s_add_u32 s32, s38, 1152
    buffer_load_dwordx4 v6, s[16:19], s32 offen lds
    s_waitcnt lgkmcnt(5)
    v_mfma_f32_32x32x16_bf16 v[64:79], a[8:11], a[16:19], v[64:79]
    ds_read_b128 a[32:35], v14 offset:8192
    v_mfma_f32_32x32x16_bf16 v[128:143], a[8:11], a[20:23], v[128:143]
    ds_read_b128 a[36:39], v14 offset:12288
    s_add_u32 m0, s40, 2048
    s_add_u32 s32, s38, 1152
    buffer_load_dwordx4 v7, s[16:19], s32 offen lds
    s_waitcnt lgkmcnt(6)
    v_mfma_f32_32x32x16_bf16 v[80:95], a[12:15], a[16:19], v[80:95]
    v_mfma_f32_32x32x16_bf16 v[144:159], a[12:15], a[20:23], v[144:159]
    s_add_u32 m0, s40, 3072
    s_add_u32 s32, s38, 1152
    buffer_load_dwordx4 v8, s[16:19], s32 offen lds
    s_waitcnt lgkmcnt(3)
    v_mfma_f32_32x32x16_bf16 v[32:47], a[24:27], a[40:43], v[32:47]
    ds_read_b128 a[16:19], v166 offset:0
    v_mfma_f32_32x32x16_bf16 v[96:111], a[24:27], a[44:47], v[96:111]
    ds_read_b128 a[20:23], v166 offset:4096
    s_add_u32 m0, s40, 4096
    s_add_u32 s32, s38, 1152
    buffer_load_dwordx4 v5, s[20:23], s32 offen lds
    s_waitcnt lgkmcnt(4)
    v_mfma_f32_32x32x16_bf16 v[48:63], a[28:31], a[40:43], v[48:63]
    ds_read_b128 a[0:3], v15 offset:0
    v_mfma_f32_32x32x16_bf16 v[112:127], a[28:31], a[44:47], v[112:127]
    ds_read_b128 a[4:7], v15 offset:4096
    s_add_u32 m0, s40, 5120
    s_add_u32 s32, s38, 1152
    buffer_load_dwordx4 v6, s[20:23], s32 offen lds
    s_waitcnt lgkmcnt(5)
    v_mfma_f32_32x32x16_bf16 v[64:79], a[32:35], a[40:43], v[64:79]
    ds_read_b128 a[8:11], v15 offset:8192
    v_mfma_f32_32x32x16_bf16 v[128:143], a[32:35], a[44:47], v[128:143]
    ds_read_b128 a[12:15], v15 offset:12288
    s_add_u32 m0, s40, 6144
    s_add_u32 s32, s38, 1152
    buffer_load_dwordx4 v7, s[20:23], s32 offen lds
    s_waitcnt lgkmcnt(6)
    v_mfma_f32_32x32x16_bf16 v[80:95], a[36:39], a[40:43], v[80:95]
    v_mfma_f32_32x32x16_bf16 v[144:159], a[36:39], a[44:47], v[144:159]
    s_add_u32 m0, s40, 7168
    s_add_u32 s32, s38, 1152
    buffer_load_dwordx4 v8, s[20:23], s32 offen lds
    s_waitcnt lgkmcnt(3)
    v_mfma_f32_32x32x16_bf16 v[32:47], a[0:3], a[16:19], v[32:47]
    ds_read_b128 a[40:43], v167 offset:0
    v_mfma_f32_32x32x16_bf16 v[96:111], a[0:3], a[20:23], v[96:111]
    ds_read_b128 a[44:47], v167 offset:4096
    s_waitcnt lgkmcnt(4)
    v_mfma_f32_32x32x16_bf16 v[48:63], a[4:7], a[16:19], v[48:63]
    ds_read_b128 a[24:27], v16 offset:0
    v_mfma_f32_32x32x16_bf16 v[112:127], a[4:7], a[20:23], v[112:127]
    ds_read_b128 a[28:31], v16 offset:4096
    s_waitcnt lgkmcnt(5)
    v_mfma_f32_32x32x16_bf16 v[64:79], a[8:11], a[16:19], v[64:79]
    ds_read_b128 a[32:35], v16 offset:8192
    v_mfma_f32_32x32x16_bf16 v[128:143], a[8:11], a[20:23], v[128:143]
    ds_read_b128 a[36:39], v16 offset:12288
    s_waitcnt lgkmcnt(6)
    v_mfma_f32_32x32x16_bf16 v[80:95], a[12:15], a[16:19], v[80:95]
    v_mfma_f32_32x32x16_bf16 v[144:159], a[12:15], a[20:23], v[144:159]
    s_waitcnt lgkmcnt(0)
    s_waitcnt vmcnt(12)
    s_barrier
    v_mfma_f32_32x32x16_bf16 v[32:47], a[24:27], a[40:43], v[32:47]
    ds_read_b128 a[16:19], v168 offset:0
    v_mfma_f32_32x32x16_bf16 v[96:111], a[24:27], a[44:47], v[96:111]
    ds_read_b128 a[20:23], v168 offset:4096
    v_mfma_f32_32x32x16_bf16 v[48:63], a[28:31], a[40:43], v[48:63]
    ds_read_b128 a[0:3], v17 offset:0
    v_mfma_f32_32x32x16_bf16 v[112:127], a[28:31], a[44:47], v[112:127]
    ds_read_b128 a[4:7], v17 offset:4096
    v_mfma_f32_32x32x16_bf16 v[64:79], a[32:35], a[40:43], v[64:79]
    ds_read_b128 a[8:11], v17 offset:8192
    v_mfma_f32_32x32x16_bf16 v[128:143], a[32:35], a[44:47], v[128:143]
    ds_read_b128 a[12:15], v17 offset:12288
    v_mfma_f32_32x32x16_bf16 v[80:95], a[36:39], a[40:43], v[80:95]
    v_mfma_f32_32x32x16_bf16 v[144:159], a[36:39], a[44:47], v[144:159]
    s_waitcnt lgkmcnt(3)
    v_mfma_f32_32x32x16_bf16 v[32:47], a[0:3], a[16:19], v[32:47]
    ds_read_b128 a[40:43], v169 offset:0
    v_mfma_f32_32x32x16_bf16 v[96:111], a[0:3], a[20:23], v[96:111]
    ds_read_b128 a[44:47], v169 offset:4096
    s_waitcnt lgkmcnt(4)
    v_mfma_f32_32x32x16_bf16 v[48:63], a[4:7], a[16:19], v[48:63]
    ds_read_b128 a[24:27], v18 offset:0
    v_mfma_f32_32x32x16_bf16 v[112:127], a[4:7], a[20:23], v[112:127]
    ds_read_b128 a[28:31], v18 offset:4096
    s_waitcnt lgkmcnt(5)
    v_mfma_f32_32x32x16_bf16 v[64:79], a[8:11], a[16:19], v[64:79]
    ds_read_b128 a[32:35], v18 offset:8192
    v_mfma_f32_32x32x16_bf16 v[128:143], a[8:11], a[20:23], v[128:143]
    ds_read_b128 a[36:39], v18 offset:12288
    s_waitcnt lgkmcnt(6)
    v_mfma_f32_32x32x16_bf16 v[80:95], a[12:15], a[16:19], v[80:95]
    v_mfma_f32_32x32x16_bf16 v[144:159], a[12:15], a[20:23], v[144:159]
    s_waitcnt lgkmcnt(3)
    v_mfma_f32_32x32x16_bf16 v[32:47], a[24:27], a[40:43], v[32:47]
    ds_read_b128 a[16:19], v170 offset:0
    v_mfma_f32_32x32x16_bf16 v[96:111], a[24:27], a[44:47], v[96:111]
    ds_read_b128 a[20:23], v170 offset:4096
    s_waitcnt lgkmcnt(4)
    v_mfma_f32_32x32x16_bf16 v[48:63], a[28:31], a[40:43], v[48:63]
    ds_read_b128 a[0:3], v19 offset:0
    v_mfma_f32_32x32x16_bf16 v[112:127], a[28:31], a[44:47], v[112:127]
    ds_read_b128 a[4:7], v19 offset:4096
    s_waitcnt lgkmcnt(5)
    v_mfma_f32_32x32x16_bf16 v[64:79], a[32:35], a[40:43], v[64:79]
    ds_read_b128 a[8:11], v19 offset:8192
    v_mfma_f32_32x32x16_bf16 v[128:143], a[32:35], a[44:47], v[128:143]
    ds_read_b128 a[12:15], v19 offset:12288
    s_waitcnt lgkmcnt(6)
    v_mfma_f32_32x32x16_bf16 v[80:95], a[36:39], a[40:43], v[80:95]
    v_mfma_f32_32x32x16_bf16 v[144:159], a[36:39], a[44:47], v[144:159]
    s_waitcnt lgkmcnt(3)
    v_mfma_f32_32x32x16_bf16 v[32:47], a[0:3], a[16:19], v[32:47]
    ds_read_b128 a[40:43], v171 offset:0
    v_mfma_f32_32x32x16_bf16 v[96:111], a[0:3], a[20:23], v[96:111]
    ds_read_b128 a[44:47], v171 offset:4096
    s_waitcnt lgkmcnt(4)
    v_mfma_f32_32x32x16_bf16 v[48:63], a[4:7], a[16:19], v[48:63]
    ds_read_b128 a[24:27], v20 offset:0
    v_mfma_f32_32x32x16_bf16 v[112:127], a[4:7], a[20:23], v[112:127]
    ds_read_b128 a[28:31], v20 offset:4096
    s_waitcnt lgkmcnt(5)
    v_mfma_f32_32x32x16_bf16 v[64:79], a[8:11], a[16:19], v[64:79]
    ds_read_b128 a[32:35], v20 offset:8192
    v_mfma_f32_32x32x16_bf16 v[128:143], a[8:11], a[20:23], v[128:143]
    ds_read_b128 a[36:39], v20 offset:12288
    s_waitcnt lgkmcnt(6)
    v_mfma_f32_32x32x16_bf16 v[80:95], a[12:15], a[16:19], v[80:95]
    v_mfma_f32_32x32x16_bf16 v[144:159], a[12:15], a[20:23], v[144:159]
    s_waitcnt lgkmcnt(0)
    s_waitcnt vmcnt(0)
    s_barrier
    v_mfma_f32_32x32x16_bf16 v[32:47], a[24:27], a[40:43], v[32:47]
    ds_read_b128 a[16:19], v160 offset:0
    v_mfma_f32_32x32x16_bf16 v[96:111], a[24:27], a[44:47], v[96:111]
    ds_read_b128 a[20:23], v160 offset:4096
    v_mfma_f32_32x32x16_bf16 v[48:63], a[28:31], a[40:43], v[48:63]
    ds_read_b128 a[0:3], v9 offset:0
    v_mfma_f32_32x32x16_bf16 v[112:127], a[28:31], a[44:47], v[112:127]
    ds_read_b128 a[4:7], v9 offset:4096
    v_mfma_f32_32x32x16_bf16 v[64:79], a[32:35], a[40:43], v[64:79]
    ds_read_b128 a[8:11], v9 offset:8192
    v_mfma_f32_32x32x16_bf16 v[128:143], a[32:35], a[44:47], v[128:143]
    ds_read_b128 a[12:15], v9 offset:12288
    v_mfma_f32_32x32x16_bf16 v[80:95], a[36:39], a[40:43], v[80:95]
    v_mfma_f32_32x32x16_bf16 v[144:159], a[36:39], a[44:47], v[144:159]
    s_waitcnt lgkmcnt(3)
    v_mfma_f32_32x32x16_bf16 v[32:47], a[0:3], a[16:19], v[32:47]
    ds_read_b128 a[40:43], v161 offset:0
    v_mfma_f32_32x32x16_bf16 v[96:111], a[0:3], a[20:23], v[96:111]
    ds_read_b128 a[44:47], v161 offset:4096
    s_waitcnt lgkmcnt(4)
    v_mfma_f32_32x32x16_bf16 v[48:63], a[4:7], a[16:19], v[48:63]
    ds_read_b128 a[24:27], v10 offset:0
    v_mfma_f32_32x32x16_bf16 v[112:127], a[4:7], a[20:23], v[112:127]
    ds_read_b128 a[28:31], v10 offset:4096
    s_waitcnt lgkmcnt(5)
    v_mfma_f32_32x32x16_bf16 v[64:79], a[8:11], a[16:19], v[64:79]
    ds_read_b128 a[32:35], v10 offset:8192
    v_mfma_f32_32x32x16_bf16 v[128:143], a[8:11], a[20:23], v[128:143]
    ds_read_b128 a[36:39], v10 offset:12288
    s_waitcnt lgkmcnt(6)
    v_mfma_f32_32x32x16_bf16 v[80:95], a[12:15], a[16:19], v[80:95]
    v_mfma_f32_32x32x16_bf16 v[144:159], a[12:15], a[20:23], v[144:159]
    s_waitcnt lgkmcnt(3)
    v_mfma_f32_32x32x16_bf16 v[32:47], a[24:27], a[40:43], v[32:47]
    ds_read_b128 a[16:19], v162 offset:0
    v_mfma_f32_32x32x16_bf16 v[96:111], a[24:27], a[44:47], v[96:111]
    ds_read_b128 a[20:23], v162 offset:4096
    s_waitcnt lgkmcnt(4)
    v_mfma_f32_32x32x16_bf16 v[48:63], a[28:31], a[40:43], v[48:63]
    ds_read_b128 a[0:3], v11 offset:0
    v_mfma_f32_32x32x16_bf16 v[112:127], a[28:31], a[44:47], v[112:127]
    ds_read_b128 a[4:7], v11 offset:4096
    s_waitcnt lgkmcnt(5)
    v_mfma_f32_32x32x16_bf16 v[64:79], a[32:35], a[40:43], v[64:79]
    ds_read_b128 a[8:11], v11 offset:8192
    v_mfma_f32_32x32x16_bf16 v[128:143], a[32:35], a[44:47], v[128:143]
    ds_read_b128 a[12:15], v11 offset:12288
    s_waitcnt lgkmcnt(6)
    v_mfma_f32_32x32x16_bf16 v[80:95], a[36:39], a[40:43], v[80:95]
    v_mfma_f32_32x32x16_bf16 v[144:159], a[36:39], a[44:47], v[144:159]
    s_waitcnt lgkmcnt(3)
    v_mfma_f32_32x32x16_bf16 v[32:47], a[0:3], a[16:19], v[32:47]
    ds_read_b128 a[40:43], v163 offset:0
    v_mfma_f32_32x32x16_bf16 v[96:111], a[0:3], a[20:23], v[96:111]
    ds_read_b128 a[44:47], v163 offset:4096
    s_waitcnt lgkmcnt(4)
    v_mfma_f32_32x32x16_bf16 v[48:63], a[4:7], a[16:19], v[48:63]
    ds_read_b128 a[24:27], v12 offset:0
    v_mfma_f32_32x32x16_bf16 v[112:127], a[4:7], a[20:23], v[112:127]
    ds_read_b128 a[28:31], v12 offset:4096
    s_waitcnt lgkmcnt(5)
    v_mfma_f32_32x32x16_bf16 v[64:79], a[8:11], a[16:19], v[64:79]
    ds_read_b128 a[32:35], v12 offset:8192
    v_mfma_f32_32x32x16_bf16 v[128:143], a[8:11], a[20:23], v[128:143]
    ds_read_b128 a[36:39], v12 offset:12288
    s_waitcnt lgkmcnt(6)
    v_mfma_f32_32x32x16_bf16 v[80:95], a[12:15], a[16:19], v[80:95]
    v_mfma_f32_32x32x16_bf16 v[144:159], a[12:15], a[20:23], v[144:159]
    s_waitcnt lgkmcnt(3)
    v_mfma_f32_32x32x16_bf16 v[32:47], a[24:27], a[40:43], v[32:47]
    v_mfma_f32_32x32x16_bf16 v[96:111], a[24:27], a[44:47], v[96:111]
    s_waitcnt lgkmcnt(2)
    v_mfma_f32_32x32x16_bf16 v[48:63], a[28:31], a[40:43], v[48:63]
    v_mfma_f32_32x32x16_bf16 v[112:127], a[28:31], a[44:47], v[112:127]
    s_waitcnt lgkmcnt(1)
    v_mfma_f32_32x32x16_bf16 v[64:79], a[32:35], a[40:43], v[64:79]
    v_mfma_f32_32x32x16_bf16 v[128:143], a[32:35], a[44:47], v[128:143]
    s_waitcnt lgkmcnt(0)
    v_mfma_f32_32x32x16_bf16 v[80:95], a[36:39], a[40:43], v[80:95]
    v_mfma_f32_32x32x16_bf16 v[144:159], a[36:39], a[44:47], v[144:159]
    v_lshlrev_b32 v232, 16, v232
    v_lshlrev_b32 v233, 16, v233
    v_lshlrev_b32 v234, 16, v234
    v_mul_f32 v234, 0x3fb8aa3b, v234
    v_exp_f32 v234, v234
    s_nop 0
    v_cvt_pk_bf16_f32 v234, v234, v234
    v_lshlrev_b32 v234, 16, v234
    v_mul_f32 v242, v234, v232
    v_mul_f32 v242, 0x3fb8aa3b, v242
    v_exp_f32 v242, v242
    v_mul_f32 v243, v234, v233
    v_mul_f32 v243, 0.15915494309189535, v243
    v_rndne_f32 v244, v243
    v_sub_f32 v243, v243, v244
    v_cos_f32 v236, v243
    v_sin_f32 v237, v243
    v_mul_f32 v236, v236, v242
    v_mul_f32 v237, v237, v242
    v_mul_f32 v242, v232, v232
    v_fma_f32 v242, v233, v233, v242
    v_rcp_f32 v242, v242
    v_add_f32 v243, -1.0, v236
    v_add_f32 v242, v242, v242
    v_mul_f32 v238, v243, v232
    v_fma_f32 v238, v237, v233, v238
    v_mul_f32 v239, v237, v232
    v_fma_f32 v239, -v243, v233, v239
    v_mul_f32 v238, v238, v242
    v_mul_f32 v239, v239, v242
    v_mov_b32 v240, v236
    v_mov_b32 v241, v237
    v_mul_f32 v242, v241, v241
    v_mul_f32 v243, v240, v241
    v_fma_f32 v242, v240, v240, -v242
    v_fma_f32 v241, v241, v240, v243
    v_mov_b32 v240, v242
    v_mul_f32 v242, v241, v241
    v_mul_f32 v243, v240, v241
    v_fma_f32 v242, v240, v240, -v242
    v_fma_f32 v241, v241, v240, v243
    v_mov_b32 v240, v242
    v_mul_f32 v242, v241, v241
    v_mul_f32 v243, v240, v241
    v_fma_f32 v242, v240, v240, -v242
    v_fma_f32 v241, v241, v240, v243
    v_mov_b32 v240, v242
    v_mul_f32 v242, v241, v241
    v_mul_f32 v243, v240, v241
    v_fma_f32 v242, v240, v240, -v242
    v_fma_f32 v241, v241, v240, v243
    v_mov_b32 v240, v242
    v_mul_f32 v242, v241, v241
    v_mul_f32 v243, v240, v241
    v_fma_f32 v242, v240, v240, -v242
    v_fma_f32 v241, v241, v240, v243
    v_mov_b32 v240, v242
    v_mul_f32 v242, v241, v241
    v_mul_f32 v243, v240, v241
    v_fma_f32 v242, v240, v240, -v242
    v_fma_f32 v241, v241, v240, v243
    v_mov_b32 v240, v242
    v_mov_b32 v244, v32
    v_mov_b32 v245, v96
    v_fma_f32 v246, v236, v244, v33
    v_fma_f32 v247, v236, v245, v97
    v_fma_f32 v246, -v237, v245, v246
    v_fma_f32 v245, v237, v244, v247
    v_fma_f32 v244, v236, v246, v34
    v_fma_f32 v247, v236, v245, v98
    v_fma_f32 v244, -v237, v245, v244
    v_fma_f32 v245, v237, v246, v247
    v_fma_f32 v246, v236, v244, v35
    v_fma_f32 v247, v236, v245, v99
    v_fma_f32 v246, -v237, v245, v246
    v_fma_f32 v245, v237, v244, v247
    v_fma_f32 v244, v236, v246, v36
    v_fma_f32 v247, v236, v245, v100
    v_fma_f32 v244, -v237, v245, v244
    v_fma_f32 v245, v237, v246, v247
    v_fma_f32 v246, v236, v244, v37
    v_fma_f32 v247, v236, v245, v101
    v_fma_f32 v246, -v237, v245, v246
    v_fma_f32 v245, v237, v244, v247
    v_fma_f32 v244, v236, v246, v38
    v_fma_f32 v247, v236, v245, v102
    v_fma_f32 v244, -v237, v245, v244
    v_fma_f32 v245, v237, v246, v247
    v_fma_f32 v246, v236, v244, v39
    v_fma_f32 v247, v236, v245, v103
    v_fma_f32 v246, -v237, v245, v246
    v_fma_f32 v245, v237, v244, v247
    v_fma_f32 v244, v236, v246, v40
    v_fma_f32 v247, v236, v245, v104
    v_fma_f32 v244, -v237, v245, v244
    v_fma_f32 v245, v237, v246, v247
    v_fma_f32 v246, v236, v244, v41
    v_fma_f32 v247, v236, v245, v105
    v_fma_f32 v246, -v237, v245, v246
    v_fma_f32 v245, v237, v244, v247
    v_fma_f32 v244, v236, v246, v42
    v_fma_f32 v247, v236, v245, v106
    v_fma_f32 v244, -v237, v245, v244
    v_fma_f32 v245, v237, v246, v247
    v_fma_f32 v246, v236, v244, v43
    v_fma_f32 v247, v236, v245, v107
    v_fma_f32 v246, -v237, v245, v246
    v_fma_f32 v245, v237, v244, v247
    v_fma_f32 v244, v236, v246, v44
    v_fma_f32 v247, v236, v245, v108
    v_fma_f32 v244, -v237, v245, v244
    v_fma_f32 v245, v237, v246, v247
    v_fma_f32 v246, v236, v244, v45
    v_fma_f32 v247, v236, v245, v109
    v_fma_f32 v246, -v237, v245, v246
    v_fma_f32 v245, v237, v244, v247
    v_fma_f32 v244, v236, v246, v46
    v_fma_f32 v247, v236, v245, v110
    v_fma_f32 v244, -v237, v245, v244
    v_fma_f32 v245, v237, v246, v247
    v_fma_f32 v246, v236, v244, v47
    v_fma_f32 v247, v236, v245, v111
    v_fma_f32 v246, -v237, v245, v246
    v_fma_f32 v245, v237, v244, v247
    v_fma_f32 v244, v236, v246, v48
    v_fma_f32 v247, v236, v245, v112
    v_fma_f32 v244, -v237, v245, v244
    v_fma_f32 v245, v237, v246, v247
    v_fma_f32 v246, v236, v244, v49
    v_fma_f32 v247, v236, v245, v113
    v_fma_f32 v246, -v237, v245, v246
    v_fma_f32 v245, v237, v244, v247
    v_fma_f32 v244, v236, v246, v50
    v_fma_f32 v247, v236, v245, v114
    v_fma_f32 v244, -v237, v245, v244
    v_fma_f32 v245, v237, v246, v247
    v_fma_f32 v246, v236, v244, v51
    v_fma_f32 v247, v236, v245, v115
    v_fma_f32 v246, -v237, v245, v246
    v_fma_f32 v245, v237, v244, v247
    v_fma_f32 v244, v236, v246, v52
    v_fma_f32 v247, v236, v245, v116
    v_fma_f32 v244, -v237, v245, v244
    v_fma_f32 v245, v237, v246, v247
    v_fma_f32 v246, v236, v244, v53
    v_fma_f32 v247, v236, v245, v117
    v_fma_f32 v246, -v237, v245, v246
    v_fma_f32 v245, v237, v244, v247
    v_fma_f32 v244, v236, v246, v54
    v_fma_f32 v247, v236, v245, v118
    v_fma_f32 v244, -v237, v245, v244
    v_fma_f32 v245, v237, v246, v247
    v_fma_f32 v246, v236, v244, v55
    v_fma_f32 v247, v236, v245, v119
    v_fma_f32 v246, -v237, v245, v246
    v_fma_f32 v245, v237, v244, v247
    v_fma_f32 v244, v236, v246, v56
    v_fma_f32 v247, v236, v245, v120
    v_fma_f32 v244, -v237, v245, v244
    v_fma_f32 v245, v237, v246, v247
    v_fma_f32 v246, v236, v244, v57
    v_fma_f32 v247, v236, v245, v121
    v_fma_f32 v246, -v237, v245, v246
    v_fma_f32 v245, v237, v244, v247
    v_fma_f32 v244, v236, v246, v58
    v_fma_f32 v247, v236, v245, v122
    v_fma_f32 v244, -v237, v245, v244
    v_fma_f32 v245, v237, v246, v247
    v_fma_f32 v246, v236, v244, v59
    v_fma_f32 v247, v236, v245, v123
    v_fma_f32 v246, -v237, v245, v246
    v_fma_f32 v245, v237, v244, v247
    v_fma_f32 v244, v236, v246, v60
    v_fma_f32 v247, v236, v245, v124
    v_fma_f32 v244, -v237, v245, v244
    v_fma_f32 v245, v237, v246, v247
    v_fma_f32 v246, v236, v244, v61
    v_fma_f32 v247, v236, v245, v125
    v_fma_f32 v246, -v237, v245, v246
    v_fma_f32 v245, v237, v244, v247
    v_fma_f32 v244, v236, v246, v62
    v_fma_f32 v247, v236, v245, v126
    v_fma_f32 v244, -v237, v245, v244
    v_fma_f32 v245, v237, v246, v247
    v_fma_f32 v246, v236, v244, v63
    v_fma_f32 v247, v236, v245, v127
    v_fma_f32 v246, -v237, v245, v246
    v_fma_f32 v245, v237, v244, v247
    v_fma_f32 v244, v236, v246, v64
    v_fma_f32 v247, v236, v245, v128
    v_fma_f32 v244, -v237, v245, v244
    v_fma_f32 v245, v237, v246, v247
    v_fma_f32 v246, v236, v244, v65
    v_fma_f32 v247, v236, v245, v129
    v_fma_f32 v246, -v237, v245, v246
    v_fma_f32 v245, v237, v244, v247
    v_fma_f32 v244, v236, v246, v66
    v_fma_f32 v247, v236, v245, v130
    v_fma_f32 v244, -v237, v245, v244
    v_fma_f32 v245, v237, v246, v247
    v_fma_f32 v246, v236, v244, v67
    v_fma_f32 v247, v236, v245, v131
    v_fma_f32 v246, -v237, v245, v246
    v_fma_f32 v245, v237, v244, v247
    v_fma_f32 v244, v236, v246, v68
    v_fma_f32 v247, v236, v245, v132
    v_fma_f32 v244, -v237, v245, v244
    v_fma_f32 v245, v237, v246, v247
    v_fma_f32 v246, v236, v244, v69
    v_fma_f32 v247, v236, v245, v133
    v_fma_f32 v246, -v237, v245, v246
    v_fma_f32 v245, v237, v244, v247
    v_fma_f32 v244, v236, v246, v70
    v_fma_f32 v247, v236, v245, v134
    v_fma_f32 v244, -v237, v245, v244
    v_fma_f32 v245, v237, v246, v247
    v_fma_f32 v246, v236, v244, v71
    v_fma_f32 v247, v236, v245, v135
    v_fma_f32 v246, -v237, v245, v246
    v_fma_f32 v245, v237, v244, v247
    v_fma_f32 v244, v236, v246, v72
    v_fma_f32 v247, v236, v245, v136
    v_fma_f32 v244, -v237, v245, v244
    v_fma_f32 v245, v237, v246, v247
    v_fma_f32 v246, v236, v244, v73
    v_fma_f32 v247, v236, v245, v137
    v_fma_f32 v246, -v237, v245, v246
    v_fma_f32 v245, v237, v244, v247
    v_fma_f32 v244, v236, v246, v74
    v_fma_f32 v247, v236, v245, v138
    v_fma_f32 v244, -v237, v245, v244
    v_fma_f32 v245, v237, v246, v247
    v_fma_f32 v246, v236, v244, v75
    v_fma_f32 v247, v236, v245, v139
    v_fma_f32 v246, -v237, v245, v246
    v_fma_f32 v245, v237, v244, v247
    v_fma_f32 v244, v236, v246, v76
    v_fma_f32 v247, v236, v245, v140
    v_fma_f32 v244, -v237, v245, v244
    v_fma_f32 v245, v237, v246, v247
    v_fma_f32 v246, v236, v244, v77
    v_fma_f32 v247, v236, v245, v141
    v_fma_f32 v246, -v237, v245, v246
    v_fma_f32 v245, v237, v244, v247
    v_fma_f32 v244, v236, v246, v78
    v_fma_f32 v247, v236, v245, v142
    v_fma_f32 v244, -v237, v245, v244
    v_fma_f32 v245, v237, v246, v247
    v_fma_f32 v246, v236, v244, v79
    v_fma_f32 v247, v236, v245, v143
    v_fma_f32 v246, -v237, v245, v246
    v_fma_f32 v245, v237, v244, v247
    v_fma_f32 v244, v236, v246, v80
    v_fma_f32 v247, v236, v245, v144
    v_fma_f32 v244, -v237, v245, v244
    v_fma_f32 v245, v237, v246, v247
    v_fma_f32 v246, v236, v244, v81
    v_fma_f32 v247, v236, v245, v145
    v_fma_f32 v246, -v237, v245, v246
    v_fma_f32 v245, v237, v244, v247
    v_fma_f32 v244, v236, v246, v82
    v_fma_f32 v247, v236, v245, v146
    v_fma_f32 v244, -v237, v245, v244
    v_fma_f32 v245, v237, v246, v247
    v_fma_f32 v246, v236, v244, v83
    v_fma_f32 v247, v236, v245, v147
    v_fma_f32 v246, -v237, v245, v246
    v_fma_f32 v245, v237, v244, v247
    v_fma_f32 v244, v236, v246, v84
    v_fma_f32 v247, v236, v245, v148
    v_fma_f32 v244, -v237, v245, v244
    v_fma_f32 v245, v237, v246, v247
    v_fma_f32 v246, v236, v244, v85
    v_fma_f32 v247, v236, v245, v149
    v_fma_f32 v246, -v237, v245, v246
    v_fma_f32 v245, v237, v244, v247
    v_fma_f32 v244, v236, v246, v86
    v_fma_f32 v247, v236, v245, v150
    v_fma_f32 v244, -v237, v245, v244
    v_fma_f32 v245, v237, v246, v247
    v_fma_f32 v246, v236, v244, v87
    v_fma_f32 v247, v236, v245, v151
    v_fma_f32 v246, -v237, v245, v246
    v_fma_f32 v245, v237, v244, v247
    v_fma_f32 v244, v236, v246, v88
    v_fma_f32 v247, v236, v245, v152
    v_fma_f32 v244, -v237, v245, v244
    v_fma_f32 v245, v237, v246, v247
    v_fma_f32 v246, v236, v244, v89
    v_fma_f32 v247, v236, v245, v153
    v_fma_f32 v246, -v237, v245, v246
    v_fma_f32 v245, v237, v244, v247
    v_fma_f32 v244, v236, v246, v90
    v_fma_f32 v247, v236, v245, v154
    v_fma_f32 v244, -v237, v245, v244
    v_fma_f32 v245, v237, v246, v247
    v_fma_f32 v246, v236, v244, v91
    v_fma_f32 v247, v236, v245, v155
    v_fma_f32 v246, -v237, v245, v246
    v_fma_f32 v245, v237, v244, v247
    v_fma_f32 v244, v236, v246, v92
    v_fma_f32 v247, v236, v245, v156
    v_fma_f32 v244, -v237, v245, v244
    v_fma_f32 v245, v237, v246, v247
    v_fma_f32 v246, v236, v244, v93
    v_fma_f32 v247, v236, v245, v157
    v_fma_f32 v246, -v237, v245, v246
    v_fma_f32 v245, v237, v244, v247
    v_fma_f32 v244, v236, v246, v94
    v_fma_f32 v247, v236, v245, v158
    v_fma_f32 v244, -v237, v245, v244
    v_fma_f32 v245, v237, v246, v247
    v_fma_f32 v246, v236, v244, v95
    v_fma_f32 v247, v236, v245, v159
    v_fma_f32 v246, -v237, v245, v246
    v_fma_f32 v245, v237, v244, v247
    v_mov_b32 v244, v246
    v_and_b32 v26, 31, v0
    v_lshlrev_b32 v26, 3, v26
    v_lshrrev_b32 v28, 5, v0
    v_mul_u32_u24 v27, 5120, v28
    v_add_u32 v27, v27, v26
    s_lshl_b32 s37, s36, 10
    s_lshl_b32 s32, s28, 8
    s_add_u32 s37, s37, s32
    s_add_u32 s37, s37, 174063616
    s_mul_i32 s32, s35, 10240
    s_add_u32 s32, s32, s37
    buffer_store_dwordx2 v[244:245], v27, s[8:11], s32 offen sc1
    s_lshl_b32 s38, s36, 2
    s_add_u32 s38, s38, 16
    s_lshl_b32 s39, 1, s35
    s_waitcnt vmcnt(0)
    s_barrier
    s_cmp_lg_u32 s28, 0
    s_cbranch_scc1 sb_12
    v_mov_b32 v29, s39
    s_mov_b64 exec, 1
    buffer_atomic_or v29, off, s[12:15], s38 sc1
    s_mov_b64 exec, -1
sb_12:
    s_lshl_b32 s40, s39, 1
    s_sub_u32 s40, s40, 1
wb_13:
    buffer_load_dword v29, off, s[12:15], s38 sc1
    s_waitcnt vmcnt(0)
    v_readfirstlane_b32 s33, v29
    s_nop 0
    s_and_b32 s33, s33, s40
    s_cmp_eq_u32 s33, s40
    s_cbranch_scc1 wbd_14
    s_sleep 8
    s_sub_u32 s44, s44, 1
    s_cbranch_scc0 wb_13
    s_mov_b32 s44, 0
wbd_14:
    s_add_u32 s32, s37, 0
    buffer_load_dwordx2 v[164:165], v26, s[8:11], s32 offen sc1
    s_add_u32 s32, s37, 5120
    buffer_load_dwordx2 v[166:167], v26, s[8:11], s32 offen sc1
    s_add_u32 s32, s37, 10240
    buffer_load_dwordx2 v[168:169], v26, s[8:11], s32 offen sc1
    s_add_u32 s32, s37, 15360
    buffer_load_dwordx2 v[170:171], v26, s[8:11], s32 offen sc1
    s_add_u32 s32, s37, 20480
    buffer_load_dwordx2 v[172:173], v26, s[8:11], s32 offen sc1
    s_add_u32 s32, s37, 25600
    buffer_load_dwordx2 v[174:175], v26, s[8:11], s32 offen sc1
    s_add_u32 s32, s37, 30720
    buffer_load_dwordx2 v[176:177], v26, s[8:11], s32 offen sc1
    s_add_u32 s32, s37, 35840
    buffer_load_dwordx2 v[178:179], v26, s[8:11], s32 offen sc1
    s_add_u32 s32, s37, 40960
    buffer_load_dwordx2 v[180:181], v26, s[8:11], s32 offen sc1
    s_add_u32 s32, s37, 46080
    buffer_load_dwordx2 v[182:183], v26, s[8:11], s32 offen sc1
    s_add_u32 s32, s37, 51200
    buffer_load_dwordx2 v[184:185], v26, s[8:11], s32 offen sc1
    s_add_u32 s32, s37, 56320
    buffer_load_dwordx2 v[186:187], v26, s[8:11], s32 offen sc1
    s_add_u32 s32, s37, 61440
    buffer_load_dwordx2 v[188:189], v26, s[8:11], s32 offen sc1
    s_add_u32 s32, s37, 66560
    buffer_load_dwordx2 v[190:191], v26, s[8:11], s32 offen sc1
    s_add_u32 s32, s37, 71680
    buffer_load_dwordx2 v[192:193], v26, s[8:11], s32 offen sc1
    s_add_u32 s32, s37, 76800
    buffer_load_dwordx2 v[194:195], v26, s[8:11], s32 offen sc1
    s_add_u32 s32, s37, 81920
    buffer_load_dwordx2 v[196:197], v26, s[8:11], s32 offen sc1
    s_add_u32 s32, s37, 87040
    buffer_load_dwordx2 v[198:199], v26, s[8:11], s32 offen sc1
    s_add_u32 s32, s37, 92160
    buffer_load_dwordx2 v[200:201], v26, s[8:11], s32 offen sc1
    s_add_u32 s32, s37, 97280
    buffer_load_dwordx2 v[202:203], v26, s[8:11], s32 offen sc1
    s_add_u32 s32, s37, 102400
    buffer_load_dwordx2 v[204:205], v26, s[8:11], s32 offen sc1
    s_add_u32 s32, s37, 107520
    buffer_load_dwordx2 v[206:207], v26, s[8:11], s32 offen sc1
    s_add_u32 s32, s37, 112640
    buffer_load_dwordx2 v[208:209], v26, s[8:11], s32 offen sc1
    s_add_u32 s32, s37, 117760
    buffer_load_dwordx2 v[210:211], v26, s[8:11], s32 offen sc1
    s_add_u32 s32, s37, 122880
    buffer_load_dwordx2 v[212:213], v26, s[8:11], s32 offen sc1
    s_add_u32 s32, s37, 128000
    buffer_load_dwordx2 v[214:215], v26, s[8:11], s32 offen sc1
    s_add_u32 s32, s37, 133120
    buffer_load_dwordx2 v[216:217], v26, s[8:11], s32 offen sc1
    s_add_u32 s32, s37, 138240
    buffer_load_dwordx2 v[218:219], v26, s[8:11], s32 offen sc1
    s_add_u32 s32, s37, 143360
    buffer_load_dwordx2 v[220:221], v26, s[8:11], s32 offen sc1
    s_add_u32 s32, s37, 148480
    buffer_load_dwordx2 v[222:223], v26, s[8:11], s32 offen sc1
    s_add_u32 s32, s37, 153600
    buffer_load_dwordx2 v[224:225], v26, s[8:11], s32 offen sc1
    s_lshl_b32 s32, s35, 1
    v_add_u32 v28, s32, v28
    v_mov_b64 v[244:245], 0
    s_waitcnt vmcnt(0)
    v_cmp_lt_u32 vcc, 0, v28
    v_fma_f32 v246, v240, v244, v164
    v_fma_f32 v247, v240, v245, v165
    v_fma_f32 v246, -v241, v245, v246
    v_fma_f32 v247, v241, v244, v247
    v_cndmask_b32 v244, v244, v246, vcc
    v_cndmask_b32 v245, v245, v247, vcc
    v_cmp_lt_u32 vcc, 1, v28
    v_fma_f32 v246, v240, v244, v166
    v_fma_f32 v247, v240, v245, v167
    v_fma_f32 v246, -v241, v245, v246
    v_fma_f32 v247, v241, v244, v247
    v_cndmask_b32 v244, v244, v246, vcc
    v_cndmask_b32 v245, v245, v247, vcc
    v_cmp_lt_u32 vcc, 2, v28
    v_fma_f32 v246, v240, v244, v168
    v_fma_f32 v247, v240, v245, v169
    v_fma_f32 v246, -v241, v245, v246
    v_fma_f32 v247, v241, v244, v247
    v_cndmask_b32 v244, v244, v246, vcc
    v_cndmask_b32 v245, v245, v247, vcc
    v_cmp_lt_u32 vcc, 3, v28
    v_fma_f32 v246, v240, v244, v170
    v_fma_f32 v247, v240, v245, v171
    v_fma_f32 v246, -v241, v245, v246
    v_fma_f32 v247, v241, v244, v247
    v_cndmask_b32 v244, v244, v246, vcc
    v_cndmask_b32 v245, v245, v247, vcc
    v_cmp_lt_u32 vcc, 4, v28
    v_fma_f32 v246, v240, v244, v172
    v_fma_f32 v247, v240, v245, v173
    v_fma_f32 v246, -v241, v245, v246
    v_fma_f32 v247, v241, v244, v247
    v_cndmask_b32 v244, v244, v246, vcc
    v_cndmask_b32 v245, v245, v247, vcc
    v_cmp_lt_u32 vcc, 5, v28
    v_fma_f32 v246, v240, v244, v174
    v_fma_f32 v247, v240, v245, v175
    v_fma_f32 v246, -v241, v245, v246
    v_fma_f32 v247, v241, v244, v247
    v_cndmask_b32 v244, v244, v246, vcc
    v_cndmask_b32 v245, v245, v247, vcc
    v_cmp_lt_u32 vcc, 6, v28
    v_fma_f32 v246, v240, v244, v176
    v_fma_f32 v247, v240, v245, v177
    v_fma_f32 v246, -v241, v245, v246
    v_fma_f32 v247, v241, v244, v247
    v_cndmask_b32 v244, v244, v246, vcc
    v_cndmask_b32 v245, v245, v247, vcc
    v_cmp_lt_u32 vcc, 7, v28
    v_fma_f32 v246, v240, v244, v178
    v_fma_f32 v247, v240, v245, v179
    v_fma_f32 v246, -v241, v245, v246
    v_fma_f32 v247, v241, v244, v247
    v_cndmask_b32 v244, v244, v246, vcc
    v_cndmask_b32 v245, v245, v247, vcc
    v_cmp_lt_u32 vcc, 8, v28
    v_fma_f32 v246, v240, v244, v180
    v_fma_f32 v247, v240, v245, v181
    v_fma_f32 v246, -v241, v245, v246
    v_fma_f32 v247, v241, v244, v247
    v_cndmask_b32 v244, v244, v246, vcc
    v_cndmask_b32 v245, v245, v247, vcc
    v_cmp_lt_u32 vcc, 9, v28
    v_fma_f32 v246, v240, v244, v182
    v_fma_f32 v247, v240, v245, v183
    v_fma_f32 v246, -v241, v245, v246
    v_fma_f32 v247, v241, v244, v247
    v_cndmask_b32 v244, v244, v246, vcc
    v_cndmask_b32 v245, v245, v247, vcc
    v_cmp_lt_u32 vcc, 10, v28
    v_fma_f32 v246, v240, v244, v184
    v_fma_f32 v247, v240, v245, v185
    v_fma_f32 v246, -v241, v245, v246
    v_fma_f32 v247, v241, v244, v247
    v_cndmask_b32 v244, v244, v246, vcc
    v_cndmask_b32 v245, v245, v247, vcc
    v_cmp_lt_u32 vcc, 11, v28
    v_fma_f32 v246, v240, v244, v186
    v_fma_f32 v247, v240, v245, v187
    v_fma_f32 v246, -v241, v245, v246
    v_fma_f32 v247, v241, v244, v247
    v_cndmask_b32 v244, v244, v246, vcc
    v_cndmask_b32 v245, v245, v247, vcc
    v_cmp_lt_u32 vcc, 12, v28
    v_fma_f32 v246, v240, v244, v188
    v_fma_f32 v247, v240, v245, v189
    v_fma_f32 v246, -v241, v245, v246
    v_fma_f32 v247, v241, v244, v247
    v_cndmask_b32 v244, v244, v246, vcc
    v_cndmask_b32 v245, v245, v247, vcc
    v_cmp_lt_u32 vcc, 13, v28
    v_fma_f32 v246, v240, v244, v190
    v_fma_f32 v247, v240, v245, v191
    v_fma_f32 v246, -v241, v245, v246
    v_fma_f32 v247, v241, v244, v247
    v_cndmask_b32 v244, v244, v246, vcc
    v_cndmask_b32 v245, v245, v247, vcc
    v_cmp_lt_u32 vcc, 14, v28
    v_fma_f32 v246, v240, v244, v192
    v_fma_f32 v247, v240, v245, v193
    v_fma_f32 v246, -v241, v245, v246
    v_fma_f32 v247, v241, v244, v247
    v_cndmask_b32 v244, v244, v246, vcc
    v_cndmask_b32 v245, v245, v247, vcc
    v_cmp_lt_u32 vcc, 15, v28
    v_fma_f32 v246, v240, v244, v194
    v_fma_f32 v247, v240, v245, v195
    v_fma_f32 v246, -v241, v245, v246
    v_fma_f32 v247, v241, v244, v247
    v_cndmask_b32 v244, v244, v246, vcc
    v_cndmask_b32 v245, v245, v247, vcc
    v_cmp_lt_u32 vcc, 16, v28
    v_fma_f32 v246, v240, v244, v196
    v_fma_f32 v247, v240, v245, v197
    v_fma_f32 v246, -v241, v245, v246
    v_fma_f32 v247, v241, v244, v247
    v_cndmask_b32 v244, v244, v246, vcc
    v_cndmask_b32 v245, v245, v247, vcc
    v_cmp_lt_u32 vcc, 17, v28
    v_fma_f32 v246, v240, v244, v198
    v_fma_f32 v247, v240, v245, v199
    v_fma_f32 v246, -v241, v245, v246
    v_fma_f32 v247, v241, v244, v247
    v_cndmask_b32 v244, v244, v246, vcc
    v_cndmask_b32 v245, v245, v247, vcc
    v_cmp_lt_u32 vcc, 18, v28
    v_fma_f32 v246, v240, v244, v200
    v_fma_f32 v247, v240, v245, v201
    v_fma_f32 v246, -v241, v245, v246
    v_fma_f32 v247, v241, v244, v247
    v_cndmask_b32 v244, v244, v246, vcc
    v_cndmask_b32 v245, v245, v247, vcc
    v_cmp_lt_u32 vcc, 19, v28
    v_fma_f32 v246, v240, v244, v202
    v_fma_f32 v247, v240, v245, v203
    v_fma_f32 v246, -v241, v245, v246
    v_fma_f32 v247, v241, v244, v247
    v_cndmask_b32 v244, v244, v246, vcc
    v_cndmask_b32 v245, v245, v247, vcc
    v_cmp_lt_u32 vcc, 20, v28
    v_fma_f32 v246, v240, v244, v204
    v_fma_f32 v247, v240, v245, v205
    v_fma_f32 v246, -v241, v245, v246
    v_fma_f32 v247, v241, v244, v247
    v_cndmask_b32 v244, v244, v246, vcc
    v_cndmask_b32 v245, v245, v247, vcc
    v_cmp_lt_u32 vcc, 21, v28
    v_fma_f32 v246, v240, v244, v206
    v_fma_f32 v247, v240, v245, v207
    v_fma_f32 v246, -v241, v245, v246
    v_fma_f32 v247, v241, v244, v247
    v_cndmask_b32 v244, v244, v246, vcc
    v_cndmask_b32 v245, v245, v247, vcc
    v_cmp_lt_u32 vcc, 22, v28
    v_fma_f32 v246, v240, v244, v208
    v_fma_f32 v247, v240, v245, v209
    v_fma_f32 v246, -v241, v245, v246
    v_fma_f32 v247, v241, v244, v247
    v_cndmask_b32 v244, v244, v246, vcc
    v_cndmask_b32 v245, v245, v247, vcc
    v_cmp_lt_u32 vcc, 23, v28
    v_fma_f32 v246, v240, v244, v210
    v_fma_f32 v247, v240, v245, v211
    v_fma_f32 v246, -v241, v245, v246
    v_fma_f32 v247, v241, v244, v247
    v_cndmask_b32 v244, v244, v246, vcc
    v_cndmask_b32 v245, v245, v247, vcc
    v_cmp_lt_u32 vcc, 24, v28
    v_fma_f32 v246, v240, v244, v212
    v_fma_f32 v247, v240, v245, v213
    v_fma_f32 v246, -v241, v245, v246
    v_fma_f32 v247, v241, v244, v247
    v_cndmask_b32 v244, v244, v246, vcc
    v_cndmask_b32 v245, v245, v247, vcc
    v_cmp_lt_u32 vcc, 25, v28
    v_fma_f32 v246, v240, v244, v214
    v_fma_f32 v247, v240, v245, v215
    v_fma_f32 v246, -v241, v245, v246
    v_fma_f32 v247, v241, v244, v247
    v_cndmask_b32 v244, v244, v246, vcc
    v_cndmask_b32 v245, v245, v247, vcc
    v_cmp_lt_u32 vcc, 26, v28
    v_fma_f32 v246, v240, v244, v216
    v_fma_f32 v247, v240, v245, v217
    v_fma_f32 v246, -v241, v245, v246
    v_fma_f32 v247, v241, v244, v247
    v_cndmask_b32 v244, v244, v246, vcc
    v_cndmask_b32 v245, v245, v247, vcc
    v_cmp_lt_u32 vcc, 27, v28
    v_fma_f32 v246, v240, v244, v218
    v_fma_f32 v247, v240, v245, v219
    v_fma_f32 v246, -v241, v245, v246
    v_fma_f32 v247, v241, v244, v247
    v_cndmask_b32 v244, v244, v246, vcc
    v_cndmask_b32 v245, v245, v247, vcc
    v_cmp_lt_u32 vcc, 28, v28
    v_fma_f32 v246, v240, v244, v220
    v_fma_f32 v247, v240, v245, v221
    v_fma_f32 v246, -v241, v245, v246
    v_fma_f32 v247, v241, v244, v247
    v_cndmask_b32 v244, v244, v246, vcc
    v_cndmask_b32 v245, v245, v247, vcc
    v_cmp_lt_u32 vcc, 29, v28
    v_fma_f32 v246, v240, v244, v222
    v_fma_f32 v247, v240, v245, v223
    v_fma_f32 v246, -v241, v245, v246
    v_fma_f32 v247, v241, v244, v247
    v_cndmask_b32 v244, v244, v246, vcc
    v_cndmask_b32 v245, v245, v247, vcc
    v_cmp_lt_u32 vcc, 30, v28
    v_fma_f32 v246, v240, v244, v224
    v_fma_f32 v247, v240, v245, v225
    v_fma_f32 v246, -v241, v245, v246
    v_fma_f32 v247, v241, v244, v247
    v_cndmask_b32 v244, v244, v246, vcc
    v_cndmask_b32 v245, v245, v247, vcc
    v_bfe_u32 v26, v0, 2, 3
    v_lshlrev_b32 v26, 10, v26
    v_and_b32 v27, 3, v0
    v_lshl_add_u32 v26, v27, 4, v26
    v_lshrrev_b32 v27, 5, v0
    v_lshl_add_u32 v26, v27, 9, v26
    s_mul_i32 s37, s35, 327680
    s_lshl_b32 s32, s36, 15
    s_add_u32 s37, s37, s32
    s_lshl_b32 s32, s28, 13
    s_add_u32 s37, s37, s32
    s_add_u32 s37, s37, 167772160
    s_add_u32 s40, s37, 163840
    v_fma_f32 v32, v236, v244, v32
    v_fma_f32 v96, v236, v245, v96
    v_fma_f32 v32, -v237, v245, v32
    v_fma_f32 v96, v237, v244, v96
    v_fma_f32 v33, v236, v32, v33
    v_fma_f32 v97, v236, v96, v97
    v_mul_f32 v180, v238, v32
    v_mul_f32 v188, v238, v96
    v_fma_f32 v33, -v237, v96, v33
    v_fma_f32 v97, v237, v32, v97
    v_fma_f32 v180, -v239, v96, v180
    v_fma_f32 v188, -v239, v32, -v188
    v_fma_f32 v34, v236, v33, v34
    v_fma_f32 v98, v236, v97, v98
    v_mul_f32 v181, v238, v33
    v_mul_f32 v189, v238, v97
    v_fma_f32 v34, -v237, v97, v34
    v_fma_f32 v98, v237, v33, v98
    v_fma_f32 v181, -v239, v97, v181
    v_fma_f32 v189, -v239, v33, -v189
    v_fma_f32 v35, v236, v34, v35
    v_fma_f32 v99, v236, v98, v99
    v_mul_f32 v182, v238, v34
    v_mul_f32 v190, v238, v98
    v_fma_f32 v35, -v237, v98, v35
    v_fma_f32 v99, v237, v34, v99
    v_fma_f32 v182, -v239, v98, v182
    v_fma_f32 v190, -v239, v34, -v190
    v_fma_f32 v36, v236, v35, v36
    v_fma_f32 v100, v236, v99, v100
    v_mul_f32 v183, v238, v35
    v_mul_f32 v191, v238, v99
    v_fma_f32 v36, -v237, v99, v36
    v_fma_f32 v100, v237, v35, v100
    v_fma_f32 v183, -v239, v99, v183
    v_fma_f32 v191, -v239, v35, -v191
    v_fma_f32 v37, v236, v36, v37
    v_fma_f32 v101, v236, v100, v101
    v_mul_f32 v184, v238, v36
    v_mul_f32 v192, v238, v100
    v_fma_f32 v37, -v237, v100, v37
    v_fma_f32 v101, v237, v36, v101
    v_fma_f32 v184, -v239, v100, v184
    v_fma_f32 v192, -v239, v36, -v192
    v_fma_f32 v38, v236, v37, v38
    v_fma_f32 v102, v236, v101, v102
    v_mul_f32 v185, v238, v37
    v_mul_f32 v193, v238, v101
    v_fma_f32 v38, -v237, v101, v38
    v_fma_f32 v102, v237, v37, v102
    v_fma_f32 v185, -v239, v101, v185
    v_fma_f32 v193, -v239, v37, -v193
    v_fma_f32 v39, v236, v38, v39
    v_fma_f32 v103, v236, v102, v103
    v_mul_f32 v186, v238, v38
    v_mul_f32 v194, v238, v102
    v_fma_f32 v39, -v237, v102, v39
    v_fma_f32 v103, v237, v38, v103
    v_fma_f32 v186, -v239, v102, v186
    v_fma_f32 v194, -v239, v38, -v194
    v_fma_f32 v40, v236, v39, v40
    v_fma_f32 v104, v236, v103, v104
    v_mul_f32 v187, v238, v39
    v_mul_f32 v195, v238, v103
    v_fma_f32 v40, -v237, v103, v40
    v_fma_f32 v104, v237, v39, v104
    v_fma_f32 v187, -v239, v103, v187
    v_fma_f32 v195, -v239, v39, -v195
    v_cvt_pk_bf16_f32 v196, v180, v181
    v_cvt_pk_bf16_f32 v200, v188, v189
    v_cvt_pk_bf16_f32 v197, v182, v183
    v_cvt_pk_bf16_f32 v201, v190, v191
    v_cvt_pk_bf16_f32 v198, v184, v185
    v_cvt_pk_bf16_f32 v202, v192, v193
    v_cvt_pk_bf16_f32 v199, v186, v187
    v_cvt_pk_bf16_f32 v203, v194, v195
    buffer_store_dwordx4 v[196:199], v26, s[8:11], s37 offen offset:0 sc1
    buffer_store_dwordx4 v[200:203], v26, s[8:11], s40 offen offset:0 sc1
    v_fma_f32 v41, v236, v40, v41
    v_fma_f32 v105, v236, v104, v105
    v_mul_f32 v180, v238, v40
    v_mul_f32 v188, v238, v104
    v_fma_f32 v41, -v237, v104, v41
    v_fma_f32 v105, v237, v40, v105
    v_fma_f32 v180, -v239, v104, v180
    v_fma_f32 v188, -v239, v40, -v188
    v_fma_f32 v42, v236, v41, v42
    v_fma_f32 v106, v236, v105, v106
    v_mul_f32 v181, v238, v41
    v_mul_f32 v189, v238, v105
    v_fma_f32 v42, -v237, v105, v42
    v_fma_f32 v106, v237, v41, v106
    v_fma_f32 v181, -v239, v105, v181
    v_fma_f32 v189, -v239, v41, -v189
    v_fma_f32 v43, v236, v42, v43
    v_fma_f32 v107, v236, v106, v107
    v_mul_f32 v182, v238, v42
    v_mul_f32 v190, v238, v106
    v_fma_f32 v43, -v237, v106, v43
    v_fma_f32 v107, v237, v42, v107
    v_fma_f32 v182, -v239, v106, v182
    v_fma_f32 v190, -v239, v42, -v190
    v_fma_f32 v44, v236, v43, v44
    v_fma_f32 v108, v236, v107, v108
    v_mul_f32 v183, v238, v43
    v_mul_f32 v191, v238, v107
    v_fma_f32 v44, -v237, v107, v44
    v_fma_f32 v108, v237, v43, v108
    v_fma_f32 v183, -v239, v107, v183
    v_fma_f32 v191, -v239, v43, -v191
    v_fma_f32 v45, v236, v44, v45
    v_fma_f32 v109, v236, v108, v109
    v_mul_f32 v184, v238, v44
    v_mul_f32 v192, v238, v108
    v_fma_f32 v45, -v237, v108, v45
    v_fma_f32 v109, v237, v44, v109
    v_fma_f32 v184, -v239, v108, v184
    v_fma_f32 v192, -v239, v44, -v192
    v_fma_f32 v46, v236, v45, v46
    v_fma_f32 v110, v236, v109, v110
    v_mul_f32 v185, v238, v45
    v_mul_f32 v193, v238, v109
    v_fma_f32 v46, -v237, v109, v46
    v_fma_f32 v110, v237, v45, v110
    v_fma_f32 v185, -v239, v109, v185
    v_fma_f32 v193, -v239, v45, -v193
    v_fma_f32 v47, v236, v46, v47
    v_fma_f32 v111, v236, v110, v111
    v_mul_f32 v186, v238, v46
    v_mul_f32 v194, v238, v110
    v_fma_f32 v47, -v237, v110, v47
    v_fma_f32 v111, v237, v46, v111
    v_fma_f32 v186, -v239, v110, v186
    v_fma_f32 v194, -v239, v46, -v194
    v_fma_f32 v48, v236, v47, v48
    v_fma_f32 v112, v236, v111, v112
    v_mul_f32 v187, v238, v47
    v_mul_f32 v195, v238, v111
    v_fma_f32 v48, -v237, v111, v48
    v_fma_f32 v112, v237, v47, v112
    v_fma_f32 v187, -v239, v111, v187
    v_fma_f32 v195, -v239, v47, -v195
    v_cvt_pk_bf16_f32 v204, v180, v181
    v_cvt_pk_bf16_f32 v208, v188, v189
    v_cvt_pk_bf16_f32 v205, v182, v183
    v_cvt_pk_bf16_f32 v209, v190, v191
    v_cvt_pk_bf16_f32 v206, v184, v185
    v_cvt_pk_bf16_f32 v210, v192, v193
    v_cvt_pk_bf16_f32 v207, v186, v187
    v_cvt_pk_bf16_f32 v211, v194, v195
    buffer_store_dwordx4 v[204:207], v26, s[8:11], s37 offen offset:64 sc1
    buffer_store_dwordx4 v[208:211], v26, s[8:11], s40 offen offset:64 sc1
    v_fma_f32 v49, v236, v48, v49
    v_fma_f32 v113, v236, v112, v113
    v_mul_f32 v180, v238, v48
    v_mul_f32 v188, v238, v112
    v_fma_f32 v49, -v237, v112, v49
    v_fma_f32 v113, v237, v48, v113
    v_fma_f32 v180, -v239, v112, v180
    v_fma_f32 v188, -v239, v48, -v188
    v_fma_f32 v50, v236, v49, v50
    v_fma_f32 v114, v236, v113, v114
    v_mul_f32 v181, v238, v49
    v_mul_f32 v189, v238, v113
    v_fma_f32 v50, -v237, v113, v50
    v_fma_f32 v114, v237, v49, v114
    v_fma_f32 v181, -v239, v113, v181
    v_fma_f32 v189, -v239, v49, -v189
    v_fma_f32 v51, v236, v50, v51
    v_fma_f32 v115, v236, v114, v115
    v_mul_f32 v182, v238, v50
    v_mul_f32 v190, v238, v114
    v_fma_f32 v51, -v237, v114, v51
    v_fma_f32 v115, v237, v50, v115
    v_fma_f32 v182, -v239, v114, v182
    v_fma_f32 v190, -v239, v50, -v190
    v_fma_f32 v52, v236, v51, v52
    v_fma_f32 v116, v236, v115, v116
    v_mul_f32 v183, v238, v51
    v_mul_f32 v191, v238, v115
    v_fma_f32 v52, -v237, v115, v52
    v_fma_f32 v116, v237, v51, v116
    v_fma_f32 v183, -v239, v115, v183
    v_fma_f32 v191, -v239, v51, -v191
    v_fma_f32 v53, v236, v52, v53
    v_fma_f32 v117, v236, v116, v117
    v_mul_f32 v184, v238, v52
    v_mul_f32 v192, v238, v116
    v_fma_f32 v53, -v237, v116, v53
    v_fma_f32 v117, v237, v52, v117
    v_fma_f32 v184, -v239, v116, v184
    v_fma_f32 v192, -v239, v52, -v192
    v_fma_f32 v54, v236, v53, v54
    v_fma_f32 v118, v236, v117, v118
    v_mul_f32 v185, v238, v53
    v_mul_f32 v193, v238, v117
    v_fma_f32 v54, -v237, v117, v54
    v_fma_f32 v118, v237, v53, v118
    v_fma_f32 v185, -v239, v117, v185
    v_fma_f32 v193, -v239, v53, -v193
    v_fma_f32 v55, v236, v54, v55
    v_fma_f32 v119, v236, v118, v119
    v_mul_f32 v186, v238, v54
    v_mul_f32 v194, v238, v118
    v_fma_f32 v55, -v237, v118, v55
    v_fma_f32 v119, v237, v54, v119
    v_fma_f32 v186, -v239, v118, v186
    v_fma_f32 v194, -v239, v54, -v194
    v_fma_f32 v56, v236, v55, v56
    v_fma_f32 v120, v236, v119, v120
    v_mul_f32 v187, v238, v55
    v_mul_f32 v195, v238, v119
    v_fma_f32 v56, -v237, v119, v56
    v_fma_f32 v120, v237, v55, v120
    v_fma_f32 v187, -v239, v119, v187
    v_fma_f32 v195, -v239, v55, -v195
    v_cvt_pk_bf16_f32 v196, v180, v181
    v_cvt_pk_bf16_f32 v200, v188, v189
    v_cvt_pk_bf16_f32 v197, v182, v183
    v_cvt_pk_bf16_f32 v201, v190, v191
    v_cvt_pk_bf16_f32 v198, v184, v185
    v_cvt_pk_bf16_f32 v202, v192, v193
    v_cvt_pk_bf16_f32 v199, v186, v187
    v_cvt_pk_bf16_f32 v203, v194, v195
    buffer_store_dwordx4 v[196:199], v26, s[8:11], s37 offen offset:128 sc1
    buffer_store_dwordx4 v[200:203], v26, s[8:11], s40 offen offset:128 sc1
    v_fma_f32 v57, v236, v56, v57
    v_fma_f32 v121, v236, v120, v121
    v_mul_f32 v180, v238, v56
    v_mul_f32 v188, v238, v120
    v_fma_f32 v57, -v237, v120, v57
    v_fma_f32 v121, v237, v56, v121
    v_fma_f32 v180, -v239, v120, v180
    v_fma_f32 v188, -v239, v56, -v188
    v_fma_f32 v58, v236, v57, v58
    v_fma_f32 v122, v236, v121, v122
    v_mul_f32 v181, v238, v57
    v_mul_f32 v189, v238, v121
    v_fma_f32 v58, -v237, v121, v58
    v_fma_f32 v122, v237, v57, v122
    v_fma_f32 v181, -v239, v121, v181
    v_fma_f32 v189, -v239, v57, -v189
    v_fma_f32 v59, v236, v58, v59
    v_fma_f32 v123, v236, v122, v123
    v_mul_f32 v182, v238, v58
    v_mul_f32 v190, v238, v122
    v_fma_f32 v59, -v237, v122, v59
    v_fma_f32 v123, v237, v58, v123
    v_fma_f32 v182, -v239, v122, v182
    v_fma_f32 v190, -v239, v58, -v190
    v_fma_f32 v60, v236, v59, v60
    v_fma_f32 v124, v236, v123, v124
    v_mul_f32 v183, v238, v59
    v_mul_f32 v191, v238, v123
    v_fma_f32 v60, -v237, v123, v60
    v_fma_f32 v124, v237, v59, v124
    v_fma_f32 v183, -v239, v123, v183
    v_fma_f32 v191, -v239, v59, -v191
    v_fma_f32 v61, v236, v60, v61
    v_fma_f32 v125, v236, v124, v125
    v_mul_f32 v184, v238, v60
    v_mul_f32 v192, v238, v124
    v_fma_f32 v61, -v237, v124, v61
    v_fma_f32 v125, v237, v60, v125
    v_fma_f32 v184, -v239, v124, v184
    v_fma_f32 v192, -v239, v60, -v192
    v_fma_f32 v62, v236, v61, v62
    v_fma_f32 v126, v236, v125, v126
    v_mul_f32 v185, v238, v61
    v_mul_f32 v193, v238, v125
    v_fma_f32 v62, -v237, v125, v62
    v_fma_f32 v126, v237, v61, v126
    v_fma_f32 v185, -v239, v125, v185
    v_fma_f32 v193, -v239, v61, -v193
    v_fma_f32 v63, v236, v62, v63
    v_fma_f32 v127, v236, v126, v127
    v_mul_f32 v186, v238, v62
    v_mul_f32 v194, v238, v126
    v_fma_f32 v63, -v237, v126, v63
    v_fma_f32 v127, v237, v62, v127
    v_fma_f32 v186, -v239, v126, v186
    v_fma_f32 v194, -v239, v62, -v194
    v_fma_f32 v64, v236, v63, v64
    v_fma_f32 v128, v236, v127, v128
    v_mul_f32 v187, v238, v63
    v_mul_f32 v195, v238, v127
    v_fma_f32 v64, -v237, v127, v64
    v_fma_f32 v128, v237, v63, v128
    v_fma_f32 v187, -v239, v127, v187
    v_fma_f32 v195, -v239, v63, -v195
    v_cvt_pk_bf16_f32 v204, v180, v181
    v_cvt_pk_bf16_f32 v208, v188, v189
    v_cvt_pk_bf16_f32 v205, v182, v183
    v_cvt_pk_bf16_f32 v209, v190, v191
    v_cvt_pk_bf16_f32 v206, v184, v185
    v_cvt_pk_bf16_f32 v210, v192, v193
    v_cvt_pk_bf16_f32 v207, v186, v187
    v_cvt_pk_bf16_f32 v211, v194, v195
    buffer_store_dwordx4 v[204:207], v26, s[8:11], s37 offen offset:192 sc1
    buffer_store_dwordx4 v[208:211], v26, s[8:11], s40 offen offset:192 sc1
    v_fma_f32 v65, v236, v64, v65
    v_fma_f32 v129, v236, v128, v129
    v_mul_f32 v180, v238, v64
    v_mul_f32 v188, v238, v128
    v_fma_f32 v65, -v237, v128, v65
    v_fma_f32 v129, v237, v64, v129
    v_fma_f32 v180, -v239, v128, v180
    v_fma_f32 v188, -v239, v64, -v188
    v_fma_f32 v66, v236, v65, v66
    v_fma_f32 v130, v236, v129, v130
    v_mul_f32 v181, v238, v65
    v_mul_f32 v189, v238, v129
    v_fma_f32 v66, -v237, v129, v66
    v_fma_f32 v130, v237, v65, v130
    v_fma_f32 v181, -v239, v129, v181
    v_fma_f32 v189, -v239, v65, -v189
    v_fma_f32 v67, v236, v66, v67
    v_fma_f32 v131, v236, v130, v131
    v_mul_f32 v182, v238, v66
    v_mul_f32 v190, v238, v130
    v_fma_f32 v67, -v237, v130, v67
    v_fma_f32 v131, v237, v66, v131
    v_fma_f32 v182, -v239, v130, v182
    v_fma_f32 v190, -v239, v66, -v190
    v_fma_f32 v68, v236, v67, v68
    v_fma_f32 v132, v236, v131, v132
    v_mul_f32 v183, v238, v67
    v_mul_f32 v191, v238, v131
    v_fma_f32 v68, -v237, v131, v68
    v_fma_f32 v132, v237, v67, v132
    v_fma_f32 v183, -v239, v131, v183
    v_fma_f32 v191, -v239, v67, -v191
    v_fma_f32 v69, v236, v68, v69
    v_fma_f32 v133, v236, v132, v133
    v_mul_f32 v184, v238, v68
    v_mul_f32 v192, v238, v132
    v_fma_f32 v69, -v237, v132, v69
    v_fma_f32 v133, v237, v68, v133
    v_fma_f32 v184, -v239, v132, v184
    v_fma_f32 v192, -v239, v68, -v192
    v_fma_f32 v70, v236, v69, v70
    v_fma_f32 v134, v236, v133, v134
    v_mul_f32 v185, v238, v69
    v_mul_f32 v193, v238, v133
    v_fma_f32 v70, -v237, v133, v70
    v_fma_f32 v134, v237, v69, v134
    v_fma_f32 v185, -v239, v133, v185
    v_fma_f32 v193, -v239, v69, -v193
    v_fma_f32 v71, v236, v70, v71
    v_fma_f32 v135, v236, v134, v135
    v_mul_f32 v186, v238, v70
    v_mul_f32 v194, v238, v134
    v_fma_f32 v71, -v237, v134, v71
    v_fma_f32 v135, v237, v70, v135
    v_fma_f32 v186, -v239, v134, v186
    v_fma_f32 v194, -v239, v70, -v194
    v_fma_f32 v72, v236, v71, v72
    v_fma_f32 v136, v236, v135, v136
    v_mul_f32 v187, v238, v71
    v_mul_f32 v195, v238, v135
    v_fma_f32 v72, -v237, v135, v72
    v_fma_f32 v136, v237, v71, v136
    v_fma_f32 v187, -v239, v135, v187
    v_fma_f32 v195, -v239, v71, -v195
    v_cvt_pk_bf16_f32 v196, v180, v181
    v_cvt_pk_bf16_f32 v200, v188, v189
    v_cvt_pk_bf16_f32 v197, v182, v183
    v_cvt_pk_bf16_f32 v201, v190, v191
    v_cvt_pk_bf16_f32 v198, v184, v185
    v_cvt_pk_bf16_f32 v202, v192, v193
    v_cvt_pk_bf16_f32 v199, v186, v187
    v_cvt_pk_bf16_f32 v203, v194, v195
    buffer_store_dwordx4 v[196:199], v26, s[8:11], s37 offen offset:256 sc1
    buffer_store_dwordx4 v[200:203], v26, s[8:11], s40 offen offset:256 sc1
    v_fma_f32 v73, v236, v72, v73
    v_fma_f32 v137, v236, v136, v137
    v_mul_f32 v180, v238, v72
    v_mul_f32 v188, v238, v136
    v_fma_f32 v73, -v237, v136, v73
    v_fma_f32 v137, v237, v72, v137
    v_fma_f32 v180, -v239, v136, v180
    v_fma_f32 v188, -v239, v72, -v188
    v_fma_f32 v74, v236, v73, v74
    v_fma_f32 v138, v236, v137, v138
    v_mul_f32 v181, v238, v73
    v_mul_f32 v189, v238, v137
    v_fma_f32 v74, -v237, v137, v74
    v_fma_f32 v138, v237, v73, v138
    v_fma_f32 v181, -v239, v137, v181
    v_fma_f32 v189, -v239, v73, -v189
    v_fma_f32 v75, v236, v74, v75
    v_fma_f32 v139, v236, v138, v139
    v_mul_f32 v182, v238, v74
    v_mul_f32 v190, v238, v138
    v_fma_f32 v75, -v237, v138, v75
    v_fma_f32 v139, v237, v74, v139
    v_fma_f32 v182, -v239, v138, v182
    v_fma_f32 v190, -v239, v74, -v190
    v_fma_f32 v76, v236, v75, v76
    v_fma_f32 v140, v236, v139, v140
    v_mul_f32 v183, v238, v75
    v_mul_f32 v191, v238, v139
    v_fma_f32 v76, -v237, v139, v76
    v_fma_f32 v140, v237, v75, v140
    v_fma_f32 v183, -v239, v139, v183
    v_fma_f32 v191, -v239, v75, -v191
    v_fma_f32 v77, v236, v76, v77
    v_fma_f32 v141, v236, v140, v141
    v_mul_f32 v184, v238, v76
    v_mul_f32 v192, v238, v140
    v_fma_f32 v77, -v237, v140, v77
    v_fma_f32 v141, v237, v76, v141
    v_fma_f32 v184, -v239, v140, v184
    v_fma_f32 v192, -v239, v76, -v192
    v_fma_f32 v78, v236, v77, v78
    v_fma_f32 v142, v236, v141, v142
    v_mul_f32 v185, v238, v77
    v_mul_f32 v193, v238, v141
    v_fma_f32 v78, -v237, v141, v78
    v_fma_f32 v142, v237, v77, v142
    v_fma_f32 v185, -v239, v141, v185
    v_fma_f32 v193, -v239, v77, -v193
    v_fma_f32 v79, v236, v78, v79
    v_fma_f32 v143, v236, v142, v143
    v_mul_f32 v186, v238, v78
    v_mul_f32 v194, v238, v142
    v_fma_f32 v79, -v237, v142, v79
    v_fma_f32 v143, v237, v78, v143
    v_fma_f32 v186, -v239, v142, v186
    v_fma_f32 v194, -v239, v78, -v194
    v_fma_f32 v80, v236, v79, v80
    v_fma_f32 v144, v236, v143, v144
    v_mul_f32 v187, v238, v79
    v_mul_f32 v195, v238, v143
    v_fma_f32 v80, -v237, v143, v80
    v_fma_f32 v144, v237, v79, v144
    v_fma_f32 v187, -v239, v143, v187
    v_fma_f32 v195, -v239, v79, -v195
    v_cvt_pk_bf16_f32 v204, v180, v181
    v_cvt_pk_bf16_f32 v208, v188, v189
    v_cvt_pk_bf16_f32 v205, v182, v183
    v_cvt_pk_bf16_f32 v209, v190, v191
    v_cvt_pk_bf16_f32 v206, v184, v185
    v_cvt_pk_bf16_f32 v210, v192, v193
    v_cvt_pk_bf16_f32 v207, v186, v187
    v_cvt_pk_bf16_f32 v211, v194, v195
    buffer_store_dwordx4 v[204:207], v26, s[8:11], s37 offen offset:320 sc1
    buffer_store_dwordx4 v[208:211], v26, s[8:11], s40 offen offset:320 sc1
    v_fma_f32 v81, v236, v80, v81
    v_fma_f32 v145, v236, v144, v145
    v_mul_f32 v180, v238, v80
    v_mul_f32 v188, v238, v144
    v_fma_f32 v81, -v237, v144, v81
    v_fma_f32 v145, v237, v80, v145
    v_fma_f32 v180, -v239, v144, v180
    v_fma_f32 v188, -v239, v80, -v188
    v_fma_f32 v82, v236, v81, v82
    v_fma_f32 v146, v236, v145, v146
    v_mul_f32 v181, v238, v81
    v_mul_f32 v189, v238, v145
    v_fma_f32 v82, -v237, v145, v82
    v_fma_f32 v146, v237, v81, v146
    v_fma_f32 v181, -v239, v145, v181
    v_fma_f32 v189, -v239, v81, -v189
    v_fma_f32 v83, v236, v82, v83
    v_fma_f32 v147, v236, v146, v147
    v_mul_f32 v182, v238, v82
    v_mul_f32 v190, v238, v146
    v_fma_f32 v83, -v237, v146, v83
    v_fma_f32 v147, v237, v82, v147
    v_fma_f32 v182, -v239, v146, v182
    v_fma_f32 v190, -v239, v82, -v190
    v_fma_f32 v84, v236, v83, v84
    v_fma_f32 v148, v236, v147, v148
    v_mul_f32 v183, v238, v83
    v_mul_f32 v191, v238, v147
    v_fma_f32 v84, -v237, v147, v84
    v_fma_f32 v148, v237, v83, v148
    v_fma_f32 v183, -v239, v147, v183
    v_fma_f32 v191, -v239, v83, -v191
    v_fma_f32 v85, v236, v84, v85
    v_fma_f32 v149, v236, v148, v149
    v_mul_f32 v184, v238, v84
    v_mul_f32 v192, v238, v148
    v_fma_f32 v85, -v237, v148, v85
    v_fma_f32 v149, v237, v84, v149
    v_fma_f32 v184, -v239, v148, v184
    v_fma_f32 v192, -v239, v84, -v192
    v_fma_f32 v86, v236, v85, v86
    v_fma_f32 v150, v236, v149, v150
    v_mul_f32 v185, v238, v85
    v_mul_f32 v193, v238, v149
    v_fma_f32 v86, -v237, v149, v86
    v_fma_f32 v150, v237, v85, v150
    v_fma_f32 v185, -v239, v149, v185
    v_fma_f32 v193, -v239, v85, -v193
    v_fma_f32 v87, v236, v86, v87
    v_fma_f32 v151, v236, v150, v151
    v_mul_f32 v186, v238, v86
    v_mul_f32 v194, v238, v150
    v_fma_f32 v87, -v237, v150, v87
    v_fma_f32 v151, v237, v86, v151
    v_fma_f32 v186, -v239, v150, v186
    v_fma_f32 v194, -v239, v86, -v194
    v_fma_f32 v88, v236, v87, v88
    v_fma_f32 v152, v236, v151, v152
    v_mul_f32 v187, v238, v87
    v_mul_f32 v195, v238, v151
    v_fma_f32 v88, -v237, v151, v88
    v_fma_f32 v152, v237, v87, v152
    v_fma_f32 v187, -v239, v151, v187
    v_fma_f32 v195, -v239, v87, -v195
    v_cvt_pk_bf16_f32 v196, v180, v181
    v_cvt_pk_bf16_f32 v200, v188, v189
    v_cvt_pk_bf16_f32 v197, v182, v183
    v_cvt_pk_bf16_f32 v201, v190, v191
    v_cvt_pk_bf16_f32 v198, v184, v185
    v_cvt_pk_bf16_f32 v202, v192, v193
    v_cvt_pk_bf16_f32 v199, v186, v187
    v_cvt_pk_bf16_f32 v203, v194, v195
    buffer_store_dwordx4 v[196:199], v26, s[8:11], s37 offen offset:384 sc1
    buffer_store_dwordx4 v[200:203], v26, s[8:11], s40 offen offset:384 sc1
    v_fma_f32 v89, v236, v88, v89
    v_fma_f32 v153, v236, v152, v153
    v_mul_f32 v180, v238, v88
    v_mul_f32 v188, v238, v152
    v_fma_f32 v89, -v237, v152, v89
    v_fma_f32 v153, v237, v88, v153
    v_fma_f32 v180, -v239, v152, v180
    v_fma_f32 v188, -v239, v88, -v188
    v_fma_f32 v90, v236, v89, v90
    v_fma_f32 v154, v236, v153, v154
    v_mul_f32 v181, v238, v89
    v_mul_f32 v189, v238, v153
    v_fma_f32 v90, -v237, v153, v90
    v_fma_f32 v154, v237, v89, v154
    v_fma_f32 v181, -v239, v153, v181
    v_fma_f32 v189, -v239, v89, -v189
    v_fma_f32 v91, v236, v90, v91
    v_fma_f32 v155, v236, v154, v155
    v_mul_f32 v182, v238, v90
    v_mul_f32 v190, v238, v154
    v_fma_f32 v91, -v237, v154, v91
    v_fma_f32 v155, v237, v90, v155
    v_fma_f32 v182, -v239, v154, v182
    v_fma_f32 v190, -v239, v90, -v190
    v_fma_f32 v92, v236, v91, v92
    v_fma_f32 v156, v236, v155, v156
    v_mul_f32 v183, v238, v91
    v_mul_f32 v191, v238, v155
    v_fma_f32 v92, -v237, v155, v92
    v_fma_f32 v156, v237, v91, v156
    v_fma_f32 v183, -v239, v155, v183
    v_fma_f32 v191, -v239, v91, -v191
    v_fma_f32 v93, v236, v92, v93
    v_fma_f32 v157, v236, v156, v157
    v_mul_f32 v184, v238, v92
    v_mul_f32 v192, v238, v156
    v_fma_f32 v93, -v237, v156, v93
    v_fma_f32 v157, v237, v92, v157
    v_fma_f32 v184, -v239, v156, v184
    v_fma_f32 v192, -v239, v92, -v192
    v_fma_f32 v94, v236, v93, v94
    v_fma_f32 v158, v236, v157, v158
    v_mul_f32 v185, v238, v93
    v_mul_f32 v193, v238, v157
    v_fma_f32 v94, -v237, v157, v94
    v_fma_f32 v158, v237, v93, v158
    v_fma_f32 v185, -v239, v157, v185
    v_fma_f32 v193, -v239, v93, -v193
    v_fma_f32 v95, v236, v94, v95
    v_fma_f32 v159, v236, v158, v159
    v_mul_f32 v186, v238, v94
    v_mul_f32 v194, v238, v158
    v_fma_f32 v95, -v237, v158, v95
    v_fma_f32 v159, v237, v94, v159
    v_fma_f32 v186, -v239, v158, v186
    v_fma_f32 v194, -v239, v94, -v194
    v_mul_f32 v187, v238, v95
    v_mul_f32 v195, v238, v159
    v_fma_f32 v187, -v239, v159, v187
    v_fma_f32 v195, -v239, v95, -v195
    v_cvt_pk_bf16_f32 v204, v180, v181
    v_cvt_pk_bf16_f32 v208, v188, v189
    v_cvt_pk_bf16_f32 v205, v182, v183
    v_cvt_pk_bf16_f32 v209, v190, v191
    v_cvt_pk_bf16_f32 v206, v184, v185
    v_cvt_pk_bf16_f32 v210, v192, v193
    v_cvt_pk_bf16_f32 v207, v186, v187
    v_cvt_pk_bf16_f32 v211, v194, v195
    buffer_store_dwordx4 v[204:207], v26, s[8:11], s37 offen offset:448 sc1
    buffer_store_dwordx4 v[208:211], v26, s[8:11], s40 offen offset:448 sc1
    s_add_u32 s38, s38, 20
    s_waitcnt vmcnt(0)
    s_barrier
    s_cmp_lg_u32 s28, 0
    s_cbranch_scc1 sb_15
    v_mov_b32 v29, s39
    s_mov_b64 exec, 1
    buffer_atomic_or v29, off, s[12:15], s38 sc1
    s_mov_b64 exec, -1
sb_15:
    s_mov_b32 s16, s74
    s_mov_b32 s17, s75
    s_mov_b32 s18, 0xc8000
    s_mov_b32 s19, 0x20000
    s_mov_b32 s20, s76
    s_mov_b32 s21, s77
    s_mov_b32 s22, 0xc8000
    s_mov_b32 s23, 0x20000
    v_lshlrev_b32 v1, 4, v0
    v_lshrrev_b32 v26, 5, v0
    v_and_b32 v27, 31, v0
    v_bfe_u32 v28, v0, 1, 3
    v_xor_b32 v28, v28, v26
    v_lshlrev_b32 v27, 7, v27
    v_xor_b32 v29, 0, v28
    v_lshl_add_u32 v9, v29, 4, v27
    v_xor_b32 v29, 2, v28
    v_lshl_add_u32 v10, v29, 4, v27
    v_xor_b32 v29, 4, v28
    v_lshl_add_u32 v11, v29, 4, v27
    v_xor_b32 v29, 6, v28
    v_lshl_add_u32 v12, v29, 4, v27
    s_lshl_b32 s32, s28, 12
    s_add_u32 s40, s32, 16384
    s_mov_b32 s39, s32
    v_add_u32 v9, s40, v9
    v_add_u32 v13, 65536, v9
    v_add_u32 v17, 131072, v9
    v_add_u32 v10, s40, v10
    v_add_u32 v14, 65536, v10
    v_add_u32 v18, 131072, v10
    v_add_u32 v11, s40, v11
    v_add_u32 v15, 65536, v11
    v_add_u32 v19, 131072, v11
    v_add_u32 v12, s40, v12
    v_add_u32 v16, 65536, v12
    v_add_u32 v20, 131072, v12
    v_lshrrev_b32 v26, 5, v0
    v_lshlrev_b32 v21, 11, v26
    v_bfe_u32 v26, v0, 2, 2
    v_lshl_add_u32 v21, v26, 4, v21
    v_bfe_u32 v26, v0, 4, 1
    v_lshl_add_u32 v21, v26, 7, v21
    v_bfe_u32 v26, v0, 1, 1
    v_lshl_add_u32 v21, v26, 6, v21
    v_and_b32 v26, 1, v0
    v_lshl_add_u32 v21, v26, 3, v21
    v_add_u32 v22, 65536, v21
    v_add_u32 v23, 131072, v21
    s_mul_i32 s37, s35, 327680
    s_add_u32 s37, s37, s32
    s_add_u32 s37, s37, 167772160
    s_lshl_b32 s41, s36, 7
    s_lshl_b32 s32, s28, 5
    s_add_u32 s41, s41, s32
    v_and_b32 v26, 31, v0
    v_mul_u32_u24 v27, 1280, v26
    v_lshrrev_b32 v28, 5, v0
    v_lshl_add_u32 v27, v28, 4, v27
    s_mul_i32 s32, s35, 163840
    s_lshl_b32 s33, s41, 1
    s_add_u32 s32, s32, s33
    s_add_u32 s34, s32, 0
    buffer_load_dwordx4 v[100:103], v27, s[24:27], s34 offen offset:0
    buffer_load_dwordx4 v[104:107], v27, s[24:27], s34 offen offset:32
    s_add_u32 s34, s32, 40960
    buffer_load_dwordx4 v[108:111], v27, s[24:27], s34 offen offset:0
    buffer_load_dwordx4 v[112:115], v27, s[24:27], s34 offen offset:32
    s_add_u32 s34, s32, 81920
    buffer_load_dwordx4 v[116:119], v27, s[24:27], s34 offen offset:0
    buffer_load_dwordx4 v[120:123], v27, s[24:27], s34 offen offset:32
    s_add_u32 s34, s32, 122880
    buffer_load_dwordx4 v[124:127], v27, s[24:27], s34 offen offset:0
    buffer_load_dwordx4 v[128:131], v27, s[24:27], s34 offen offset:32
    s_mov_b32 s52, s80
    s_mov_b32 s53, s81
    s_mov_b32 s54, 0x500
    s_mov_b32 s55, 0x20000
    v_lshlrev_b32 v27, 1, v26
    buffer_load_ushort v29, v27, s[52:55], s33 offen
    v_lshlrev_b32 v28, 3, v28
    v_sub_u32 v26, v26, v28
    s_waitcnt vmcnt(0)
    v_lshlrev_b32 v30, 16, v29
    v_cmp_eq_u32 vcc, 0, v26
    s_nop 1
    v_cndmask_b32 v132, 0, v29, vcc
    v_cmp_eq_u32 vcc, 1, v26
    s_nop 1
    v_cndmask_b32 v132, v132, v30, vcc
    v_cmp_eq_u32 vcc, 2, v26
    s_nop 1
    v_cndmask_b32 v133, 0, v29, vcc
    v_cmp_eq_u32 vcc, 3, v26
    s_nop 1
    v_cndmask_b32 v133, v133, v30, vcc
    v_cmp_eq_u32 vcc, 4, v26
    s_nop 1
    v_cndmask_b32 v134, 0, v29, vcc
    v_cmp_eq_u32 vcc, 5, v26
    s_nop 1
    v_cndmask_b32 v134, v134, v30, vcc
    v_cmp_eq_u32 vcc, 6, v26
    s_nop 1
    v_cndmask_b32 v135, 0, v29, vcc
    v_cmp_eq_u32 vcc, 7, v26
    s_nop 1
    v_cndmask_b32 v135, v135, v30, vcc
    v_cmp_eq_u32 vcc, 16, v26
    s_nop 1
    v_cndmask_b32 v136, 0, v29, vcc
    v_cmp_eq_u32 vcc, 17, v26
    s_nop 1
    v_cndmask_b32 v136, v136, v30, vcc
    v_cmp_eq_u32 vcc, 18, v26
    s_nop 1
    v_cndmask_b32 v137, 0, v29, vcc
    v_cmp_eq_u32 vcc, 19, v26
    s_nop 1
    v_cndmask_b32 v137, v137, v30, vcc
    v_cmp_eq_u32 vcc, 20, v26
    s_nop 1
    v_cndmask_b32 v138, 0, v29, vcc
    v_cmp_eq_u32 vcc, 21, v26
    s_nop 1
    v_cndmask_b32 v138, v138, v30, vcc
    v_cmp_eq_u32 vcc, 22, v26
    s_nop 1
    v_cndmask_b32 v139, 0, v29, vcc
    v_cmp_eq_u32 vcc, 23, v26
    s_nop 1
    v_cndmask_b32 v139, v139, v30, vcc
    v_mfma_f32_32x32x16_bf16 v[32:47], v[100:103], v[132:135], 0
    s_nop 0
    v_mfma_f32_32x32x16_bf16 v[32:47], v[104:107], v[136:139], v[32:47]
    v_mfma_f32_32x32x16_bf16 v[48:63], v[108:111], v[132:135], 0
    v_mfma_f32_32x32x16_bf16 v[48:63], v[112:115], v[136:139], v[48:63]
    v_mfma_f32_32x32x16_bf16 v[64:79], v[116:119], v[132:135], 0
    v_mfma_f32_32x32x16_bf16 v[64:79], v[120:123], v[136:139], v[64:79]
    v_mfma_f32_32x32x16_bf16 v[80:95], v[124:127], v[132:135], 0
    v_mfma_f32_32x32x16_bf16 v[80:95], v[128:131], v[136:139], v[80:95]
    s_mul_i32 s38, s41, 1280
    s_lshl_b32 s34, 1, s35
    s_mov_b32 s32, 36
wb_16:
    buffer_load_dword v29, off, s[12:15], s32 sc1
    s_waitcnt vmcnt(0)
    v_readfirstlane_b32 s33, v29
    s_nop 0
    s_and_b32 s33, s33, s34
    s_cmp_eq_u32 s33, s34
    s_cbranch_scc1 wbd_17
    s_sleep 8
    s_sub_u32 s44, s44, 1
    s_cbranch_scc0 wb_16
    s_mov_b32 s44, 0
wbd_17:
    s_mov_b32 s32, 40
wb_18:
    buffer_load_dword v29, off, s[12:15], s32 sc1
    s_waitcnt vmcnt(0)
    v_readfirstlane_b32 s33, v29
    s_nop 0
    s_and_b32 s33, s33, s34
    s_cmp_eq_u32 s33, s34
    s_cbranch_scc1 wbd_19
    s_sleep 8
    s_sub_u32 s44, s44, 1
    s_cbranch_scc0 wb_18
    s_mov_b32 s44, 0
wbd_19:
    s_mov_b32 s32, 44
wb_20:
    buffer_load_dword v29, off, s[12:15], s32 sc1
    s_waitcnt vmcnt(0)
    v_readfirstlane_b32 s33, v29
    s_nop 0
    s_and_b32 s33, s33, s34
    s_cmp_eq_u32 s33, s34
    s_cbranch_scc1 wbd_21
    s_sleep 8
    s_sub_u32 s44, s44, 1
    s_cbranch_scc0 wb_20
    s_mov_b32 s44, 0
wbd_21:
    s_mov_b32 s32, 48
wb_22:
    buffer_load_dword v29, off, s[12:15], s32 sc1
    s_waitcnt vmcnt(0)
    v_readfirstlane_b32 s33, v29
    s_nop 0
    s_and_b32 s33, s33, s34
    s_cmp_eq_u32 s33, s34
    s_cbranch_scc1 wbd_23
    s_sleep 8
    s_sub_u32 s44, s44, 1
    s_cbranch_scc0 wb_22
    s_mov_b32 s44, 0
wbd_23:
    s_mov_b32 s32, 52
wb_24:
    buffer_load_dword v29, off, s[12:15], s32 sc1
    s_waitcnt vmcnt(0)
    v_readfirstlane_b32 s33, v29
    s_nop 0
    s_and_b32 s33, s33, s34
    s_cmp_eq_u32 s33, s34
    s_cbranch_scc1 wbd_25
    s_sleep 8
    s_sub_u32 s44, s44, 1
    s_cbranch_scc0 wb_24
    s_mov_b32 s44, 0
wbd_25:
    s_add_u32 m0, s39, 0
    s_add_u32 s32, s37, 0
    buffer_load_dwordx4 v1, s[8:11], s32 offen sc1 lds
    s_add_u32 m0, s39, 1024
    s_add_u32 s32, s37, 1024
    buffer_load_dwordx4 v1, s[8:11], s32 offen sc1 lds
    s_add_u32 m0, s39, 2048
    s_add_u32 s32, s37, 2048
    buffer_load_dwordx4 v1, s[8:11], s32 offen sc1 lds
    s_add_u32 m0, s39, 3072
    s_add_u32 s32, s37, 3072
    buffer_load_dwordx4 v1, s[8:11], s32 offen sc1 lds
    s_add_u32 m0, s40, 0
    s_add_u32 s32, s38, 0
    buffer_load_dwordx4 v5, s[16:19], s32 offen lds
    s_add_u32 m0, s40, 1024
    s_add_u32 s32, s38, 0
    buffer_load_dwordx4 v6, s[16:19], s32 offen lds
    s_add_u32 m0, s40, 2048
    s_add_u32 s32, s38, 0
    buffer_load_dwordx4 v7, s[16:19], s32 offen lds
    s_add_u32 m0, s40, 3072
    s_add_u32 s32, s38, 0
    buffer_load_dwordx4 v8, s[16:19], s32 offen lds
    s_add_u32 m0, s39, 32768
    s_add_u32 s32, s37, 16384
    buffer_load_dwordx4 v1, s[8:11], s32 offen sc1 lds
    s_add_u32 m0, s39, 33792
    s_add_u32 s32, s37, 17408
    buffer_load_dwordx4 v1, s[8:11], s32 offen sc1 lds
    s_add_u32 m0, s39, 34816
    s_add_u32 s32, s37, 18432
    buffer_load_dwordx4 v1, s[8:11], s32 offen sc1 lds
    s_add_u32 m0, s39, 35840
    s_add_u32 s32, s37, 19456
    buffer_load_dwordx4 v1, s[8:11], s32 offen sc1 lds
    s_add_u32 m0, s40, 32768
    s_add_u32 s32, s38, 128
    buffer_load_dwordx4 v5, s[16:19], s32 offen lds
    s_add_u32 m0, s40, 33792
    s_add_u32 s32, s38, 128
    buffer_load_dwordx4 v6, s[16:19], s32 offen lds
    s_add_u32 m0, s40, 34816
    s_add_u32 s32, s38, 128
    buffer_load_dwordx4 v7, s[16:19], s32 offen lds
    s_add_u32 m0, s40, 35840
    s_add_u32 s32, s38, 128
    buffer_load_dwordx4 v8, s[16:19], s32 offen lds
    s_add_u32 m0, s39, 65536
    s_add_u32 s32, s37, 32768
    buffer_load_dwordx4 v1, s[8:11], s32 offen sc1 lds
    s_add_u32 m0, s39, 66560
    s_add_u32 s32, s37, 33792
    buffer_load_dwordx4 v1, s[8:11], s32 offen sc1 lds
    s_add_u32 m0, s39, 67584
    s_add_u32 s32, s37, 34816
    buffer_load_dwordx4 v1, s[8:11], s32 offen sc1 lds
    s_add_u32 m0, s39, 68608
    s_add_u32 s32, s37, 35840
    buffer_load_dwordx4 v1, s[8:11], s32 offen sc1 lds
    s_add_u32 m0, s40, 65536
    s_add_u32 s32, s38, 256
    buffer_load_dwordx4 v5, s[16:19], s32 offen lds
    s_add_u32 m0, s40, 66560
    s_add_u32 s32, s38, 256
    buffer_load_dwordx4 v6, s[16:19], s32 offen lds
    s_add_u32 m0, s40, 67584
    s_add_u32 s32, s38, 256
    buffer_load_dwordx4 v7, s[16:19], s32 offen lds
    s_add_u32 m0, s40, 68608
    s_add_u32 s32, s38, 256
    buffer_load_dwordx4 v8, s[16:19], s32 offen lds
    s_add_u32 m0, s39, 98304
    s_add_u32 s32, s37, 49152
    buffer_load_dwordx4 v1, s[8:11], s32 offen sc1 lds
    s_add_u32 m0, s39, 99328
    s_add_u32 s32, s37, 50176
    buffer_load_dwordx4 v1, s[8:11], s32 offen sc1 lds
    s_add_u32 m0, s39, 100352
    s_add_u32 s32, s37, 51200
    buffer_load_dwordx4 v1, s[8:11], s32 offen sc1 lds
    s_add_u32 m0, s39, 101376
    s_add_u32 s32, s37, 52224
    buffer_load_dwordx4 v1, s[8:11], s32 offen sc1 lds
    s_add_u32 m0, s40, 98304
    s_add_u32 s32, s38, 384
    buffer_load_dwordx4 v5, s[16:19], s32 offen lds
    s_add_u32 m0, s40, 99328
    s_add_u32 s32, s38, 384
    buffer_load_dwordx4 v6, s[16:19], s32 offen lds
    s_add_u32 m0, s40, 100352
    s_add_u32 s32, s38, 384
    buffer_load_dwordx4 v7, s[16:19], s32 offen lds
    s_add_u32 m0, s40, 101376
    s_add_u32 s32, s38, 384
    buffer_load_dwordx4 v8, s[16:19], s32 offen lds
    s_add_u32 m0, s39, 131072
    s_add_u32 s32, s37, 65536
    buffer_load_dwordx4 v1, s[8:11], s32 offen sc1 lds
    s_add_u32 m0, s39, 132096
    s_add_u32 s32, s37, 66560
    buffer_load_dwordx4 v1, s[8:11], s32 offen sc1 lds
    s_add_u32 m0, s39, 133120
    s_add_u32 s32, s37, 67584
    buffer_load_dwordx4 v1, s[8:11], s32 offen sc1 lds
    s_add_u32 m0, s39, 134144
    s_add_u32 s32, s37, 68608
    buffer_load_dwordx4 v1, s[8:11], s32 offen sc1 lds
    s_add_u32 m0, s40, 131072
    s_add_u32 s32, s38, 512
    buffer_load_dwordx4 v5, s[16:19], s32 offen lds
    s_add_u32 m0, s40, 132096
    s_add_u32 s32, s38, 512
    buffer_load_dwordx4 v6, s[16:19], s32 offen lds
    s_add_u32 m0, s40, 133120
    s_add_u32 s32, s38, 512
    buffer_load_dwordx4 v7, s[16:19], s32 offen lds
    s_add_u32 m0, s40, 134144
    s_add_u32 s32, s38, 512
    buffer_load_dwordx4 v8, s[16:19], s32 offen lds
    s_waitcnt vmcnt(32)
    s_barrier
    ds_read_b128 a[16:19], v9 offset:0
    ds_read_b64_tr_b16 a[0:1], v21 offset:0
    ds_read_b64_tr_b16 a[2:3], v21 offset:1024
    ds_read_b64_tr_b16 a[4:5], v21 offset:256
    ds_read_b64_tr_b16 a[6:7], v21 offset:1280
    ds_read_b64_tr_b16 a[8:9], v21 offset:512
    ds_read_b64_tr_b16 a[10:11], v21 offset:1536
    ds_read_b64_tr_b16 a[12:13], v21 offset:768
    ds_read_b64_tr_b16 a[14:15], v21 offset:1792
    s_waitcnt lgkmcnt(6)
    v_mfma_f32_32x32x16_bf16 v[32:47], a[0:3], a[16:19], v[32:47]
    ds_read_b128 a[36:39], v10 offset:0
    ds_read_b64_tr_b16 a[20:21], v21 offset:4096
    ds_read_b64_tr_b16 a[22:23], v21 offset:5120
    s_waitcnt lgkmcnt(7)
    v_mfma_f32_32x32x16_bf16 v[48:63], a[4:7], a[16:19], v[48:63]
    ds_read_b64_tr_b16 a[24:25], v21 offset:4352
    ds_read_b64_tr_b16 a[26:27], v21 offset:5376
    ds_read_b64_tr_b16 a[28:29], v21 offset:4608
    s_waitcnt lgkmcnt(8)
    v_mfma_f32_32x32x16_bf16 v[64:79], a[8:11], a[16:19], v[64:79]
    ds_read_b64_tr_b16 a[30:31], v21 offset:5632
    ds_read_b64_tr_b16 a[32:33], v21 offset:4864
    ds_read_b64_tr_b16 a[34:35], v21 offset:5888
    s_waitcnt lgkmcnt(9)
    v_mfma_f32_32x32x16_bf16 v[80:95], a[12:15], a[16:19], v[80:95]
    s_waitcnt lgkmcnt(6)
    v_mfma_f32_32x32x16_bf16 v[32:47], a[20:23], a[36:39], v[32:47]
    ds_read_b128 a[16:19], v11 offset:0
    ds_read_b64_tr_b16 a[0:1], v21 offset:8192
    ds_read_b64_tr_b16 a[2:3], v21 offset:9216
    s_waitcnt lgkmcnt(7)
    v_mfma_f32_32x32x16_bf16 v[48:63], a[24:27], a[36:39], v[48:63]
    ds_read_b64_tr_b16 a[4:5], v21 offset:8448
    ds_read_b64_tr_b16 a[6:7], v21 offset:9472
    ds_read_b64_tr_b16 a[8:9], v21 offset:8704
    s_waitcnt lgkmcnt(8)
    v_mfma_f32_32x32x16_bf16 v[64:79], a[28:31], a[36:39], v[64:79]
    ds_read_b64_tr_b16 a[10:11], v21 offset:9728
    ds_read_b64_tr_b16 a[12:13], v21 offset:8960
    ds_read_b64_tr_b16 a[14:15], v21 offset:9984
    s_waitcnt lgkmcnt(9)
    v_mfma_f32_32x32x16_bf16 v[80:95], a[32:35], a[36:39], v[80:95]
    s_waitcnt lgkmcnt(6)
    v_mfma_f32_32x32x16_bf16 v[32:47], a[0:3], a[16:19], v[32:47]
    ds_read_b128 a[36:39], v12 offset:0
    ds_read_b64_tr_b16 a[20:21], v21 offset:12288
    ds_read_b64_tr_b16 a[22:23], v21 offset:13312
    s_waitcnt lgkmcnt(7)
    v_mfma_f32_32x32x16_bf16 v[48:63], a[4:7], a[16:19], v[48:63]
    ds_read_b64_tr_b16 a[24:25], v21 offset:12544
    ds_read_b64_tr_b16 a[26:27], v21 offset:13568
    ds_read_b64_tr_b16 a[28:29], v21 offset:12800
    s_waitcnt lgkmcnt(8)
    v_mfma_f32_32x32x16_bf16 v[64:79], a[8:11], a[16:19], v[64:79]
    ds_read_b64_tr_b16 a[30:31], v21 offset:13824
    ds_read_b64_tr_b16 a[32:33], v21 offset:13056
    ds_read_b64_tr_b16 a[34:35], v21 offset:14080
    s_waitcnt lgkmcnt(9)
    v_mfma_f32_32x32x16_bf16 v[80:95], a[12:15], a[16:19], v[80:95]
    s_waitcnt lgkmcnt(0)
    s_waitcnt vmcnt(24)
    s_barrier
    v_mfma_f32_32x32x16_bf16 v[32:47], a[20:23], a[36:39], v[32:47]
    ds_read_b128 a[16:19], v9 offset:32768
    ds_read_b64_tr_b16 a[0:1], v21 offset:32768
    ds_read_b64_tr_b16 a[2:3], v21 offset:33792
    v_mfma_f32_32x32x16_bf16 v[48:63], a[24:27], a[36:39], v[48:63]
    ds_read_b64_tr_b16 a[4:5], v21 offset:33024
    ds_read_b64_tr_b16 a[6:7], v21 offset:34048
    ds_read_b64_tr_b16 a[8:9], v21 offset:33280
    s_add_u32 m0, s39, 0
    s_add_u32 s32, s37, 81920
    buffer_load_dwordx4 v1, s[8:11], s32 offen sc1 lds
    v_mfma_f32_32x32x16_bf16 v[64:79], a[28:31], a[36:39], v[64:79]
    ds_read_b64_tr_b16 a[10:11], v21 offset:34304
    ds_read_b64_tr_b16 a[12:13], v21 offset:33536
    ds_read_b64_tr_b16 a[14:15], v21 offset:34560
    v_mfma_f32_32x32x16_bf16 v[80:95], a[32:35], a[36:39], v[80:95]
    s_add_u32 m0, s39, 1024
    s_add_u32 s32, s37, 82944
    buffer_load_dwordx4 v1, s[8:11], s32 offen sc1 lds
    s_waitcnt lgkmcnt(6)
    v_mfma_f32_32x32x16_bf16 v[32:47], a[0:3], a[16:19], v[32:47]
    ds_read_b128 a[36:39], v10 offset:32768
    ds_read_b64_tr_b16 a[20:21], v21 offset:36864
    ds_read_b64_tr_b16 a[22:23], v21 offset:37888
    s_waitcnt lgkmcnt(7)
    v_mfma_f32_32x32x16_bf16 v[48:63], a[4:7], a[16:19], v[48:63]
    ds_read_b64_tr_b16 a[24:25], v21 offset:37120
    ds_read_b64_tr_b16 a[26:27], v21 offset:38144
    ds_read_b64_tr_b16 a[28:29], v21 offset:37376
    s_add_u32 m0, s39, 2048
    s_add_u32 s32, s37, 83968
    buffer_load_dwordx4 v1, s[8:11], s32 offen sc1 lds
    s_waitcnt lgkmcnt(8)
    v_mfma_f32_32x32x16_bf16 v[64:79], a[8:11], a[16:19], v[64:79]
    ds_read_b64_tr_b16 a[30:31], v21 offset:38400
    ds_read_b64_tr_b16 a[32:33], v21 offset:37632
    ds_read_b64_tr_b16 a[34:35], v21 offset:38656
    s_waitcnt lgkmcnt(9)
    v_mfma_f32_32x32x16_bf16 v[80:95], a[12:15], a[16:19], v[80:95]
    s_add_u32 m0, s39, 3072
    s_add_u32 s32, s37, 84992
    buffer_load_dwordx4 v1, s[8:11], s32 offen sc1 lds
    s_waitcnt lgkmcnt(6)
    v_mfma_f32_32x32x16_bf16 v[32:47], a[20:23], a[36:39], v[32:47]
    ds_read_b128 a[16:19], v11 offset:32768
    ds_read_b64_tr_b16 a[0:1], v21 offset:40960
    ds_read_b64_tr_b16 a[2:3], v21 offset:41984
    s_waitcnt lgkmcnt(7)
    v_mfma_f32_32x32x16_bf16 v[48:63], a[24:27], a[36:39], v[48:63]
    ds_read_b64_tr_b16 a[4:5], v21 offset:41216
    ds_read_b64_tr_b16 a[6:7], v21 offset:42240
    ds_read_b64_tr_b16 a[8:9], v21 offset:41472
    s_add_u32 m0, s40, 0
    s_add_u32 s32, s38, 640
    buffer_load_dwordx4 v5, s[16:19], s32 offen lds
    s_waitcnt lgkmcnt(8)
    v_mfma_f32_32x32x16_bf16 v[64:79], a[28:31], a[36:39], v[64:79]
    ds_read_b64_tr_b16 a[10:11], v21 offset:42496
    ds_read_b64_tr_b16 a[12:13], v21 offset:41728
    ds_read_b64_tr_b16 a[14:15], v21 offset:42752
    s_waitcnt lgkmcnt(9)
    v_mfma_f32_32x32x16_bf16 v[80:95], a[32:35], a[36:39], v[80:95]
    s_add_u32 m0, s40, 1024
    s_add_u32 s32, s38, 640
    buffer_load_dwordx4 v6, s[16:19], s32 offen lds
    s_waitcnt lgkmcnt(6)
    v_mfma_f32_32x32x16_bf16 v[32:47], a[0:3], a[16:19], v[32:47]
    ds_read_b128 a[36:39], v12 offset:32768
    ds_read_b64_tr_b16 a[20:21], v21 offset:45056
    ds_read_b64_tr_b16 a[22:23], v21 offset:46080
    s_waitcnt lgkmcnt(7)
    v_mfma_f32_32x32x16_bf16 v[48:63], a[4:7], a[16:19], v[48:63]
    ds_read_b64_tr_b16 a[24:25], v21 offset:45312
    ds_read_b64_tr_b16 a[26:27], v21 offset:46336
    ds_read_b64_tr_b16 a[28:29], v21 offset:45568
    s_add_u32 m0, s40, 2048
    s_add_u32 s32, s38, 640
    buffer_load_dwordx4 v7, s[16:19], s32 offen lds
    s_waitcnt lgkmcnt(8)
    v_mfma_f32_32x32x16_bf16 v[64:79], a[8:11], a[16:19], v[64:79]
    ds_read_b64_tr_b16 a[30:31], v21 offset:46592
    ds_read_b64_tr_b16 a[32:33], v21 offset:45824
    ds_read_b64_tr_b16 a[34:35], v21 offset:46848
    s_waitcnt lgkmcnt(9)
    v_mfma_f32_32x32x16_bf16 v[80:95], a[12:15], a[16:19], v[80:95]
    s_add_u32 m0, s40, 3072
    s_add_u32 s32, s38, 640
    buffer_load_dwordx4 v8, s[16:19], s32 offen lds
    s_waitcnt lgkmcnt(0)
    s_waitcnt vmcnt(24)
    s_barrier
    v_mfma_f32_32x32x16_bf16 v[32:47], a[20:23], a[36:39], v[32:47]
    ds_read_b128 a[16:19], v13 offset:0
    ds_read_b64_tr_b16 a[0:1], v22 offset:0
    ds_read_b64_tr_b16 a[2:3], v22 offset:1024
    v_mfma_f32_32x32x16_bf16 v[48:63], a[24:27], a[36:39], v[48:63]
    ds_read_b64_tr_b16 a[4:5], v22 offset:256
    ds_read_b64_tr_b16 a[6:7], v22 offset:1280
    ds_read_b64_tr_b16 a[8:9], v22 offset:512
    s_add_u32 m0, s39, 32768
    s_add_u32 s32, s37, 98304
    buffer_load_dwordx4 v1, s[8:11], s32 offen sc1 lds
    v_mfma_f32_32x32x16_bf16 v[64:79], a[28:31], a[36:39], v[64:79]
    ds_read_b64_tr_b16 a[10:11], v22 offset:1536
    ds_read_b64_tr_b16 a[12:13], v22 offset:768
    ds_read_b64_tr_b16 a[14:15], v22 offset:1792
    v_mfma_f32_32x32x16_bf16 v[80:95], a[32:35], a[36:39], v[80:95]
    s_add_u32 m0, s39, 33792
    s_add_u32 s32, s37, 99328
    buffer_load_dwordx4 v1, s[8:11], s32 offen sc1 lds
    s_waitcnt lgkmcnt(6)
    v_mfma_f32_32x32x16_bf16 v[32:47], a[0:3], a[16:19], v[32:47]
    ds_read_b128 a[36:39], v14 offset:0
    ds_read_b64_tr_b16 a[20:21], v22 offset:4096
    ds_read_b64_tr_b16 a[22:23], v22 offset:5120
    s_waitcnt lgkmcnt(7)
    v_mfma_f32_32x32x16_bf16 v[48:63], a[4:7], a[16:19], v[48:63]
    ds_read_b64_tr_b16 a[24:25], v22 offset:4352
    ds_read_b64_tr_b16 a[26:27], v22 offset:5376
    ds_read_b64_tr_b16 a[28:29], v22 offset:4608
    s_add_u32 m0, s39, 34816
    s_add_u32 s32, s37, 100352
    buffer_load_dwordx4 v1, s[8:11], s32 offen sc1 lds
    s_waitcnt lgkmcnt(8)
    v_mfma_f32_32x32x16_bf16 v[64:79], a[8:11], a[16:19], v[64:79]
    ds_read_b64_tr_b16 a[30:31], v22 offset:5632
    ds_read_b64_tr_b16 a[32:33], v22 offset:4864
    ds_read_b64_tr_b16 a[34:35], v22 offset:5888
    s_waitcnt lgkmcnt(9)
    v_mfma_f32_32x32x16_bf16 v[80:95], a[12:15], a[16:19], v[80:95]
    s_add_u32 m0, s39, 35840
    s_add_u32 s32, s37, 101376
    buffer_load_dwordx4 v1, s[8:11], s32 offen sc1 lds
    s_waitcnt lgkmcnt(6)
    v_mfma_f32_32x32x16_bf16 v[32:47], a[20:23], a[36:39], v[32:47]
    ds_read_b128 a[16:19], v15 offset:0
    ds_read_b64_tr_b16 a[0:1], v22 offset:8192
    ds_read_b64_tr_b16 a[2:3], v22 offset:9216
    s_waitcnt lgkmcnt(7)
    v_mfma_f32_32x32x16_bf16 v[48:63], a[24:27], a[36:39], v[48:63]
    ds_read_b64_tr_b16 a[4:5], v22 offset:8448
    ds_read_b64_tr_b16 a[6:7], v22 offset:9472
    ds_read_b64_tr_b16 a[8:9], v22 offset:8704
    s_add_u32 m0, s40, 32768
    s_add_u32 s32, s38, 768
    buffer_load_dwordx4 v5, s[16:19], s32 offen lds
    s_waitcnt lgkmcnt(8)
    v_mfma_f32_32x32x16_bf16 v[64:79], a[28:31], a[36:39], v[64:79]
    ds_read_b64_tr_b16 a[10:11], v22 offset:9728
    ds_read_b64_tr_b16 a[12:13], v22 offset:8960
    ds_read_b64_tr_b16 a[14:15], v22 offset:9984
    s_waitcnt lgkmcnt(9)
    v_mfma_f32_32x32x16_bf16 v[80:95], a[32:35], a[36:39], v[80:95]
    s_add_u32 m0, s40, 33792
    s_add_u32 s32, s38, 768
    buffer_load_dwordx4 v6, s[16:19], s32 offen lds
    s_waitcnt lgkmcnt(6)
    v_mfma_f32_32x32x16_bf16 v[32:47], a[0:3], a[16:19], v[32:47]
    ds_read_b128 a[36:39], v16 offset:0
    ds_read_b64_tr_b16 a[20:21], v22 offset:12288
    ds_read_b64_tr_b16 a[22:23], v22 offset:13312
    s_waitcnt lgkmcnt(7)
    v_mfma_f32_32x32x16_bf16 v[48:63], a[4:7], a[16:19], v[48:63]
    ds_read_b64_tr_b16 a[24:25], v22 offset:12544
    ds_read_b64_tr_b16 a[26:27], v22 offset:13568
    ds_read_b64_tr_b16 a[28:29], v22 offset:12800
    s_add_u32 m0, s40, 34816
    s_add_u32 s32, s38, 768
    buffer_load_dwordx4 v7, s[16:19], s32 offen lds
    s_waitcnt lgkmcnt(8)
    v_mfma_f32_32x32x16_bf16 v[64:79], a[8:11], a[16:19], v[64:79]
    ds_read_b64_tr_b16 a[30:31], v22 offset:13824
    ds_read_b64_tr_b16 a[32:33], v22 offset:13056
    ds_read_b64_tr_b16 a[34:35], v22 offset:14080
    s_waitcnt lgkmcnt(9)
    v_mfma_f32_32x32x16_bf16 v[80:95], a[12:15], a[16:19], v[80:95]
    s_add_u32 m0, s40, 35840
    s_add_u32 s32, s38, 768
    buffer_load_dwordx4 v8, s[16:19], s32 offen lds
    s_waitcnt lgkmcnt(0)
    s_waitcnt vmcnt(24)
    s_barrier
    v_mfma_f32_32x32x16_bf16 v[32:47], a[20:23], a[36:39], v[32:47]
    ds_read_b128 a[16:19], v13 offset:32768
    ds_read_b64_tr_b16 a[0:1], v22 offset:32768
    ds_read_b64_tr_b16 a[2:3], v22 offset:33792
    v_mfma_f32_32x32x16_bf16 v[48:63], a[24:27], a[36:39], v[48:63]
    ds_read_b64_tr_b16 a[4:5], v22 offset:33024
    ds_read_b64_tr_b16 a[6:7], v22 offset:34048
    ds_read_b64_tr_b16 a[8:9], v22 offset:33280
    s_add_u32 m0, s39, 65536
    s_add_u32 s32, s37, 114688
    buffer_load_dwordx4 v1, s[8:11], s32 offen sc1 lds
    v_mfma_f32_32x32x16_bf16 v[64:79], a[28:31], a[36:39], v[64:79]
    ds_read_b64_tr_b16 a[10:11], v22 offset:34304
    ds_read_b64_tr_b16 a[12:13], v22 offset:33536
    ds_read_b64_tr_b16 a[14:15], v22 offset:34560
    v_mfma_f32_32x32x16_bf16 v[80:95], a[32:35], a[36:39], v[80:95]
    s_add_u32 m0, s39, 66560
    s_add_u32 s32, s37, 115712
    buffer_load_dwordx4 v1, s[8:11], s32 offen sc1 lds
    s_waitcnt lgkmcnt(6)
    v_mfma_f32_32x32x16_bf16 v[32:47], a[0:3], a[16:19], v[32:47]
    ds_read_b128 a[36:39], v14 offset:32768
    ds_read_b64_tr_b16 a[20:21], v22 offset:36864
    ds_read_b64_tr_b16 a[22:23], v22 offset:37888
    s_waitcnt lgkmcnt(7)
    v_mfma_f32_32x32x16_bf16 v[48:63], a[4:7], a[16:19], v[48:63]
    ds_read_b64_tr_b16 a[24:25], v22 offset:37120
    ds_read_b64_tr_b16 a[26:27], v22 offset:38144
    ds_read_b64_tr_b16 a[28:29], v22 offset:37376
    s_add_u32 m0, s39, 67584
    s_add_u32 s32, s37, 116736
    buffer_load_dwordx4 v1, s[8:11], s32 offen sc1 lds
    s_waitcnt lgkmcnt(8)
    v_mfma_f32_32x32x16_bf16 v[64:79], a[8:11], a[16:19], v[64:79]
    ds_read_b64_tr_b16 a[30:31], v22 offset:38400
    ds_read_b64_tr_b16 a[32:33], v22 offset:37632
    ds_read_b64_tr_b16 a[34:35], v22 offset:38656
    s_waitcnt lgkmcnt(9)
    v_mfma_f32_32x32x16_bf16 v[80:95], a[12:15], a[16:19], v[80:95]
    s_add_u32 m0, s39, 68608
    s_add_u32 s32, s37, 117760
    buffer_load_dwordx4 v1, s[8:11], s32 offen sc1 lds
    s_waitcnt lgkmcnt(6)
    v_mfma_f32_32x32x16_bf16 v[32:47], a[20:23], a[36:39], v[32:47]
    ds_read_b128 a[16:19], v15 offset:32768
    ds_read_b64_tr_b16 a[0:1], v22 offset:40960
    ds_read_b64_tr_b16 a[2:3], v22 offset:41984
    s_waitcnt lgkmcnt(7)
    v_mfma_f32_32x32x16_bf16 v[48:63], a[24:27], a[36:39], v[48:63]
    ds_read_b64_tr_b16 a[4:5], v22 offset:41216
    ds_read_b64_tr_b16 a[6:7], v22 offset:42240
    ds_read_b64_tr_b16 a[8:9], v22 offset:41472
    s_add_u32 m0, s40, 65536
    s_add_u32 s32, s38, 896
    buffer_load_dwordx4 v5, s[16:19], s32 offen lds
    s_waitcnt lgkmcnt(8)
    v_mfma_f32_32x32x16_bf16 v[64:79], a[28:31], a[36:39], v[64:79]
    ds_read_b64_tr_b16 a[10:11], v22 offset:42496
    ds_read_b64_tr_b16 a[12:13], v22 offset:41728
    ds_read_b64_tr_b16 a[14:15], v22 offset:42752
    s_waitcnt lgkmcnt(9)
    v_mfma_f32_32x32x16_bf16 v[80:95], a[32:35], a[36:39], v[80:95]
    s_add_u32 m0, s40, 66560
    s_add_u32 s32, s38, 896
    buffer_load_dwordx4 v6, s[16:19], s32 offen lds
    s_waitcnt lgkmcnt(6)
    v_mfma_f32_32x32x16_bf16 v[32:47], a[0:3], a[16:19], v[32:47]
    ds_read_b128 a[36:39], v16 offset:32768
    ds_read_b64_tr_b16 a[20:21], v22 offset:45056
    ds_read_b64_tr_b16 a[22:23], v22 offset:46080
    s_waitcnt lgkmcnt(7)
    v_mfma_f32_32x32x16_bf16 v[48:63], a[4:7], a[16:19], v[48:63]
    ds_read_b64_tr_b16 a[24:25], v22 offset:45312
    ds_read_b64_tr_b16 a[26:27], v22 offset:46336
    ds_read_b64_tr_b16 a[28:29], v22 offset:45568
    s_add_u32 m0, s40, 67584
    s_add_u32 s32, s38, 896
    buffer_load_dwordx4 v7, s[16:19], s32 offen lds
    s_waitcnt lgkmcnt(8)
    v_mfma_f32_32x32x16_bf16 v[64:79], a[8:11], a[16:19], v[64:79]
    ds_read_b64_tr_b16 a[30:31], v22 offset:46592
    ds_read_b64_tr_b16 a[32:33], v22 offset:45824
    ds_read_b64_tr_b16 a[34:35], v22 offset:46848
    s_waitcnt lgkmcnt(9)
    v_mfma_f32_32x32x16_bf16 v[80:95], a[12:15], a[16:19], v[80:95]
    s_add_u32 m0, s40, 68608
    s_add_u32 s32, s38, 896
    buffer_load_dwordx4 v8, s[16:19], s32 offen lds
    s_waitcnt lgkmcnt(0)
    s_waitcnt vmcnt(24)
    s_barrier
    v_mfma_f32_32x32x16_bf16 v[32:47], a[20:23], a[36:39], v[32:47]
    ds_read_b128 a[16:19], v17 offset:0
    ds_read_b64_tr_b16 a[0:1], v23 offset:0
    ds_read_b64_tr_b16 a[2:3], v23 offset:1024
    v_mfma_f32_32x32x16_bf16 v[48:63], a[24:27], a[36:39], v[48:63]
    ds_read_b64_tr_b16 a[4:5], v23 offset:256
    ds_read_b64_tr_b16 a[6:7], v23 offset:1280
    ds_read_b64_tr_b16 a[8:9], v23 offset:512
    s_add_u32 m0, s39, 98304
    s_add_u32 s32, s37, 131072
    buffer_load_dwordx4 v1, s[8:11], s32 offen sc1 lds
    v_mfma_f32_32x32x16_bf16 v[64:79], a[28:31], a[36:39], v[64:79]
    ds_read_b64_tr_b16 a[10:11], v23 offset:1536
    ds_read_b64_tr_b16 a[12:13], v23 offset:768
    ds_read_b64_tr_b16 a[14:15], v23 offset:1792
    v_mfma_f32_32x32x16_bf16 v[80:95], a[32:35], a[36:39], v[80:95]
    s_add_u32 m0, s39, 99328
    s_add_u32 s32, s37, 132096
    buffer_load_dwordx4 v1, s[8:11], s32 offen sc1 lds
    s_waitcnt lgkmcnt(6)
    v_mfma_f32_32x32x16_bf16 v[32:47], a[0:3], a[16:19], v[32:47]
    ds_read_b128 a[36:39], v18 offset:0
    ds_read_b64_tr_b16 a[20:21], v23 offset:4096
    ds_read_b64_tr_b16 a[22:23], v23 offset:5120
    s_waitcnt lgkmcnt(7)
    v_mfma_f32_32x32x16_bf16 v[48:63], a[4:7], a[16:19], v[48:63]
    ds_read_b64_tr_b16 a[24:25], v23 offset:4352
    ds_read_b64_tr_b16 a[26:27], v23 offset:5376
    ds_read_b64_tr_b16 a[28:29], v23 offset:4608
    s_add_u32 m0, s39, 100352
    s_add_u32 s32, s37, 133120
    buffer_load_dwordx4 v1, s[8:11], s32 offen sc1 lds
    s_waitcnt lgkmcnt(8)
    v_mfma_f32_32x32x16_bf16 v[64:79], a[8:11], a[16:19], v[64:79]
    ds_read_b64_tr_b16 a[30:31], v23 offset:5632
    ds_read_b64_tr_b16 a[32:33], v23 offset:4864
    ds_read_b64_tr_b16 a[34:35], v23 offset:5888
    s_waitcnt lgkmcnt(9)
    v_mfma_f32_32x32x16_bf16 v[80:95], a[12:15], a[16:19], v[80:95]
    s_add_u32 m0, s39, 101376
    s_add_u32 s32, s37, 134144
    buffer_load_dwordx4 v1, s[8:11], s32 offen sc1 lds
    s_waitcnt lgkmcnt(6)
    v_mfma_f32_32x32x16_bf16 v[32:47], a[20:23], a[36:39], v[32:47]
    ds_read_b128 a[16:19], v19 offset:0
    ds_read_b64_tr_b16 a[0:1], v23 offset:8192
    ds_read_b64_tr_b16 a[2:3], v23 offset:9216
    s_waitcnt lgkmcnt(7)
    v_mfma_f32_32x32x16_bf16 v[48:63], a[24:27], a[36:39], v[48:63]
    ds_read_b64_tr_b16 a[4:5], v23 offset:8448
    ds_read_b64_tr_b16 a[6:7], v23 offset:9472
    ds_read_b64_tr_b16 a[8:9], v23 offset:8704
    s_add_u32 m0, s40, 98304
    s_add_u32 s32, s38, 1024
    buffer_load_dwordx4 v5, s[16:19], s32 offen lds
    s_waitcnt lgkmcnt(8)
    v_mfma_f32_32x32x16_bf16 v[64:79], a[28:31], a[36:39], v[64:79]
    ds_read_b64_tr_b16 a[10:11], v23 offset:9728
    ds_read_b64_tr_b16 a[12:13], v23 offset:8960
    ds_read_b64_tr_b16 a[14:15], v23 offset:9984
    s_waitcnt lgkmcnt(9)
    v_mfma_f32_32x32x16_bf16 v[80:95], a[32:35], a[36:39], v[80:95]
    s_add_u32 m0, s40, 99328
    s_add_u32 s32, s38, 1024
    buffer_load_dwordx4 v6, s[16:19], s32 offen lds
    s_waitcnt lgkmcnt(6)
    v_mfma_f32_32x32x16_bf16 v[32:47], a[0:3], a[16:19], v[32:47]
    ds_read_b128 a[36:39], v20 offset:0
    ds_read_b64_tr_b16 a[20:21], v23 offset:12288
    ds_read_b64_tr_b16 a[22:23], v23 offset:13312
    s_waitcnt lgkmcnt(7)
    v_mfma_f32_32x32x16_bf16 v[48:63], a[4:7], a[16:19], v[48:63]
    ds_read_b64_tr_b16 a[24:25], v23 offset:12544
    ds_read_b64_tr_b16 a[26:27], v23 offset:13568
    ds_read_b64_tr_b16 a[28:29], v23 offset:12800
    s_add_u32 m0, s40, 100352
    s_add_u32 s32, s38, 1024
    buffer_load_dwordx4 v7, s[16:19], s32 offen lds
    s_waitcnt lgkmcnt(8)
    v_mfma_f32_32x32x16_bf16 v[64:79], a[8:11], a[16:19], v[64:79]
    ds_read_b64_tr_b16 a[30:31], v23 offset:13824
    ds_read_b64_tr_b16 a[32:33], v23 offset:13056
    ds_read_b64_tr_b16 a[34:35], v23 offset:14080
    s_waitcnt lgkmcnt(9)
    v_mfma_f32_32x32x16_bf16 v[80:95], a[12:15], a[16:19], v[80:95]
    s_add_u32 m0, s40, 101376
    s_add_u32 s32, s38, 1024
    buffer_load_dwordx4 v8, s[16:19], s32 offen lds
    s_waitcnt lgkmcnt(0)
    s_waitcnt vmcnt(24)
    s_barrier
    v_mfma_f32_32x32x16_bf16 v[32:47], a[20:23], a[36:39], v[32:47]
    ds_read_b128 a[16:19], v9 offset:0
    ds_read_b64_tr_b16 a[0:1], v21 offset:0
    ds_read_b64_tr_b16 a[2:3], v21 offset:1024
    v_mfma_f32_32x32x16_bf16 v[48:63], a[24:27], a[36:39], v[48:63]
    ds_read_b64_tr_b16 a[4:5], v21 offset:256
    ds_read_b64_tr_b16 a[6:7], v21 offset:1280
    ds_read_b64_tr_b16 a[8:9], v21 offset:512
    s_add_u32 m0, s39, 131072
    s_add_u32 s32, s37, 147456
    buffer_load_dwordx4 v1, s[8:11], s32 offen sc1 lds
    v_mfma_f32_32x32x16_bf16 v[64:79], a[28:31], a[36:39], v[64:79]
    ds_read_b64_tr_b16 a[10:11], v21 offset:1536
    ds_read_b64_tr_b16 a[12:13], v21 offset:768
    ds_read_b64_tr_b16 a[14:15], v21 offset:1792
    v_mfma_f32_32x32x16_bf16 v[80:95], a[32:35], a[36:39], v[80:95]
    s_add_u32 m0, s39, 132096
    s_add_u32 s32, s37, 148480
    buffer_load_dwordx4 v1, s[8:11], s32 offen sc1 lds
    s_waitcnt lgkmcnt(6)
    v_mfma_f32_32x32x16_bf16 v[32:47], a[0:3], a[16:19], v[32:47]
    ds_read_b128 a[36:39], v10 offset:0
    ds_read_b64_tr_b16 a[20:21], v21 offset:4096
    ds_read_b64_tr_b16 a[22:23], v21 offset:5120
    s_waitcnt lgkmcnt(7)
    v_mfma_f32_32x32x16_bf16 v[48:63], a[4:7], a[16:19], v[48:63]
    ds_read_b64_tr_b16 a[24:25], v21 offset:4352
    ds_read_b64_tr_b16 a[26:27], v21 offset:5376
    ds_read_b64_tr_b16 a[28:29], v21 offset:4608
    s_add_u32 m0, s39, 133120
    s_add_u32 s32, s37, 149504
    buffer_load_dwordx4 v1, s[8:11], s32 offen sc1 lds
    s_waitcnt lgkmcnt(8)
    v_mfma_f32_32x32x16_bf16 v[64:79], a[8:11], a[16:19], v[64:79]
    ds_read_b64_tr_b16 a[30:31], v21 offset:5632
    ds_read_b64_tr_b16 a[32:33], v21 offset:4864
    ds_read_b64_tr_b16 a[34:35], v21 offset:5888
    s_waitcnt lgkmcnt(9)
    v_mfma_f32_32x32x16_bf16 v[80:95], a[12:15], a[16:19], v[80:95]
    s_add_u32 m0, s39, 134144
    s_add_u32 s32, s37, 150528
    buffer_load_dwordx4 v1, s[8:11], s32 offen sc1 lds
    s_waitcnt lgkmcnt(6)
    v_mfma_f32_32x32x16_bf16 v[32:47], a[20:23], a[36:39], v[32:47]
    ds_read_b128 a[16:19], v11 offset:0
    ds_read_b64_tr_b16 a[0:1], v21 offset:8192
    ds_read_b64_tr_b16 a[2:3], v21 offset:9216
    s_waitcnt lgkmcnt(7)
    v_mfma_f32_32x32x16_bf16 v[48:63], a[24:27], a[36:39], v[48:63]
    ds_read_b64_tr_b16 a[4:5], v21 offset:8448
    ds_read_b64_tr_b16 a[6:7], v21 offset:9472
    ds_read_b64_tr_b16 a[8:9], v21 offset:8704
    s_add_u32 m0, s40, 131072
    s_add_u32 s32, s38, 1152
    buffer_load_dwordx4 v5, s[16:19], s32 offen lds
    s_waitcnt lgkmcnt(8)
    v_mfma_f32_32x32x16_bf16 v[64:79], a[28:31], a[36:39], v[64:79]
    ds_read_b64_tr_b16 a[10:11], v21 offset:9728
    ds_read_b64_tr_b16 a[12:13], v21 offset:8960
    ds_read_b64_tr_b16 a[14:15], v21 offset:9984
    s_waitcnt lgkmcnt(9)
    v_mfma_f32_32x32x16_bf16 v[80:95], a[32:35], a[36:39], v[80:95]
    s_add_u32 m0, s40, 132096
    s_add_u32 s32, s38, 1152
    buffer_load_dwordx4 v6, s[16:19], s32 offen lds
    s_waitcnt lgkmcnt(6)
    v_mfma_f32_32x32x16_bf16 v[32:47], a[0:3], a[16:19], v[32:47]
    ds_read_b128 a[36:39], v12 offset:0
    ds_read_b64_tr_b16 a[20:21], v21 offset:12288
    ds_read_b64_tr_b16 a[22:23], v21 offset:13312
    s_waitcnt lgkmcnt(7)
    v_mfma_f32_32x32x16_bf16 v[48:63], a[4:7], a[16:19], v[48:63]
    ds_read_b64_tr_b16 a[24:25], v21 offset:12544
    ds_read_b64_tr_b16 a[26:27], v21 offset:13568
    ds_read_b64_tr_b16 a[28:29], v21 offset:12800
    s_add_u32 m0, s40, 133120
    s_add_u32 s32, s38, 1152
    buffer_load_dwordx4 v7, s[16:19], s32 offen lds
    s_waitcnt lgkmcnt(8)
    v_mfma_f32_32x32x16_bf16 v[64:79], a[8:11], a[16:19], v[64:79]
    ds_read_b64_tr_b16 a[30:31], v21 offset:13824
    ds_read_b64_tr_b16 a[32:33], v21 offset:13056
    ds_read_b64_tr_b16 a[34:35], v21 offset:14080
    s_waitcnt lgkmcnt(9)
    v_mfma_f32_32x32x16_bf16 v[80:95], a[12:15], a[16:19], v[80:95]
    s_add_u32 m0, s40, 134144
    s_add_u32 s32, s38, 1152
    buffer_load_dwordx4 v8, s[16:19], s32 offen lds
    s_waitcnt lgkmcnt(0)
    s_waitcnt vmcnt(24)
    s_barrier
    v_mfma_f32_32x32x16_bf16 v[32:47], a[20:23], a[36:39], v[32:47]
    ds_read_b128 a[16:19], v9 offset:32768
    ds_read_b64_tr_b16 a[0:1], v21 offset:32768
    ds_read_b64_tr_b16 a[2:3], v21 offset:33792
    v_mfma_f32_32x32x16_bf16 v[48:63], a[24:27], a[36:39], v[48:63]
    ds_read_b64_tr_b16 a[4:5], v21 offset:33024
    ds_read_b64_tr_b16 a[6:7], v21 offset:34048
    ds_read_b64_tr_b16 a[8:9], v21 offset:33280
    s_add_u32 m0, s39, 0
    s_add_u32 s32, s37, 163840
    buffer_load_dwordx4 v1, s[8:11], s32 offen sc1 lds
    v_mfma_f32_32x32x16_bf16 v[64:79], a[28:31], a[36:39], v[64:79]
    ds_read_b64_tr_b16 a[10:11], v21 offset:34304
    ds_read_b64_tr_b16 a[12:13], v21 offset:33536
    ds_read_b64_tr_b16 a[14:15], v21 offset:34560
    v_mfma_f32_32x32x16_bf16 v[80:95], a[32:35], a[36:39], v[80:95]
    s_add_u32 m0, s39, 1024
    s_add_u32 s32, s37, 164864
    buffer_load_dwordx4 v1, s[8:11], s32 offen sc1 lds
    s_waitcnt lgkmcnt(6)
    v_mfma_f32_32x32x16_bf16 v[32:47], a[0:3], a[16:19], v[32:47]
    ds_read_b128 a[36:39], v10 offset:32768
    ds_read_b64_tr_b16 a[20:21], v21 offset:36864
    ds_read_b64_tr_b16 a[22:23], v21 offset:37888
    s_waitcnt lgkmcnt(7)
    v_mfma_f32_32x32x16_bf16 v[48:63], a[4:7], a[16:19], v[48:63]
    ds_read_b64_tr_b16 a[24:25], v21 offset:37120
    ds_read_b64_tr_b16 a[26:27], v21 offset:38144
    ds_read_b64_tr_b16 a[28:29], v21 offset:37376
    s_add_u32 m0, s39, 2048
    s_add_u32 s32, s37, 165888
    buffer_load_dwordx4 v1, s[8:11], s32 offen sc1 lds
    s_waitcnt lgkmcnt(8)
    v_mfma_f32_32x32x16_bf16 v[64:79], a[8:11], a[16:19], v[64:79]
    ds_read_b64_tr_b16 a[30:31], v21 offset:38400
    ds_read_b64_tr_b16 a[32:33], v21 offset:37632
    ds_read_b64_tr_b16 a[34:35], v21 offset:38656
    s_waitcnt lgkmcnt(9)
    v_mfma_f32_32x32x16_bf16 v[80:95], a[12:15], a[16:19], v[80:95]
    s_add_u32 m0, s39, 3072
    s_add_u32 s32, s37, 166912
    buffer_load_dwordx4 v1, s[8:11], s32 offen sc1 lds
    s_waitcnt lgkmcnt(6)
    v_mfma_f32_32x32x16_bf16 v[32:47], a[20:23], a[36:39], v[32:47]
    ds_read_b128 a[16:19], v11 offset:32768
    ds_read_b64_tr_b16 a[0:1], v21 offset:40960
    ds_read_b64_tr_b16 a[2:3], v21 offset:41984
    s_waitcnt lgkmcnt(7)
    v_mfma_f32_32x32x16_bf16 v[48:63], a[24:27], a[36:39], v[48:63]
    ds_read_b64_tr_b16 a[4:5], v21 offset:41216
    ds_read_b64_tr_b16 a[6:7], v21 offset:42240
    ds_read_b64_tr_b16 a[8:9], v21 offset:41472
    s_add_u32 m0, s40, 0
    s_add_u32 s32, s38, 0
    buffer_load_dwordx4 v5, s[20:23], s32 offen lds
    s_waitcnt lgkmcnt(8)
    v_mfma_f32_32x32x16_bf16 v[64:79], a[28:31], a[36:39], v[64:79]
    ds_read_b64_tr_b16 a[10:11], v21 offset:42496
    ds_read_b64_tr_b16 a[12:13], v21 offset:41728
    ds_read_b64_tr_b16 a[14:15], v21 offset:42752
    s_waitcnt lgkmcnt(9)
    v_mfma_f32_32x32x16_bf16 v[80:95], a[32:35], a[36:39], v[80:95]
    s_add_u32 m0, s40, 1024
    s_add_u32 s32, s38, 0
    buffer_load_dwordx4 v6, s[20:23], s32 offen lds
    s_waitcnt lgkmcnt(6)
    v_mfma_f32_32x32x16_bf16 v[32:47], a[0:3], a[16:19], v[32:47]
    ds_read_b128 a[36:39], v12 offset:32768
    ds_read_b64_tr_b16 a[20:21], v21 offset:45056
    ds_read_b64_tr_b16 a[22:23], v21 offset:46080
    s_waitcnt lgkmcnt(7)
    v_mfma_f32_32x32x16_bf16 v[48:63], a[4:7], a[16:19], v[48:63]
    ds_read_b64_tr_b16 a[24:25], v21 offset:45312
    ds_read_b64_tr_b16 a[26:27], v21 offset:46336
    ds_read_b64_tr_b16 a[28:29], v21 offset:45568
    s_add_u32 m0, s40, 2048
    s_add_u32 s32, s38, 0
    buffer_load_dwordx4 v7, s[20:23], s32 offen lds
    s_waitcnt lgkmcnt(8)
    v_mfma_f32_32x32x16_bf16 v[64:79], a[8:11], a[16:19], v[64:79]
    ds_read_b64_tr_b16 a[30:31], v21 offset:46592
    ds_read_b64_tr_b16 a[32:33], v21 offset:45824
    ds_read_b64_tr_b16 a[34:35], v21 offset:46848
    s_waitcnt lgkmcnt(9)
    v_mfma_f32_32x32x16_bf16 v[80:95], a[12:15], a[16:19], v[80:95]
    s_add_u32 m0, s40, 3072
    s_add_u32 s32, s38, 0
    buffer_load_dwordx4 v8, s[20:23], s32 offen lds
    s_waitcnt lgkmcnt(0)
    s_waitcnt vmcnt(24)
    s_barrier
    v_mfma_f32_32x32x16_bf16 v[32:47], a[20:23], a[36:39], v[32:47]
    ds_read_b128 a[16:19], v13 offset:0
    ds_read_b64_tr_b16 a[0:1], v22 offset:0
    ds_read_b64_tr_b16 a[2:3], v22 offset:1024
    v_mfma_f32_32x32x16_bf16 v[48:63], a[24:27], a[36:39], v[48:63]
    ds_read_b64_tr_b16 a[4:5], v22 offset:256
    ds_read_b64_tr_b16 a[6:7], v22 offset:1280
    ds_read_b64_tr_b16 a[8:9], v22 offset:512
    s_add_u32 m0, s39, 32768
    s_add_u32 s32, s37, 180224
    buffer_load_dwordx4 v1, s[8:11], s32 offen sc1 lds
    v_mfma_f32_32x32x16_bf16 v[64:79], a[28:31], a[36:39], v[64:79]
    ds_read_b64_tr_b16 a[10:11], v22 offset:1536
    ds_read_b64_tr_b16 a[12:13], v22 offset:768
    ds_read_b64_tr_b16 a[14:15], v22 offset:1792
    v_mfma_f32_32x32x16_bf16 v[80:95], a[32:35], a[36:39], v[80:95]
    s_add_u32 m0, s39, 33792
    s_add_u32 s32, s37, 181248
    buffer_load_dwordx4 v1, s[8:11], s32 offen sc1 lds
    s_waitcnt lgkmcnt(6)
    v_mfma_f32_32x32x16_bf16 v[32:47], a[0:3], a[16:19], v[32:47]
    ds_read_b128 a[36:39], v14 offset:0
    ds_read_b64_tr_b16 a[20:21], v22 offset:4096
    ds_read_b64_tr_b16 a[22:23], v22 offset:5120
    s_waitcnt lgkmcnt(7)
    v_mfma_f32_32x32x16_bf16 v[48:63], a[4:7], a[16:19], v[48:63]
    ds_read_b64_tr_b16 a[24:25], v22 offset:4352
    ds_read_b64_tr_b16 a[26:27], v22 offset:5376
    ds_read_b64_tr_b16 a[28:29], v22 offset:4608
    s_add_u32 m0, s39, 34816
    s_add_u32 s32, s37, 182272
    buffer_load_dwordx4 v1, s[8:11], s32 offen sc1 lds
    s_waitcnt lgkmcnt(8)
    v_mfma_f32_32x32x16_bf16 v[64:79], a[8:11], a[16:19], v[64:79]
    ds_read_b64_tr_b16 a[30:31], v22 offset:5632
    ds_read_b64_tr_b16 a[32:33], v22 offset:4864
    ds_read_b64_tr_b16 a[34:35], v22 offset:5888
    s_waitcnt lgkmcnt(9)
    v_mfma_f32_32x32x16_bf16 v[80:95], a[12:15], a[16:19], v[80:95]
    s_add_u32 m0, s39, 35840
    s_add_u32 s32, s37, 183296
    buffer_load_dwordx4 v1, s[8:11], s32 offen sc1 lds
    s_waitcnt lgkmcnt(6)
    v_mfma_f32_32x32x16_bf16 v[32:47], a[20:23], a[36:39], v[32:47]
    ds_read_b128 a[16:19], v15 offset:0
    ds_read_b64_tr_b16 a[0:1], v22 offset:8192
    ds_read_b64_tr_b16 a[2:3], v22 offset:9216
    s_waitcnt lgkmcnt(7)
    v_mfma_f32_32x32x16_bf16 v[48:63], a[24:27], a[36:39], v[48:63]
    ds_read_b64_tr_b16 a[4:5], v22 offset:8448
    ds_read_b64_tr_b16 a[6:7], v22 offset:9472
    ds_read_b64_tr_b16 a[8:9], v22 offset:8704
    s_add_u32 m0, s40, 32768
    s_add_u32 s32, s38, 128
    buffer_load_dwordx4 v5, s[20:23], s32 offen lds
    s_waitcnt lgkmcnt(8)
    v_mfma_f32_32x32x16_bf16 v[64:79], a[28:31], a[36:39], v[64:79]
    ds_read_b64_tr_b16 a[10:11], v22 offset:9728
    ds_read_b64_tr_b16 a[12:13], v22 offset:8960
    ds_read_b64_tr_b16 a[14:15], v22 offset:9984
    s_waitcnt lgkmcnt(9)
    v_mfma_f32_32x32x16_bf16 v[80:95], a[32:35], a[36:39], v[80:95]
    s_add_u32 m0, s40, 33792
    s_add_u32 s32, s38, 128
    buffer_load_dwordx4 v6, s[20:23], s32 offen lds
    s_waitcnt lgkmcnt(6)
    v_mfma_f32_32x32x16_bf16 v[32:47], a[0:3], a[16:19], v[32:47]
    ds_read_b128 a[36:39], v16 offset:0
    ds_read_b64_tr_b16 a[20:21], v22 offset:12288
    ds_read_b64_tr_b16 a[22:23], v22 offset:13312
    s_waitcnt lgkmcnt(7)
    v_mfma_f32_32x32x16_bf16 v[48:63], a[4:7], a[16:19], v[48:63]
    ds_read_b64_tr_b16 a[24:25], v22 offset:12544
    ds_read_b64_tr_b16 a[26:27], v22 offset:13568
    ds_read_b64_tr_b16 a[28:29], v22 offset:12800
    s_add_u32 m0, s40, 34816
    s_add_u32 s32, s38, 128
    buffer_load_dwordx4 v7, s[20:23], s32 offen lds
    s_waitcnt lgkmcnt(8)
    v_mfma_f32_32x32x16_bf16 v[64:79], a[8:11], a[16:19], v[64:79]
    ds_read_b64_tr_b16 a[30:31], v22 offset:13824
    ds_read_b64_tr_b16 a[32:33], v22 offset:13056
    ds_read_b64_tr_b16 a[34:35], v22 offset:14080
    s_waitcnt lgkmcnt(9)
    v_mfma_f32_32x32x16_bf16 v[80:95], a[12:15], a[16:19], v[80:95]
    s_add_u32 m0, s40, 35840
    s_add_u32 s32, s38, 128
    buffer_load_dwordx4 v8, s[20:23], s32 offen lds
    s_waitcnt lgkmcnt(0)
    s_waitcnt vmcnt(24)
    s_barrier
    v_mfma_f32_32x32x16_bf16 v[32:47], a[20:23], a[36:39], v[32:47]
    ds_read_b128 a[16:19], v13 offset:32768
    ds_read_b64_tr_b16 a[0:1], v22 offset:32768
    ds_read_b64_tr_b16 a[2:3], v22 offset:33792
    v_mfma_f32_32x32x16_bf16 v[48:63], a[24:27], a[36:39], v[48:63]
    ds_read_b64_tr_b16 a[4:5], v22 offset:33024
    ds_read_b64_tr_b16 a[6:7], v22 offset:34048
    ds_read_b64_tr_b16 a[8:9], v22 offset:33280
    s_add_u32 m0, s39, 65536
    s_add_u32 s32, s37, 196608
    buffer_load_dwordx4 v1, s[8:11], s32 offen sc1 lds
    v_mfma_f32_32x32x16_bf16 v[64:79], a[28:31], a[36:39], v[64:79]
    ds_read_b64_tr_b16 a[10:11], v22 offset:34304
    ds_read_b64_tr_b16 a[12:13], v22 offset:33536
    ds_read_b64_tr_b16 a[14:15], v22 offset:34560
    v_mfma_f32_32x32x16_bf16 v[80:95], a[32:35], a[36:39], v[80:95]
    s_add_u32 m0, s39, 66560
    s_add_u32 s32, s37, 197632
    buffer_load_dwordx4 v1, s[8:11], s32 offen sc1 lds
    s_waitcnt lgkmcnt(6)
    v_mfma_f32_32x32x16_bf16 v[32:47], a[0:3], a[16:19], v[32:47]
    ds_read_b128 a[36:39], v14 offset:32768
    ds_read_b64_tr_b16 a[20:21], v22 offset:36864
    ds_read_b64_tr_b16 a[22:23], v22 offset:37888
    s_waitcnt lgkmcnt(7)
    v_mfma_f32_32x32x16_bf16 v[48:63], a[4:7], a[16:19], v[48:63]
    ds_read_b64_tr_b16 a[24:25], v22 offset:37120
    ds_read_b64_tr_b16 a[26:27], v22 offset:38144
    ds_read_b64_tr_b16 a[28:29], v22 offset:37376
    s_add_u32 m0, s39, 67584
    s_add_u32 s32, s37, 198656
    buffer_load_dwordx4 v1, s[8:11], s32 offen sc1 lds
    s_waitcnt lgkmcnt(8)
    v_mfma_f32_32x32x16_bf16 v[64:79], a[8:11], a[16:19], v[64:79]
    ds_read_b64_tr_b16 a[30:31], v22 offset:38400
    ds_read_b64_tr_b16 a[32:33], v22 offset:37632
    ds_read_b64_tr_b16 a[34:35], v22 offset:38656
    s_waitcnt lgkmcnt(9)
    v_mfma_f32_32x32x16_bf16 v[80:95], a[12:15], a[16:19], v[80:95]
    s_add_u32 m0, s39, 68608
    s_add_u32 s32, s37, 199680
    buffer_load_dwordx4 v1, s[8:11], s32 offen sc1 lds
    s_waitcnt lgkmcnt(6)
    v_mfma_f32_32x32x16_bf16 v[32:47], a[20:23], a[36:39], v[32:47]
    ds_read_b128 a[16:19], v15 offset:32768
    ds_read_b64_tr_b16 a[0:1], v22 offset:40960
    ds_read_b64_tr_b16 a[2:3], v22 offset:41984
    s_waitcnt lgkmcnt(7)
    v_mfma_f32_32x32x16_bf16 v[48:63], a[24:27], a[36:39], v[48:63]
    ds_read_b64_tr_b16 a[4:5], v22 offset:41216
    ds_read_b64_tr_b16 a[6:7], v22 offset:42240
    ds_read_b64_tr_b16 a[8:9], v22 offset:41472
    s_add_u32 m0, s40, 65536
    s_add_u32 s32, s38, 256
    buffer_load_dwordx4 v5, s[20:23], s32 offen lds
    s_waitcnt lgkmcnt(8)
    v_mfma_f32_32x32x16_bf16 v[64:79], a[28:31], a[36:39], v[64:79]
    ds_read_b64_tr_b16 a[10:11], v22 offset:42496
    ds_read_b64_tr_b16 a[12:13], v22 offset:41728
    ds_read_b64_tr_b16 a[14:15], v22 offset:42752
    s_waitcnt lgkmcnt(9)
    v_mfma_f32_32x32x16_bf16 v[80:95], a[32:35], a[36:39], v[80:95]
    s_add_u32 m0, s40, 66560
    s_add_u32 s32, s38, 256
    buffer_load_dwordx4 v6, s[20:23], s32 offen lds
    s_waitcnt lgkmcnt(6)
    v_mfma_f32_32x32x16_bf16 v[32:47], a[0:3], a[16:19], v[32:47]
    ds_read_b128 a[36:39], v16 offset:32768
    ds_read_b64_tr_b16 a[20:21], v22 offset:45056
    ds_read_b64_tr_b16 a[22:23], v22 offset:46080
    s_waitcnt lgkmcnt(7)
    v_mfma_f32_32x32x16_bf16 v[48:63], a[4:7], a[16:19], v[48:63]
    ds_read_b64_tr_b16 a[24:25], v22 offset:45312
    ds_read_b64_tr_b16 a[26:27], v22 offset:46336
    ds_read_b64_tr_b16 a[28:29], v22 offset:45568
    s_add_u32 m0, s40, 67584
    s_add_u32 s32, s38, 256
    buffer_load_dwordx4 v7, s[20:23], s32 offen lds
    s_waitcnt lgkmcnt(8)
    v_mfma_f32_32x32x16_bf16 v[64:79], a[8:11], a[16:19], v[64:79]
    ds_read_b64_tr_b16 a[30:31], v22 offset:46592
    ds_read_b64_tr_b16 a[32:33], v22 offset:45824
    ds_read_b64_tr_b16 a[34:35], v22 offset:46848
    s_waitcnt lgkmcnt(9)
    v_mfma_f32_32x32x16_bf16 v[80:95], a[12:15], a[16:19], v[80:95]
    s_add_u32 m0, s40, 68608
    s_add_u32 s32, s38, 256
    buffer_load_dwordx4 v8, s[20:23], s32 offen lds
    s_waitcnt lgkmcnt(0)
    s_waitcnt vmcnt(24)
    s_barrier
    v_mfma_f32_32x32x16_bf16 v[32:47], a[20:23], a[36:39], v[32:47]
    ds_read_b128 a[16:19], v17 offset:0
    ds_read_b64_tr_b16 a[0:1], v23 offset:0
    ds_read_b64_tr_b16 a[2:3], v23 offset:1024
    v_mfma_f32_32x32x16_bf16 v[48:63], a[24:27], a[36:39], v[48:63]
    ds_read_b64_tr_b16 a[4:5], v23 offset:256
    ds_read_b64_tr_b16 a[6:7], v23 offset:1280
    ds_read_b64_tr_b16 a[8:9], v23 offset:512
    s_add_u32 m0, s39, 98304
    s_add_u32 s32, s37, 212992
    buffer_load_dwordx4 v1, s[8:11], s32 offen sc1 lds
    v_mfma_f32_32x32x16_bf16 v[64:79], a[28:31], a[36:39], v[64:79]
    ds_read_b64_tr_b16 a[10:11], v23 offset:1536
    ds_read_b64_tr_b16 a[12:13], v23 offset:768
    ds_read_b64_tr_b16 a[14:15], v23 offset:1792
    v_mfma_f32_32x32x16_bf16 v[80:95], a[32:35], a[36:39], v[80:95]
    s_add_u32 m0, s39, 99328
    s_add_u32 s32, s37, 214016
    buffer_load_dwordx4 v1, s[8:11], s32 offen sc1 lds
    s_waitcnt lgkmcnt(6)
    v_mfma_f32_32x32x16_bf16 v[32:47], a[0:3], a[16:19], v[32:47]
    ds_read_b128 a[36:39], v18 offset:0
    ds_read_b64_tr_b16 a[20:21], v23 offset:4096
    ds_read_b64_tr_b16 a[22:23], v23 offset:5120
    s_waitcnt lgkmcnt(7)
    v_mfma_f32_32x32x16_bf16 v[48:63], a[4:7], a[16:19], v[48:63]
    ds_read_b64_tr_b16 a[24:25], v23 offset:4352
    ds_read_b64_tr_b16 a[26:27], v23 offset:5376
    ds_read_b64_tr_b16 a[28:29], v23 offset:4608
    s_add_u32 m0, s39, 100352
    s_add_u32 s32, s37, 215040
    buffer_load_dwordx4 v1, s[8:11], s32 offen sc1 lds
    s_waitcnt lgkmcnt(8)
    v_mfma_f32_32x32x16_bf16 v[64:79], a[8:11], a[16:19], v[64:79]
    ds_read_b64_tr_b16 a[30:31], v23 offset:5632
    ds_read_b64_tr_b16 a[32:33], v23 offset:4864
    ds_read_b64_tr_b16 a[34:35], v23 offset:5888
    s_waitcnt lgkmcnt(9)
    v_mfma_f32_32x32x16_bf16 v[80:95], a[12:15], a[16:19], v[80:95]
    s_add_u32 m0, s39, 101376
    s_add_u32 s32, s37, 216064
    buffer_load_dwordx4 v1, s[8:11], s32 offen sc1 lds
    s_waitcnt lgkmcnt(6)
    v_mfma_f32_32x32x16_bf16 v[32:47], a[20:23], a[36:39], v[32:47]
    ds_read_b128 a[16:19], v19 offset:0
    ds_read_b64_tr_b16 a[0:1], v23 offset:8192
    ds_read_b64_tr_b16 a[2:3], v23 offset:9216
    s_waitcnt lgkmcnt(7)
    v_mfma_f32_32x32x16_bf16 v[48:63], a[24:27], a[36:39], v[48:63]
    ds_read_b64_tr_b16 a[4:5], v23 offset:8448
    ds_read_b64_tr_b16 a[6:7], v23 offset:9472
    ds_read_b64_tr_b16 a[8:9], v23 offset:8704
    s_add_u32 m0, s40, 98304
    s_add_u32 s32, s38, 384
    buffer_load_dwordx4 v5, s[20:23], s32 offen lds
    s_waitcnt lgkmcnt(8)
    v_mfma_f32_32x32x16_bf16 v[64:79], a[28:31], a[36:39], v[64:79]
    ds_read_b64_tr_b16 a[10:11], v23 offset:9728
    ds_read_b64_tr_b16 a[12:13], v23 offset:8960
    ds_read_b64_tr_b16 a[14:15], v23 offset:9984
    s_waitcnt lgkmcnt(9)
    v_mfma_f32_32x32x16_bf16 v[80:95], a[32:35], a[36:39], v[80:95]
    s_add_u32 m0, s40, 99328
    s_add_u32 s32, s38, 384
    buffer_load_dwordx4 v6, s[20:23], s32 offen lds
    s_waitcnt lgkmcnt(6)
    v_mfma_f32_32x32x16_bf16 v[32:47], a[0:3], a[16:19], v[32:47]
    ds_read_b128 a[36:39], v20 offset:0
    ds_read_b64_tr_b16 a[20:21], v23 offset:12288
    ds_read_b64_tr_b16 a[22:23], v23 offset:13312
    s_waitcnt lgkmcnt(7)
    v_mfma_f32_32x32x16_bf16 v[48:63], a[4:7], a[16:19], v[48:63]
    ds_read_b64_tr_b16 a[24:25], v23 offset:12544
    ds_read_b64_tr_b16 a[26:27], v23 offset:13568
    ds_read_b64_tr_b16 a[28:29], v23 offset:12800
    s_add_u32 m0, s40, 100352
    s_add_u32 s32, s38, 384
    buffer_load_dwordx4 v7, s[20:23], s32 offen lds
    s_waitcnt lgkmcnt(8)
    v_mfma_f32_32x32x16_bf16 v[64:79], a[8:11], a[16:19], v[64:79]
    ds_read_b64_tr_b16 a[30:31], v23 offset:13824
    ds_read_b64_tr_b16 a[32:33], v23 offset:13056
    ds_read_b64_tr_b16 a[34:35], v23 offset:14080
    s_waitcnt lgkmcnt(9)
    v_mfma_f32_32x32x16_bf16 v[80:95], a[12:15], a[16:19], v[80:95]
    s_add_u32 m0, s40, 101376
    s_add_u32 s32, s38, 384
    buffer_load_dwordx4 v8, s[20:23], s32 offen lds
    s_waitcnt lgkmcnt(0)
    s_waitcnt vmcnt(24)
    s_barrier
    v_mfma_f32_32x32x16_bf16 v[32:47], a[20:23], a[36:39], v[32:47]
    ds_read_b128 a[16:19], v9 offset:0
    ds_read_b64_tr_b16 a[0:1], v21 offset:0
    ds_read_b64_tr_b16 a[2:3], v21 offset:1024
    v_mfma_f32_32x32x16_bf16 v[48:63], a[24:27], a[36:39], v[48:63]
    ds_read_b64_tr_b16 a[4:5], v21 offset:256
    ds_read_b64_tr_b16 a[6:7], v21 offset:1280
    ds_read_b64_tr_b16 a[8:9], v21 offset:512
    s_add_u32 m0, s39, 131072
    s_add_u32 s32, s37, 229376
    buffer_load_dwordx4 v1, s[8:11], s32 offen sc1 lds
    v_mfma_f32_32x32x16_bf16 v[64:79], a[28:31], a[36:39], v[64:79]
    ds_read_b64_tr_b16 a[10:11], v21 offset:1536
    ds_read_b64_tr_b16 a[12:13], v21 offset:768
    ds_read_b64_tr_b16 a[14:15], v21 offset:1792
    v_mfma_f32_32x32x16_bf16 v[80:95], a[32:35], a[36:39], v[80:95]
    s_add_u32 m0, s39, 132096
    s_add_u32 s32, s37, 230400
    buffer_load_dwordx4 v1, s[8:11], s32 offen sc1 lds
    s_waitcnt lgkmcnt(6)
    v_mfma_f32_32x32x16_bf16 v[32:47], a[0:3], a[16:19], v[32:47]
    ds_read_b128 a[36:39], v10 offset:0
    ds_read_b64_tr_b16 a[20:21], v21 offset:4096
    ds_read_b64_tr_b16 a[22:23], v21 offset:5120
    s_waitcnt lgkmcnt(7)
    v_mfma_f32_32x32x16_bf16 v[48:63], a[4:7], a[16:19], v[48:63]
    ds_read_b64_tr_b16 a[24:25], v21 offset:4352
    ds_read_b64_tr_b16 a[26:27], v21 offset:5376
    ds_read_b64_tr_b16 a[28:29], v21 offset:4608
    s_add_u32 m0, s39, 133120
    s_add_u32 s32, s37, 231424
    buffer_load_dwordx4 v1, s[8:11], s32 offen sc1 lds
    s_waitcnt lgkmcnt(8)
    v_mfma_f32_32x32x16_bf16 v[64:79], a[8:11], a[16:19], v[64:79]
    ds_read_b64_tr_b16 a[30:31], v21 offset:5632
    ds_read_b64_tr_b16 a[32:33], v21 offset:4864
    ds_read_b64_tr_b16 a[34:35], v21 offset:5888
    s_waitcnt lgkmcnt(9)
    v_mfma_f32_32x32x16_bf16 v[80:95], a[12:15], a[16:19], v[80:95]
    s_add_u32 m0, s39, 134144
    s_add_u32 s32, s37, 232448
    buffer_load_dwordx4 v1, s[8:11], s32 offen sc1 lds
    s_waitcnt lgkmcnt(6)
    v_mfma_f32_32x32x16_bf16 v[32:47], a[20:23], a[36:39], v[32:47]
    ds_read_b128 a[16:19], v11 offset:0
    ds_read_b64_tr_b16 a[0:1], v21 offset:8192
    ds_read_b64_tr_b16 a[2:3], v21 offset:9216
    s_waitcnt lgkmcnt(7)
    v_mfma_f32_32x32x16_bf16 v[48:63], a[24:27], a[36:39], v[48:63]
    ds_read_b64_tr_b16 a[4:5], v21 offset:8448
    ds_read_b64_tr_b16 a[6:7], v21 offset:9472
    ds_read_b64_tr_b16 a[8:9], v21 offset:8704
    s_add_u32 m0, s40, 131072
    s_add_u32 s32, s38, 512
    buffer_load_dwordx4 v5, s[20:23], s32 offen lds
    s_waitcnt lgkmcnt(8)
    v_mfma_f32_32x32x16_bf16 v[64:79], a[28:31], a[36:39], v[64:79]
    ds_read_b64_tr_b16 a[10:11], v21 offset:9728
    ds_read_b64_tr_b16 a[12:13], v21 offset:8960
    ds_read_b64_tr_b16 a[14:15], v21 offset:9984
    s_waitcnt lgkmcnt(9)
    v_mfma_f32_32x32x16_bf16 v[80:95], a[32:35], a[36:39], v[80:95]
    s_add_u32 m0, s40, 132096
    s_add_u32 s32, s38, 512
    buffer_load_dwordx4 v6, s[20:23], s32 offen lds
    s_waitcnt lgkmcnt(6)
    v_mfma_f32_32x32x16_bf16 v[32:47], a[0:3], a[16:19], v[32:47]
    ds_read_b128 a[36:39], v12 offset:0
    ds_read_b64_tr_b16 a[20:21], v21 offset:12288
    ds_read_b64_tr_b16 a[22:23], v21 offset:13312
    s_waitcnt lgkmcnt(7)
    v_mfma_f32_32x32x16_bf16 v[48:63], a[4:7], a[16:19], v[48:63]
    ds_read_b64_tr_b16 a[24:25], v21 offset:12544
    ds_read_b64_tr_b16 a[26:27], v21 offset:13568
    ds_read_b64_tr_b16 a[28:29], v21 offset:12800
    s_add_u32 m0, s40, 133120
    s_add_u32 s32, s38, 512
    buffer_load_dwordx4 v7, s[20:23], s32 offen lds
    s_waitcnt lgkmcnt(8)
    v_mfma_f32_32x32x16_bf16 v[64:79], a[8:11], a[16:19], v[64:79]
    ds_read_b64_tr_b16 a[30:31], v21 offset:13824
    ds_read_b64_tr_b16 a[32:33], v21 offset:13056
    ds_read_b64_tr_b16 a[34:35], v21 offset:14080
    s_waitcnt lgkmcnt(9)
    v_mfma_f32_32x32x16_bf16 v[80:95], a[12:15], a[16:19], v[80:95]
    s_add_u32 m0, s40, 134144
    s_add_u32 s32, s38, 512
    buffer_load_dwordx4 v8, s[20:23], s32 offen lds
    s_waitcnt lgkmcnt(0)
    s_waitcnt vmcnt(24)
    s_barrier
    v_mfma_f32_32x32x16_bf16 v[32:47], a[20:23], a[36:39], v[32:47]
    ds_read_b128 a[16:19], v9 offset:32768
    ds_read_b64_tr_b16 a[0:1], v21 offset:32768
    ds_read_b64_tr_b16 a[2:3], v21 offset:33792
    v_mfma_f32_32x32x16_bf16 v[48:63], a[24:27], a[36:39], v[48:63]
    ds_read_b64_tr_b16 a[4:5], v21 offset:33024
    ds_read_b64_tr_b16 a[6:7], v21 offset:34048
    ds_read_b64_tr_b16 a[8:9], v21 offset:33280
    s_add_u32 m0, s39, 0
    s_add_u32 s32, s37, 245760
    buffer_load_dwordx4 v1, s[8:11], s32 offen sc1 lds
    v_mfma_f32_32x32x16_bf16 v[64:79], a[28:31], a[36:39], v[64:79]
    ds_read_b64_tr_b16 a[10:11], v21 offset:34304
    ds_read_b64_tr_b16 a[12:13], v21 offset:33536
    ds_read_b64_tr_b16 a[14:15], v21 offset:34560
    v_mfma_f32_32x32x16_bf16 v[80:95], a[32:35], a[36:39], v[80:95]
    s_add_u32 m0, s39, 1024
    s_add_u32 s32, s37, 246784
    buffer_load_dwordx4 v1, s[8:11], s32 offen sc1 lds
    s_waitcnt lgkmcnt(6)
    v_mfma_f32_32x32x16_bf16 v[32:47], a[0:3], a[16:19], v[32:47]
    ds_read_b128 a[36:39], v10 offset:32768
    ds_read_b64_tr_b16 a[20:21], v21 offset:36864
    ds_read_b64_tr_b16 a[22:23], v21 offset:37888
    s_waitcnt lgkmcnt(7)
    v_mfma_f32_32x32x16_bf16 v[48:63], a[4:7], a[16:19], v[48:63]
    ds_read_b64_tr_b16 a[24:25], v21 offset:37120
    ds_read_b64_tr_b16 a[26:27], v21 offset:38144
    ds_read_b64_tr_b16 a[28:29], v21 offset:37376
    s_add_u32 m0, s39, 2048
    s_add_u32 s32, s37, 247808
    buffer_load_dwordx4 v1, s[8:11], s32 offen sc1 lds
    s_waitcnt lgkmcnt(8)
    v_mfma_f32_32x32x16_bf16 v[64:79], a[8:11], a[16:19], v[64:79]
    ds_read_b64_tr_b16 a[30:31], v21 offset:38400
    ds_read_b64_tr_b16 a[32:33], v21 offset:37632
    ds_read_b64_tr_b16 a[34:35], v21 offset:38656
    s_waitcnt lgkmcnt(9)
    v_mfma_f32_32x32x16_bf16 v[80:95], a[12:15], a[16:19], v[80:95]
    s_add_u32 m0, s39, 3072
    s_add_u32 s32, s37, 248832
    buffer_load_dwordx4 v1, s[8:11], s32 offen sc1 lds
    s_waitcnt lgkmcnt(6)
    v_mfma_f32_32x32x16_bf16 v[32:47], a[20:23], a[36:39], v[32:47]
    ds_read_b128 a[16:19], v11 offset:32768
    ds_read_b64_tr_b16 a[0:1], v21 offset:40960
    ds_read_b64_tr_b16 a[2:3], v21 offset:41984
    s_waitcnt lgkmcnt(7)
    v_mfma_f32_32x32x16_bf16 v[48:63], a[24:27], a[36:39], v[48:63]
    ds_read_b64_tr_b16 a[4:5], v21 offset:41216
    ds_read_b64_tr_b16 a[6:7], v21 offset:42240
    ds_read_b64_tr_b16 a[8:9], v21 offset:41472
    s_add_u32 m0, s40, 0
    s_add_u32 s32, s38, 640
    buffer_load_dwordx4 v5, s[20:23], s32 offen lds
    s_waitcnt lgkmcnt(8)
    v_mfma_f32_32x32x16_bf16 v[64:79], a[28:31], a[36:39], v[64:79]
    ds_read_b64_tr_b16 a[10:11], v21 offset:42496
    ds_read_b64_tr_b16 a[12:13], v21 offset:41728
    ds_read_b64_tr_b16 a[14:15], v21 offset:42752
    s_waitcnt lgkmcnt(9)
    v_mfma_f32_32x32x16_bf16 v[80:95], a[32:35], a[36:39], v[80:95]
    s_add_u32 m0, s40, 1024
    s_add_u32 s32, s38, 640
    buffer_load_dwordx4 v6, s[20:23], s32 offen lds
    s_waitcnt lgkmcnt(6)
    v_mfma_f32_32x32x16_bf16 v[32:47], a[0:3], a[16:19], v[32:47]
    ds_read_b128 a[36:39], v12 offset:32768
    ds_read_b64_tr_b16 a[20:21], v21 offset:45056
    ds_read_b64_tr_b16 a[22:23], v21 offset:46080
    s_waitcnt lgkmcnt(7)
    v_mfma_f32_32x32x16_bf16 v[48:63], a[4:7], a[16:19], v[48:63]
    ds_read_b64_tr_b16 a[24:25], v21 offset:45312
    ds_read_b64_tr_b16 a[26:27], v21 offset:46336
    ds_read_b64_tr_b16 a[28:29], v21 offset:45568
    s_add_u32 m0, s40, 2048
    s_add_u32 s32, s38, 640
    buffer_load_dwordx4 v7, s[20:23], s32 offen lds
    s_waitcnt lgkmcnt(8)
    v_mfma_f32_32x32x16_bf16 v[64:79], a[8:11], a[16:19], v[64:79]
    ds_read_b64_tr_b16 a[30:31], v21 offset:46592
    ds_read_b64_tr_b16 a[32:33], v21 offset:45824
    ds_read_b64_tr_b16 a[34:35], v21 offset:46848
    s_waitcnt lgkmcnt(9)
    v_mfma_f32_32x32x16_bf16 v[80:95], a[12:15], a[16:19], v[80:95]
    s_add_u32 m0, s40, 3072
    s_add_u32 s32, s38, 640
    buffer_load_dwordx4 v8, s[20:23], s32 offen lds
    s_waitcnt lgkmcnt(0)
    s_waitcnt vmcnt(24)
    s_barrier
    v_mfma_f32_32x32x16_bf16 v[32:47], a[20:23], a[36:39], v[32:47]
    ds_read_b128 a[16:19], v13 offset:0
    ds_read_b64_tr_b16 a[0:1], v22 offset:0
    ds_read_b64_tr_b16 a[2:3], v22 offset:1024
    v_mfma_f32_32x32x16_bf16 v[48:63], a[24:27], a[36:39], v[48:63]
    ds_read_b64_tr_b16 a[4:5], v22 offset:256
    ds_read_b64_tr_b16 a[6:7], v22 offset:1280
    ds_read_b64_tr_b16 a[8:9], v22 offset:512
    s_add_u32 m0, s39, 32768
    s_add_u32 s32, s37, 262144
    buffer_load_dwordx4 v1, s[8:11], s32 offen sc1 lds
    v_mfma_f32_32x32x16_bf16 v[64:79], a[28:31], a[36:39], v[64:79]
    ds_read_b64_tr_b16 a[10:11], v22 offset:1536
    ds_read_b64_tr_b16 a[12:13], v22 offset:768
    ds_read_b64_tr_b16 a[14:15], v22 offset:1792
    v_mfma_f32_32x32x16_bf16 v[80:95], a[32:35], a[36:39], v[80:95]
    s_add_u32 m0, s39, 33792
    s_add_u32 s32, s37, 263168
    buffer_load_dwordx4 v1, s[8:11], s32 offen sc1 lds
    s_waitcnt lgkmcnt(6)
    v_mfma_f32_32x32x16_bf16 v[32:47], a[0:3], a[16:19], v[32:47]
    ds_read_b128 a[36:39], v14 offset:0
    ds_read_b64_tr_b16 a[20:21], v22 offset:4096
    ds_read_b64_tr_b16 a[22:23], v22 offset:5120
    s_waitcnt lgkmcnt(7)
    v_mfma_f32_32x32x16_bf16 v[48:63], a[4:7], a[16:19], v[48:63]
    ds_read_b64_tr_b16 a[24:25], v22 offset:4352
    ds_read_b64_tr_b16 a[26:27], v22 offset:5376
    ds_read_b64_tr_b16 a[28:29], v22 offset:4608
    s_add_u32 m0, s39, 34816
    s_add_u32 s32, s37, 264192
    buffer_load_dwordx4 v1, s[8:11], s32 offen sc1 lds
    s_waitcnt lgkmcnt(8)
    v_mfma_f32_32x32x16_bf16 v[64:79], a[8:11], a[16:19], v[64:79]
    ds_read_b64_tr_b16 a[30:31], v22 offset:5632
    ds_read_b64_tr_b16 a[32:33], v22 offset:4864
    ds_read_b64_tr_b16 a[34:35], v22 offset:5888
    s_waitcnt lgkmcnt(9)
    v_mfma_f32_32x32x16_bf16 v[80:95], a[12:15], a[16:19], v[80:95]
    s_add_u32 m0, s39, 35840
    s_add_u32 s32, s37, 265216
    buffer_load_dwordx4 v1, s[8:11], s32 offen sc1 lds
    s_waitcnt lgkmcnt(6)
    v_mfma_f32_32x32x16_bf16 v[32:47], a[20:23], a[36:39], v[32:47]
    ds_read_b128 a[16:19], v15 offset:0
    ds_read_b64_tr_b16 a[0:1], v22 offset:8192
    ds_read_b64_tr_b16 a[2:3], v22 offset:9216
    s_waitcnt lgkmcnt(7)
    v_mfma_f32_32x32x16_bf16 v[48:63], a[24:27], a[36:39], v[48:63]
    ds_read_b64_tr_b16 a[4:5], v22 offset:8448
    ds_read_b64_tr_b16 a[6:7], v22 offset:9472
    ds_read_b64_tr_b16 a[8:9], v22 offset:8704
    s_add_u32 m0, s40, 32768
    s_add_u32 s32, s38, 768
    buffer_load_dwordx4 v5, s[20:23], s32 offen lds
    s_waitcnt lgkmcnt(8)
    v_mfma_f32_32x32x16_bf16 v[64:79], a[28:31], a[36:39], v[64:79]
    ds_read_b64_tr_b16 a[10:11], v22 offset:9728
    ds_read_b64_tr_b16 a[12:13], v22 offset:8960
    ds_read_b64_tr_b16 a[14:15], v22 offset:9984
    s_waitcnt lgkmcnt(9)
    v_mfma_f32_32x32x16_bf16 v[80:95], a[32:35], a[36:39], v[80:95]
    s_add_u32 m0, s40, 33792
    s_add_u32 s32, s38, 768
    buffer_load_dwordx4 v6, s[20:23], s32 offen lds
    s_waitcnt lgkmcnt(6)
    v_mfma_f32_32x32x16_bf16 v[32:47], a[0:3], a[16:19], v[32:47]
    ds_read_b128 a[36:39], v16 offset:0
    ds_read_b64_tr_b16 a[20:21], v22 offset:12288
    ds_read_b64_tr_b16 a[22:23], v22 offset:13312
    s_waitcnt lgkmcnt(7)
    v_mfma_f32_32x32x16_bf16 v[48:63], a[4:7], a[16:19], v[48:63]
    ds_read_b64_tr_b16 a[24:25], v22 offset:12544
    ds_read_b64_tr_b16 a[26:27], v22 offset:13568
    ds_read_b64_tr_b16 a[28:29], v22 offset:12800
    s_add_u32 m0, s40, 34816
    s_add_u32 s32, s38, 768
    buffer_load_dwordx4 v7, s[20:23], s32 offen lds
    s_waitcnt lgkmcnt(8)
    v_mfma_f32_32x32x16_bf16 v[64:79], a[8:11], a[16:19], v[64:79]
    ds_read_b64_tr_b16 a[30:31], v22 offset:13824
    ds_read_b64_tr_b16 a[32:33], v22 offset:13056
    ds_read_b64_tr_b16 a[34:35], v22 offset:14080
    s_waitcnt lgkmcnt(9)
    v_mfma_f32_32x32x16_bf16 v[80:95], a[12:15], a[16:19], v[80:95]
    s_add_u32 m0, s40, 35840
    s_add_u32 s32, s38, 768
    buffer_load_dwordx4 v8, s[20:23], s32 offen lds
    s_waitcnt lgkmcnt(0)
    s_waitcnt vmcnt(24)
    s_barrier
    v_mfma_f32_32x32x16_bf16 v[32:47], a[20:23], a[36:39], v[32:47]
    ds_read_b128 a[16:19], v13 offset:32768
    ds_read_b64_tr_b16 a[0:1], v22 offset:32768
    ds_read_b64_tr_b16 a[2:3], v22 offset:33792
    v_mfma_f32_32x32x16_bf16 v[48:63], a[24:27], a[36:39], v[48:63]
    ds_read_b64_tr_b16 a[4:5], v22 offset:33024
    ds_read_b64_tr_b16 a[6:7], v22 offset:34048
    ds_read_b64_tr_b16 a[8:9], v22 offset:33280
    s_add_u32 m0, s39, 65536
    s_add_u32 s32, s37, 278528
    buffer_load_dwordx4 v1, s[8:11], s32 offen sc1 lds
    v_mfma_f32_32x32x16_bf16 v[64:79], a[28:31], a[36:39], v[64:79]
    ds_read_b64_tr_b16 a[10:11], v22 offset:34304
    ds_read_b64_tr_b16 a[12:13], v22 offset:33536
    ds_read_b64_tr_b16 a[14:15], v22 offset:34560
    v_mfma_f32_32x32x16_bf16 v[80:95], a[32:35], a[36:39], v[80:95]
    s_add_u32 m0, s39, 66560
    s_add_u32 s32, s37, 279552
    buffer_load_dwordx4 v1, s[8:11], s32 offen sc1 lds
    s_waitcnt lgkmcnt(6)
    v_mfma_f32_32x32x16_bf16 v[32:47], a[0:3], a[16:19], v[32:47]
    ds_read_b128 a[36:39], v14 offset:32768
    ds_read_b64_tr_b16 a[20:21], v22 offset:36864
    ds_read_b64_tr_b16 a[22:23], v22 offset:37888
    s_waitcnt lgkmcnt(7)
    v_mfma_f32_32x32x16_bf16 v[48:63], a[4:7], a[16:19], v[48:63]
    ds_read_b64_tr_b16 a[24:25], v22 offset:37120
    ds_read_b64_tr_b16 a[26:27], v22 offset:38144
    ds_read_b64_tr_b16 a[28:29], v22 offset:37376
    s_add_u32 m0, s39, 67584
    s_add_u32 s32, s37, 280576
    buffer_load_dwordx4 v1, s[8:11], s32 offen sc1 lds
    s_waitcnt lgkmcnt(8)
    v_mfma_f32_32x32x16_bf16 v[64:79], a[8:11], a[16:19], v[64:79]
    ds_read_b64_tr_b16 a[30:31], v22 offset:38400
    ds_read_b64_tr_b16 a[32:33], v22 offset:37632
    ds_read_b64_tr_b16 a[34:35], v22 offset:38656
    s_waitcnt lgkmcnt(9)
    v_mfma_f32_32x32x16_bf16 v[80:95], a[12:15], a[16:19], v[80:95]
    s_add_u32 m0, s39, 68608
    s_add_u32 s32, s37, 281600
    buffer_load_dwordx4 v1, s[8:11], s32 offen sc1 lds
    s_waitcnt lgkmcnt(6)
    v_mfma_f32_32x32x16_bf16 v[32:47], a[20:23], a[36:39], v[32:47]
    ds_read_b128 a[16:19], v15 offset:32768
    ds_read_b64_tr_b16 a[0:1], v22 offset:40960
    ds_read_b64_tr_b16 a[2:3], v22 offset:41984
    s_waitcnt lgkmcnt(7)
    v_mfma_f32_32x32x16_bf16 v[48:63], a[24:27], a[36:39], v[48:63]
    ds_read_b64_tr_b16 a[4:5], v22 offset:41216
    ds_read_b64_tr_b16 a[6:7], v22 offset:42240
    ds_read_b64_tr_b16 a[8:9], v22 offset:41472
    s_add_u32 m0, s40, 65536
    s_add_u32 s32, s38, 896
    buffer_load_dwordx4 v5, s[20:23], s32 offen lds
    s_waitcnt lgkmcnt(8)
    v_mfma_f32_32x32x16_bf16 v[64:79], a[28:31], a[36:39], v[64:79]
    ds_read_b64_tr_b16 a[10:11], v22 offset:42496
    ds_read_b64_tr_b16 a[12:13], v22 offset:41728
    ds_read_b64_tr_b16 a[14:15], v22 offset:42752
    s_waitcnt lgkmcnt(9)
    v_mfma_f32_32x32x16_bf16 v[80:95], a[32:35], a[36:39], v[80:95]
    s_add_u32 m0, s40, 66560
    s_add_u32 s32, s38, 896
    buffer_load_dwordx4 v6, s[20:23], s32 offen lds
    s_waitcnt lgkmcnt(6)
    v_mfma_f32_32x32x16_bf16 v[32:47], a[0:3], a[16:19], v[32:47]
    ds_read_b128 a[36:39], v16 offset:32768
    ds_read_b64_tr_b16 a[20:21], v22 offset:45056
    ds_read_b64_tr_b16 a[22:23], v22 offset:46080
    s_waitcnt lgkmcnt(7)
    v_mfma_f32_32x32x16_bf16 v[48:63], a[4:7], a[16:19], v[48:63]
    ds_read_b64_tr_b16 a[24:25], v22 offset:45312
    ds_read_b64_tr_b16 a[26:27], v22 offset:46336
    ds_read_b64_tr_b16 a[28:29], v22 offset:45568
    s_add_u32 m0, s40, 67584
    s_add_u32 s32, s38, 896
    buffer_load_dwordx4 v7, s[20:23], s32 offen lds
    s_waitcnt lgkmcnt(8)
    v_mfma_f32_32x32x16_bf16 v[64:79], a[8:11], a[16:19], v[64:79]
    ds_read_b64_tr_b16 a[30:31], v22 offset:46592
    ds_read_b64_tr_b16 a[32:33], v22 offset:45824
    ds_read_b64_tr_b16 a[34:35], v22 offset:46848
    s_waitcnt lgkmcnt(9)
    v_mfma_f32_32x32x16_bf16 v[80:95], a[12:15], a[16:19], v[80:95]
    s_add_u32 m0, s40, 68608
    s_add_u32 s32, s38, 896
    buffer_load_dwordx4 v8, s[20:23], s32 offen lds
    s_waitcnt lgkmcnt(0)
    s_waitcnt vmcnt(24)
    s_barrier
    v_mfma_f32_32x32x16_bf16 v[32:47], a[20:23], a[36:39], v[32:47]
    ds_read_b128 a[16:19], v17 offset:0
    ds_read_b64_tr_b16 a[0:1], v23 offset:0
    ds_read_b64_tr_b16 a[2:3], v23 offset:1024
    v_mfma_f32_32x32x16_bf16 v[48:63], a[24:27], a[36:39], v[48:63]
    ds_read_b64_tr_b16 a[4:5], v23 offset:256
    ds_read_b64_tr_b16 a[6:7], v23 offset:1280
    ds_read_b64_tr_b16 a[8:9], v23 offset:512
    s_add_u32 m0, s39, 98304
    s_add_u32 s32, s37, 294912
    buffer_load_dwordx4 v1, s[8:11], s32 offen sc1 lds
    v_mfma_f32_32x32x16_bf16 v[64:79], a[28:31], a[36:39], v[64:79]
    ds_read_b64_tr_b16 a[10:11], v23 offset:1536
    ds_read_b64_tr_b16 a[12:13], v23 offset:768
    ds_read_b64_tr_b16 a[14:15], v23 offset:1792
    v_mfma_f32_32x32x16_bf16 v[80:95], a[32:35], a[36:39], v[80:95]
    s_add_u32 m0, s39, 99328
    s_add_u32 s32, s37, 295936
    buffer_load_dwordx4 v1, s[8:11], s32 offen sc1 lds
    s_waitcnt lgkmcnt(6)
    v_mfma_f32_32x32x16_bf16 v[32:47], a[0:3], a[16:19], v[32:47]
    ds_read_b128 a[36:39], v18 offset:0
    ds_read_b64_tr_b16 a[20:21], v23 offset:4096
    ds_read_b64_tr_b16 a[22:23], v23 offset:5120
    s_waitcnt lgkmcnt(7)
    v_mfma_f32_32x32x16_bf16 v[48:63], a[4:7], a[16:19], v[48:63]
    ds_read_b64_tr_b16 a[24:25], v23 offset:4352
    ds_read_b64_tr_b16 a[26:27], v23 offset:5376
    ds_read_b64_tr_b16 a[28:29], v23 offset:4608
    s_add_u32 m0, s39, 100352
    s_add_u32 s32, s37, 296960
    buffer_load_dwordx4 v1, s[8:11], s32 offen sc1 lds
    s_waitcnt lgkmcnt(8)
    v_mfma_f32_32x32x16_bf16 v[64:79], a[8:11], a[16:19], v[64:79]
    ds_read_b64_tr_b16 a[30:31], v23 offset:5632
    ds_read_b64_tr_b16 a[32:33], v23 offset:4864
    ds_read_b64_tr_b16 a[34:35], v23 offset:5888
    s_waitcnt lgkmcnt(9)
    v_mfma_f32_32x32x16_bf16 v[80:95], a[12:15], a[16:19], v[80:95]
    s_add_u32 m0, s39, 101376
    s_add_u32 s32, s37, 297984
    buffer_load_dwordx4 v1, s[8:11], s32 offen sc1 lds
    s_waitcnt lgkmcnt(6)
    v_mfma_f32_32x32x16_bf16 v[32:47], a[20:23], a[36:39], v[32:47]
    ds_read_b128 a[16:19], v19 offset:0
    ds_read_b64_tr_b16 a[0:1], v23 offset:8192
    ds_read_b64_tr_b16 a[2:3], v23 offset:9216
    s_waitcnt lgkmcnt(7)
    v_mfma_f32_32x32x16_bf16 v[48:63], a[24:27], a[36:39], v[48:63]
    ds_read_b64_tr_b16 a[4:5], v23 offset:8448
    ds_read_b64_tr_b16 a[6:7], v23 offset:9472
    ds_read_b64_tr_b16 a[8:9], v23 offset:8704
    s_add_u32 m0, s40, 98304
    s_add_u32 s32, s38, 1024
    buffer_load_dwordx4 v5, s[20:23], s32 offen lds
    s_waitcnt lgkmcnt(8)
    v_mfma_f32_32x32x16_bf16 v[64:79], a[28:31], a[36:39], v[64:79]
    ds_read_b64_tr_b16 a[10:11], v23 offset:9728
    ds_read_b64_tr_b16 a[12:13], v23 offset:8960
    ds_read_b64_tr_b16 a[14:15], v23 offset:9984
    s_waitcnt lgkmcnt(9)
    v_mfma_f32_32x32x16_bf16 v[80:95], a[32:35], a[36:39], v[80:95]
    s_add_u32 m0, s40, 99328
    s_add_u32 s32, s38, 1024
    buffer_load_dwordx4 v6, s[20:23], s32 offen lds
    s_waitcnt lgkmcnt(6)
    v_mfma_f32_32x32x16_bf16 v[32:47], a[0:3], a[16:19], v[32:47]
    ds_read_b128 a[36:39], v20 offset:0
    ds_read_b64_tr_b16 a[20:21], v23 offset:12288
    ds_read_b64_tr_b16 a[22:23], v23 offset:13312
    s_waitcnt lgkmcnt(7)
    v_mfma_f32_32x32x16_bf16 v[48:63], a[4:7], a[16:19], v[48:63]
    ds_read_b64_tr_b16 a[24:25], v23 offset:12544
    ds_read_b64_tr_b16 a[26:27], v23 offset:13568
    ds_read_b64_tr_b16 a[28:29], v23 offset:12800
    s_add_u32 m0, s40, 100352
    s_add_u32 s32, s38, 1024
    buffer_load_dwordx4 v7, s[20:23], s32 offen lds
    s_waitcnt lgkmcnt(8)
    v_mfma_f32_32x32x16_bf16 v[64:79], a[8:11], a[16:19], v[64:79]
    ds_read_b64_tr_b16 a[30:31], v23 offset:13824
    ds_read_b64_tr_b16 a[32:33], v23 offset:13056
    ds_read_b64_tr_b16 a[34:35], v23 offset:14080
    s_waitcnt lgkmcnt(9)
    v_mfma_f32_32x32x16_bf16 v[80:95], a[12:15], a[16:19], v[80:95]
    s_add_u32 m0, s40, 101376
    s_add_u32 s32, s38, 1024
    buffer_load_dwordx4 v8, s[20:23], s32 offen lds
    s_waitcnt lgkmcnt(0)
    s_waitcnt vmcnt(24)
    s_barrier
    v_mfma_f32_32x32x16_bf16 v[32:47], a[20:23], a[36:39], v[32:47]
    ds_read_b128 a[16:19], v9 offset:0
    ds_read_b64_tr_b16 a[0:1], v21 offset:0
    ds_read_b64_tr_b16 a[2:3], v21 offset:1024
    v_mfma_f32_32x32x16_bf16 v[48:63], a[24:27], a[36:39], v[48:63]
    ds_read_b64_tr_b16 a[4:5], v21 offset:256
    ds_read_b64_tr_b16 a[6:7], v21 offset:1280
    ds_read_b64_tr_b16 a[8:9], v21 offset:512
    s_add_u32 m0, s39, 131072
    s_add_u32 s32, s37, 311296
    buffer_load_dwordx4 v1, s[8:11], s32 offen sc1 lds
    v_mfma_f32_32x32x16_bf16 v[64:79], a[28:31], a[36:39], v[64:79]
    ds_read_b64_tr_b16 a[10:11], v21 offset:1536
    ds_read_b64_tr_b16 a[12:13], v21 offset:768
    ds_read_b64_tr_b16 a[14:15], v21 offset:1792
    v_mfma_f32_32x32x16_bf16 v[80:95], a[32:35], a[36:39], v[80:95]
    s_add_u32 m0, s39, 132096
    s_add_u32 s32, s37, 312320
    buffer_load_dwordx4 v1, s[8:11], s32 offen sc1 lds
    s_waitcnt lgkmcnt(6)
    v_mfma_f32_32x32x16_bf16 v[32:47], a[0:3], a[16:19], v[32:47]
    ds_read_b128 a[36:39], v10 offset:0
    ds_read_b64_tr_b16 a[20:21], v21 offset:4096
    ds_read_b64_tr_b16 a[22:23], v21 offset:5120
    s_waitcnt lgkmcnt(7)
    v_mfma_f32_32x32x16_bf16 v[48:63], a[4:7], a[16:19], v[48:63]
    ds_read_b64_tr_b16 a[24:25], v21 offset:4352
    ds_read_b64_tr_b16 a[26:27], v21 offset:5376
    ds_read_b64_tr_b16 a[28:29], v21 offset:4608
    s_add_u32 m0, s39, 133120
    s_add_u32 s32, s37, 313344
    buffer_load_dwordx4 v1, s[8:11], s32 offen sc1 lds
    s_waitcnt lgkmcnt(8)
    v_mfma_f32_32x32x16_bf16 v[64:79], a[8:11], a[16:19], v[64:79]
    ds_read_b64_tr_b16 a[30:31], v21 offset:5632
    ds_read_b64_tr_b16 a[32:33], v21 offset:4864
    ds_read_b64_tr_b16 a[34:35], v21 offset:5888
    s_waitcnt lgkmcnt(9)
    v_mfma_f32_32x32x16_bf16 v[80:95], a[12:15], a[16:19], v[80:95]
    s_add_u32 m0, s39, 134144
    s_add_u32 s32, s37, 314368
    buffer_load_dwordx4 v1, s[8:11], s32 offen sc1 lds
    s_waitcnt lgkmcnt(6)
    v_mfma_f32_32x32x16_bf16 v[32:47], a[20:23], a[36:39], v[32:47]
    ds_read_b128 a[16:19], v11 offset:0
    ds_read_b64_tr_b16 a[0:1], v21 offset:8192
    ds_read_b64_tr_b16 a[2:3], v21 offset:9216
    s_waitcnt lgkmcnt(7)
    v_mfma_f32_32x32x16_bf16 v[48:63], a[24:27], a[36:39], v[48:63]
    ds_read_b64_tr_b16 a[4:5], v21 offset:8448
    ds_read_b64_tr_b16 a[6:7], v21 offset:9472
    ds_read_b64_tr_b16 a[8:9], v21 offset:8704
    s_add_u32 m0, s40, 131072
    s_add_u32 s32, s38, 1152
    buffer_load_dwordx4 v5, s[20:23], s32 offen lds
    s_waitcnt lgkmcnt(8)
    v_mfma_f32_32x32x16_bf16 v[64:79], a[28:31], a[36:39], v[64:79]
    ds_read_b64_tr_b16 a[10:11], v21 offset:9728
    ds_read_b64_tr_b16 a[12:13], v21 offset:8960
    ds_read_b64_tr_b16 a[14:15], v21 offset:9984
    s_waitcnt lgkmcnt(9)
    v_mfma_f32_32x32x16_bf16 v[80:95], a[32:35], a[36:39], v[80:95]
    s_add_u32 m0, s40, 132096
    s_add_u32 s32, s38, 1152
    buffer_load_dwordx4 v6, s[20:23], s32 offen lds
    s_waitcnt lgkmcnt(6)
    v_mfma_f32_32x32x16_bf16 v[32:47], a[0:3], a[16:19], v[32:47]
    ds_read_b128 a[36:39], v12 offset:0
    ds_read_b64_tr_b16 a[20:21], v21 offset:12288
    ds_read_b64_tr_b16 a[22:23], v21 offset:13312
    s_waitcnt lgkmcnt(7)
    v_mfma_f32_32x32x16_bf16 v[48:63], a[4:7], a[16:19], v[48:63]
    ds_read_b64_tr_b16 a[24:25], v21 offset:12544
    ds_read_b64_tr_b16 a[26:27], v21 offset:13568
    ds_read_b64_tr_b16 a[28:29], v21 offset:12800
    s_add_u32 m0, s40, 133120
    s_add_u32 s32, s38, 1152
    buffer_load_dwordx4 v7, s[20:23], s32 offen lds
    s_waitcnt lgkmcnt(8)
    v_mfma_f32_32x32x16_bf16 v[64:79], a[8:11], a[16:19], v[64:79]
    ds_read_b64_tr_b16 a[30:31], v21 offset:13824
    ds_read_b64_tr_b16 a[32:33], v21 offset:13056
    ds_read_b64_tr_b16 a[34:35], v21 offset:14080
    s_waitcnt lgkmcnt(9)
    v_mfma_f32_32x32x16_bf16 v[80:95], a[12:15], a[16:19], v[80:95]
    s_add_u32 m0, s40, 134144
    s_add_u32 s32, s38, 1152
    buffer_load_dwordx4 v8, s[20:23], s32 offen lds
    s_waitcnt lgkmcnt(0)
    s_waitcnt vmcnt(24)
    s_barrier
    v_mfma_f32_32x32x16_bf16 v[32:47], a[20:23], a[36:39], v[32:47]
    ds_read_b128 a[16:19], v9 offset:32768
    ds_read_b64_tr_b16 a[0:1], v21 offset:32768
    ds_read_b64_tr_b16 a[2:3], v21 offset:33792
    v_mfma_f32_32x32x16_bf16 v[48:63], a[24:27], a[36:39], v[48:63]
    ds_read_b64_tr_b16 a[4:5], v21 offset:33024
    ds_read_b64_tr_b16 a[6:7], v21 offset:34048
    ds_read_b64_tr_b16 a[8:9], v21 offset:33280
    v_mfma_f32_32x32x16_bf16 v[64:79], a[28:31], a[36:39], v[64:79]
    ds_read_b64_tr_b16 a[10:11], v21 offset:34304
    ds_read_b64_tr_b16 a[12:13], v21 offset:33536
    ds_read_b64_tr_b16 a[14:15], v21 offset:34560
    v_mfma_f32_32x32x16_bf16 v[80:95], a[32:35], a[36:39], v[80:95]
    s_waitcnt lgkmcnt(6)
    v_mfma_f32_32x32x16_bf16 v[32:47], a[0:3], a[16:19], v[32:47]
    ds_read_b128 a[36:39], v10 offset:32768
    ds_read_b64_tr_b16 a[20:21], v21 offset:36864
    ds_read_b64_tr_b16 a[22:23], v21 offset:37888
    s_waitcnt lgkmcnt(7)
    v_mfma_f32_32x32x16_bf16 v[48:63], a[4:7], a[16:19], v[48:63]
    ds_read_b64_tr_b16 a[24:25], v21 offset:37120
    ds_read_b64_tr_b16 a[26:27], v21 offset:38144
    ds_read_b64_tr_b16 a[28:29], v21 offset:37376
    s_waitcnt lgkmcnt(8)
    v_mfma_f32_32x32x16_bf16 v[64:79], a[8:11], a[16:19], v[64:79]
    ds_read_b64_tr_b16 a[30:31], v21 offset:38400
    ds_read_b64_tr_b16 a[32:33], v21 offset:37632
    ds_read_b64_tr_b16 a[34:35], v21 offset:38656
    s_waitcnt lgkmcnt(9)
    v_mfma_f32_32x32x16_bf16 v[80:95], a[12:15], a[16:19], v[80:95]
    s_waitcnt lgkmcnt(6)
    v_mfma_f32_32x32x16_bf16 v[32:47], a[20:23], a[36:39], v[32:47]
    ds_read_b128 a[16:19], v11 offset:32768
    ds_read_b64_tr_b16 a[0:1], v21 offset:40960
    ds_read_b64_tr_b16 a[2:3], v21 offset:41984
    s_waitcnt lgkmcnt(7)
    v_mfma_f32_32x32x16_bf16 v[48:63], a[24:27], a[36:39], v[48:63]
    ds_read_b64_tr_b16 a[4:5], v21 offset:41216
    ds_read_b64_tr_b16 a[6:7], v21 offset:42240
    ds_read_b64_tr_b16 a[8:9], v21 offset:41472
    s_waitcnt lgkmcnt(8)
    v_mfma_f32_32x32x16_bf16 v[64:79], a[28:31], a[36:39], v[64:79]
    ds_read_b64_tr_b16 a[10:11], v21 offset:42496
    ds_read_b64_tr_b16 a[12:13], v21 offset:41728
    ds_read_b64_tr_b16 a[14:15], v21 offset:42752
    s_waitcnt lgkmcnt(9)
    v_mfma_f32_32x32x16_bf16 v[80:95], a[32:35], a[36:39], v[80:95]
    s_waitcnt lgkmcnt(6)
    v_mfma_f32_32x32x16_bf16 v[32:47], a[0:3], a[16:19], v[32:47]
    ds_read_b128 a[36:39], v12 offset:32768
    ds_read_b64_tr_b16 a[20:21], v21 offset:45056
    ds_read_b64_tr_b16 a[22:23], v21 offset:46080
    s_waitcnt lgkmcnt(7)
    v_mfma_f32_32x32x16_bf16 v[48:63], a[4:7], a[16:19], v[48:63]
    ds_read_b64_tr_b16 a[24:25], v21 offset:45312
    ds_read_b64_tr_b16 a[26:27], v21 offset:46336
    ds_read_b64_tr_b16 a[28:29], v21 offset:45568
    s_waitcnt lgkmcnt(8)
    v_mfma_f32_32x32x16_bf16 v[64:79], a[8:11], a[16:19], v[64:79]
    ds_read_b64_tr_b16 a[30:31], v21 offset:46592
    ds_read_b64_tr_b16 a[32:33], v21 offset:45824
    ds_read_b64_tr_b16 a[34:35], v21 offset:46848
    s_waitcnt lgkmcnt(9)
    v_mfma_f32_32x32x16_bf16 v[80:95], a[12:15], a[16:19], v[80:95]
    s_waitcnt lgkmcnt(0)
    s_waitcnt vmcnt(16)
    s_barrier
    v_mfma_f32_32x32x16_bf16 v[32:47], a[20:23], a[36:39], v[32:47]
    ds_read_b128 a[16:19], v13 offset:0
    ds_read_b64_tr_b16 a[0:1], v22 offset:0
    ds_read_b64_tr_b16 a[2:3], v22 offset:1024
    v_mfma_f32_32x32x16_bf16 v[48:63], a[24:27], a[36:39], v[48:63]
    ds_read_b64_tr_b16 a[4:5], v22 offset:256
    ds_read_b64_tr_b16 a[6:7], v22 offset:1280
    ds_read_b64_tr_b16 a[8:9], v22 offset:512
    v_mfma_f32_32x32x16_bf16 v[64:79], a[28:31], a[36:39], v[64:79]
    ds_read_b64_tr_b16 a[10:11], v22 offset:1536
    ds_read_b64_tr_b16 a[12:13], v22 offset:768
    ds_read_b64_tr_b16 a[14:15], v22 offset:1792
    v_mfma_f32_32x32x16_bf16 v[80:95], a[32:35], a[36:39], v[80:95]
    s_waitcnt lgkmcnt(6)
    v_mfma_f32_32x32x16_bf16 v[32:47], a[0:3], a[16:19], v[32:47]
    ds_read_b128 a[36:39], v14 offset:0
    ds_read_b64_tr_b16 a[20:21], v22 offset:4096
    ds_read_b64_tr_b16 a[22:23], v22 offset:5120
    s_waitcnt lgkmcnt(7)
    v_mfma_f32_32x32x16_bf16 v[48:63], a[4:7], a[16:19], v[48:63]
    ds_read_b64_tr_b16 a[24:25], v22 offset:4352
    ds_read_b64_tr_b16 a[26:27], v22 offset:5376
    ds_read_b64_tr_b16 a[28:29], v22 offset:4608
    s_waitcnt lgkmcnt(8)
    v_mfma_f32_32x32x16_bf16 v[64:79], a[8:11], a[16:19], v[64:79]
    ds_read_b64_tr_b16 a[30:31], v22 offset:5632
    ds_read_b64_tr_b16 a[32:33], v22 offset:4864
    ds_read_b64_tr_b16 a[34:35], v22 offset:5888
    s_waitcnt lgkmcnt(9)
    v_mfma_f32_32x32x16_bf16 v[80:95], a[12:15], a[16:19], v[80:95]
    s_waitcnt lgkmcnt(6)
    v_mfma_f32_32x32x16_bf16 v[32:47], a[20:23], a[36:39], v[32:47]
    ds_read_b128 a[16:19], v15 offset:0
    ds_read_b64_tr_b16 a[0:1], v22 offset:8192
    ds_read_b64_tr_b16 a[2:3], v22 offset:9216
    s_waitcnt lgkmcnt(7)
    v_mfma_f32_32x32x16_bf16 v[48:63], a[24:27], a[36:39], v[48:63]
    ds_read_b64_tr_b16 a[4:5], v22 offset:8448
    ds_read_b64_tr_b16 a[6:7], v22 offset:9472
    ds_read_b64_tr_b16 a[8:9], v22 offset:8704
    s_waitcnt lgkmcnt(8)
    v_mfma_f32_32x32x16_bf16 v[64:79], a[28:31], a[36:39], v[64:79]
    ds_read_b64_tr_b16 a[10:11], v22 offset:9728
    ds_read_b64_tr_b16 a[12:13], v22 offset:8960
    ds_read_b64_tr_b16 a[14:15], v22 offset:9984
    s_waitcnt lgkmcnt(9)
    v_mfma_f32_32x32x16_bf16 v[80:95], a[32:35], a[36:39], v[80:95]
    s_waitcnt lgkmcnt(6)
    v_mfma_f32_32x32x16_bf16 v[32:47], a[0:3], a[16:19], v[32:47]
    ds_read_b128 a[36:39], v16 offset:0
    ds_read_b64_tr_b16 a[20:21], v22 offset:12288
    ds_read_b64_tr_b16 a[22:23], v22 offset:13312
    s_waitcnt lgkmcnt(7)
    v_mfma_f32_32x32x16_bf16 v[48:63], a[4:7], a[16:19], v[48:63]
    ds_read_b64_tr_b16 a[24:25], v22 offset:12544
    ds_read_b64_tr_b16 a[26:27], v22 offset:13568
    ds_read_b64_tr_b16 a[28:29], v22 offset:12800
    s_waitcnt lgkmcnt(8)
    v_mfma_f32_32x32x16_bf16 v[64:79], a[8:11], a[16:19], v[64:79]
    ds_read_b64_tr_b16 a[30:31], v22 offset:13824
    ds_read_b64_tr_b16 a[32:33], v22 offset:13056
    ds_read_b64_tr_b16 a[34:35], v22 offset:14080
    s_waitcnt lgkmcnt(9)
    v_mfma_f32_32x32x16_bf16 v[80:95], a[12:15], a[16:19], v[80:95]
    s_waitcnt lgkmcnt(0)
    s_waitcnt vmcnt(8)
    s_barrier
    v_mfma_f32_32x32x16_bf16 v[32:47], a[20:23], a[36:39], v[32:47]
    ds_read_b128 a[16:19], v13 offset:32768
    ds_read_b64_tr_b16 a[0:1], v22 offset:32768
    ds_read_b64_tr_b16 a[2:3], v22 offset:33792
    v_mfma_f32_32x32x16_bf16 v[48:63], a[24:27], a[36:39], v[48:63]
    ds_read_b64_tr_b16 a[4:5], v22 offset:33024
    ds_read_b64_tr_b16 a[6:7], v22 offset:34048
    ds_read_b64_tr_b16 a[8:9], v22 offset:33280
    v_mfma_f32_32x32x16_bf16 v[64:79], a[28:31], a[36:39], v[64:79]
    ds_read_b64_tr_b16 a[10:11], v22 offset:34304
    ds_read_b64_tr_b16 a[12:13], v22 offset:33536
    ds_read_b64_tr_b16 a[14:15], v22 offset:34560
    v_mfma_f32_32x32x16_bf16 v[80:95], a[32:35], a[36:39], v[80:95]
    s_waitcnt lgkmcnt(6)
    v_mfma_f32_32x32x16_bf16 v[32:47], a[0:3], a[16:19], v[32:47]
    ds_read_b128 a[36:39], v14 offset:32768
    ds_read_b64_tr_b16 a[20:21], v22 offset:36864
    ds_read_b64_tr_b16 a[22:23], v22 offset:37888
    s_waitcnt lgkmcnt(7)
    v_mfma_f32_32x32x16_bf16 v[48:63], a[4:7], a[16:19], v[48:63]
    ds_read_b64_tr_b16 a[24:25], v22 offset:37120
    ds_read_b64_tr_b16 a[26:27], v22 offset:38144
    ds_read_b64_tr_b16 a[28:29], v22 offset:37376
    s_waitcnt lgkmcnt(8)
    v_mfma_f32_32x32x16_bf16 v[64:79], a[8:11], a[16:19], v[64:79]
    ds_read_b64_tr_b16 a[30:31], v22 offset:38400
    ds_read_b64_tr_b16 a[32:33], v22 offset:37632
    ds_read_b64_tr_b16 a[34:35], v22 offset:38656
    s_waitcnt lgkmcnt(9)
    v_mfma_f32_32x32x16_bf16 v[80:95], a[12:15], a[16:19], v[80:95]
    s_waitcnt lgkmcnt(6)
    v_mfma_f32_32x32x16_bf16 v[32:47], a[20:23], a[36:39], v[32:47]
    ds_read_b128 a[16:19], v15 offset:32768
    ds_read_b64_tr_b16 a[0:1], v22 offset:40960
    ds_read_b64_tr_b16 a[2:3], v22 offset:41984
    s_waitcnt lgkmcnt(7)
    v_mfma_f32_32x32x16_bf16 v[48:63], a[24:27], a[36:39], v[48:63]
    ds_read_b64_tr_b16 a[4:5], v22 offset:41216
    ds_read_b64_tr_b16 a[6:7], v22 offset:42240
    ds_read_b64_tr_b16 a[8:9], v22 offset:41472
    s_waitcnt lgkmcnt(8)
    v_mfma_f32_32x32x16_bf16 v[64:79], a[28:31], a[36:39], v[64:79]
    ds_read_b64_tr_b16 a[10:11], v22 offset:42496
    ds_read_b64_tr_b16 a[12:13], v22 offset:41728
    ds_read_b64_tr_b16 a[14:15], v22 offset:42752
    s_waitcnt lgkmcnt(9)
    v_mfma_f32_32x32x16_bf16 v[80:95], a[32:35], a[36:39], v[80:95]
    s_waitcnt lgkmcnt(6)
    v_mfma_f32_32x32x16_bf16 v[32:47], a[0:3], a[16:19], v[32:47]
    ds_read_b128 a[36:39], v16 offset:32768
    ds_read_b64_tr_b16 a[20:21], v22 offset:45056
    ds_read_b64_tr_b16 a[22:23], v22 offset:46080
    s_waitcnt lgkmcnt(7)
    v_mfma_f32_32x32x16_bf16 v[48:63], a[4:7], a[16:19], v[48:63]
    ds_read_b64_tr_b16 a[24:25], v22 offset:45312
    ds_read_b64_tr_b16 a[26:27], v22 offset:46336
    ds_read_b64_tr_b16 a[28:29], v22 offset:45568
    s_waitcnt lgkmcnt(8)
    v_mfma_f32_32x32x16_bf16 v[64:79], a[8:11], a[16:19], v[64:79]
    ds_read_b64_tr_b16 a[30:31], v22 offset:46592
    ds_read_b64_tr_b16 a[32:33], v22 offset:45824
    ds_read_b64_tr_b16 a[34:35], v22 offset:46848
    s_waitcnt lgkmcnt(9)
    v_mfma_f32_32x32x16_bf16 v[80:95], a[12:15], a[16:19], v[80:95]
    s_waitcnt lgkmcnt(0)
    s_waitcnt vmcnt(0)
    s_barrier
    v_mfma_f32_32x32x16_bf16 v[32:47], a[20:23], a[36:39], v[32:47]
    ds_read_b128 a[16:19], v17 offset:0
    ds_read_b64_tr_b16 a[0:1], v23 offset:0
    ds_read_b64_tr_b16 a[2:3], v23 offset:1024
    v_mfma_f32_32x32x16_bf16 v[48:63], a[24:27], a[36:39], v[48:63]
    ds_read_b64_tr_b16 a[4:5], v23 offset:256
    ds_read_b64_tr_b16 a[6:7], v23 offset:1280
    ds_read_b64_tr_b16 a[8:9], v23 offset:512
    v_mfma_f32_32x32x16_bf16 v[64:79], a[28:31], a[36:39], v[64:79]
    ds_read_b64_tr_b16 a[10:11], v23 offset:1536
    ds_read_b64_tr_b16 a[12:13], v23 offset:768
    ds_read_b64_tr_b16 a[14:15], v23 offset:1792
    v_mfma_f32_32x32x16_bf16 v[80:95], a[32:35], a[36:39], v[80:95]
    s_waitcnt lgkmcnt(6)
    v_mfma_f32_32x32x16_bf16 v[32:47], a[0:3], a[16:19], v[32:47]
    ds_read_b128 a[36:39], v18 offset:0
    ds_read_b64_tr_b16 a[20:21], v23 offset:4096
    ds_read_b64_tr_b16 a[22:23], v23 offset:5120
    s_waitcnt lgkmcnt(7)
    v_mfma_f32_32x32x16_bf16 v[48:63], a[4:7], a[16:19], v[48:63]
    ds_read_b64_tr_b16 a[24:25], v23 offset:4352
    ds_read_b64_tr_b16 a[26:27], v23 offset:5376
    ds_read_b64_tr_b16 a[28:29], v23 offset:4608
    s_waitcnt lgkmcnt(8)
    v_mfma_f32_32x32x16_bf16 v[64:79], a[8:11], a[16:19], v[64:79]
    ds_read_b64_tr_b16 a[30:31], v23 offset:5632
    ds_read_b64_tr_b16 a[32:33], v23 offset:4864
    ds_read_b64_tr_b16 a[34:35], v23 offset:5888
    s_waitcnt lgkmcnt(9)
    v_mfma_f32_32x32x16_bf16 v[80:95], a[12:15], a[16:19], v[80:95]
    s_waitcnt lgkmcnt(6)
    v_mfma_f32_32x32x16_bf16 v[32:47], a[20:23], a[36:39], v[32:47]
    ds_read_b128 a[16:19], v19 offset:0
    ds_read_b64_tr_b16 a[0:1], v23 offset:8192
    ds_read_b64_tr_b16 a[2:3], v23 offset:9216
    s_waitcnt lgkmcnt(7)
    v_mfma_f32_32x32x16_bf16 v[48:63], a[24:27], a[36:39], v[48:63]
    ds_read_b64_tr_b16 a[4:5], v23 offset:8448
    ds_read_b64_tr_b16 a[6:7], v23 offset:9472
    ds_read_b64_tr_b16 a[8:9], v23 offset:8704
    s_waitcnt lgkmcnt(8)
    v_mfma_f32_32x32x16_bf16 v[64:79], a[28:31], a[36:39], v[64:79]
    ds_read_b64_tr_b16 a[10:11], v23 offset:9728
    ds_read_b64_tr_b16 a[12:13], v23 offset:8960
    ds_read_b64_tr_b16 a[14:15], v23 offset:9984
    s_waitcnt lgkmcnt(9)
    v_mfma_f32_32x32x16_bf16 v[80:95], a[32:35], a[36:39], v[80:95]
    s_waitcnt lgkmcnt(6)
    v_mfma_f32_32x32x16_bf16 v[32:47], a[0:3], a[16:19], v[32:47]
    ds_read_b128 a[36:39], v20 offset:0
    ds_read_b64_tr_b16 a[20:21], v23 offset:12288
    ds_read_b64_tr_b16 a[22:23], v23 offset:13312
    s_waitcnt lgkmcnt(7)
    v_mfma_f32_32x32x16_bf16 v[48:63], a[4:7], a[16:19], v[48:63]
    ds_read_b64_tr_b16 a[24:25], v23 offset:12544
    ds_read_b64_tr_b16 a[26:27], v23 offset:13568
    ds_read_b64_tr_b16 a[28:29], v23 offset:12800
    s_waitcnt lgkmcnt(8)
    v_mfma_f32_32x32x16_bf16 v[64:79], a[8:11], a[16:19], v[64:79]
    ds_read_b64_tr_b16 a[30:31], v23 offset:13824
    ds_read_b64_tr_b16 a[32:33], v23 offset:13056
    ds_read_b64_tr_b16 a[34:35], v23 offset:14080
    s_waitcnt lgkmcnt(9)
    v_mfma_f32_32x32x16_bf16 v[80:95], a[12:15], a[16:19], v[80:95]
    s_waitcnt lgkmcnt(6)
    v_mfma_f32_32x32x16_bf16 v[32:47], a[20:23], a[36:39], v[32:47]
    s_waitcnt lgkmcnt(4)
    v_mfma_f32_32x32x16_bf16 v[48:63], a[24:27], a[36:39], v[48:63]
    s_waitcnt lgkmcnt(2)
    v_mfma_f32_32x32x16_bf16 v[64:79], a[28:31], a[36:39], v[64:79]
    s_waitcnt lgkmcnt(0)
    v_mfma_f32_32x32x16_bf16 v[80:95], a[32:35], a[36:39], v[80:95]
    v_and_b32 v26, 31, v0
    v_lshlrev_b32 v26, 2, v26
    v_lshrrev_b32 v27, 5, v0
    v_mul_u32_u24 v27, 20480, v27
    v_add_u32 v26, v26, v27
    s_mul_i32 s37, s35, 655360
    s_lshl_b32 s32, s41, 2
    s_add_u32 s37, s37, s32
    s_add_u32 s37, s37, 2560
    s_add_u32 s32, s37, 0
    buffer_store_dword v32, v26, s[48:51], s32 offen
    s_add_u32 s32, s37, 5120
    buffer_store_dword v33, v26, s[48:51], s32 offen
    s_add_u32 s32, s37, 10240
    buffer_store_dword v34, v26, s[48:51], s32 offen
    s_add_u32 s32, s37, 15360
    buffer_store_dword v35, v26, s[48:51], s32 offen
    s_add_u32 s32, s37, 40960
    buffer_store_dword v36, v26, s[48:51], s32 offen
    s_add_u32 s32, s37, 46080
    buffer_store_dword v37, v26, s[48:51], s32 offen
    s_add_u32 s32, s37, 51200
    buffer_store_dword v38, v26, s[48:51], s32 offen
    s_add_u32 s32, s37, 56320
    buffer_store_dword v39, v26, s[48:51], s32 offen
    s_add_u32 s32, s37, 81920
    buffer_store_dword v40, v26, s[48:51], s32 offen
    s_add_u32 s32, s37, 87040
    buffer_store_dword v41, v26, s[48:51], s32 offen
    s_add_u32 s32, s37, 92160
    buffer_store_dword v42, v26, s[48:51], s32 offen
    s_add_u32 s32, s37, 97280
    buffer_store_dword v43, v26, s[48:51], s32 offen
    s_add_u32 s32, s37, 122880
    buffer_store_dword v44, v26, s[48:51], s32 offen
    s_add_u32 s32, s37, 128000
    buffer_store_dword v45, v26, s[48:51], s32 offen
    s_add_u32 s32, s37, 133120
    buffer_store_dword v46, v26, s[48:51], s32 offen
    s_add_u32 s32, s37, 138240
    buffer_store_dword v47, v26, s[48:51], s32 offen
    s_add_u32 s32, s37, 163840
    buffer_store_dword v48, v26, s[48:51], s32 offen
    s_add_u32 s32, s37, 168960
    buffer_store_dword v49, v26, s[48:51], s32 offen
    s_add_u32 s32, s37, 174080
    buffer_store_dword v50, v26, s[48:51], s32 offen
    s_add_u32 s32, s37, 179200
    buffer_store_dword v51, v26, s[48:51], s32 offen
    s_add_u32 s32, s37, 204800
    buffer_store_dword v52, v26, s[48:51], s32 offen
    s_add_u32 s32, s37, 209920
    buffer_store_dword v53, v26, s[48:51], s32 offen
    s_add_u32 s32, s37, 215040
    buffer_store_dword v54, v26, s[48:51], s32 offen
    s_add_u32 s32, s37, 220160
    buffer_store_dword v55, v26, s[48:51], s32 offen
    s_add_u32 s32, s37, 245760
    buffer_store_dword v56, v26, s[48:51], s32 offen
    s_add_u32 s32, s37, 250880
    buffer_store_dword v57, v26, s[48:51], s32 offen
    s_add_u32 s32, s37, 256000
    buffer_store_dword v58, v26, s[48:51], s32 offen
    s_add_u32 s32, s37, 261120
    buffer_store_dword v59, v26, s[48:51], s32 offen
    s_add_u32 s32, s37, 286720
    buffer_store_dword v60, v26, s[48:51], s32 offen
    s_add_u32 s32, s37, 291840
    buffer_store_dword v61, v26, s[48:51], s32 offen
    s_add_u32 s32, s37, 296960
    buffer_store_dword v62, v26, s[48:51], s32 offen
    s_add_u32 s32, s37, 302080
    buffer_store_dword v63, v26, s[48:51], s32 offen
    s_add_u32 s32, s37, 327680
    buffer_store_dword v64, v26, s[48:51], s32 offen
    s_add_u32 s32, s37, 332800
    buffer_store_dword v65, v26, s[48:51], s32 offen
    s_add_u32 s32, s37, 337920
    buffer_store_dword v66, v26, s[48:51], s32 offen
    s_add_u32 s32, s37, 343040
    buffer_store_dword v67, v26, s[48:51], s32 offen
    s_add_u32 s32, s37, 368640
    buffer_store_dword v68, v26, s[48:51], s32 offen
    s_add_u32 s32, s37, 373760
    buffer_store_dword v69, v26, s[48:51], s32 offen
    s_add_u32 s32, s37, 378880
    buffer_store_dword v70, v26, s[48:51], s32 offen
    s_add_u32 s32, s37, 384000
    buffer_store_dword v71, v26, s[48:51], s32 offen
    s_add_u32 s32, s37, 409600
    buffer_store_dword v72, v26, s[48:51], s32 offen
    s_add_u32 s32, s37, 414720
    buffer_store_dword v73, v26, s[48:51], s32 offen
    s_add_u32 s32, s37, 419840
    buffer_store_dword v74, v26, s[48:51], s32 offen
    s_add_u32 s32, s37, 424960
    buffer_store_dword v75, v26, s[48:51], s32 offen
    s_add_u32 s32, s37, 450560
    buffer_store_dword v76, v26, s[48:51], s32 offen
    s_add_u32 s32, s37, 455680
    buffer_store_dword v77, v26, s[48:51], s32 offen
    s_add_u32 s32, s37, 460800
    buffer_store_dword v78, v26, s[48:51], s32 offen
    s_add_u32 s32, s37, 465920
    buffer_store_dword v79, v26, s[48:51], s32 offen
    s_add_u32 s32, s37, 491520
    buffer_store_dword v80, v26, s[48:51], s32 offen
    s_add_u32 s32, s37, 496640
    buffer_store_dword v81, v26, s[48:51], s32 offen
    s_add_u32 s32, s37, 501760
    buffer_store_dword v82, v26, s[48:51], s32 offen
    s_add_u32 s32, s37, 506880
    buffer_store_dword v83, v26, s[48:51], s32 offen
    s_add_u32 s32, s37, 532480
    buffer_store_dword v84, v26, s[48:51], s32 offen
    s_add_u32 s32, s37, 537600
    buffer_store_dword v85, v26, s[48:51], s32 offen
    s_add_u32 s32, s37, 542720
    buffer_store_dword v86, v26, s[48:51], s32 offen
    s_add_u32 s32, s37, 547840
    buffer_store_dword v87, v26, s[48:51], s32 offen
    s_add_u32 s32, s37, 573440
    buffer_store_dword v88, v26, s[48:51], s32 offen
    s_add_u32 s32, s37, 578560
    buffer_store_dword v89, v26, s[48:51], s32 offen
    s_add_u32 s32, s37, 583680
    buffer_store_dword v90, v26, s[48:51], s32 offen
    s_add_u32 s32, s37, 588800
    buffer_store_dword v91, v26, s[48:51], s32 offen
    s_add_u32 s32, s37, 614400
    buffer_store_dword v92, v26, s[48:51], s32 offen
    s_add_u32 s32, s37, 619520
    buffer_store_dword v93, v26, s[48:51], s32 offen
    s_add_u32 s32, s37, 624640
    buffer_store_dword v94, v26, s[48:51], s32 offen
    s_add_u32 s32, s37, 629760
    buffer_store_dword v95, v26, s[48:51], s32 offen
L_post:
    s_and_b32 s32, s43, 31
    s_mul_i32 s32, s32, 6
    s_lshr_b32 s33, s43, 5
    s_add_u32 s45, s32, s33
    s_load_dwordx2 s[82:83], s[0:1], 128
    v_lshlrev_b32 v1, 4, v0
    v_lshrrev_b32 v27, 4, v0
    v_and_b32 v26, 15, v0
    v_mul_u32_u24 v2, 10240, v27
    v_lshl_add_u32 v2, v26, 4, v2
    v_mul_u32_u24 v3, 5120, v26
    v_lshl_add_u32 v3, v27, 4, v3
    v_mov_b32 v4, v0
    s_mul_i32 s32, s28, 10240
    v_add_u32 v5, s32, v1
    s_waitcnt lgkmcnt(0)
    s_barrier
    s_mov_b32 s48, s82
    s_mov_b32 s49, s83
    s_mov_b32 s50, 0xa00000
    s_mov_b32 s51, 0x20000
ptop_26:
    s_cmp_lg_u32 s28, 0
    s_cbranch_scc1 nq_28
    v_mov_b32 v6, 1
    v_mov_b32 v7, 0
    s_mov_b64 exec, 1
    buffer_atomic_add v6, off, s[12:15], 0 offset:60 sc0 sc1
    s_waitcnt vmcnt(0)
    ds_write_b32 v7, v6 offset:49152
    s_waitcnt lgkmcnt(0)
    s_mov_b64 exec, -1
nq_28:
    s_barrier
    v_mov_b32 v7, 0
    ds_read_b32 v6, v7 offset:49152
    s_waitcnt lgkmcnt(0)
    v_readfirstlane_b32 s41, v6
    s_nop 0
    s_cmp_ge_u32 s41, 512
    s_cbranch_scc1 pend_27
    s_lshr_b32 s35, s41, 3
    s_and_b32 s36, s41, 7
    s_mul_i32 s36, s36, 5
    s_mul_i32 s37, s35, 1310720
    s_lshr_b32 s32, s28, 1
    s_mul_i32 s32, s32, 655360
    s_add_u32 s37, s37, s32
    s_and_b32 s32, s28, 1
    s_lshl_b32 s32, s32, 13
    s_add_u32 s37, s37, s32
    s_lshl_b32 s32, s36, 14
    s_add_u32 s37, s37, s32
    s_add_u32 s37, s37, 50331648
    s_lshr_b32 s32, s35, 2
    s_cmp_eq_u32 s32, 0
    s_cselect_b32 s34, 2, 1
    s_mul_i32 s34, s34, 0x1010
    s_and_b32 s33, s32, 1
    s_lshl_b32 s33, s33, 4
    s_lshl_b32 s34, s34, s33
    s_lshr_b32 s32, s32, 1
    s_lshl_b32 s32, s32, 2
    s_add_u32 s32, s32, 200
wb_29:
    buffer_load_dword v6, off, s[12:15], s32 sc1
    s_waitcnt vmcnt(0)
    v_readfirstlane_b32 s33, v6
    s_nop 0
    s_and_b32 s33, s33, s34
    s_cmp_eq_u32 s33, s34
    s_cbranch_scc1 wbd_30
    s_sleep 8
    s_sub_u32 s44, s44, 1
    s_cbranch_scc0 wb_29
    s_mov_b32 s44, 0
wbd_30:
    s_add_u32 s32, s37, 0
    buffer_load_dwordx4 a[0:3], v1, s[8:11], s32 offen offset:0 sc1
    buffer_load_dwordx4 a[4:7], v1, s[8:11], s32 offen offset:1024 sc1
    buffer_load_dwordx4 a[8:11], v1, s[8:11], s32 offen offset:2048 sc1
    buffer_load_dwordx4 a[12:15], v1, s[8:11], s32 offen offset:3072 sc1
    s_add_u32 s32, s37, 4096
    buffer_load_dwordx4 a[16:19], v1, s[8:11], s32 offen offset:0 sc1
    buffer_load_dwordx4 a[20:23], v1, s[8:11], s32 offen offset:1024 sc1
    buffer_load_dwordx4 a[24:27], v1, s[8:11], s32 offen offset:2048 sc1
    buffer_load_dwordx4 a[28:31], v1, s[8:11], s32 offen offset:3072 sc1
    s_add_u32 s32, s37, 16384
    buffer_load_dwordx4 a[40:43], v1, s[8:11], s32 offen offset:0 sc1
    buffer_load_dwordx4 a[44:47], v1, s[8:11], s32 offen offset:1024 sc1
    buffer_load_dwordx4 a[48:51], v1, s[8:11], s32 offen offset:2048 sc1
    buffer_load_dwordx4 a[52:55], v1, s[8:11], s32 offen offset:3072 sc1
    s_add_u32 s32, s37, 20480
    buffer_load_dwordx4 a[56:59], v1, s[8:11], s32 offen offset:0 sc1
    buffer_load_dwordx4 a[60:63], v1, s[8:11], s32 offen offset:1024 sc1
    buffer_load_dwordx4 a[64:67], v1, s[8:11], s32 offen offset:2048 sc1
    buffer_load_dwordx4 a[68:71], v1, s[8:11], s32 offen offset:3072 sc1
    s_add_u32 s32, s37, 32768
    buffer_load_dwordx4 a[80:83], v1, s[8:11], s32 offen offset:0 sc1
    buffer_load_dwordx4 a[84:87], v1, s[8:11], s32 offen offset:1024 sc1
    buffer_load_dwordx4 a[88:91], v1, s[8:11], s32 offen offset:2048 sc1
    buffer_load_dwordx4 a[92:95], v1, s[8:11], s32 offen offset:3072 sc1
    s_add_u32 s32, s37, 36864
    buffer_load_dwordx4 a[96:99], v1, s[8:11], s32 offen offset:0 sc1
    buffer_load_dwordx4 a[100:103], v1, s[8:11], s32 offen offset:1024 sc1
    buffer_load_dwordx4 a[104:107], v1, s[8:11], s32 offen offset:2048 sc1
    buffer_load_dwordx4 a[108:111], v1, s[8:11], s32 offen offset:3072 sc1
    s_add_u32 s32, s37, 49152
    buffer_load_dwordx4 a[120:123], v1, s[8:11], s32 offen offset:0 sc1
    buffer_load_dwordx4 a[124:127], v1, s[8:11], s32 offen offset:1024 sc1
    buffer_load_dwordx4 a[128:131], v1, s[8:11], s32 offen offset:2048 sc1
    buffer_load_dwordx4 a[132:135], v1, s[8:11], s32 offen offset:3072 sc1
    s_add_u32 s32, s37, 53248
    buffer_load_dwordx4 a[136:139], v1, s[8:11], s32 offen offset:0 sc1
    buffer_load_dwordx4 a[140:143], v1, s[8:11], s32 offen offset:1024 sc1
    buffer_load_dwordx4 a[144:147], v1, s[8:11], s32 offen offset:2048 sc1
    buffer_load_dwordx4 a[148:151], v1, s[8:11], s32 offen offset:3072 sc1
    s_add_u32 s32, s37, 65536
    buffer_load_dwordx4 a[160:163], v1, s[8:11], s32 offen offset:0 sc1
    buffer_load_dwordx4 a[164:167], v1, s[8:11], s32 offen offset:1024 sc1
    buffer_load_dwordx4 a[168:171], v1, s[8:11], s32 offen offset:2048 sc1
    buffer_load_dwordx4 a[172:175], v1, s[8:11], s32 offen offset:3072 sc1
    s_add_u32 s32, s37, 69632
    buffer_load_dwordx4 a[176:179], v1, s[8:11], s32 offen offset:0 sc1
    buffer_load_dwordx4 a[180:183], v1, s[8:11], s32 offen offset:1024 sc1
    buffer_load_dwordx4 a[184:187], v1, s[8:11], s32 offen offset:2048 sc1
    buffer_load_dwordx4 a[188:191], v1, s[8:11], s32 offen offset:3072 sc1
pw_31:
    buffer_load_dwordx2 v[6:7], off, s[12:15], 0 offset:192 sc1
    s_waitcnt vmcnt(0)
    v_and_b32 v7, 64, v7
    v_max_u32 v6, v6, v7
    v_cmp_ge_u32 vcc, s35, v6
    s_cbranch_vccz pwd_32
    s_sleep 3
    s_sub_u32 s44, s44, 1
    s_cbranch_scc0 pw_31
    s_mov_b32 s44, 0
pwd_32:
    s_mul_i32 s38, s35, 65536
    s_lshl_b32 s32, s28, 14
    s_add_u32 s38, s38, s32
    s_add_u32 s38, s38, 162529280
    s_add_u32 s32, s38, 0
    buffer_load_dwordx4 v[8:11], v1, s[8:11], s32 offen offset:0 sc1
    buffer_load_dwordx4 v[12:15], v1, s[8:11], s32 offen offset:1024 sc1
    buffer_load_dwordx4 v[16:19], v1, s[8:11], s32 offen offset:2048 sc1
    buffer_load_dwordx4 v[20:23], v1, s[8:11], s32 offen offset:3072 sc1
    s_add_u32 s32, s38, 4096
    buffer_load_dwordx4 v[24:27], v1, s[8:11], s32 offen offset:0 sc1
    buffer_load_dwordx4 v[28:31], v1, s[8:11], s32 offen offset:1024 sc1
    buffer_load_dwordx4 v[32:35], v1, s[8:11], s32 offen offset:2048 sc1
    buffer_load_dwordx4 v[36:39], v1, s[8:11], s32 offen offset:3072 sc1
    s_add_u32 s32, s38, 8192
    buffer_load_dwordx4 v[40:43], v1, s[8:11], s32 offen offset:0 sc1
    buffer_load_dwordx4 v[44:47], v1, s[8:11], s32 offen offset:1024 sc1
    buffer_load_dwordx4 v[48:51], v1, s[8:11], s32 offen offset:2048 sc1
    buffer_load_dwordx4 v[52:55], v1, s[8:11], s32 offen offset:3072 sc1
    s_add_u32 s32, s38, 12288
    buffer_load_dwordx4 v[56:59], v1, s[8:11], s32 offen offset:0 sc1
    buffer_load_dwordx4 v[60:63], v1, s[8:11], s32 offen offset:1024 sc1
    buffer_load_dwordx4 v[64:67], v1, s[8:11], s32 offen offset:2048 sc1
    buffer_load_dwordx4 v[68:71], v1, s[8:11], s32 offen offset:3072 sc1
    s_mul_i32 s38, s35, 16384
    s_lshl_b32 s32, s28, 12
    s_add_u32 s38, s38, s32
    s_add_u32 s38, s38, 166723584
    buffer_load_dwordx4 v[72:75], v1, s[8:11], s38 offen offset:0 sc1
    buffer_load_dwordx4 v[76:79], v1, s[8:11], s38 offen offset:1024 sc1
    buffer_load_dwordx4 v[80:83], v1, s[8:11], s38 offen offset:2048 sc1
    buffer_load_dwordx4 v[84:87], v1, s[8:11], s38 offen offset:3072 sc1
    s_mul_i32 s39, s35, 327680
    s_mul_i32 s32, s28, 81920
    s_add_u32 s39, s39, s32
    s_add_u32 s39, s39, 134217728
    s_add_u32 s33, s36, 0
    s_and_b32 s32, s33, 3
    s_mul_i32 s32, s32, 2560
    s_lshr_b32 s33, s33, 2
    s_lshl_b32 s33, s33, 8
    s_add_u32 s32, s32, s33
    s_add_u32 s32, s32, s39
    buffer_load_dwordx4 a[32:35], v2, s[8:11], s32 offen sc1
    s_add_u32 s32, s32, 40960
    buffer_load_dwordx4 a[36:39], v2, s[8:11], s32 offen sc1
    s_add_u32 s33, s36, 1
    s_and_b32 s32, s33, 3
    s_mul_i32 s32, s32, 2560
    s_lshr_b32 s33, s33, 2
    s_lshl_b32 s33, s33, 8
    s_add_u32 s32, s32, s33
    s_add_u32 s32, s32, s39
    buffer_load_dwordx4 a[72:75], v2, s[8:11], s32 offen sc1
    s_add_u32 s32, s32, 40960
    buffer_load_dwordx4 a[76:79], v2, s[8:11], s32 offen sc1
    s_add_u32 s33, s36, 2
    s_and_b32 s32, s33, 3
    s_mul_i32 s32, s32, 2560
    s_lshr_b32 s33, s33, 2
    s_lshl_b32 s33, s33, 8
    s_add_u32 s32, s32, s33
    s_add_u32 s32, s32, s39
    buffer_load_dwordx4 a[112:115], v2, s[8:11], s32 offen sc1
    s_add_u32 s32, s32, 40960
    buffer_load_dwordx4 a[116:119], v2, s[8:11], s32 offen sc1
    s_add_u32 s33, s36, 3
    s_and_b32 s32, s33, 3
    s_mul_i32 s32, s32, 2560
    s_lshr_b32 s33, s33, 2
    s_lshl_b32 s33, s33, 8
    s_add_u32 s32, s32, s33
    s_add_u32 s32, s32, s39
    buffer_load_dwordx4 a[152:155], v2, s[8:11], s32 offen sc1
    s_add_u32 s32, s32, 40960
    buffer_load_dwordx4 a[156:159], v2, s[8:11], s32 offen sc1
    s_add_u32 s33, s36, 4
    s_and_b32 s32, s33, 3
    s_mul_i32 s32, s32, 2560
    s_lshr_b32 s33, s33, 2
    s_lshl_b32 s33, s33, 8
    s_add_u32 s32, s32, s33
    s_add_u32 s32, s32, s39
    buffer_load_dwordx4 a[192:195], v2, s[8:11], s32 offen sc1
    s_add_u32 s32, s32, 40960
    buffer_load_dwordx4 a[196:199], v2, s[8:11], s32 offen sc1
    s_waitcnt vmcnt(28)
    v_mfma_f32_16x16x32_bf16 v[88:91], a[0:3], v[8:11], 0
    v_mfma_f32_16x16x32_bf16 v[92:95], a[0:3], v[12:15], 0
    v_mfma_f32_16x16x32_bf16 v[96:99], a[40:43], v[8:11], 0
    v_mfma_f32_16x16x32_bf16 v[100:103], a[40:43], v[12:15], 0
    v_mfma_f32_16x16x32_bf16 v[104:107], a[80:83], v[8:11], 0
    v_mfma_f32_16x16x32_bf16 v[108:111], a[80:83], v[12:15], 0
    v_mfma_f32_16x16x32_bf16 v[112:115], a[120:123], v[8:11], 0
    v_mfma_f32_16x16x32_bf16 v[116:119], a[120:123], v[12:15], 0
    v_mfma_f32_16x16x32_bf16 v[120:123], a[160:163], v[8:11], 0
    v_mfma_f32_16x16x32_bf16 v[124:127], a[160:163], v[12:15], 0
    s_waitcnt vmcnt(26)
    v_mfma_f32_16x16x32_bf16 v[88:91], a[4:7], v[16:19], v[88:91]
    v_mfma_f32_16x16x32_bf16 v[92:95], a[4:7], v[20:23], v[92:95]
    v_mfma_f32_16x16x32_bf16 v[96:99], a[44:47], v[16:19], v[96:99]
    v_mfma_f32_16x16x32_bf16 v[100:103], a[44:47], v[20:23], v[100:103]
    v_mfma_f32_16x16x32_bf16 v[104:107], a[84:87], v[16:19], v[104:107]
    v_mfma_f32_16x16x32_bf16 v[108:111], a[84:87], v[20:23], v[108:111]
    v_mfma_f32_16x16x32_bf16 v[112:115], a[124:127], v[16:19], v[112:115]
    v_mfma_f32_16x16x32_bf16 v[116:119], a[124:127], v[20:23], v[116:119]
    v_mfma_f32_16x16x32_bf16 v[120:123], a[164:167], v[16:19], v[120:123]
    v_mfma_f32_16x16x32_bf16 v[124:127], a[164:167], v[20:23], v[124:127]
    s_waitcnt vmcnt(24)
    v_mfma_f32_16x16x32_bf16 v[88:91], a[8:11], v[24:27], v[88:91]
    v_mfma_f32_16x16x32_bf16 v[92:95], a[8:11], v[28:31], v[92:95]
    v_mfma_f32_16x16x32_bf16 v[96:99], a[48:51], v[24:27], v[96:99]
    v_mfma_f32_16x16x32_bf16 v[100:103], a[48:51], v[28:31], v[100:103]
    v_mfma_f32_16x16x32_bf16 v[104:107], a[88:91], v[24:27], v[104:107]
    v_mfma_f32_16x16x32_bf16 v[108:111], a[88:91], v[28:31], v[108:111]
    v_mfma_f32_16x16x32_bf16 v[112:115], a[128:131], v[24:27], v[112:115]
    v_mfma_f32_16x16x32_bf16 v[116:119], a[128:131], v[28:31], v[116:119]
    v_mfma_f32_16x16x32_bf16 v[120:123], a[168:171], v[24:27], v[120:123]
    v_mfma_f32_16x16x32_bf16 v[124:127], a[168:171], v[28:31], v[124:127]
    s_waitcnt vmcnt(22)
    v_mfma_f32_16x16x32_bf16 v[88:91], a[12:15], v[32:35], v[88:91]
    v_mfma_f32_16x16x32_bf16 v[92:95], a[12:15], v[36:39], v[92:95]
    v_mfma_f32_16x16x32_bf16 v[96:99], a[52:55], v[32:35], v[96:99]
    v_mfma_f32_16x16x32_bf16 v[100:103], a[52:55], v[36:39], v[100:103]
    v_mfma_f32_16x16x32_bf16 v[104:107], a[92:95], v[32:35], v[104:107]
    v_mfma_f32_16x16x32_bf16 v[108:111], a[92:95], v[36:39], v[108:111]
    v_mfma_f32_16x16x32_bf16 v[112:115], a[132:135], v[32:35], v[112:115]
    v_mfma_f32_16x16x32_bf16 v[116:119], a[132:135], v[36:39], v[116:119]
    v_mfma_f32_16x16x32_bf16 v[120:123], a[172:175], v[32:35], v[120:123]
    v_mfma_f32_16x16x32_bf16 v[124:127], a[172:175], v[36:39], v[124:127]
    s_waitcnt vmcnt(20)
    v_mfma_f32_16x16x32_bf16 v[88:91], a[16:19], v[40:43], v[88:91]
    v_mfma_f32_16x16x32_bf16 v[92:95], a[16:19], v[44:47], v[92:95]
    v_mfma_f32_16x16x32_bf16 v[96:99], a[56:59], v[40:43], v[96:99]
    v_mfma_f32_16x16x32_bf16 v[100:103], a[56:59], v[44:47], v[100:103]
    v_mfma_f32_16x16x32_bf16 v[104:107], a[96:99], v[40:43], v[104:107]
    v_mfma_f32_16x16x32_bf16 v[108:111], a[96:99], v[44:47], v[108:111]
    v_mfma_f32_16x16x32_bf16 v[112:115], a[136:139], v[40:43], v[112:115]
    v_mfma_f32_16x16x32_bf16 v[116:119], a[136:139], v[44:47], v[116:119]
    v_mfma_f32_16x16x32_bf16 v[120:123], a[176:179], v[40:43], v[120:123]
    v_mfma_f32_16x16x32_bf16 v[124:127], a[176:179], v[44:47], v[124:127]
    s_waitcnt vmcnt(18)
    v_mfma_f32_16x16x32_bf16 v[88:91], a[20:23], v[48:51], v[88:91]
    v_mfma_f32_16x16x32_bf16 v[92:95], a[20:23], v[52:55], v[92:95]
    v_mfma_f32_16x16x32_bf16 v[96:99], a[60:63], v[48:51], v[96:99]
    v_mfma_f32_16x16x32_bf16 v[100:103], a[60:63], v[52:55], v[100:103]
    v_mfma_f32_16x16x32_bf16 v[104:107], a[100:103], v[48:51], v[104:107]
    v_mfma_f32_16x16x32_bf16 v[108:111], a[100:103], v[52:55], v[108:111]
    v_mfma_f32_16x16x32_bf16 v[112:115], a[140:143], v[48:51], v[112:115]
    v_mfma_f32_16x16x32_bf16 v[116:119], a[140:143], v[52:55], v[116:119]
    v_mfma_f32_16x16x32_bf16 v[120:123], a[180:183], v[48:51], v[120:123]
    v_mfma_f32_16x16x32_bf16 v[124:127], a[180:183], v[52:55], v[124:127]
    s_waitcnt vmcnt(16)
    v_mfma_f32_16x16x32_bf16 v[88:91], a[24:27], v[56:59], v[88:91]
    v_mfma_f32_16x16x32_bf16 v[92:95], a[24:27], v[60:63], v[92:95]
    v_mfma_f32_16x16x32_bf16 v[96:99], a[64:67], v[56:59], v[96:99]
    v_mfma_f32_16x16x32_bf16 v[100:103], a[64:67], v[60:63], v[100:103]
    v_mfma_f32_16x16x32_bf16 v[104:107], a[104:107], v[56:59], v[104:107]
    v_mfma_f32_16x16x32_bf16 v[108:111], a[104:107], v[60:63], v[108:111]
    v_mfma_f32_16x16x32_bf16 v[112:115], a[144:147], v[56:59], v[112:115]
    v_mfma_f32_16x16x32_bf16 v[116:119], a[144:147], v[60:63], v[116:119]
    v_mfma_f32_16x16x32_bf16 v[120:123], a[184:187], v[56:59], v[120:123]
    v_mfma_f32_16x16x32_bf16 v[124:127], a[184:187], v[60:63], v[124:127]
    s_waitcnt vmcnt(14)
    v_mfma_f32_16x16x32_bf16 v[88:91], a[28:31], v[64:67], v[88:91]
    v_mfma_f32_16x16x32_bf16 v[92:95], a[28:31], v[68:71], v[92:95]
    v_mfma_f32_16x16x32_bf16 v[96:99], a[68:71], v[64:67], v[96:99]
    v_mfma_f32_16x16x32_bf16 v[100:103], a[68:71], v[68:71], v[100:103]
    v_mfma_f32_16x16x32_bf16 v[104:107], a[108:111], v[64:67], v[104:107]
    v_mfma_f32_16x16x32_bf16 v[108:111], a[108:111], v[68:71], v[108:111]
    v_mfma_f32_16x16x32_bf16 v[112:115], a[148:151], v[64:67], v[112:115]
    v_mfma_f32_16x16x32_bf16 v[116:119], a[148:151], v[68:71], v[116:119]
    v_mfma_f32_16x16x32_bf16 v[120:123], a[188:191], v[64:67], v[120:123]
    v_mfma_f32_16x16x32_bf16 v[124:127], a[188:191], v[68:71], v[124:127]
    s_waitcnt vmcnt(0)
    v_mfma_f32_16x16x32_bf16 v[88:91], a[32:35], v[72:75], v[88:91]
    v_mfma_f32_16x16x32_bf16 v[92:95], a[32:35], v[76:79], v[92:95]
    v_mfma_f32_16x16x32_bf16 v[96:99], a[72:75], v[72:75], v[96:99]
    v_mfma_f32_16x16x32_bf16 v[100:103], a[72:75], v[76:79], v[100:103]
    v_mfma_f32_16x16x32_bf16 v[104:107], a[112:115], v[72:75], v[104:107]
    v_mfma_f32_16x16x32_bf16 v[108:111], a[112:115], v[76:79], v[108:111]
    v_mfma_f32_16x16x32_bf16 v[112:115], a[152:155], v[72:75], v[112:115]
    v_mfma_f32_16x16x32_bf16 v[116:119], a[152:155], v[76:79], v[116:119]
    v_mfma_f32_16x16x32_bf16 v[120:123], a[192:195], v[72:75], v[120:123]
    v_mfma_f32_16x16x32_bf16 v[124:127], a[192:195], v[76:79], v[124:127]
    s_waitcnt vmcnt(0)
    v_mfma_f32_16x16x32_bf16 v[88:91], a[36:39], v[80:83], v[88:91]
    v_mfma_f32_16x16x32_bf16 v[92:95], a[36:39], v[84:87], v[92:95]
    v_mfma_f32_16x16x32_bf16 v[96:99], a[76:79], v[80:83], v[96:99]
    v_mfma_f32_16x16x32_bf16 v[100:103], a[76:79], v[84:87], v[100:103]
    v_mfma_f32_16x16x32_bf16 v[104:107], a[116:119], v[80:83], v[104:107]
    v_mfma_f32_16x16x32_bf16 v[108:111], a[116:119], v[84:87], v[108:111]
    v_mfma_f32_16x16x32_bf16 v[112:115], a[156:159], v[80:83], v[112:115]
    v_mfma_f32_16x16x32_bf16 v[116:119], a[156:159], v[84:87], v[116:119]
    v_mfma_f32_16x16x32_bf16 v[120:123], a[196:199], v[80:83], v[120:123]
    v_mfma_f32_16x16x32_bf16 v[124:127], a[196:199], v[84:87], v[124:127]
    s_barrier
    ds_write_b128 v5, v[88:91] offset:0
    ds_write_b128 v5, v[92:95] offset:1024
    ds_write_b128 v5, v[96:99] offset:2048
    ds_write_b128 v5, v[100:103] offset:3072
    ds_write_b128 v5, v[104:107] offset:4096
    ds_write_b128 v5, v[108:111] offset:5120
    ds_write_b128 v5, v[112:115] offset:6144
    ds_write_b128 v5, v[116:119] offset:7168
    ds_write_b128 v5, v[120:123] offset:8192
    ds_write_b128 v5, v[124:127] offset:9216
    s_waitcnt lgkmcnt(0)
    s_barrier
    s_lshl_b32 s32, s28, 10
    v_add_u32 v6, s32, v1
    ds_read_b128 v[8:11], v6 offset:0
    ds_read_b128 v[12:15], v6 offset:10240
    ds_read_b128 v[16:19], v6 offset:20480
    ds_read_b128 v[20:23], v6 offset:30720
    ds_read_b128 v[24:27], v6 offset:4096
    ds_read_b128 v[28:31], v6 offset:14336
    ds_read_b128 v[32:35], v6 offset:24576
    ds_read_b128 v[36:39], v6 offset:34816
    ds_read_b128 v[40:43], v6 offset:8192
    ds_read_b128 v[44:47], v6 offset:18432
    ds_read_b128 v[48:51], v6 offset:28672
    ds_read_b128 v[52:55], v6 offset:38912
    s_lshl_b32 s37, s35, 5
    s_and_b32 s32, s28, 1
    s_lshl_b32 s32, s32, 4
    s_add_u32 s37, s37, s32
    s_mul_i32 s37, s37, 5120
    s_lshr_b32 s32, s28, 1
    s_add_u32 s32, s32, s36
    s_lshl_b32 s32, s32, 6
    s_add_u32 s37, s37, s32
    s_cmp_lt_u32 s28, 2
    s_cselect_b32 s38, s37, 0x40000000
    s_waitcnt lgkmcnt(0)
    v_add_f32 v8, v8, v12
    v_add_f32 v16, v16, v20
    v_add_f32 v9, v9, v13
    v_add_f32 v17, v17, v21
    v_add_f32 v10, v10, v14
    v_add_f32 v18, v18, v22
    v_add_f32 v11, v11, v15
    v_add_f32 v19, v19, v23
    v_add_f32 v8, v8, v16
    v_add_f32 v9, v9, v17
    v_add_f32 v10, v10, v18
    v_add_f32 v11, v11, v19
    buffer_store_dwordx4 v[8:11], v3, s[48:51], s37 offen offset:0
    v_add_f32 v24, v24, v28
    v_add_f32 v32, v32, v36
    v_add_f32 v25, v25, v29
    v_add_f32 v33, v33, v37
    v_add_f32 v26, v26, v30
    v_add_f32 v34, v34, v38
    v_add_f32 v27, v27, v31
    v_add_f32 v35, v35, v39
    v_add_f32 v24, v24, v32
    v_add_f32 v25, v25, v33
    v_add_f32 v26, v26, v34
    v_add_f32 v27, v27, v35
    buffer_store_dwordx4 v[24:27], v3, s[48:51], s37 offen offset:128
    v_add_f32 v40, v40, v44
    v_add_f32 v48, v48, v52
    v_add_f32 v41, v41, v45
    v_add_f32 v49, v49, v53
    v_add_f32 v42, v42, v46
    v_add_f32 v50, v50, v54
    v_add_f32 v43, v43, v47
    v_add_f32 v51, v51, v55
    v_add_f32 v40, v40, v48
    v_add_f32 v41, v41, v49
    v_add_f32 v42, v42, v50
    v_add_f32 v43, v43, v51
    buffer_store_dwordx4 v[40:43], v3, s[48:51], s38 offen offset:256
    s_waitcnt vmcnt(0)
    s_branch ptop_26
pend_27:
    s_endpgm
L_rec:
    s_load_dwordx2 s[4:5], s[0:1], 144
    s_load_dwordx2 s[6:7], s[0:1], 136
    s_load_dwordx2 s[56:57], s[0:1], 8
    s_load_dwordx8 s[60:67], s[0:1], 16
    v_lshrrev_b32 v1, 6, v0
    s_nop 0
    v_readfirstlane_b32 s28, v1
    s_and_b32 s29, s2, 7
    s_lshr_b32 s34, s2, 3
    s_and_b32 s30, s34, 15
    s_lshl_b32 s31, s29, 4
    s_add_u32 s31, s31, s30
    s_mov_b32 s32, 0
    s_mov_b32 s33, 0x10000
    s_mov_b32 s47, 0x3dd53b95
    s_getreg_b32 s48, hwreg(HW_REG_XCC_ID)
    s_and_b32 s48, s48, 7
    s_waitcnt lgkmcnt(0)
    s_mov_b32 s8, s4
    s_mov_b32 s9, s5
    s_mov_b32 s10, 0x10000000
    s_mov_b32 s11, 0x20000
    s_mov_b32 s12, s6
    s_mov_b32 s13, s7
    s_mov_b32 s14, 0x100
    s_mov_b32 s15, 0x20000
    s_mov_b32 s24, s56
    s_mov_b32 s25, s57
    s_mov_b32 s26, 0x2800
    s_mov_b32 s27, 0x20000
    v_mov_b32 v12, v0
    v_and_b32 v13, 63, v0
    v_and_b32 v14, 15, v13
    v_lshrrev_b32 v15, 4, v13
    v_bfe_u32 v16, v14, 1, 1
    v_mul_u32_u24 v17, 0x5555, v16
    v_add_u32 v1, 0x8888, v17
    v_lshlrev_b32 v2, 8, v15
    v_and_b32 v17, 3, v14
    v_lshl_add_u32 v2, v17, 6, v2
    v_lshrrev_b32 v17, 2, v14
    v_lshl_add_u32 v2, v17, 3, v2
    v_and_b32 v17, 1, v15
    v_lshl_add_u32 v2, v17, 5, v2
    v_xor_b32 v0, 32, v2
    v_lshlrev_b32 v4, 2, v12
    s_and_b32 s34, s28, 1
    s_lshl_b32 s34, s34, 5
    v_xor_b32 v4, s34, v4
    v_lshlrev_b32 v5, 4, v13
    s_mul_i32 s34, s28, 2560
    v_add_u32 v6, s34, v5
    v_lshl_add_u32 v3, v13, 3, s34
    s_lshr_b32 s34, s28, 1
    s_lshl_b32 s34, s34, 14
    s_and_b32 s35, s28, 1
    s_lshl_b32 s35, s35, 12
    s_add_u32 s34, s34, s35
    s_mul_i32 s35, s28, 2560
    s_sub_u32 s34, s34, s35
    s_add_u32 s34, s34, 203423744
    s_lshl_b32 s38, s29, 15
    s_xor_b32 s39, s38, 32768
    s_add_u32 s38, s38, s34
    s_add_u32 s39, s39, s34
    s_mul_i32 s34, s28, 20480
    s_add_u32 s34, s34, 26624
    v_add_u32 v7, s34, v5
    s_lshr_b32 s34, s2, 7
    s_cmp_lg_u32 s34, 0
    s_cbranch_scc1 role_vo_33
    s_mov_b32 s16, s60
    s_mov_b32 s17, s61
    s_mov_b32 s18, 0x780000
    s_mov_b32 s19, 0x20000
    s_mov_b32 s20, s62
    s_mov_b32 s21, s63
    s_mov_b32 s22, 0x780000
    s_mov_b32 s23, 0x20000
    v_add_u32 v8, 108544, v5
    s_lshl_b32 s34, s28, 8
    v_lshlrev_b32 v9, 4, v14
    v_lshl_add_u32 v9, v15, 2, v9
    v_add_u32 v9, s34, v9
    v_lshrrev_b32 v16, 2, v14
    v_lshl_add_u32 v16, v15, 3, v16
    v_and_b32 v17, 1, v14
    v_lshlrev_b32 v17, 3, v17
    v_lshl_add_u32 v10, v16, 4, v17
    v_cmp_gt_u32 vcc, 8, v14
    v_mov_b32 v16, 0x40000000
    s_nop 0
    v_cndmask_b32 v11, v16, v4, vcc
    s_cmp_eq_u32 s28, 0
    s_cbranch_scc1 v11_34
    v_lshlrev_b32 v17, 4, v14
    v_lshl_add_u32 v17, v15, 3, v17
    v_cmp_gt_u32 vcc, 2, v15
    s_nop 1
    v_cndmask_b32 v11, v16, v17, vcc
v11_34:
    s_mul_i32 s43, s29, 10240
    s_add_u32 s43, s43, 160432128
    s_lshr_b32 s34, s30, 1
    s_lshl_b32 s34, s34, 8
    s_add_u32 s44, s43, s34
    s_add_u32 s44, s44, 8192
    s_lshr_b32 s34, s30, 1
    s_xor_b32 s34, s34, s30
    s_and_b32 s34, s34, 1
    s_lshl_b32 s34, s34, 5
    s_add_u32 s44, s44, s34
    s_lshl_b32 s34, s30, 9
    s_add_u32 s43, s43, s34
    s_cmp_lg_u32 s28, 0
    s_cbranch_scc1 qkclr_35
    v_mov_b32 v16, -1
    s_add_u32 s34, s43, 0
    s_add_u32 s35, s44, 0
    buffer_store_dword v16, v4, s[8:11], s34 offen sc1
    buffer_store_dword v16, v4, s[8:11], s34 offen offset:256 sc1
    buffer_store_dword v16, v11, s[8:11], s35 offen sc1
    s_add_u32 s34, s43, 20480
    s_add_u32 s35, s44, 20480
    buffer_store_dword v16, v4, s[8:11], s34 offen sc1
    buffer_store_dword v16, v4, s[8:11], s34 offen offset:256 sc1
    buffer_store_dword v16, v11, s[8:11], s35 offen sc1
qkclr_35:
    v_add_u32 v20, 0, v13
    v_mul_u32_u24 v21, 0xaaab, v20
    v_lshrrev_b32 v21, 20, v21
    v_mul_u32_u24 v22, 24, v21
    v_sub_u32 v22, v20, v22
    v_mul_u32_u24 v21, 12288, v21
    v_lshl_add_u32 v16, v22, 4, v21
    v_add_u32 v20, 64, v13
    v_mul_u32_u24 v21, 0xaaab, v20
    v_lshrrev_b32 v21, 20, v21
    v_mul_u32_u24 v22, 24, v21
    v_sub_u32 v22, v20, v22
    v_mul_u32_u24 v21, 12288, v21
    v_lshl_add_u32 v17, v22, 4, v21
    v_add_u32 v20, 128, v13
    v_mul_u32_u24 v21, 0xaaab, v20
    v_lshrrev_b32 v21, 20, v21
    v_mul_u32_u24 v22, 24, v21
    v_sub_u32 v22, v20, v22
    v_mul_u32_u24 v21, 12288, v21
    v_lshl_add_u32 v18, v22, 4, v21
    s_mul_i32 s40, s28, 196608
    s_mul_i32 s34, s31, 384
    s_add_u32 s40, s40, s34
    v_lshrrev_b32 v21, 3, v13
    v_mul_u32_u24 v21, 1280, v21
    v_and_b32 v22, 7, v13
    v_lshl_add_u32 v19, v22, 4, v21
    s_mul_i32 s41, s28, 61440
    s_mul_i32 s34, s31, 245760
    s_add_u32 s41, s41, s34
    s_mul_i32 s42, s28, 6144
    v_lshrrev_b32 v21, 2, v14
    v_lshl_add_u32 v21, v15, 3, v21
    v_and_b32 v22, 3, v14
    v_lshlrev_b32 v22, 3, v22
    s_lshl_b32 s34, s28, 5
    v_add_u32 v22, s34, v22
    v_mul_u32_u24 v23, 384, v21
    v_add_u32 v23, v23, v22
    v_lshl_add_u32 v24, v21, 7, v22
    v_lshrrev_b32 v26, 6, v12
    v_lshl_add_u32 v26, v26, 4, v14
    v_lshlrev_b32 v26, 1, v26
    v_mul_u32_u24 v27, 2560, v15
    v_add_u32 v27, v26, v27
    buffer_load_ushort v32, v27, s[24:27], 0 offen offset:0
    buffer_load_ushort v33, v27, s[24:27], 0 offen offset:1280
    buffer_load_ushort v34, v27, s[24:27], 0 offen offset:128
    buffer_load_ushort v35, v27, s[24:27], 0 offen offset:1408
    buffer_load_ushort v36, v27, s[24:27], 0 offen offset:256
    buffer_load_ushort v37, v27, s[24:27], 0 offen offset:1536
    buffer_load_ushort v38, v27, s[24:27], 0 offen offset:384
    buffer_load_ushort v39, v27, s[24:27], 0 offen offset:1664
    buffer_load_ushort v40, v27, s[24:27], 0 offen offset:512
    buffer_load_ushort v41, v27, s[24:27], 0 offen offset:1792
    buffer_load_ushort v42, v27, s[24:27], 0 offen offset:640
    buffer_load_ushort v43, v27, s[24:27], 0 offen offset:1920
    buffer_load_ushort v44, v27, s[24:27], 0 offen offset:768
    buffer_load_ushort v45, v27, s[24:27], 0 offen offset:2048
    buffer_load_ushort v46, v27, s[24:27], 0 offen offset:896
    buffer_load_ushort v47, v27, s[24:27], 0 offen offset:2176
    buffer_load_ushort v48, v27, s[24:27], 0 offen offset:1024
    buffer_load_ushort v49, v27, s[24:27], 0 offen offset:2304
    buffer_load_ushort v50, v27, s[24:27], 0 offen offset:1152
    buffer_load_ushort v51, v27, s[24:27], 0 offen offset:2432
    v_add_u32 v26, 147456, v4
    s_add_u32 m0, s42, 0
    s_add_u32 s34, s40, 0
    buffer_load_dwordx4 v16, s[16:19], s34 offen lds
    s_add_u32 m0, s42, 1024
    s_add_u32 s34, s40, 0
    buffer_load_dwordx4 v17, s[16:19], s34 offen lds
    s_add_u32 m0, s42, 2048
    s_add_u32 s34, s40, 0
    buffer_load_dwordx4 v18, s[16:19], s34 offen lds
    s_add_u32 m0, s42, 3072
    s_add_u32 s34, s40, 98304
    buffer_load_dwordx4 v16, s[16:19], s34 offen lds
    s_add_u32 m0, s42, 4096
    s_add_u32 s34, s40, 98304
    buffer_load_dwordx4 v17, s[16:19], s34 offen lds
    s_add_u32 m0, s42, 5120
    s_add_u32 s34, s40, 98304
    buffer_load_dwordx4 v18, s[16:19], s34 offen lds
    s_add_u32 m0, s42, 24576
    s_add_u32 s34, s40, 786432
    buffer_load_dwordx4 v16, s[16:19], s34 offen lds
    s_add_u32 m0, s42, 25600
    s_add_u32 s34, s40, 786432
    buffer_load_dwordx4 v17, s[16:19], s34 offen lds
    s_add_u32 m0, s42, 26624
    s_add_u32 s34, s40, 786432
    buffer_load_dwordx4 v18, s[16:19], s34 offen lds
    s_add_u32 m0, s42, 27648
    s_add_u32 s34, s40, 884736
    buffer_load_dwordx4 v16, s[16:19], s34 offen lds
    s_add_u32 m0, s42, 28672
    s_add_u32 s34, s40, 884736
    buffer_load_dwordx4 v17, s[16:19], s34 offen lds
    s_add_u32 m0, s42, 29696
    s_add_u32 s34, s40, 884736
    buffer_load_dwordx4 v18, s[16:19], s34 offen lds
    s_add_u32 m0, s42, 49152
    s_add_u32 s34, s40, 1572864
    buffer_load_dwordx4 v16, s[16:19], s34 offen lds
    s_add_u32 m0, s42, 50176
    s_add_u32 s34, s40, 1572864
    buffer_load_dwordx4 v17, s[16:19], s34 offen lds
    s_add_u32 m0, s42, 51200
    s_add_u32 s34, s40, 1572864
    buffer_load_dwordx4 v18, s[16:19], s34 offen lds
    s_add_u32 m0, s42, 52224
    s_add_u32 s34, s40, 1671168
    buffer_load_dwordx4 v16, s[16:19], s34 offen lds
    s_add_u32 m0, s42, 53248
    s_add_u32 s34, s40, 1671168
    buffer_load_dwordx4 v17, s[16:19], s34 offen lds
    s_add_u32 m0, s42, 54272
    s_add_u32 s34, s40, 1671168
    buffer_load_dwordx4 v18, s[16:19], s34 offen lds
    s_add_u32 m0, s42, 73728
    s_add_u32 s34, s40, 2359296
    buffer_load_dwordx4 v16, s[16:19], s34 offen lds
    s_add_u32 m0, s42, 74752
    s_add_u32 s34, s40, 2359296
    buffer_load_dwordx4 v17, s[16:19], s34 offen lds
    s_add_u32 m0, s42, 75776
    s_add_u32 s34, s40, 2359296
    buffer_load_dwordx4 v18, s[16:19], s34 offen lds
    s_add_u32 m0, s42, 76800
    s_add_u32 s34, s40, 2457600
    buffer_load_dwordx4 v16, s[16:19], s34 offen lds
    s_add_u32 m0, s42, 77824
    s_add_u32 s34, s40, 2457600
    buffer_load_dwordx4 v17, s[16:19], s34 offen lds
    s_add_u32 m0, s42, 78848
    s_add_u32 s34, s40, 2457600
    buffer_load_dwordx4 v18, s[16:19], s34 offen lds
    s_add_u32 m0, s42, 98304
    s_add_u32 s34, s40, 3145728
    buffer_load_dwordx4 v16, s[16:19], s34 offen lds
    s_add_u32 m0, s42, 99328
    s_add_u32 s34, s40, 3145728
    buffer_load_dwordx4 v17, s[16:19], s34 offen lds
    s_add_u32 m0, s42, 100352
    s_add_u32 s34, s40, 3145728
    buffer_load_dwordx4 v18, s[16:19], s34 offen lds
    s_add_u32 m0, s42, 101376
    s_add_u32 s34, s40, 3244032
    buffer_load_dwordx4 v16, s[16:19], s34 offen lds
    s_add_u32 m0, s42, 102400
    s_add_u32 s34, s40, 3244032
    buffer_load_dwordx4 v17, s[16:19], s34 offen lds
    s_add_u32 m0, s42, 103424
    s_add_u32 s34, s40, 3244032
    buffer_load_dwordx4 v18, s[16:19], s34 offen lds
    s_waitcnt vmcnt(24) lgkmcnt(0)
    s_barrier
    s_cmp_lg_u32 s28, 0
    s_cbranch_scc1 cens_36
    s_lshl_b32 s34, s48, 3
    s_lshl_b64 s[50:51], 1, s34
    v_mov_b32 v28, s50
    v_mov_b32 v29, s51
    s_lshl_b32 s34, s29, 3
    s_mov_b64 exec, 1
    buffer_atomic_add_x2 v[28:29], off, s[12:15], s34 offset:0 sc1
    s_mov_b64 exec, -1
cens_36:
    v_lshl_or_b32 v32, v33, 16, v32
    ds_write_b32 v26, v32 offset:0
    v_lshl_or_b32 v34, v35, 16, v34
    ds_write_b32 v26, v34 offset:1024
    v_lshl_or_b32 v36, v37, 16, v36
    ds_write_b32 v26, v36 offset:2048
    v_lshl_or_b32 v38, v39, 16, v38
    ds_write_b32 v26, v38 offset:3072
    v_lshl_or_b32 v40, v41, 16, v40
    ds_write_b32 v26, v40 offset:4096
    v_lshl_or_b32 v42, v43, 16, v42
    ds_write_b32 v26, v42 offset:5120
    v_lshl_or_b32 v44, v45, 16, v44
    ds_write_b32 v26, v44 offset:6144
    v_lshl_or_b32 v46, v47, 16, v46
    ds_write_b32 v26, v46 offset:7168
    v_lshl_or_b32 v48, v49, 16, v48
    ds_write_b32 v26, v48 offset:8192
    v_lshl_or_b32 v50, v51, 16, v50
    ds_write_b32 v26, v50 offset:9216
    s_add_u32 m0, s42, 122880
    s_add_u32 s34, s40, 3932160
    buffer_load_dwordx4 v16, s[16:19], s34 offen lds
    s_add_u32 m0, s42, 123904
    s_add_u32 s34, s40, 3932160
    buffer_load_dwordx4 v17, s[16:19], s34 offen lds
    s_add_u32 m0, s42, 124928
    s_add_u32 s34, s40, 3932160
    buffer_load_dwordx4 v18, s[16:19], s34 offen lds
    s_add_u32 m0, s42, 125952
    s_add_u32 s34, s40, 4030464
    buffer_load_dwordx4 v16, s[16:19], s34 offen lds
    s_add_u32 m0, s42, 126976
    s_add_u32 s34, s40, 4030464
    buffer_load_dwordx4 v17, s[16:19], s34 offen lds
    s_add_u32 m0, s42, 128000
    s_add_u32 s34, s40, 4030464
    buffer_load_dwordx4 v18, s[16:19], s34 offen lds
    v_add_u32 v25, 0, v23
    ds_read_b64_tr_b16 a[0:1], v25 offset:0
    ds_read_b64_tr_b16 a[2:3], v25 offset:1536
    ds_read_b64_tr_b16 a[4:5], v25 offset:12288
    ds_read_b64_tr_b16 a[6:7], v25 offset:13824
    ds_read_b64_tr_b16 a[8:9], v25 offset:128
    ds_read_b64_tr_b16 a[10:11], v25 offset:1664
    ds_read_b64_tr_b16 a[12:13], v25 offset:12416
    ds_read_b64_tr_b16 a[14:15], v25 offset:13952
    ds_read_b64_tr_b16 a[16:17], v25 offset:256
    ds_read_b64_tr_b16 a[18:19], v25 offset:1792
    ds_read_b64_tr_b16 a[20:21], v25 offset:12544
    ds_read_b64_tr_b16 a[22:23], v25 offset:14080
    s_waitcnt vmcnt(24) lgkmcnt(0)
    s_barrier
    s_add_u32 m0, s42, 0
    s_add_u32 s34, s40, 4718592
    buffer_load_dwordx4 v16, s[16:19], s34 offen lds
    s_add_u32 m0, s42, 1024
    s_add_u32 s34, s40, 4718592
    buffer_load_dwordx4 v17, s[16:19], s34 offen lds
    s_add_u32 m0, s42, 2048
    s_add_u32 s34, s40, 4718592
    buffer_load_dwordx4 v18, s[16:19], s34 offen lds
    s_add_u32 m0, s42, 3072
    s_add_u32 s34, s40, 4816896
    buffer_load_dwordx4 v16, s[16:19], s34 offen lds
    s_add_u32 m0, s42, 4096
    s_add_u32 s34, s40, 4816896
    buffer_load_dwordx4 v17, s[16:19], s34 offen lds
    s_add_u32 m0, s42, 5120
    s_add_u32 s34, s40, 4816896
    buffer_load_dwordx4 v18, s[16:19], s34 offen lds
    v_add_u32 v25, 24576, v23
    ds_read_b64_tr_b16 a[24:25], v25 offset:0
    ds_read_b64_tr_b16 a[26:27], v25 offset:1536
    ds_read_b64_tr_b16 a[28:29], v25 offset:12288
    ds_read_b64_tr_b16 a[30:31], v25 offset:13824
    ds_read_b64_tr_b16 a[32:33], v25 offset:128
    ds_read_b64_tr_b16 a[34:35], v25 offset:1664
    ds_read_b64_tr_b16 a[36:37], v25 offset:12416
    ds_read_b64_tr_b16 a[38:39], v25 offset:13952
    ds_read_b64_tr_b16 a[40:41], v25 offset:256
    ds_read_b64_tr_b16 a[42:43], v25 offset:1792
    ds_read_b64_tr_b16 a[44:45], v25 offset:12544
    ds_read_b64_tr_b16 a[46:47], v25 offset:14080
    s_waitcnt vmcnt(24) lgkmcnt(0)
    s_barrier
    s_add_u32 m0, s42, 24576
    s_add_u32 s34, s40, 5505024
    buffer_load_dwordx4 v16, s[16:19], s34 offen lds
    s_add_u32 m0, s42, 25600
    s_add_u32 s34, s40, 5505024
    buffer_load_dwordx4 v17, s[16:19], s34 offen lds
    s_add_u32 m0, s42, 26624
    s_add_u32 s34, s40, 5505024
    buffer_load_dwordx4 v18, s[16:19], s34 offen lds
    s_add_u32 m0, s42, 27648
    s_add_u32 s34, s40, 5603328
    buffer_load_dwordx4 v16, s[16:19], s34 offen lds
    s_add_u32 m0, s42, 28672
    s_add_u32 s34, s40, 5603328
    buffer_load_dwordx4 v17, s[16:19], s34 offen lds
    s_add_u32 m0, s42, 29696
    s_add_u32 s34, s40, 5603328
    buffer_load_dwordx4 v18, s[16:19], s34 offen lds
    v_add_u32 v25, 49152, v23
    ds_read_b64_tr_b16 a[48:49], v25 offset:0
    ds_read_b64_tr_b16 a[50:51], v25 offset:1536
    ds_read_b64_tr_b16 a[52:53], v25 offset:12288
    ds_read_b64_tr_b16 a[54:55], v25 offset:13824
    ds_read_b64_tr_b16 a[56:57], v25 offset:128
    ds_read_b64_tr_b16 a[58:59], v25 offset:1664
    ds_read_b64_tr_b16 a[60:61], v25 offset:12416
    ds_read_b64_tr_b16 a[62:63], v25 offset:13952
    ds_read_b64_tr_b16 a[64:65], v25 offset:256
    ds_read_b64_tr_b16 a[66:67], v25 offset:1792
    ds_read_b64_tr_b16 a[68:69], v25 offset:12544
    ds_read_b64_tr_b16 a[70:71], v25 offset:14080
    s_waitcnt vmcnt(24) lgkmcnt(0)
    s_barrier
    s_add_u32 m0, s42, 49152
    s_add_u32 s34, s40, 6291456
    buffer_load_dwordx4 v16, s[16:19], s34 offen lds
    s_add_u32 m0, s42, 50176
    s_add_u32 s34, s40, 6291456
    buffer_load_dwordx4 v17, s[16:19], s34 offen lds
    s_add_u32 m0, s42, 51200
    s_add_u32 s34, s40, 6291456
    buffer_load_dwordx4 v18, s[16:19], s34 offen lds
    s_add_u32 m0, s42, 52224
    s_add_u32 s34, s40, 6389760
    buffer_load_dwordx4 v16, s[16:19], s34 offen lds
    s_add_u32 m0, s42, 53248
    s_add_u32 s34, s40, 6389760
    buffer_load_dwordx4 v17, s[16:19], s34 offen lds
    s_add_u32 m0, s42, 54272
    s_add_u32 s34, s40, 6389760
    buffer_load_dwordx4 v18, s[16:19], s34 offen lds
    v_add_u32 v25, 73728, v23
    ds_read_b64_tr_b16 a[72:73], v25 offset:0
    ds_read_b64_tr_b16 a[74:75], v25 offset:1536
    ds_read_b64_tr_b16 a[76:77], v25 offset:12288
    ds_read_b64_tr_b16 a[78:79], v25 offset:13824
    ds_read_b64_tr_b16 a[80:81], v25 offset:128
    ds_read_b64_tr_b16 a[82:83], v25 offset:1664
    ds_read_b64_tr_b16 a[84:85], v25 offset:12416
    ds_read_b64_tr_b16 a[86:87], v25 offset:13952
    ds_read_b64_tr_b16 a[88:89], v25 offset:256
    ds_read_b64_tr_b16 a[90:91], v25 offset:1792
    ds_read_b64_tr_b16 a[92:93], v25 offset:12544
    ds_read_b64_tr_b16 a[94:95], v25 offset:14080
    s_waitcnt vmcnt(24) lgkmcnt(0)
    s_barrier
    s_add_u32 m0, s42, 73728
    s_add_u32 s34, s40, 7077888
    buffer_load_dwordx4 v16, s[16:19], s34 offen lds
    s_add_u32 m0, s42, 74752
    s_add_u32 s34, s40, 7077888
    buffer_load_dwordx4 v17, s[16:19], s34 offen lds
    s_add_u32 m0, s42, 75776
    s_add_u32 s34, s40, 7077888
    buffer_load_dwordx4 v18, s[16:19], s34 offen lds
    s_add_u32 m0, s42, 76800
    s_add_u32 s34, s40, 7176192
    buffer_load_dwordx4 v16, s[16:19], s34 offen lds
    s_add_u32 m0, s42, 77824
    s_add_u32 s34, s40, 7176192
    buffer_load_dwordx4 v17, s[16:19], s34 offen lds
    s_add_u32 m0, s42, 78848
    s_add_u32 s34, s40, 7176192
    buffer_load_dwordx4 v18, s[16:19], s34 offen lds
    v_add_u32 v25, 98304, v23
    ds_read_b64_tr_b16 a[96:97], v25 offset:0
    ds_read_b64_tr_b16 a[98:99], v25 offset:1536
    ds_read_b64_tr_b16 a[100:101], v25 offset:12288
    ds_read_b64_tr_b16 a[102:103], v25 offset:13824
    ds_read_b64_tr_b16 a[104:105], v25 offset:128
    ds_read_b64_tr_b16 a[106:107], v25 offset:1664
    ds_read_b64_tr_b16 a[108:109], v25 offset:12416
    ds_read_b64_tr_b16 a[110:111], v25 offset:13952
    ds_read_b64_tr_b16 a[112:113], v25 offset:256
    ds_read_b64_tr_b16 a[114:115], v25 offset:1792
    ds_read_b64_tr_b16 a[116:117], v25 offset:12544
    ds_read_b64_tr_b16 a[118:119], v25 offset:14080
    s_waitcnt vmcnt(24) lgkmcnt(0)
    s_barrier
    s_add_u32 m0, s42, 98304
    s_add_u32 s34, s40, 0
    buffer_load_dwordx4 v16, s[20:23], s34 offen lds
    s_add_u32 m0, s42, 99328
    s_add_u32 s34, s40, 0
    buffer_load_dwordx4 v17, s[20:23], s34 offen lds
    s_add_u32 m0, s42, 100352
    s_add_u32 s34, s40, 0
    buffer_load_dwordx4 v18, s[20:23], s34 offen lds
    s_add_u32 m0, s42, 101376
    s_add_u32 s34, s40, 98304
    buffer_load_dwordx4 v16, s[20:23], s34 offen lds
    s_add_u32 m0, s42, 102400
    s_add_u32 s34, s40, 98304
    buffer_load_dwordx4 v17, s[20:23], s34 offen lds
    s_add_u32 m0, s42, 103424
    s_add_u32 s34, s40, 98304
    buffer_load_dwordx4 v18, s[20:23], s34 offen lds
    v_add_u32 v25, 122880, v23
    ds_read_b64_tr_b16 a[120:121], v25 offset:0
    ds_read_b64_tr_b16 a[122:123], v25 offset:1536
    ds_read_b64_tr_b16 a[124:125], v25 offset:12288
    ds_read_b64_tr_b16 a[126:127], v25 offset:13824
    ds_read_b64_tr_b16 a[128:129], v25 offset:128
    ds_read_b64_tr_b16 a[130:131], v25 offset:1664
    ds_read_b64_tr_b16 a[132:133], v25 offset:12416
    ds_read_b64_tr_b16 a[134:135], v25 offset:13952
    ds_read_b64_tr_b16 a[136:137], v25 offset:256
    ds_read_b64_tr_b16 a[138:139], v25 offset:1792
    ds_read_b64_tr_b16 a[140:141], v25 offset:12544
    ds_read_b64_tr_b16 a[142:143], v25 offset:14080
    s_waitcnt vmcnt(24) lgkmcnt(0)
    s_barrier
    s_add_u32 m0, s42, 122880
    s_add_u32 s34, s40, 786432
    buffer_load_dwordx4 v16, s[20:23], s34 offen lds
    s_add_u32 m0, s42, 123904
    s_add_u32 s34, s40, 786432
    buffer_load_dwordx4 v17, s[20:23], s34 offen lds
    s_add_u32 m0, s42, 124928
    s_add_u32 s34, s40, 786432
    buffer_load_dwordx4 v18, s[20:23], s34 offen lds
    s_add_u32 m0, s42, 125952
    s_add_u32 s34, s40, 884736
    buffer_load_dwordx4 v16, s[20:23], s34 offen lds
    s_add_u32 m0, s42, 126976
    s_add_u32 s34, s40, 884736
    buffer_load_dwordx4 v17, s[20:23], s34 offen lds
    s_add_u32 m0, s42, 128000
    s_add_u32 s34, s40, 884736
    buffer_load_dwordx4 v18, s[20:23], s34 offen lds
    v_add_u32 v25, 0, v23
    ds_read_b64_tr_b16 a[144:145], v25 offset:0
    ds_read_b64_tr_b16 a[146:147], v25 offset:1536
    ds_read_b64_tr_b16 a[148:149], v25 offset:12288
    ds_read_b64_tr_b16 a[150:151], v25 offset:13824
    ds_read_b64_tr_b16 a[152:153], v25 offset:128
    ds_read_b64_tr_b16 a[154:155], v25 offset:1664
    ds_read_b64_tr_b16 a[156:157], v25 offset:12416
    ds_read_b64_tr_b16 a[158:159], v25 offset:13952
    ds_read_b64_tr_b16 a[160:161], v25 offset:256
    ds_read_b64_tr_b16 a[162:163], v25 offset:1792
    ds_read_b64_tr_b16 a[164:165], v25 offset:12544
    ds_read_b64_tr_b16 a[166:167], v25 offset:14080
    s_waitcnt vmcnt(24) lgkmcnt(0)
    s_barrier
    s_add_u32 m0, s42, 0
    s_add_u32 s34, s40, 1572864
    buffer_load_dwordx4 v16, s[20:23], s34 offen lds
    s_add_u32 m0, s42, 1024
    s_add_u32 s34, s40, 1572864
    buffer_load_dwordx4 v17, s[20:23], s34 offen lds
    s_add_u32 m0, s42, 2048
    s_add_u32 s34, s40, 1572864
    buffer_load_dwordx4 v18, s[20:23], s34 offen lds
    s_add_u32 m0, s42, 3072
    s_add_u32 s34, s40, 1671168
    buffer_load_dwordx4 v16, s[20:23], s34 offen lds
    s_add_u32 m0, s42, 4096
    s_add_u32 s34, s40, 1671168
    buffer_load_dwordx4 v17, s[20:23], s34 offen lds
    s_add_u32 m0, s42, 5120
    s_add_u32 s34, s40, 1671168
    buffer_load_dwordx4 v18, s[20:23], s34 offen lds
    v_add_u32 v25, 24576, v23
    ds_read_b64_tr_b16 a[168:169], v25 offset:0
    ds_read_b64_tr_b16 a[170:171], v25 offset:1536
    ds_read_b64_tr_b16 a[172:173], v25 offset:12288
    ds_read_b64_tr_b16 a[174:175], v25 offset:13824
    ds_read_b64_tr_b16 a[176:177], v25 offset:128
    ds_read_b64_tr_b16 a[178:179], v25 offset:1664
    ds_read_b64_tr_b16 a[180:181], v25 offset:12416
    ds_read_b64_tr_b16 a[182:183], v25 offset:13952
    ds_read_b64_tr_b16 a[184:185], v25 offset:256
    ds_read_b64_tr_b16 a[186:187], v25 offset:1792
    ds_read_b64_tr_b16 a[188:189], v25 offset:12544
    ds_read_b64_tr_b16 a[190:191], v25 offset:14080
    s_waitcnt vmcnt(24) lgkmcnt(0)
    s_barrier
    s_add_u32 m0, s42, 24576
    s_add_u32 s34, s40, 2359296
    buffer_load_dwordx4 v16, s[20:23], s34 offen lds
    s_add_u32 m0, s42, 25600
    s_add_u32 s34, s40, 2359296
    buffer_load_dwordx4 v17, s[20:23], s34 offen lds
    s_add_u32 m0, s42, 26624
    s_add_u32 s34, s40, 2359296
    buffer_load_dwordx4 v18, s[20:23], s34 offen lds
    s_add_u32 m0, s42, 27648
    s_add_u32 s34, s40, 2457600
    buffer_load_dwordx4 v16, s[20:23], s34 offen lds
    s_add_u32 m0, s42, 28672
    s_add_u32 s34, s40, 2457600
    buffer_load_dwordx4 v17, s[20:23], s34 offen lds
    s_add_u32 m0, s42, 29696
    s_add_u32 s34, s40, 2457600
    buffer_load_dwordx4 v18, s[20:23], s34 offen lds
    v_add_u32 v25, 49152, v23
    ds_read_b64_tr_b16 a[192:193], v25 offset:0
    ds_read_b64_tr_b16 a[194:195], v25 offset:1536
    ds_read_b64_tr_b16 a[196:197], v25 offset:12288
    ds_read_b64_tr_b16 a[198:199], v25 offset:13824
    ds_read_b64_tr_b16 a[200:201], v25 offset:128
    ds_read_b64_tr_b16 a[202:203], v25 offset:1664
    ds_read_b64_tr_b16 a[204:205], v25 offset:12416
    ds_read_b64_tr_b16 a[206:207], v25 offset:13952
    ds_read_b64_tr_b16 a[208:209], v25 offset:256
    ds_read_b64_tr_b16 a[210:211], v25 offset:1792
    ds_read_b64_tr_b16 a[212:213], v25 offset:12544
    ds_read_b64_tr_b16 a[214:215], v25 offset:14080
    s_waitcnt vmcnt(24) lgkmcnt(0)
    s_barrier
    s_add_u32 m0, s42, 49152
    s_add_u32 s34, s40, 3145728
    buffer_load_dwordx4 v16, s[20:23], s34 offen lds
    s_add_u32 m0, s42, 50176
    s_add_u32 s34, s40, 3145728
    buffer_load_dwordx4 v17, s[20:23], s34 offen lds
    s_add_u32 m0, s42, 51200
    s_add_u32 s34, s40, 3145728
    buffer_load_dwordx4 v18, s[20:23], s34 offen lds
    s_add_u32 m0, s42, 52224
    s_add_u32 s34, s40, 3244032
    buffer_load_dwordx4 v16, s[20:23], s34 offen lds
    s_add_u32 m0, s42, 53248
    s_add_u32 s34, s40, 3244032
    buffer_load_dwordx4 v17, s[20:23], s34 offen lds
    s_add_u32 m0, s42, 54272
    s_add_u32 s34, s40, 3244032
    buffer_load_dwordx4 v18, s[20:23], s34 offen lds
    v_add_u32 v25, 73728, v23
    ds_read_b64_tr_b16 a[216:217], v25 offset:0
    ds_read_b64_tr_b16 a[218:219], v25 offset:1536
    ds_read_b64_tr_b16 a[220:221], v25 offset:12288
    ds_read_b64_tr_b16 a[222:223], v25 offset:13824
    ds_read_b64_tr_b16 a[224:225], v25 offset:128
    ds_read_b64_tr_b16 a[226:227], v25 offset:1664
    ds_read_b64_tr_b16 a[228:229], v25 offset:12416
    ds_read_b64_tr_b16 a[230:231], v25 offset:13952
    ds_read_b64_tr_b16 a[232:233], v25 offset:256
    ds_read_b64_tr_b16 a[234:235], v25 offset:1792
    ds_read_b64_tr_b16 a[236:237], v25 offset:12544
    ds_read_b64_tr_b16 a[238:239], v25 offset:14080
    s_waitcnt vmcnt(24) lgkmcnt(0)
    s_barrier
    s_add_u32 m0, s42, 73728
    s_add_u32 s34, s40, 3932160
    buffer_load_dwordx4 v16, s[20:23], s34 offen lds
    s_add_u32 m0, s42, 74752
    s_add_u32 s34, s40, 3932160
    buffer_load_dwordx4 v17, s[20:23], s34 offen lds
    s_add_u32 m0, s42, 75776
    s_add_u32 s34, s40, 3932160
    buffer_load_dwordx4 v18, s[20:23], s34 offen lds
    s_add_u32 m0, s42, 76800
    s_add_u32 s34, s40, 4030464
    buffer_load_dwordx4 v16, s[20:23], s34 offen lds
    s_add_u32 m0, s42, 77824
    s_add_u32 s34, s40, 4030464
    buffer_load_dwordx4 v17, s[20:23], s34 offen lds
    s_add_u32 m0, s42, 78848
    s_add_u32 s34, s40, 4030464
    buffer_load_dwordx4 v18, s[20:23], s34 offen lds
    v_add_u32 v25, 98304, v23
    ds_read_b64_tr_b16 a[240:241], v25 offset:0
    ds_read_b64_tr_b16 a[242:243], v25 offset:1536
    ds_read_b64_tr_b16 a[244:245], v25 offset:12288
    ds_read_b64_tr_b16 a[246:247], v25 offset:13824
    ds_read_b64_tr_b16 a[248:249], v25 offset:128
    ds_read_b64_tr_b16 a[250:251], v25 offset:1664
    ds_read_b64_tr_b16 a[252:253], v25 offset:12416
    ds_read_b64_tr_b16 a[254:255], v25 offset:13952
    ds_read_b64_tr_b16 v[32:33], v25 offset:256
    ds_read_b64_tr_b16 v[34:35], v25 offset:1792
    ds_read_b64_tr_b16 v[36:37], v25 offset:12544
    ds_read_b64_tr_b16 v[38:39], v25 offset:14080
    s_waitcnt vmcnt(24) lgkmcnt(0)
    s_barrier
    s_add_u32 m0, s42, 98304
    s_add_u32 s34, s40, 4718592
    buffer_load_dwordx4 v16, s[20:23], s34 offen lds
    s_add_u32 m0, s42, 99328
    s_add_u32 s34, s40, 4718592
    buffer_load_dwordx4 v17, s[20:23], s34 offen lds
    s_add_u32 m0, s42, 100352
    s_add_u32 s34, s40, 4718592
    buffer_load_dwordx4 v18, s[20:23], s34 offen lds
    s_add_u32 m0, s42, 101376
    s_add_u32 s34, s40, 4816896
    buffer_load_dwordx4 v16, s[20:23], s34 offen lds
    s_add_u32 m0, s42, 102400
    s_add_u32 s34, s40, 4816896
    buffer_load_dwordx4 v17, s[20:23], s34 offen lds
    s_add_u32 m0, s42, 103424
    s_add_u32 s34, s40, 4816896
    buffer_load_dwordx4 v18, s[20:23], s34 offen lds
    v_add_u32 v25, 122880, v23
    ds_read_b64_tr_b16 v[112:113], v25 offset:0
    ds_read_b64_tr_b16 v[114:115], v25 offset:1536
    ds_read_b64_tr_b16 v[116:117], v25 offset:12288
    ds_read_b64_tr_b16 v[118:119], v25 offset:13824
    ds_read_b64_tr_b16 v[120:121], v25 offset:128
    ds_read_b64_tr_b16 v[122:123], v25 offset:1664
    ds_read_b64_tr_b16 v[124:125], v25 offset:12416
    ds_read_b64_tr_b16 v[126:127], v25 offset:13952
    ds_read_b64_tr_b16 v[40:41], v25 offset:256
    ds_read_b64_tr_b16 v[42:43], v25 offset:1792
    ds_read_b64_tr_b16 v[44:45], v25 offset:12544
    ds_read_b64_tr_b16 v[46:47], v25 offset:14080
    s_waitcnt vmcnt(24) lgkmcnt(0)
    s_barrier
    s_add_u32 m0, s42, 122880
    s_add_u32 s34, s40, 5505024
    buffer_load_dwordx4 v16, s[20:23], s34 offen lds
    s_add_u32 m0, s42, 123904
    s_add_u32 s34, s40, 5505024
    buffer_load_dwordx4 v17, s[20:23], s34 offen lds
    s_add_u32 m0, s42, 124928
    s_add_u32 s34, s40, 5505024
    buffer_load_dwordx4 v18, s[20:23], s34 offen lds
    s_add_u32 m0, s42, 125952
    s_add_u32 s34, s40, 5603328
    buffer_load_dwordx4 v16, s[20:23], s34 offen lds
    s_add_u32 m0, s42, 126976
    s_add_u32 s34, s40, 5603328
    buffer_load_dwordx4 v17, s[20:23], s34 offen lds
    s_add_u32 m0, s42, 128000
    s_add_u32 s34, s40, 5603328
    buffer_load_dwordx4 v18, s[20:23], s34 offen lds
    v_add_u32 v25, 0, v23
    ds_read_b64_tr_b16 v[128:129], v25 offset:0
    ds_read_b64_tr_b16 v[130:131], v25 offset:1536
    ds_read_b64_tr_b16 v[132:133], v25 offset:12288
    ds_read_b64_tr_b16 v[134:135], v25 offset:13824
    ds_read_b64_tr_b16 v[136:137], v25 offset:128
    ds_read_b64_tr_b16 v[138:139], v25 offset:1664
    ds_read_b64_tr_b16 v[140:141], v25 offset:12416
    ds_read_b64_tr_b16 v[142:143], v25 offset:13952
    ds_read_b64_tr_b16 v[48:49], v25 offset:256
    ds_read_b64_tr_b16 v[50:51], v25 offset:1792
    ds_read_b64_tr_b16 v[52:53], v25 offset:12544
    ds_read_b64_tr_b16 v[54:55], v25 offset:14080
    s_waitcnt vmcnt(24) lgkmcnt(0)
    s_barrier
    s_add_u32 m0, s42, 0
    s_add_u32 s34, s40, 6291456
    buffer_load_dwordx4 v16, s[20:23], s34 offen lds
    s_add_u32 m0, s42, 1024
    s_add_u32 s34, s40, 6291456
    buffer_load_dwordx4 v17, s[20:23], s34 offen lds
    s_add_u32 m0, s42, 2048
    s_add_u32 s34, s40, 6291456
    buffer_load_dwordx4 v18, s[20:23], s34 offen lds
    s_add_u32 m0, s42, 3072
    s_add_u32 s34, s40, 6389760
    buffer_load_dwordx4 v16, s[20:23], s34 offen lds
    s_add_u32 m0, s42, 4096
    s_add_u32 s34, s40, 6389760
    buffer_load_dwordx4 v17, s[20:23], s34 offen lds
    s_add_u32 m0, s42, 5120
    s_add_u32 s34, s40, 6389760
    buffer_load_dwordx4 v18, s[20:23], s34 offen lds
    v_add_u32 v25, 24576, v23
    ds_read_b64_tr_b16 v[144:145], v25 offset:0
    ds_read_b64_tr_b16 v[146:147], v25 offset:1536
    ds_read_b64_tr_b16 v[148:149], v25 offset:12288
    ds_read_b64_tr_b16 v[150:151], v25 offset:13824
    ds_read_b64_tr_b16 v[152:153], v25 offset:128
    ds_read_b64_tr_b16 v[154:155], v25 offset:1664
    ds_read_b64_tr_b16 v[156:157], v25 offset:12416
    ds_read_b64_tr_b16 v[158:159], v25 offset:13952
    ds_read_b64_tr_b16 v[56:57], v25 offset:256
    ds_read_b64_tr_b16 v[58:59], v25 offset:1792
    ds_read_b64_tr_b16 v[60:61], v25 offset:12544
    ds_read_b64_tr_b16 v[62:63], v25 offset:14080
    s_waitcnt vmcnt(24) lgkmcnt(0)
    s_barrier
    s_add_u32 m0, s42, 24576
    s_add_u32 s34, s40, 7077888
    buffer_load_dwordx4 v16, s[20:23], s34 offen lds
    s_add_u32 m0, s42, 25600
    s_add_u32 s34, s40, 7077888
    buffer_load_dwordx4 v17, s[20:23], s34 offen lds
    s_add_u32 m0, s42, 26624
    s_add_u32 s34, s40, 7077888
    buffer_load_dwordx4 v18, s[20:23], s34 offen lds
    s_add_u32 m0, s42, 27648
    s_add_u32 s34, s40, 7176192
    buffer_load_dwordx4 v16, s[20:23], s34 offen lds
    s_add_u32 m0, s42, 28672
    s_add_u32 s34, s40, 7176192
    buffer_load_dwordx4 v17, s[20:23], s34 offen lds
    s_add_u32 m0, s42, 29696
    s_add_u32 s34, s40, 7176192
    buffer_load_dwordx4 v18, s[20:23], s34 offen lds
    v_add_u32 v25, 49152, v23
    ds_read_b64_tr_b16 v[160:161], v25 offset:0
    ds_read_b64_tr_b16 v[162:163], v25 offset:1536
    ds_read_b64_tr_b16 v[164:165], v25 offset:12288
    ds_read_b64_tr_b16 v[166:167], v25 offset:13824
    ds_read_b64_tr_b16 v[168:169], v25 offset:128
    ds_read_b64_tr_b16 v[170:171], v25 offset:1664
    ds_read_b64_tr_b16 v[172:173], v25 offset:12416
    ds_read_b64_tr_b16 v[174:175], v25 offset:13952
    ds_read_b64_tr_b16 v[64:65], v25 offset:256
    ds_read_b64_tr_b16 v[66:67], v25 offset:1792
    ds_read_b64_tr_b16 v[68:69], v25 offset:12544
    ds_read_b64_tr_b16 v[70:71], v25 offset:14080
    s_waitcnt vmcnt(24) lgkmcnt(0)
    s_barrier
    v_add_u32 v25, 73728, v23
    ds_read_b64_tr_b16 v[176:177], v25 offset:0
    ds_read_b64_tr_b16 v[178:179], v25 offset:1536
    ds_read_b64_tr_b16 v[180:181], v25 offset:12288
    ds_read_b64_tr_b16 v[182:183], v25 offset:13824
    ds_read_b64_tr_b16 v[184:185], v25 offset:128
    ds_read_b64_tr_b16 v[186:187], v25 offset:1664
    ds_read_b64_tr_b16 v[188:189], v25 offset:12416
    ds_read_b64_tr_b16 v[190:191], v25 offset:13952
    ds_read_b64_tr_b16 v[72:73], v25 offset:256
    ds_read_b64_tr_b16 v[74:75], v25 offset:1792
    ds_read_b64_tr_b16 v[76:77], v25 offset:12544
    ds_read_b64_tr_b16 v[78:79], v25 offset:14080
    s_waitcnt vmcnt(18) lgkmcnt(0)
    s_barrier
    v_add_u32 v25, 98304, v23
    ds_read_b64_tr_b16 v[192:193], v25 offset:0
    ds_read_b64_tr_b16 v[194:195], v25 offset:1536
    ds_read_b64_tr_b16 v[196:197], v25 offset:12288
    ds_read_b64_tr_b16 v[198:199], v25 offset:13824
    ds_read_b64_tr_b16 v[200:201], v25 offset:128
    ds_read_b64_tr_b16 v[202:203], v25 offset:1664
    ds_read_b64_tr_b16 v[204:205], v25 offset:12416
    ds_read_b64_tr_b16 v[206:207], v25 offset:13952
    ds_read_b64_tr_b16 v[80:81], v25 offset:256
    ds_read_b64_tr_b16 v[82:83], v25 offset:1792
    ds_read_b64_tr_b16 v[84:85], v25 offset:12544
    ds_read_b64_tr_b16 v[86:87], v25 offset:14080
    s_waitcnt vmcnt(12) lgkmcnt(0)
    s_barrier
    v_add_u32 v25, 122880, v23
    ds_read_b64_tr_b16 v[208:209], v25 offset:0
    ds_read_b64_tr_b16 v[210:211], v25 offset:1536
    ds_read_b64_tr_b16 v[212:213], v25 offset:12288
    ds_read_b64_tr_b16 v[214:215], v25 offset:13824
    ds_read_b64_tr_b16 v[216:217], v25 offset:128
    ds_read_b64_tr_b16 v[218:219], v25 offset:1664
    ds_read_b64_tr_b16 v[220:221], v25 offset:12416
    ds_read_b64_tr_b16 v[222:223], v25 offset:13952
    ds_read_b64_tr_b16 v[88:89], v25 offset:256
    ds_read_b64_tr_b16 v[90:91], v25 offset:1792
    ds_read_b64_tr_b16 v[92:93], v25 offset:12544
    ds_read_b64_tr_b16 v[94:95], v25 offset:14080
    s_waitcnt vmcnt(6) lgkmcnt(0)
    s_barrier
    v_add_u32 v25, 0, v23
    ds_read_b64_tr_b16 v[224:225], v25 offset:0
    ds_read_b64_tr_b16 v[226:227], v25 offset:1536
    ds_read_b64_tr_b16 v[228:229], v25 offset:12288
    ds_read_b64_tr_b16 v[230:231], v25 offset:13824
    ds_read_b64_tr_b16 v[232:233], v25 offset:128
    ds_read_b64_tr_b16 v[234:235], v25 offset:1664
    ds_read_b64_tr_b16 v[236:237], v25 offset:12416
    ds_read_b64_tr_b16 v[238:239], v25 offset:13952
    ds_read_b64_tr_b16 v[96:97], v25 offset:256
    ds_read_b64_tr_b16 v[98:99], v25 offset:1792
    ds_read_b64_tr_b16 v[100:101], v25 offset:12544
    ds_read_b64_tr_b16 v[102:103], v25 offset:14080
    s_waitcnt vmcnt(0) lgkmcnt(0)
    s_barrier
    v_add_u32 v25, 24576, v23
    ds_read_b64_tr_b16 v[240:241], v25 offset:0
    ds_read_b64_tr_b16 v[242:243], v25 offset:1536
    ds_read_b64_tr_b16 v[244:245], v25 offset:12288
    ds_read_b64_tr_b16 v[246:247], v25 offset:13824
    ds_read_b64_tr_b16 v[248:249], v25 offset:128
    ds_read_b64_tr_b16 v[250:251], v25 offset:1664
    ds_read_b64_tr_b16 v[252:253], v25 offset:12416
    ds_read_b64_tr_b16 v[254:255], v25 offset:13952
    ds_read_b64_tr_b16 v[104:105], v25 offset:256
    ds_read_b64_tr_b16 v[106:107], v25 offset:1792
    ds_read_b64_tr_b16 v[108:109], v25 offset:12544
    ds_read_b64_tr_b16 v[110:111], v25 offset:14080
    ds_read_b32 v16, v26 offset:0
    ds_read_b32 v17, v26 offset:1024
    ds_read_b32 v18, v26 offset:2048
    ds_read_b32 v19, v26 offset:3072
    ds_read_b32 v20, v26 offset:4096
    ds_read_b32 v21, v26 offset:5120
    ds_read_b32 v22, v26 offset:6144
    ds_read_b32 v23, v26 offset:7168
    ds_read_b32 v24, v26 offset:8192
    ds_read_b32 v25, v26 offset:9216
    s_waitcnt lgkmcnt(0)
    s_barrier
    ds_write_b32 v4, v16 offset:0
    ds_write_b32 v4, v17 offset:1024
    ds_write_b32 v4, v18 offset:2048
    ds_write_b32 v4, v19 offset:3072
    ds_write_b32 v4, v20 offset:4096
    ds_write_b32 v4, v21 offset:5120
    ds_write_b32 v4, v22 offset:6144
    ds_write_b32 v4, v23 offset:7168
    ds_write_b32 v4, v24 offset:8192
    ds_write_b32 v4, v25 offset:9216
    ds_write_b128 v7, v[32:35] offset:0
    ds_write_b128 v7, v[36:39] offset:1024
    ds_write_b128 v7, v[40:43] offset:2048
    ds_write_b128 v7, v[44:47] offset:3072
    ds_write_b128 v7, v[48:51] offset:4096
    ds_write_b128 v7, v[52:55] offset:5120
    ds_write_b128 v7, v[56:59] offset:6144
    ds_write_b128 v7, v[60:63] offset:7168
    ds_write_b128 v7, v[64:67] offset:8192
    ds_write_b128 v7, v[68:71] offset:9216
    ds_write_b128 v7, v[72:75] offset:10240
    ds_write_b128 v7, v[76:79] offset:11264
    ds_write_b128 v7, v[80:83] offset:12288
    ds_write_b128 v7, v[84:87] offset:13312
    ds_write_b128 v7, v[88:91] offset:14336
    ds_write_b128 v7, v[92:95] offset:15360
    ds_write_b128 v7, v[96:99] offset:16384
    ds_write_b128 v7, v[100:103] offset:17408
    ds_write_b128 v7, v[104:107] offset:18432
    ds_write_b128 v7, v[108:111] offset:19456
    s_waitcnt lgkmcnt(0)
    s_or_b32 s34, s31, s28
    s_cmp_lg_u32 s34, 0
    s_cbranch_scc1 cal_37
    s_mov_b32 s40, -1
    s_mov_b32 s41, -1
    s_mov_b32 s34, 203685888
    s_memtime s[42:43]
    s_waitcnt lgkmcnt(0)
    buffer_store_dword v5, v4, s[8:11], s34 offen sc1
    s_waitcnt vmcnt(0)
    buffer_load_dword v16, v4, s[8:11], s34 offen sc1
    s_waitcnt vmcnt(0)
    s_memtime s[44:45]
    s_waitcnt lgkmcnt(0)
    s_sub_u32 s35, s44, s42
    s_min_u32 s40, s40, s35
    s_mov_b32 s34, 203694080
    s_memtime s[42:43]
    s_waitcnt lgkmcnt(0)
    buffer_store_dword v5, v4, s[8:11], s34 offen sc1
    s_waitcnt vmcnt(0)
    buffer_load_dword v16, v4, s[8:11], s34 offen sc1
    s_waitcnt vmcnt(0)
    s_memtime s[44:45]
    s_waitcnt lgkmcnt(0)
    s_sub_u32 s35, s44, s42
    s_min_u32 s41, s41, s35
    s_mov_b32 s34, 203702272
    s_memtime s[42:43]
    s_waitcnt lgkmcnt(0)
    buffer_store_dword v5, v4, s[8:11], s34 offen sc1
    s_waitcnt vmcnt(0)
    buffer_load_dword v16, v4, s[8:11], s34 offen sc1
    s_waitcnt vmcnt(0)
    s_memtime s[44:45]
    s_waitcnt lgkmcnt(0)
    s_sub_u32 s35, s44, s42
    s_min_u32 s40, s40, s35
    s_mov_b32 s34, 203710464
    s_memtime s[42:43]
    s_waitcnt lgkmcnt(0)
    buffer_store_dword v5, v4, s[8:11], s34 offen sc1
    s_waitcnt vmcnt(0)
    buffer_load_dword v16, v4, s[8:11], s34 offen sc1
    s_waitcnt vmcnt(0)
    s_memtime s[44:45]
    s_waitcnt lgkmcnt(0)
    s_sub_u32 s35, s44, s42
    s_min_u32 s41, s41, s35
    s_mov_b32 s34, 203718656
    s_memtime s[42:43]
    s_waitcnt lgkmcnt(0)
    buffer_store_dword v5, v4, s[8:11], s34 offen sc1
    s_waitcnt vmcnt(0)
    buffer_load_dword v16, v4, s[8:11], s34 offen sc1
    s_waitcnt vmcnt(0)
    s_memtime s[44:45]
    s_waitcnt lgkmcnt(0)
    s_sub_u32 s35, s44, s42
    s_min_u32 s40, s40, s35
    s_mov_b32 s34, 203726848
    s_memtime s[42:43]
    s_waitcnt lgkmcnt(0)
    buffer_store_dword v5, v4, s[8:11], s34 offen sc1
    s_waitcnt vmcnt(0)
    buffer_load_dword v16, v4, s[8:11], s34 offen sc1
    s_waitcnt vmcnt(0)
    s_memtime s[44:45]
    s_waitcnt lgkmcnt(0)
    s_sub_u32 s35, s44, s42
    s_min_u32 s41, s41, s35
    s_cmp_lt_u32 s40, s41
    s_cselect_b32 s34, 1, 2
    v_mov_b32 v16, s34
    s_mov_b64 exec, 1
    buffer_store_dword v16, off, s[12:15], 0 offset:56 sc1
    s_mov_b64 exec, -1
cal_37:
    v_mov_b32 v20, 0
cw_38:
    buffer_load_dwordx4 v[16:19], v20, s[12:15], 0 offen offset:0 sc1
    buffer_load_dword v22, v20, s[12:15], 0 offen offset:56 sc1
    s_waitcnt vmcnt(0)
    v_min_u32 v21, 1, v22
    v_sad_u8 v21, v16, 0, v21
    v_sad_u8 v21, v17, 0, v21
    v_sad_u8 v21, v18, 0, v21
    v_sad_u8 v21, v19, 0, v21
    s_nop 0
    v_readfirstlane_b32 s34, v21
    s_nop 0
    s_cmp_eq_u32 s34, 65
    s_cbranch_scc1 cwd_39
    s_sleep 4
    s_sub_u32 s33, s33, 1
    s_cbranch_scc0 cw_38
    s_mov_b32 s33, 0
cwd_39:
    v_readfirstlane_b32 s69, v22
    s_nop 0
    s_and_b32 s69, s69, 2
    s_lshl_b32 s69, s69, 12
    s_add_u32 s39, s39, s69
    s_xor_b32 s69, s69, 8192
    s_add_u32 s38, s38, s69
    v_readfirstlane_b32 s40, v16
    v_readfirstlane_b32 s41, v17
    v_readfirstlane_b32 s42, v18
    v_readfirstlane_b32 s43, v19
    s_cmp_eq_u32 s29, 0
    s_cselect_b32 s50, s40, s42
    s_cselect_b32 s51, s41, s43
    s_lshl_b32 s34, s48, 3
    s_lshr_b64 s[50:51], s[50:51], s34
    s_and_b32 s34, s50, 0xff
    s_cmp_eq_u32 s34, 32
    s_cselect_b32 s46, 1, 0
    s_mul_i32 s43, s29, 10240
    s_add_u32 s43, s43, 160432128
    s_lshr_b32 s34, s30, 1
    s_lshl_b32 s34, s34, 8
    s_add_u32 s44, s43, s34
    s_add_u32 s44, s44, 8192
    s_lshr_b32 s34, s30, 1
    s_xor_b32 s34, s34, s30
    s_and_b32 s34, s34, 1
    s_lshl_b32 s34, s34, 5
    s_add_u32 s44, s44, s34
    s_lshl_b32 s34, s30, 9
    s_add_u32 s43, s43, s34
    s_mov_b32 s60, s43
    s_mov_b32 s61, s44
    s_mov_b32 s64, s38
    s_mov_b32 s65, s39
    s_and_b32 s34, s32, 3
    s_mul_i32 s34, s34, 20480
    s_add_u32 s43, s60, s34
    s_and_b32 s34, s32, 3
    s_mul_i32 s34, s34, 20480
    s_add_u32 s44, s61, s34
    s_add_u32 s34, s32, 2
    s_and_b32 s34, s34, 3
    s_mul_i32 s34, s34, 20480
    s_add_u32 s66, s60, s34
    s_add_u32 s34, s32, 2
    s_and_b32 s34, s34, 3
    s_mul_i32 s34, s34, 20480
    s_add_u32 s67, s61, s34
    s_and_b32 s34, s32, 3
    s_mul_i32 s34, s34, 65536
    s_add_u32 s38, s64, s34
    s_and_b32 s34, s32, 3
    s_mul_i32 s34, s34, 65536
    s_add_u32 s39, s65, s34
    s_mul_i32 s40, s31, 24576
    s_add_u32 s40, s40, 0
    s_lshl_b32 s41, s31, 11
    s_sub_u32 s34, s28, 1
    s_lshl_b32 s35, s34, 10
    s_add_u32 s41, s41, s35
    s_add_u32 s41, s41, 162529280
    s_lshr_b32 s42, s31, 2
    s_lshl_b32 s42, s42, 11
    s_add_u32 s42, s42, s35
    s_and_b32 s34, s31, 3
    s_lshl_b32 s34, s34, 8
    s_add_u32 s42, s42, s34
    s_add_u32 s42, s42, 166723584
    s_lshl_b32 s45, 1, s31
    s_lshl_b32 s34, s29, 4
    s_lshl_b32 s58, 0xffff, s34
    s_mul_i32 s56, s29, 655360
    s_mul_i32 s34, s30, 40960
    s_add_u32 s56, s56, s34
    s_lshl_b32 s34, s28, 13
    s_add_u32 s56, s56, s34
    s_add_u32 s56, s56, 51642368
    s_add_u32 s57, s40, s34
    s_add_u32 s57, s57, 778240
    s_add_u32 s34, s56, 32768
    s_cmp_eq_u32 s28, 0
    s_cselect_b32 s57, s34, s57
    s_mov_b32 s59, 786432
    s_cselect_b32 s59, 1310720, s59
    s_cmp_lt_u32 s28, 1
    s_cselect_b32 s57, s57, 0x40000000
    s_sub_u32 s34, s28, 1
    s_cmp_lt_u32 s34, 2
    s_cselect_b32 s62, s41, 0x40000000
    s_cselect_b32 s49, s42, 0x40000000
    s_mov_b32 s41, 0x40000000
    s_mov_b32 s42, 0x40000000
    s_cmp_lg_u32 s28, 0
    s_cbranch_scc1 qkpre_40
    s_lshl_b32 s34, s32, 3
    s_lshl_b32 s50, s32, 1
    s_add_u32 s50, s50, s29
    s_cmp_eq_u32 s32, 0
    s_cselect_b32 s51, 32, 16
fl_41:
    buffer_load_dwordx2 v[16:17], off, s[12:15], s34 offset:64 sc1
    buffer_load_ubyte v18, off, s[12:15], s50 offset:200 sc1
    s_waitcnt vmcnt(0)
    v_and_b32 v16, v16, v17
    s_nop 0
    v_readfirstlane_b32 s35, v16
    s_nop 0
    s_bitcmp1_b32 s35, s31
    s_cbranch_scc0 fln_43
    v_readfirstlane_b32 s35, v18
    s_nop 0
    s_cmp_ge_u32 s35, s51
    s_cbranch_scc1 fld_42
fln_43:
    s_sleep 3
    s_sub_u32 s33, s33, 1
    s_cbranch_scc0 fl_41
    s_mov_b32 s33, 0
fld_42:
    s_mov_b32 s36, 108544
    s_add_u32 m0, s36, 0
    s_add_u32 s34, s40, 0
    buffer_load_dwordx4 v5, s[8:11], s34 offen offset:0 sc1 lds
    buffer_load_dwordx4 v5, s[8:11], s34 offen offset:1024 sc1 lds
    buffer_load_dwordx4 v5, s[8:11], s34 offen offset:2048 sc1 lds
    buffer_load_dwordx4 v5, s[8:11], s34 offen offset:3072 sc1 lds
    s_add_u32 m0, s36, 4096
    s_add_u32 s34, s40, 4096
    buffer_load_dwordx4 v5, s[8:11], s34 offen offset:0 sc1 lds
    buffer_load_dwordx4 v5, s[8:11], s34 offen offset:1024 sc1 lds
    buffer_load_dwordx4 v5, s[8:11], s34 offen offset:2048 sc1 lds
    buffer_load_dwordx4 v5, s[8:11], s34 offen offset:3072 sc1 lds
    s_add_u32 m0, s36, 8192
    s_add_u32 s34, s40, 8192
    buffer_load_dwordx4 v5, s[8:11], s34 offen offset:0 sc1 lds
    buffer_load_dwordx4 v5, s[8:11], s34 offen offset:1024 sc1 lds
    buffer_load_dwordx4 v5, s[8:11], s34 offen offset:2048 sc1 lds
    buffer_load_dwordx4 v5, s[8:11], s34 offen offset:3072 sc1 lds
    s_add_u32 m0, s36, 12288
    s_add_u32 s34, s40, 12288
    buffer_load_dwordx4 v5, s[8:11], s34 offen offset:0 sc1 lds
    buffer_load_dwordx4 v5, s[8:11], s34 offen offset:1024 sc1 lds
    buffer_load_dwordx4 v5, s[8:11], s34 offen offset:2048 sc1 lds
    buffer_load_dwordx4 v5, s[8:11], s34 offen offset:3072 sc1 lds
    s_add_u32 m0, s36, 16384
    s_add_u32 s34, s40, 16384
    buffer_load_dwordx4 v5, s[8:11], s34 offen offset:0 sc1 lds
    buffer_load_dwordx4 v5, s[8:11], s34 offen offset:1024 sc1 lds
    buffer_load_dwordx4 v5, s[8:11], s34 offen offset:2048 sc1 lds
    buffer_load_dwordx4 v5, s[8:11], s34 offen offset:3072 sc1 lds
    s_add_u32 m0, s36, 20480
    s_add_u32 s34, s40, 20480
    buffer_load_dwordx4 v5, s[8:11], s34 offen offset:0 sc1 lds
    buffer_load_dwordx4 v5, s[8:11], s34 offen offset:1024 sc1 lds
    buffer_load_dwordx4 v5, s[8:11], s34 offen offset:2048 sc1 lds
    buffer_load_dwordx4 v5, s[8:11], s34 offen offset:3072 sc1 lds
    s_add_u32 s40, s40, 786432
    s_waitcnt vmcnt(0)
qkpre_40:
    v_mov_b64 v[12:13], 0
    v_mov_b64 v[14:15], 0
    v_mov_b64 v[16:17], 0
    v_mov_b64 v[18:19], 0
    v_mov_b64 v[20:21], 0
    v_mov_b64 v[22:23], 0
    v_mov_b64 v[100:101], 0
    v_mov_b64 v[102:103], 0
    v_mov_b64 v[104:105], 0
    v_mov_b64 v[106:107], 0
    v_mov_b64 v[108:109], 0
    v_mov_b64 v[110:111], 0
    s_barrier
    s_cmp_lg_u32 s28, 0
    s_cbranch_scc1 kxe_44
    ds_read_b128 v[64:67], v8 offset:0
    ds_read_b128 v[72:75], v8 offset:1024
    ds_read_b128 v[68:71], v8 offset:2048
    ds_read_b128 v[76:79], v8 offset:3072
    ds_read_b128 v[80:83], v8 offset:4096
    ds_read_b128 v[88:91], v8 offset:5120
    ds_read_b128 v[84:87], v8 offset:6144
    ds_read_b128 v[92:95], v8 offset:7168
    ds_read_b128 v[96:99], v8 offset:8192
kxe_44:
    s_waitcnt lgkmcnt(0)
    s_cmp_eq_u32 s46, 0
    s_cbranch_scc1 qkslow_45
qkloop_46:
    s_barrier
    ds_read_b64_tr_b16 v[24:25], v2 offset:0
    ds_read_b64_tr_b16 v[26:27], v0 offset:0
    ds_read_b64_tr_b16 v[28:29], v2 offset:1024
    ds_read_b64_tr_b16 v[30:31], v0 offset:1024
    ds_read_b64_tr_b16 v[32:33], v2 offset:2048
    ds_read_b64_tr_b16 v[34:35], v0 offset:2048
    s_mov_b32 m0, 157696
    v_lshlrev_b32 v63, 3, v5
    buffer_load_dword v63, s[8:11], s56 offen sc1 lds
    s_waitcnt lgkmcnt(4)
    v_smfmac_f32_16x16x64_bf16 v[100:103], v[24:27], a[0:7], v1
    ds_read_b64_tr_b16 v[36:37], v2 offset:3072
    v_smfmac_f32_16x16x64_bf16 v[104:107], v[24:27], a[8:15], v1
    ds_read_b64_tr_b16 v[38:39], v0 offset:3072
    buffer_load_dword v63, s[8:11], s57 offen sc1 lds
    v_smfmac_f32_16x16x64_bf16 v[108:111], v[24:27], a[16:23], v1
    ds_read_b128 v[40:43], v7 offset:0
    s_waitcnt lgkmcnt(5)
    v_smfmac_f32_16x16x64_bf16 v[100:103], v[28:31], a[24:31], v1
    ds_read_b128 v[44:47], v7 offset:1024
    v_smfmac_f32_16x16x64_bf16 v[104:107], v[28:31], a[32:39], v1
    ds_read_b128 v[48:51], v7 offset:2048
    v_smfmac_f32_16x16x64_bf16 v[108:111], v[28:31], a[40:47], v1
    ds_read_b128 v[52:55], v7 offset:3072
    s_waitcnt lgkmcnt(6)
    v_smfmac_f32_16x16x64_bf16 v[100:103], v[32:35], a[48:55], v1
    ds_read_b128 v[56:59], v7 offset:4096
    v_smfmac_f32_16x16x64_bf16 v[104:107], v[32:35], a[56:63], v1
    ds_read_b128 v[60:63], v7 offset:5120
    v_smfmac_f32_16x16x64_bf16 v[108:111], v[32:35], a[64:71], v1
    v_smfmac_f32_16x16x64_bf16 v[12:15], v[24:27], a[240:247], v1
    v_smfmac_f32_16x16x64_bf16 v[16:19], v[24:27], a[248:255], v1
    s_waitcnt lgkmcnt(4)
    v_smfmac_f32_16x16x64_bf16 v[20:23], v[24:27], v[40:47], v1
    ds_read_b64_tr_b16 v[24:25], v2 offset:4096
    v_smfmac_f32_16x16x64_bf16 v[100:103], v[36:39], a[72:79], v1
    ds_read_b64_tr_b16 v[26:27], v0 offset:4096
    v_smfmac_f32_16x16x64_bf16 v[104:107], v[36:39], a[80:87], v1
    ds_read_b128 v[40:43], v7 offset:6144
    v_smfmac_f32_16x16x64_bf16 v[108:111], v[36:39], a[88:95], v1
    ds_read_b128 v[44:47], v7 offset:7168
    v_smfmac_f32_16x16x64_bf16 v[12:15], v[28:31], v[112:119], v1
    v_smfmac_f32_16x16x64_bf16 v[16:19], v[28:31], v[120:127], v1
    s_waitcnt lgkmcnt(6)
    v_smfmac_f32_16x16x64_bf16 v[20:23], v[28:31], v[48:55], v1
    ds_read_b64_tr_b16 v[28:29], v2 offset:5120
    s_waitcnt lgkmcnt(3)
    v_smfmac_f32_16x16x64_bf16 v[100:103], v[24:27], a[96:103], v1
    ds_read_b64_tr_b16 v[30:31], v0 offset:5120
    v_smfmac_f32_16x16x64_bf16 v[104:107], v[24:27], a[104:111], v1
    ds_read_b128 v[48:51], v7 offset:8192
    v_smfmac_f32_16x16x64_bf16 v[108:111], v[24:27], a[112:119], v1
    ds_read_b128 v[52:55], v7 offset:9216
    v_smfmac_f32_16x16x64_bf16 v[12:15], v[32:35], v[128:135], v1
    v_smfmac_f32_16x16x64_bf16 v[16:19], v[32:35], v[136:143], v1
    v_smfmac_f32_16x16x64_bf16 v[20:23], v[32:35], v[56:63], v1
    ds_read_b64_tr_b16 v[32:33], v2 offset:6144
    s_waitcnt lgkmcnt(3)
    v_smfmac_f32_16x16x64_bf16 v[100:103], v[28:31], a[120:127], v1
    ds_read_b64_tr_b16 v[34:35], v0 offset:6144
    v_smfmac_f32_16x16x64_bf16 v[104:107], v[28:31], a[128:135], v1
    ds_read_b128 v[56:59], v7 offset:10240
    v_smfmac_f32_16x16x64_bf16 v[108:111], v[28:31], a[136:143], v1
    ds_read_b128 v[60:63], v7 offset:11264
    v_smfmac_f32_16x16x64_bf16 v[12:15], v[36:39], v[144:151], v1
    v_smfmac_f32_16x16x64_bf16 v[16:19], v[36:39], v[152:159], v1
    v_smfmac_f32_16x16x64_bf16 v[20:23], v[36:39], v[40:47], v1
    ds_read_b64_tr_b16 v[36:37], v2 offset:7168
    s_waitcnt lgkmcnt(3)
    v_smfmac_f32_16x16x64_bf16 v[100:103], v[32:35], a[144:151], v1
    ds_read_b64_tr_b16 v[38:39], v0 offset:7168
    v_smfmac_f32_16x16x64_bf16 v[104:107], v[32:35], a[152:159], v1
    ds_read_b128 v[40:43], v7 offset:12288
    v_smfmac_f32_16x16x64_bf16 v[108:111], v[32:35], a[160:167], v1
    ds_read_b128 v[44:47], v7 offset:13312
    v_smfmac_f32_16x16x64_bf16 v[12:15], v[24:27], v[160:167], v1
    v_smfmac_f32_16x16x64_bf16 v[16:19], v[24:27], v[168:175], v1
    v_smfmac_f32_16x16x64_bf16 v[20:23], v[24:27], v[48:55], v1
    ds_read_b64_tr_b16 v[24:25], v2 offset:8192
    s_waitcnt lgkmcnt(3)
    v_smfmac_f32_16x16x64_bf16 v[100:103], v[36:39], a[168:175], v1
    ds_read_b64_tr_b16 v[26:27], v0 offset:8192
    v_smfmac_f32_16x16x64_bf16 v[104:107], v[36:39], a[176:183], v1
    ds_read_b128 v[48:51], v7 offset:14336
    v_smfmac_f32_16x16x64_bf16 v[108:111], v[36:39], a[184:191], v1
    ds_read_b128 v[52:55], v7 offset:15360
    v_smfmac_f32_16x16x64_bf16 v[12:15], v[28:31], v[176:183], v1
    v_smfmac_f32_16x16x64_bf16 v[16:19], v[28:31], v[184:191], v1
    v_smfmac_f32_16x16x64_bf16 v[20:23], v[28:31], v[56:63], v1
    ds_read_b64_tr_b16 v[28:29], v2 offset:9216
    s_waitcnt lgkmcnt(3)
    v_smfmac_f32_16x16x64_bf16 v[100:103], v[24:27], a[192:199], v1
    ds_read_b64_tr_b16 v[30:31], v0 offset:9216
    v_smfmac_f32_16x16x64_bf16 v[104:107], v[24:27], a[200:207], v1
    ds_read_b128 v[56:59], v7 offset:16384
    v_smfmac_f32_16x16x64_bf16 v[108:111], v[24:27], a[208:215], v1
    ds_read_b128 v[60:63], v7 offset:17408
    v_smfmac_f32_16x16x64_bf16 v[12:15], v[32:35], v[192:199], v1
    v_smfmac_f32_16x16x64_bf16 v[16:19], v[32:35], v[200:207], v1
    v_smfmac_f32_16x16x64_bf16 v[20:23], v[32:35], v[40:47], v1
    s_waitcnt lgkmcnt(2)
    v_smfmac_f32_16x16x64_bf16 v[100:103], v[28:31], a[216:223], v1
    ds_read_b128 v[40:43], v7 offset:18432
    v_smfmac_f32_16x16x64_bf16 v[104:107], v[28:31], a[224:231], v1
    ds_read_b128 v[44:47], v7 offset:19456
    v_smfmac_f32_16x16x64_bf16 v[108:111], v[28:31], a[232:239], v1
    v_smfmac_f32_16x16x64_bf16 v[12:15], v[36:39], v[208:215], v1
    v_smfmac_f32_16x16x64_bf16 v[16:19], v[36:39], v[216:223], v1
    s_nop 1
    v_add_f32 v100, v100, v102
    v_add_f32 v101, v101, v103
    v_smfmac_f32_16x16x64_bf16 v[20:23], v[36:39], v[48:55], v1
    v_add_f32 v104, v104, v106
    v_add_f32 v105, v105, v107
    v_smfmac_f32_16x16x64_bf16 v[12:15], v[24:27], v[224:231], v1
    v_add_f32 v108, v108, v110
    v_add_f32 v109, v109, v111
    v_smfmac_f32_16x16x64_bf16 v[16:19], v[24:27], v[232:239], v1
    v_cvt_pk_bf16_f32 v100, v100, v101
    v_cvt_pk_bf16_f32 v104, v104, v105
    s_waitcnt lgkmcnt(2)
    v_smfmac_f32_16x16x64_bf16 v[20:23], v[24:27], v[56:63], v1
    ds_write_b32 v4, v100 offset:20480
    v_cvt_pk_bf16_f32 v108, v108, v109
    v_smfmac_f32_16x16x64_bf16 v[12:15], v[28:31], v[240:247], v1
    ds_write_b32 v4, v104 offset:21504
    v_smfmac_f32_16x16x64_bf16 v[16:19], v[28:31], v[248:255], v1
    ds_write_b32 v4, v108 offset:22528
    s_waitcnt lgkmcnt(3)
    v_smfmac_f32_16x16x64_bf16 v[20:23], v[28:31], v[40:47], v1
    s_nop 2
    v_add_f32 v12, v12, v14
    v_add_f32 v13, v13, v15
    v_add_f32 v16, v16, v18
    v_add_f32 v17, v17, v19
    s_nop 0
    v_add_f32 v20, v20, v22
    v_add_f32 v21, v21, v23
    v_cvt_pk_bf16_f32 v24, v12, v13
    v_cvt_pk_bf16_f32 v25, v16, v17
    v_cvt_pk_bf16_f32 v26, v20, v21
    ds_write_b32 v9, v24 offset:23552
    ds_write_b32 v9, v25 offset:24576
    ds_write_b32 v9, v26 offset:25600
    v_mov_b64 v[12:13], 0
    v_mov_b64 v[14:15], 0
    v_mov_b64 v[16:17], 0
    v_mov_b64 v[18:19], 0
    v_mov_b64 v[20:21], 0
    v_mov_b64 v[22:23], 0
    s_waitcnt lgkmcnt(0)
    s_barrier
    s_cmp_lg_u32 s28, 0
    s_cbranch_scc1 qkwx_48
    ds_read_b64_tr_b16 v[24:25], v2 offset:20480
    ds_read_b64_tr_b16 v[26:27], v0 offset:20480
    ds_read_b64_tr_b16 v[28:29], v2 offset:21504
    ds_read_b64_tr_b16 v[30:31], v0 offset:21504
    ds_read_b64_tr_b16 v[32:33], v2 offset:22528
    ds_read_b64_tr_b16 v[34:35], v0 offset:22528
    ds_read_b128 v[104:107], v8 offset:9216
    ds_read_b128 v[100:103], v8 offset:10240
    ds_read_b128 v[108:111], v8 offset:11264
    ds_read_b64_tr_b16 v[40:41], v10 offset:23552
    ds_read_b64_tr_b16 v[42:43], v10 offset:23616
    ds_read_b64_tr_b16 v[44:45], v10 offset:24064
    ds_read_b64_tr_b16 v[46:47], v10 offset:24128
    v_mov_b32 v36, s47
    v_xor_b32 v39, 32, v4
    s_waitcnt lgkmcnt(11)
    v_smfmac_f32_16x16x64_bf16 v[12:15], v[24:27], v[64:71], v1
    v_smfmac_f32_16x16x64_bf16 v[16:19], v[24:27], v[72:79], v1
    ds_read_b64_tr_b16 v[48:49], v10 offset:24576
    ds_read_b64_tr_b16 v[50:51], v10 offset:24640
    ds_read_b64_tr_b16 v[52:53], v10 offset:25088
    ds_read_b64_tr_b16 v[54:55], v10 offset:25152
    s_waitcnt lgkmcnt(13)
    v_smfmac_f32_16x16x64_bf16 v[12:15], v[28:31], v[80:87], v1
    v_smfmac_f32_16x16x64_bf16 v[16:19], v[28:31], v[88:95], v1
    ds_read_b64_tr_b16 v[56:57], v10 offset:25600
    ds_read_b64_tr_b16 v[58:59], v10 offset:25664
    ds_read_b64_tr_b16 v[60:61], v10 offset:26112
    ds_read_b64_tr_b16 v[62:63], v10 offset:26176
    s_waitcnt lgkmcnt(12)
    v_smfmac_f32_16x16x64_bf16 v[12:15], v[32:35], v[96:103], v1
    v_smfmac_f32_16x16x64_bf16 v[16:19], v[32:35], v[104:111], v1
    s_waitcnt lgkmcnt(8)
    v_smfmac_f32_16x16x64_bf16 v[20:23], v[24:27], v[40:47], v1
    s_waitcnt lgkmcnt(4)
    v_smfmac_f32_16x16x64_bf16 v[20:23], v[28:31], v[48:55], v1
    s_waitcnt lgkmcnt(0)
    v_smfmac_f32_16x16x64_bf16 v[20:23], v[32:35], v[56:63], v1
    s_nop 0
    v_add_f32 v12, v12, v14
    v_add_f32 v13, v13, v15
    v_add_f32 v16, v16, v18
    v_add_f32 v17, v17, v19
    s_nop 2
    v_add_f32 v20, v20, v22
    v_add_f32 v21, v21, v23
    v_max3_f32 v37, v12, v16, v20
    v_max3_f32 v38, v13, v17, v21
    s_nop 0
    v_max_f32_dpp v37, v37, v37 row_ror:8 row_mask:0xf bank_mask:0xf
    v_max_f32_dpp v38, v38, v38 row_ror:8 row_mask:0xf bank_mask:0xf
    s_nop 0
    v_max_f32_dpp v37, v37, v37 row_ror:4 row_mask:0xf bank_mask:0xf
    v_max_f32_dpp v38, v38, v38 row_ror:4 row_mask:0xf bank_mask:0xf
    s_nop 0
    v_max_f32_dpp v37, v37, v37 row_ror:2 row_mask:0xf bank_mask:0xf
    v_max_f32_dpp v38, v38, v38 row_ror:2 row_mask:0xf bank_mask:0xf
    s_nop 0
    v_max_f32_dpp v37, v37, v37 row_ror:1 row_mask:0xf bank_mask:0xf
    v_max_f32_dpp v38, v38, v38 row_ror:1 row_mask:0xf bank_mask:0xf
    v_mul_f32 v37, v36, v37
    v_mul_f32 v38, v36, v38
    v_fma_f32 v12, v12, v36, -v37
    v_fma_f32 v13, v13, v36, -v38
    v_fma_f32 v16, v16, v36, -v37
    v_fma_f32 v17, v17, v36, -v38
    v_fma_f32 v20, v20, v36, -v37
    v_fma_f32 v21, v21, v36, -v38
    v_exp_f32 v20, v20
    v_exp_f32 v21, v21
    v_exp_f32 v12, v12
    v_exp_f32 v13, v13
    v_exp_f32 v16, v16
    v_exp_f32 v17, v17
    v_add_f32 v37, v12, v16
    v_add_f32 v38, v13, v17
    s_nop 0
    v_add_f32_dpp v37, v20, v37 quad_perm:[0,1,2,3] row_mask:0xf bank_mask:0x3
    v_add_f32_dpp v38, v21, v38 quad_perm:[0,1,2,3] row_mask:0xf bank_mask:0x3
    s_nop 0
    v_add_f32_dpp v37, v37, v37 row_ror:8 row_mask:0xf bank_mask:0xf
    v_add_f32_dpp v38, v38, v38 row_ror:8 row_mask:0xf bank_mask:0xf
    s_nop 0
    v_add_f32_dpp v37, v37, v37 row_ror:4 row_mask:0xf bank_mask:0xf
    v_add_f32_dpp v38, v38, v38 row_ror:4 row_mask:0xf bank_mask:0xf
    s_nop 0
    v_add_f32_dpp v37, v37, v37 row_ror:2 row_mask:0xf bank_mask:0xf
    v_add_f32_dpp v38, v38, v38 row_ror:2 row_mask:0xf bank_mask:0xf
    s_nop 0
    v_add_f32_dpp v37, v37, v37 row_ror:1 row_mask:0xf bank_mask:0xf
    v_add_f32_dpp v38, v38, v38 row_ror:1 row_mask:0xf bank_mask:0xf
    v_rcp_f32 v37, v37
    v_rcp_f32 v38, v38
    v_mul_f32 v12, v12, v37
    v_mul_f32 v13, v13, v38
    v_mul_f32 v16, v16, v37
    v_mul_f32 v17, v17, v38
    v_mul_f32 v20, v20, v37
    v_mul_f32 v21, v21, v38
    v_cvt_pk_bf16_f32 v12, v12, v13
    v_cvt_pk_bf16_f32 v16, v16, v17
    v_cvt_pk_bf16_f32 v20, v20, v21
    buffer_store_dword v12, v4, s[8:11], s43 offen offset:0
    buffer_store_dword v16, v39, s[8:11], s43 offen offset:256
    buffer_store_dword v20, v11, s[8:11], s44 offen offset:0
    v_mov_b32 v36, -1
    buffer_store_dword v36, v4, s[8:11], s66 offen
    buffer_store_dword v36, v4, s[8:11], s66 offen offset:256
    buffer_store_dword v36, v11, s[8:11], s67 offen
    s_cmp_lg_u32 s31, 0
    s_cbranch_scc1 npg_51
    s_max_u32 s34, s32, 2
    s_sub_u32 s34, s34, 2
    v_mov_b32 v40, s34
    s_mov_b64 exec, 1
    buffer_store_dword v40, off, s[12:15], 0 offset:192 sc1
    s_mov_b64 exec, -1
npg_51:
    s_cmp_eq_u32 s32, 63
    s_cbranch_scc1 qkjoin_50
    s_add_u32 s37, s32, 1
    s_and_b32 s36, s37, 1
    s_mul_i32 s36, s36, 24576
    s_add_u32 s36, s36, 108544
    s_add_u32 m0, s36, 0
    s_add_u32 s34, s40, 0
    buffer_load_dwordx4 v5, s[8:11], s34 offen offset:0 sc1 lds
    buffer_load_dwordx4 v5, s[8:11], s34 offen offset:1024 sc1 lds
    buffer_load_dwordx4 v5, s[8:11], s34 offen offset:2048 sc1 lds
    buffer_load_dwordx4 v5, s[8:11], s34 offen offset:3072 sc1 lds
    s_add_u32 m0, s36, 4096
    s_add_u32 s34, s40, 4096
    buffer_load_dwordx4 v5, s[8:11], s34 offen offset:0 sc1 lds
    buffer_load_dwordx4 v5, s[8:11], s34 offen offset:1024 sc1 lds
    buffer_load_dwordx4 v5, s[8:11], s34 offen offset:2048 sc1 lds
    buffer_load_dwordx4 v5, s[8:11], s34 offen offset:3072 sc1 lds
    s_add_u32 m0, s36, 8192
    s_add_u32 s34, s40, 8192
    buffer_load_dwordx4 v5, s[8:11], s34 offen offset:0 sc1 lds
    buffer_load_dwordx4 v5, s[8:11], s34 offen offset:1024 sc1 lds
    buffer_load_dwordx4 v5, s[8:11], s34 offen offset:2048 sc1 lds
    buffer_load_dwordx4 v5, s[8:11], s34 offen offset:3072 sc1 lds
    s_add_u32 m0, s36, 12288
    s_add_u32 s34, s40, 12288
    buffer_load_dwordx4 v5, s[8:11], s34 offen offset:0 sc1 lds
    buffer_load_dwordx4 v5, s[8:11], s34 offen offset:1024 sc1 lds
    buffer_load_dwordx4 v5, s[8:11], s34 offen offset:2048 sc1 lds
    buffer_load_dwordx4 v5, s[8:11], s34 offen offset:3072 sc1 lds
    s_add_u32 m0, s36, 16384
    s_add_u32 s34, s40, 16384
    buffer_load_dwordx4 v5, s[8:11], s34 offen offset:0 sc1 lds
    buffer_load_dwordx4 v5, s[8:11], s34 offen offset:1024 sc1 lds
    buffer_load_dwordx4 v5, s[8:11], s34 offen offset:2048 sc1 lds
    buffer_load_dwordx4 v5, s[8:11], s34 offen offset:3072 sc1 lds
    s_add_u32 m0, s36, 20480
    s_add_u32 s34, s40, 20480
    buffer_load_dwordx4 v5, s[8:11], s34 offen offset:0 sc1 lds
    buffer_load_dwordx4 v5, s[8:11], s34 offen offset:1024 sc1 lds
    buffer_load_dwordx4 v5, s[8:11], s34 offen offset:2048 sc1 lds
    buffer_load_dwordx4 v5, s[8:11], s34 offen offset:3072 sc1 lds
    s_add_u32 s40, s40, 786432
    s_branch qkjoin_50
qkwx_48:
    s_cmp_eq_u32 s28, 3
    s_cbranch_scc1 qkw3_49
    s_sleep 3
    v_bfe_u32 v100, v5, 4, 4
    v_lshrrev_b32 v101, 8, v5
    s_lshl_b32 s34, s28, 10
    s_add_u32 s34, s34, 11264
    v_add_u32 v102, s34, v8
    ds_read_b128 v[64:67], v102 offset:0
    ds_read_b128 v[68:71], v102 offset:2048
    ds_read_b128 v[72:75], v102 offset:4096
    ds_read_b128 v[76:79], v102 offset:6144
    ds_read_b128 v[80:83], v102 offset:8192
    ds_read_b128 v[84:87], v102 offset:10240
    ds_read_b64_tr_b16 v[40:41], v10 offset:23552
    ds_read_b64_tr_b16 v[42:43], v10 offset:23616
    ds_read_b64_tr_b16 v[44:45], v10 offset:24064
    ds_read_b64_tr_b16 v[46:47], v10 offset:24128
    ds_read_b64_tr_b16 v[48:49], v10 offset:24576
    ds_read_b64_tr_b16 v[50:51], v10 offset:24640
    ds_read_b64_tr_b16 v[52:53], v10 offset:25088
    ds_read_b64_tr_b16 v[54:55], v10 offset:25152
    ds_read_b64_tr_b16 v[56:57], v10 offset:25600
    ds_read_b64_tr_b16 v[58:59], v10 offset:25664
    ds_read_b64_tr_b16 v[60:61], v10 offset:26112
    ds_read_b64_tr_b16 v[62:63], v10 offset:26176
    v_sub_u32 v103, v8, v5
    v_lshrrev_b32 v104, 3, v100
    v_lshl_add_u32 v103, v104, 10, v103
    v_bfe_u32 v104, v100, 2, 1
    v_lshl_add_u32 v103, v104, 7, v103
    v_and_b32 v104, 3, v100
    v_lshl_add_u32 v103, v104, 4, v103
    v_lshl_add_u32 v103, v101, 8, v103
    s_waitcnt lgkmcnt(15)
    s_waitcnt lgkmcnt(10)
    v_mfma_f32_16x16x32_bf16 v[96:99], v[40:43], v[64:67], 0
    s_waitcnt lgkmcnt(8)
    v_mfma_f32_16x16x32_bf16 v[96:99], v[44:47], v[68:71], v[96:99]
    s_waitcnt lgkmcnt(6)
    v_mfma_f32_16x16x32_bf16 v[96:99], v[48:51], v[72:75], v[96:99]
    s_waitcnt lgkmcnt(4)
    v_mfma_f32_16x16x32_bf16 v[96:99], v[52:55], v[76:79], v[96:99]
    s_waitcnt lgkmcnt(2)
    v_mfma_f32_16x16x32_bf16 v[96:99], v[56:59], v[80:83], v[96:99]
    s_waitcnt lgkmcnt(0)
    v_mfma_f32_16x16x32_bf16 v[96:99], v[60:63], v[84:87], v[96:99]
    ds_read_b128 v[12:15], v103 offset:0
    ds_read_b128 v[16:19], v103 offset:2048
    ds_read_b128 v[20:23], v103 offset:4096
    ds_read_b128 v[24:27], v103 offset:6144
    ds_read_b128 v[28:31], v103 offset:8192
    ds_read_b128 v[32:35], v103 offset:10240
    s_waitcnt lgkmcnt(5)
    v_mfma_f32_16x16x32_bf16 v[88:91], v[12:15], v[64:67], 0
    s_waitcnt lgkmcnt(4)
    v_mfma_f32_16x16x32_bf16 v[88:91], v[16:19], v[68:71], v[88:91]
    s_waitcnt lgkmcnt(3)
    v_mfma_f32_16x16x32_bf16 v[88:91], v[20:23], v[72:75], v[88:91]
    s_waitcnt lgkmcnt(2)
    v_mfma_f32_16x16x32_bf16 v[88:91], v[24:27], v[76:79], v[88:91]
    s_waitcnt lgkmcnt(1)
    v_mfma_f32_16x16x32_bf16 v[88:91], v[28:31], v[80:83], v[88:91]
    s_waitcnt lgkmcnt(0)
    v_mfma_f32_16x16x32_bf16 v[88:91], v[32:35], v[84:87], v[88:91]
    ds_read_b128 v[12:15], v103 offset:64
    ds_read_b128 v[16:19], v103 offset:2112
    ds_read_b128 v[20:23], v103 offset:4160
    ds_read_b128 v[24:27], v103 offset:6208
    ds_read_b128 v[28:31], v103 offset:8256
    ds_read_b128 v[32:35], v103 offset:10304
    s_waitcnt lgkmcnt(5)
    v_mfma_f32_16x16x32_bf16 v[92:95], v[12:15], v[64:67], 0
    s_waitcnt lgkmcnt(4)
    v_mfma_f32_16x16x32_bf16 v[92:95], v[16:19], v[68:71], v[92:95]
    s_waitcnt lgkmcnt(3)
    v_mfma_f32_16x16x32_bf16 v[92:95], v[20:23], v[72:75], v[92:95]
    s_waitcnt lgkmcnt(2)
    v_mfma_f32_16x16x32_bf16 v[92:95], v[24:27], v[76:79], v[92:95]
    s_waitcnt lgkmcnt(1)
    v_mfma_f32_16x16x32_bf16 v[92:95], v[28:31], v[80:83], v[92:95]
    s_waitcnt lgkmcnt(0)
    v_mfma_f32_16x16x32_bf16 v[92:95], v[32:35], v[84:87], v[92:95]
    s_lshl_b32 s34, s28, 4
    s_sub_u32 s34, s34, 16
    v_lshlrev_b32 v102, 3, v101
    v_sub_u32 v102, v100, v102
    v_add_u32 v102, s34, v102
    v_mov_b32 v103, 0xff800000
    v_cmp_le_i32 vcc, 0, v102
    s_nop 1
    v_cndmask_b32 v88, v103, v88, vcc
    v_cmp_le_i32 vcc, 1, v102
    s_nop 1
    v_cndmask_b32 v89, v103, v89, vcc
    v_cmp_le_i32 vcc, 2, v102
    s_nop 1
    v_cndmask_b32 v90, v103, v90, vcc
    v_cmp_le_i32 vcc, 3, v102
    s_nop 1
    v_cndmask_b32 v91, v103, v91, vcc
    v_cmp_le_i32 vcc, 4, v102
    s_nop 1
    v_cndmask_b32 v92, v103, v92, vcc
    v_cmp_le_i32 vcc, 5, v102
    s_nop 1
    v_cndmask_b32 v93, v103, v93, vcc
    v_cmp_le_i32 vcc, 6, v102
    s_nop 1
    v_cndmask_b32 v94, v103, v94, vcc
    v_cmp_le_i32 vcc, 7, v102
    s_nop 1
    v_cndmask_b32 v95, v103, v95, vcc
    v_cmp_gt_u32 vcc, 2, v101
    s_nop 1
    v_cndmask_b32 v96, v103, v96, vcc
    v_cndmask_b32 v97, v103, v97, vcc
    v_cndmask_b32 v98, v103, v98, vcc
    v_cndmask_b32 v99, v103, v99, vcc
    v_max3_f32 v104, v88, v89, v90
    v_max3_f32 v104, v104, v91, v92
    v_max3_f32 v104, v104, v93, v94
    v_max3_f32 v104, v104, v95, v96
    v_max3_f32 v104, v104, v97, v98
    v_max_f32 v104, v104, v99
    v_mov_b32 v105, v104
    s_nop 1
    v_permlane16_swap_b32 v104, v105
    v_max_f32 v104, v104, v105
    v_mov_b32 v105, v104
    s_nop 1
    v_permlane32_swap_b32 v104, v105
    v_max_f32 v104, v104, v105
    v_mul_f32 v104, s47, v104
    v_fma_f32 v88, v88, s47, -v104
    v_fma_f32 v89, v89, s47, -v104
    v_fma_f32 v90, v90, s47, -v104
    v_fma_f32 v91, v91, s47, -v104
    v_fma_f32 v92, v92, s47, -v104
    v_fma_f32 v93, v93, s47, -v104
    v_fma_f32 v94, v94, s47, -v104
    v_fma_f32 v95, v95, s47, -v104
    v_fma_f32 v96, v96, s47, -v104
    v_fma_f32 v97, v97, s47, -v104
    v_fma_f32 v98, v98, s47, -v104
    v_fma_f32 v99, v99, s47, -v104
    v_exp_f32 v88, v88
    v_exp_f32 v89, v89
    v_exp_f32 v90, v90
    v_exp_f32 v91, v91
    v_exp_f32 v92, v92
    v_exp_f32 v93, v93
    v_exp_f32 v94, v94
    v_exp_f32 v95, v95
    v_exp_f32 v96, v96
    v_exp_f32 v97, v97
    v_exp_f32 v98, v98
    v_exp_f32 v99, v99
    v_add_f32 v104, v88, v89
    v_add_f32 v104, v104, v90
    v_add_f32 v104, v104, v91
    v_add_f32 v104, v104, v92
    v_add_f32 v104, v104, v93
    v_add_f32 v104, v104, v94
    v_add_f32 v104, v104, v95
    v_add_f32 v104, v104, v96
    v_add_f32 v104, v104, v97
    v_add_f32 v104, v104, v98
    v_add_f32 v104, v104, v99
    v_mov_b32 v105, v104
    s_nop 1
    v_permlane16_swap_b32 v104, v105
    v_add_f32 v104, v104, v105
    v_mov_b32 v105, v104
    s_nop 1
    v_permlane32_swap_b32 v104, v105
    v_add_f32 v104, v104, v105
    v_rcp_f32 v104, v104
    s_nop 0
    v_mul_f32 v88, v88, v104
    v_mul_f32 v89, v89, v104
    v_mul_f32 v90, v90, v104
    v_mul_f32 v91, v91, v104
    v_mul_f32 v92, v92, v104
    v_mul_f32 v93, v93, v104
    v_mul_f32 v94, v94, v104
    v_mul_f32 v95, v95, v104
    v_mul_f32 v96, v96, v104
    v_mul_f32 v97, v97, v104
    v_mul_f32 v98, v98, v104
    v_mul_f32 v99, v99, v104
    v_cvt_pk_bf16_f32 v64, v88, v89
    v_cvt_pk_bf16_f32 v65, v90, v91
    v_cvt_pk_bf16_f32 v66, v92, v93
    v_cvt_pk_bf16_f32 v67, v94, v95
    v_cvt_pk_bf16_f32 v68, v96, v97
    v_cvt_pk_bf16_f32 v69, v98, v99
    s_branch qkjoin_50
qkw3_49:
    s_add_u32 s37, s32, 2
    s_and_b32 s34, s37, 0x43
    s_cmp_lg_u32 s34, 0
    s_cbranch_scc1 qkjoin_50
    s_lshr_b32 s36, s37, 2
    s_lshl_b32 s34, s36, 3
    s_lshl_b32 s50, s36, 1
    s_add_u32 s50, s50, s29
    s_cmp_eq_u32 s36, 0
    s_cselect_b32 s51, 32, 16
fl_52:
    buffer_load_dwordx2 v[12:13], off, s[12:15], s34 offset:64 sc1
    buffer_load_ubyte v14, off, s[12:15], s50 offset:200 sc1
    s_waitcnt vmcnt(0)
    v_and_b32 v12, v12, v13
    s_nop 0
    v_readfirstlane_b32 s35, v12
    s_nop 0
    s_bitcmp1_b32 s35, s31
    s_cbranch_scc0 fln_54
    v_readfirstlane_b32 s35, v14
    s_nop 0
    s_cmp_ge_u32 s35, s51
    s_cbranch_scc1 fld_53
fln_54:
    s_sleep 3
    s_sub_u32 s33, s33, 1
    s_cbranch_scc0 fl_52
    s_mov_b32 s33, 0
fld_53:
qkjoin_50:
    s_mov_b32 s41, s62
    s_mov_b32 s42, s49
    s_cmp_eq_u32 s32, 63
    s_cbranch_scc1 qkend_47
    s_add_u32 s32, s32, 1
    s_and_b32 s34, s32, 3
    s_mul_i32 s34, s34, 20480
    s_add_u32 s43, s60, s34
    s_and_b32 s34, s32, 3
    s_mul_i32 s34, s34, 20480
    s_add_u32 s44, s61, s34
    s_add_u32 s34, s32, 2
    s_and_b32 s34, s34, 3
    s_mul_i32 s34, s34, 20480
    s_add_u32 s66, s60, s34
    s_add_u32 s34, s32, 2
    s_and_b32 s34, s34, 3
    s_mul_i32 s34, s34, 20480
    s_add_u32 s67, s61, s34
    s_and_b32 s34, s32, 3
    s_mul_i32 s34, s34, 65536
    s_add_u32 s38, s64, s34
    s_and_b32 s34, s32, 3
    s_mul_i32 s34, s34, 65536
    s_add_u32 s39, s65, s34
    v_mov_b64 v[16:17], 0
    v_mov_b64 v[18:19], 0
    v_mov_b64 v[20:21], 0
    v_mov_b64 v[22:23], 0
    v_mov_b64 v[100:101], 0
    v_mov_b64 v[102:103], 0
    v_mov_b64 v[104:105], 0
    v_mov_b64 v[106:107], 0
    v_mov_b64 v[108:109], 0
    v_mov_b64 v[110:111], 0
    v_bfe_u32 v12, v5, 4, 4
    v_lshrrev_b32 v13, 8, v5
    v_lshlrev_b32 v13, 2, v13
    v_sub_u32 v12, v12, v13
    v_lshlrev_b32 v13, 4, v12
    v_mov_b32 v14, 0x3f80
    v_mov_b32 v15, 0
    v_lshlrev_b64 v[14:15], v13, v[14:15]
    v_cmp_gt_u32 vcc, 4, v12
    s_nop 1
    v_cndmask_b32 v14, 0, v14, vcc
    v_cndmask_b32 v15, 0, v15, vcc
    v_xor_b32 v8, 237568, v8
    s_add_u32 s62, s62, 65536
    s_add_u32 s49, s49, 16384
    s_add_u32 s56, s56, 1310720
    s_add_u32 s57, s57, s59
    s_waitcnt vmcnt(0)
    s_cmp_lg_u32 s28, 0
    s_cbranch_scc1 kxe_57
    ds_read_b128 v[64:67], v8 offset:0
    ds_read_b128 v[72:75], v8 offset:1024
    ds_read_b128 v[68:71], v8 offset:2048
    ds_read_b128 v[76:79], v8 offset:3072
    ds_read_b128 v[80:83], v8 offset:4096
    ds_read_b128 v[88:91], v8 offset:5120
    ds_read_b128 v[84:87], v8 offset:6144
    ds_read_b128 v[92:95], v8 offset:7168
    ds_read_b128 v[96:99], v8 offset:8192
kxe_57:
    s_cmp_lg_u32 s28, 3
    s_cbranch_scc1 np_55
    s_lshl_b32 s35, s29, 8
    s_add_u32 s35, s35, 157286400
    v_bfe_u32 v25, v5, 2, 6
    v_and_b32 v25, 60, v25
    buffer_load_dword v24, v25, s[8:11], s35 offen sc1
    s_sleep 1
    buffer_load_dword v24, v25, s[8:11], s35 offen sc1
    s_sleep 1
pr_56:
    buffer_load_dword v24, v25, s[8:11], s35 offen sc1
    s_waitcnt vmcnt(2)
    v_cmp_gt_u32 vcc, s32, v24
    s_cbranch_vccz np_55_d
    s_sub_u32 s33, s33, 1
    s_cbranch_scc0 pr_56
    s_mov_b32 s33, 0
np_55_d:
    s_sleep 3
np_55:
    s_barrier
    buffer_load_dwordx4 v[44:47], v6, s[8:11], s38 offen sc1
    buffer_load_dwordx4 v[48:51], v6, s[8:11], s38 offen offset:1024 sc1
    buffer_load_dwordx2 v[52:53], v3, s[8:11], s38 offen offset:2048 sc1
    s_barrier
    buffer_load_dwordx4 v[54:57], v6, s[8:11], s39 offen sc1
    buffer_load_dwordx4 v[58:61], v6, s[8:11], s39 offen offset:1024 sc1
    buffer_load_dwordx2 v[62:63], v3, s[8:11], s39 offen offset:2048 sc1
mlc_59:
    s_waitcnt vmcnt(5)
    v_max3_u32 v12, v44, v45, v46
    s_waitcnt vmcnt(4)
    v_max3_u32 v13, v48, v49, v50
    v_max3_u32 v12, v12, v47, v51
    s_waitcnt vmcnt(3)
    v_max3_u32 v13, v13, v52, v53
    v_max_u32 v12, v12, v13
    v_cmp_eq_u32 vcc, -1, v12
    s_cbranch_vccnz ml_58
mld_60:
    v_mfma_f32_16x16x16_bf16 v[24:27], v[14:15], v[44:45], 0
    v_mfma_f32_16x16x16_bf16 v[28:31], v[14:15], v[46:47], 0
    v_mfma_f32_16x16x16_bf16 v[32:35], v[14:15], v[48:49], 0
    v_mfma_f32_16x16x16_bf16 v[36:39], v[14:15], v[50:51], 0
    v_mfma_f32_16x16x16_bf16 v[40:43], v[14:15], v[52:53], 0
    s_waitcnt vmcnt(2)
    v_mfma_f32_16x16x16_bf16 v[24:27], v[14:15], v[54:55], v[24:27]
    v_max3_u32 v12, v54, v55, v56
    v_mfma_f32_16x16x16_bf16 v[28:31], v[14:15], v[56:57], v[28:31]
    s_waitcnt vmcnt(1)
    v_mfma_f32_16x16x16_bf16 v[32:35], v[14:15], v[58:59], v[32:35]
    v_max3_u32 v13, v58, v59, v60
    v_mfma_f32_16x16x16_bf16 v[36:39], v[14:15], v[60:61], v[36:39]
    v_max3_u32 v12, v12, v57, v61
    s_waitcnt vmcnt(0)
    v_mfma_f32_16x16x16_bf16 v[40:43], v[14:15], v[62:63], v[40:43]
    v_max3_u32 v13, v13, v62, v63
    v_cvt_pk_bf16_f32 v24, v24, v25
    v_cvt_pk_bf16_f32 v25, v26, v27
    v_cvt_pk_bf16_f32 v26, v28, v29
    v_cvt_pk_bf16_f32 v27, v30, v31
    ds_write_b128 v6, v[24:27] offset:0
    v_max_u32 v12, v12, v13
    v_cvt_pk_bf16_f32 v28, v32, v33
    v_cvt_pk_bf16_f32 v29, v34, v35
    v_cvt_pk_bf16_f32 v30, v36, v37
    v_cvt_pk_bf16_f32 v31, v38, v39
    ds_write_b128 v6, v[28:31] offset:1024
    v_cmp_eq_u32 vcc, -1, v12
    v_cvt_pk_bf16_f32 v32, v40, v41
    v_cvt_pk_bf16_f32 v33, v42, v43
    ds_write_b64 v3, v[32:33] offset:2048
    s_cbranch_vccnz mr_61
mrd_63:
    v_mov_b64 v[12:13], 0
    v_mov_b64 v[14:15], 0
    buffer_store_dwordx4 v[64:67], v5, s[8:11], s41 offen sc1
    buffer_store_dwordx2 v[68:69], v11, s[8:11], s42 offen sc1
    s_waitcnt lgkmcnt(0)
    s_branch qkloop_46
ml_58:
    s_sub_u32 s33, s33, 1
    s_cbranch_scc1 ml_58_t
    buffer_load_dwordx4 v[44:47], v6, s[8:11], s38 offen sc1
    buffer_load_dwordx4 v[48:51], v6, s[8:11], s38 offen offset:1024 sc1
    buffer_load_dwordx2 v[52:53], v3, s[8:11], s38 offen offset:2048 sc1
    buffer_load_dwordx4 v[54:57], v6, s[8:11], s39 offen sc1
    buffer_load_dwordx4 v[58:61], v6, s[8:11], s39 offen offset:1024 sc1
    buffer_load_dwordx2 v[62:63], v3, s[8:11], s39 offen offset:2048 sc1
    s_branch mlc_59
ml_58_t:
    s_mov_b32 s33, 0
    s_branch mld_60
mr_61:
    s_sub_u32 s33, s33, 1
    s_cbranch_scc1 mr_61_t
    buffer_load_dwordx4 v[54:57], v6, s[8:11], s39 offen sc1
    buffer_load_dwordx4 v[58:61], v6, s[8:11], s39 offen offset:1024 sc1
    buffer_load_dwordx2 v[62:63], v3, s[8:11], s39 offen offset:2048 sc1
    s_waitcnt vmcnt(2)
    v_max3_u32 v12, v54, v55, v56
    s_waitcnt vmcnt(1)
    v_max3_u32 v13, v58, v59, v60
    v_max3_u32 v12, v12, v57, v61
    s_waitcnt vmcnt(0)
    v_max3_u32 v13, v13, v62, v63
    v_max_u32 v12, v12, v13
    v_cmp_eq_u32 vcc, -1, v12
    s_cbranch_vccnz mr_61
    s_branch mld_60
mr_61_t:
    s_mov_b32 s33, 0
    s_branch mrd_63
qkend_47:
    buffer_store_dwordx4 v[64:67], v5, s[8:11], s41 offen sc1
    buffer_store_dwordx2 v[68:69], v11, s[8:11], s42 offen sc1
    s_waitcnt vmcnt(0)
    s_barrier
    s_cmp_lg_u32 s28, 0
    s_cbranch_scc1 dn_64
    v_mov_b32 v24, 1
    s_mov_b64 exec, 1
    buffer_atomic_add v24, off, s[12:15], 0 offset:196 sc1
    s_mov_b64 exec, -1
dn_64:
    s_endpgm
qkslow_45:
qkloop_65:
    s_barrier
    ds_read_b64_tr_b16 v[24:25], v2 offset:0
    ds_read_b64_tr_b16 v[26:27], v0 offset:0
    ds_read_b64_tr_b16 v[28:29], v2 offset:1024
    ds_read_b64_tr_b16 v[30:31], v0 offset:1024
    ds_read_b64_tr_b16 v[32:33], v2 offset:2048
    ds_read_b64_tr_b16 v[34:35], v0 offset:2048
    s_mov_b32 m0, 157696
    v_lshlrev_b32 v63, 3, v5
    buffer_load_dword v63, s[8:11], s56 offen sc1 lds
    s_waitcnt lgkmcnt(4)
    v_smfmac_f32_16x16x64_bf16 v[100:103], v[24:27], a[0:7], v1
    ds_read_b64_tr_b16 v[36:37], v2 offset:3072
    v_smfmac_f32_16x16x64_bf16 v[104:107], v[24:27], a[8:15], v1
    ds_read_b64_tr_b16 v[38:39], v0 offset:3072
    buffer_load_dword v63, s[8:11], s57 offen sc1 lds
    v_smfmac_f32_16x16x64_bf16 v[108:111], v[24:27], a[16:23], v1
    ds_read_b128 v[40:43], v7 offset:0
    s_waitcnt lgkmcnt(5)
    v_smfmac_f32_16x16x64_bf16 v[100:103], v[28:31], a[24:31], v1
    ds_read_b128 v[44:47], v7 offset:1024
    v_smfmac_f32_16x16x64_bf16 v[104:107], v[28:31], a[32:39], v1
    ds_read_b128 v[48:51], v7 offset:2048
    v_smfmac_f32_16x16x64_bf16 v[108:111], v[28:31], a[40:47], v1
    ds_read_b128 v[52:55], v7 offset:3072
    s_waitcnt lgkmcnt(6)
    v_smfmac_f32_16x16x64_bf16 v[100:103], v[32:35], a[48:55], v1
    ds_read_b128 v[56:59], v7 offset:4096
    v_smfmac_f32_16x16x64_bf16 v[104:107], v[32:35], a[56:63], v1
    ds_read_b128 v[60:63], v7 offset:5120
    v_smfmac_f32_16x16x64_bf16 v[108:111], v[32:35], a[64:71], v1
    v_smfmac_f32_16x16x64_bf16 v[12:15], v[24:27], a[240:247], v1
    v_smfmac_f32_16x16x64_bf16 v[16:19], v[24:27], a[248:255], v1
    s_waitcnt lgkmcnt(4)
    v_smfmac_f32_16x16x64_bf16 v[20:23], v[24:27], v[40:47], v1
    ds_read_b64_tr_b16 v[24:25], v2 offset:4096
    v_smfmac_f32_16x16x64_bf16 v[100:103], v[36:39], a[72:79], v1
    ds_read_b64_tr_b16 v[26:27], v0 offset:4096
    v_smfmac_f32_16x16x64_bf16 v[104:107], v[36:39], a[80:87], v1
    ds_read_b128 v[40:43], v7 offset:6144
    v_smfmac_f32_16x16x64_bf16 v[108:111], v[36:39], a[88:95], v1
    ds_read_b128 v[44:47], v7 offset:7168
    v_smfmac_f32_16x16x64_bf16 v[12:15], v[28:31], v[112:119], v1
    v_smfmac_f32_16x16x64_bf16 v[16:19], v[28:31], v[120:127], v1
    s_waitcnt lgkmcnt(6)
    v_smfmac_f32_16x16x64_bf16 v[20:23], v[28:31], v[48:55], v1
    ds_read_b64_tr_b16 v[28:29], v2 offset:5120
    s_waitcnt lgkmcnt(3)
    v_smfmac_f32_16x16x64_bf16 v[100:103], v[24:27], a[96:103], v1
    ds_read_b64_tr_b16 v[30:31], v0 offset:5120
    v_smfmac_f32_16x16x64_bf16 v[104:107], v[24:27], a[104:111], v1
    ds_read_b128 v[48:51], v7 offset:8192
    v_smfmac_f32_16x16x64_bf16 v[108:111], v[24:27], a[112:119], v1
    ds_read_b128 v[52:55], v7 offset:9216
    v_smfmac_f32_16x16x64_bf16 v[12:15], v[32:35], v[128:135], v1
    v_smfmac_f32_16x16x64_bf16 v[16:19], v[32:35], v[136:143], v1
    v_smfmac_f32_16x16x64_bf16 v[20:23], v[32:35], v[56:63], v1
    ds_read_b64_tr_b16 v[32:33], v2 offset:6144
    s_waitcnt lgkmcnt(3)
    v_smfmac_f32_16x16x64_bf16 v[100:103], v[28:31], a[120:127], v1
    ds_read_b64_tr_b16 v[34:35], v0 offset:6144
    v_smfmac_f32_16x16x64_bf16 v[104:107], v[28:31], a[128:135], v1
    ds_read_b128 v[56:59], v7 offset:10240
    v_smfmac_f32_16x16x64_bf16 v[108:111], v[28:31], a[136:143], v1
    ds_read_b128 v[60:63], v7 offset:11264
    v_smfmac_f32_16x16x64_bf16 v[12:15], v[36:39], v[144:151], v1
    v_smfmac_f32_16x16x64_bf16 v[16:19], v[36:39], v[152:159], v1
    v_smfmac_f32_16x16x64_bf16 v[20:23], v[36:39], v[40:47], v1
    ds_read_b64_tr_b16 v[36:37], v2 offset:7168
    s_waitcnt lgkmcnt(3)
    v_smfmac_f32_16x16x64_bf16 v[100:103], v[32:35], a[144:151], v1
    ds_read_b64_tr_b16 v[38:39], v0 offset:7168
    v_smfmac_f32_16x16x64_bf16 v[104:107], v[32:35], a[152:159], v1
    ds_read_b128 v[40:43], v7 offset:12288
    v_smfmac_f32_16x16x64_bf16 v[108:111], v[32:35], a[160:167], v1
    ds_read_b128 v[44:47], v7 offset:13312
    v_smfmac_f32_16x16x64_bf16 v[12:15], v[24:27], v[160:167], v1
    v_smfmac_f32_16x16x64_bf16 v[16:19], v[24:27], v[168:175], v1
    v_smfmac_f32_16x16x64_bf16 v[20:23], v[24:27], v[48:55], v1
    ds_read_b64_tr_b16 v[24:25], v2 offset:8192
    s_waitcnt lgkmcnt(3)
    v_smfmac_f32_16x16x64_bf16 v[100:103], v[36:39], a[168:175], v1
    ds_read_b64_tr_b16 v[26:27], v0 offset:8192
    v_smfmac_f32_16x16x64_bf16 v[104:107], v[36:39], a[176:183], v1
    ds_read_b128 v[48:51], v7 offset:14336
    v_smfmac_f32_16x16x64_bf16 v[108:111], v[36:39], a[184:191], v1
    ds_read_b128 v[52:55], v7 offset:15360
    v_smfmac_f32_16x16x64_bf16 v[12:15], v[28:31], v[176:183], v1
    v_smfmac_f32_16x16x64_bf16 v[16:19], v[28:31], v[184:191], v1
    v_smfmac_f32_16x16x64_bf16 v[20:23], v[28:31], v[56:63], v1
    ds_read_b64_tr_b16 v[28:29], v2 offset:9216
    s_waitcnt lgkmcnt(3)
    v_smfmac_f32_16x16x64_bf16 v[100:103], v[24:27], a[192:199], v1
    ds_read_b64_tr_b16 v[30:31], v0 offset:9216
    v_smfmac_f32_16x16x64_bf16 v[104:107], v[24:27], a[200:207], v1
    ds_read_b128 v[56:59], v7 offset:16384
    v_smfmac_f32_16x16x64_bf16 v[108:111], v[24:27], a[208:215], v1
    ds_read_b128 v[60:63], v7 offset:17408
    v_smfmac_f32_16x16x64_bf16 v[12:15], v[32:35], v[192:199], v1
    v_smfmac_f32_16x16x64_bf16 v[16:19], v[32:35], v[200:207], v1
    v_smfmac_f32_16x16x64_bf16 v[20:23], v[32:35], v[40:47], v1
    s_waitcnt lgkmcnt(2)
    v_smfmac_f32_16x16x64_bf16 v[100:103], v[28:31], a[216:223], v1
    ds_read_b128 v[40:43], v7 offset:18432
    v_smfmac_f32_16x16x64_bf16 v[104:107], v[28:31], a[224:231], v1
    ds_read_b128 v[44:47], v7 offset:19456
    v_smfmac_f32_16x16x64_bf16 v[108:111], v[28:31], a[232:239], v1
    v_smfmac_f32_16x16x64_bf16 v[12:15], v[36:39], v[208:215], v1
    v_smfmac_f32_16x16x64_bf16 v[16:19], v[36:39], v[216:223], v1
    s_nop 1
    v_add_f32 v100, v100, v102
    v_add_f32 v101, v101, v103
    v_smfmac_f32_16x16x64_bf16 v[20:23], v[36:39], v[48:55], v1
    v_add_f32 v104, v104, v106
    v_add_f32 v105, v105, v107
    v_smfmac_f32_16x16x64_bf16 v[12:15], v[24:27], v[224:231], v1
    v_add_f32 v108, v108, v110
    v_add_f32 v109, v109, v111
    v_smfmac_f32_16x16x64_bf16 v[16:19], v[24:27], v[232:239], v1
    v_cvt_pk_bf16_f32 v100, v100, v101
    v_cvt_pk_bf16_f32 v104, v104, v105
    s_waitcnt lgkmcnt(2)
    v_smfmac_f32_16x16x64_bf16 v[20:23], v[24:27], v[56:63], v1
    ds_write_b32 v4, v100 offset:20480
    v_cvt_pk_bf16_f32 v108, v108, v109
    v_smfmac_f32_16x16x64_bf16 v[12:15], v[28:31], v[240:247], v1
    ds_write_b32 v4, v104 offset:21504
    v_smfmac_f32_16x16x64_bf16 v[16:19], v[28:31], v[248:255], v1
    ds_write_b32 v4, v108 offset:22528
    s_waitcnt lgkmcnt(3)
    v_smfmac_f32_16x16x64_bf16 v[20:23], v[28:31], v[40:47], v1
    s_nop 2
    v_add_f32 v12, v12, v14
    v_add_f32 v13, v13, v15
    v_add_f32 v16, v16, v18
    v_add_f32 v17, v17, v19
    s_nop 0
    v_add_f32 v20, v20, v22
    v_add_f32 v21, v21, v23
    v_cvt_pk_bf16_f32 v24, v12, v13
    v_cvt_pk_bf16_f32 v25, v16, v17
    v_cvt_pk_bf16_f32 v26, v20, v21
    ds_write_b32 v9, v24 offset:23552
    ds_write_b32 v9, v25 offset:24576
    ds_write_b32 v9, v26 offset:25600
    v_mov_b64 v[12:13], 0
    v_mov_b64 v[14:15], 0
    v_mov_b64 v[16:17], 0
    v_mov_b64 v[18:19], 0
    v_mov_b64 v[20:21], 0
    v_mov_b64 v[22:23], 0
    s_waitcnt lgkmcnt(0)
    s_barrier
    s_cmp_lg_u32 s28, 0
    s_cbranch_scc1 qkwx_67
    ds_read_b64_tr_b16 v[24:25], v2 offset:20480
    ds_read_b64_tr_b16 v[26:27], v0 offset:20480
    ds_read_b64_tr_b16 v[28:29], v2 offset:21504
    ds_read_b64_tr_b16 v[30:31], v0 offset:21504
    ds_read_b64_tr_b16 v[32:33], v2 offset:22528
    ds_read_b64_tr_b16 v[34:35], v0 offset:22528
    ds_read_b128 v[104:107], v8 offset:9216
    ds_read_b128 v[100:103], v8 offset:10240
    ds_read_b128 v[108:111], v8 offset:11264
    ds_read_b64_tr_b16 v[40:41], v10 offset:23552
    ds_read_b64_tr_b16 v[42:43], v10 offset:23616
    ds_read_b64_tr_b16 v[44:45], v10 offset:24064
    ds_read_b64_tr_b16 v[46:47], v10 offset:24128
    v_mov_b32 v36, s47
    v_xor_b32 v39, 32, v4
    s_waitcnt lgkmcnt(11)
    v_smfmac_f32_16x16x64_bf16 v[12:15], v[24:27], v[64:71], v1
    v_smfmac_f32_16x16x64_bf16 v[16:19], v[24:27], v[72:79], v1
    ds_read_b64_tr_b16 v[48:49], v10 offset:24576
    ds_read_b64_tr_b16 v[50:51], v10 offset:24640
    ds_read_b64_tr_b16 v[52:53], v10 offset:25088
    ds_read_b64_tr_b16 v[54:55], v10 offset:25152
    s_waitcnt lgkmcnt(13)
    v_smfmac_f32_16x16x64_bf16 v[12:15], v[28:31], v[80:87], v1
    v_smfmac_f32_16x16x64_bf16 v[16:19], v[28:31], v[88:95], v1
    ds_read_b64_tr_b16 v[56:57], v10 offset:25600
    ds_read_b64_tr_b16 v[58:59], v10 offset:25664
    ds_read_b64_tr_b16 v[60:61], v10 offset:26112
    ds_read_b64_tr_b16 v[62:63], v10 offset:26176
    s_waitcnt lgkmcnt(12)
    v_smfmac_f32_16x16x64_bf16 v[12:15], v[32:35], v[96:103], v1
    v_smfmac_f32_16x16x64_bf16 v[16:19], v[32:35], v[104:111], v1
    s_waitcnt lgkmcnt(8)
    v_smfmac_f32_16x16x64_bf16 v[20:23], v[24:27], v[40:47], v1
    s_waitcnt lgkmcnt(4)
    v_smfmac_f32_16x16x64_bf16 v[20:23], v[28:31], v[48:55], v1
    s_waitcnt lgkmcnt(0)
    v_smfmac_f32_16x16x64_bf16 v[20:23], v[32:35], v[56:63], v1
    s_nop 0
    v_add_f32 v12, v12, v14
    v_add_f32 v13, v13, v15
    v_add_f32 v16, v16, v18
    v_add_f32 v17, v17, v19
    s_nop 2
    v_add_f32 v20, v20, v22
    v_add_f32 v21, v21, v23
    v_max3_f32 v37, v12, v16, v20
    v_max3_f32 v38, v13, v17, v21
    s_nop 0
    v_max_f32_dpp v37, v37, v37 row_ror:8 row_mask:0xf bank_mask:0xf
    v_max_f32_dpp v38, v38, v38 row_ror:8 row_mask:0xf bank_mask:0xf
    s_nop 0
    v_max_f32_dpp v37, v37, v37 row_ror:4 row_mask:0xf bank_mask:0xf
    v_max_f32_dpp v38, v38, v38 row_ror:4 row_mask:0xf bank_mask:0xf
    s_nop 0
    v_max_f32_dpp v37, v37, v37 row_ror:2 row_mask:0xf bank_mask:0xf
    v_max_f32_dpp v38, v38, v38 row_ror:2 row_mask:0xf bank_mask:0xf
    s_nop 0
    v_max_f32_dpp v37, v37, v37 row_ror:1 row_mask:0xf bank_mask:0xf
    v_max_f32_dpp v38, v38, v38 row_ror:1 row_mask:0xf bank_mask:0xf
    v_mul_f32 v37, v36, v37
    v_mul_f32 v38, v36, v38
    v_fma_f32 v12, v12, v36, -v37
    v_fma_f32 v13, v13, v36, -v38
    v_fma_f32 v16, v16, v36, -v37
    v_fma_f32 v17, v17, v36, -v38
    v_fma_f32 v20, v20, v36, -v37
    v_fma_f32 v21, v21, v36, -v38
    v_exp_f32 v20, v20
    v_exp_f32 v21, v21
    v_exp_f32 v12, v12
    v_exp_f32 v13, v13
    v_exp_f32 v16, v16
    v_exp_f32 v17, v17
    v_add_f32 v37, v12, v16
    v_add_f32 v38, v13, v17
    s_nop 0
    v_add_f32_dpp v37, v20, v37 quad_perm:[0,1,2,3] row_mask:0xf bank_mask:0x3
    v_add_f32_dpp v38, v21, v38 quad_perm:[0,1,2,3] row_mask:0xf bank_mask:0x3
    s_nop 0
    v_add_f32_dpp v37, v37, v37 row_ror:8 row_mask:0xf bank_mask:0xf
    v_add_f32_dpp v38, v38, v38 row_ror:8 row_mask:0xf bank_mask:0xf
    s_nop 0
    v_add_f32_dpp v37, v37, v37 row_ror:4 row_mask:0xf bank_mask:0xf
    v_add_f32_dpp v38, v38, v38 row_ror:4 row_mask:0xf bank_mask:0xf
    s_nop 0
    v_add_f32_dpp v37, v37, v37 row_ror:2 row_mask:0xf bank_mask:0xf
    v_add_f32_dpp v38, v38, v38 row_ror:2 row_mask:0xf bank_mask:0xf
    s_nop 0
    v_add_f32_dpp v37, v37, v37 row_ror:1 row_mask:0xf bank_mask:0xf
    v_add_f32_dpp v38, v38, v38 row_ror:1 row_mask:0xf bank_mask:0xf
    v_rcp_f32 v37, v37
    v_rcp_f32 v38, v38
    v_mul_f32 v12, v12, v37
    v_mul_f32 v13, v13, v38
    v_mul_f32 v16, v16, v37
    v_mul_f32 v17, v17, v38
    v_mul_f32 v20, v20, v37
    v_mul_f32 v21, v21, v38
    v_cvt_pk_bf16_f32 v12, v12, v13
    v_cvt_pk_bf16_f32 v16, v16, v17
    v_cvt_pk_bf16_f32 v20, v20, v21
    buffer_store_dword v12, v4, s[8:11], s43 offen offset:0 sc1
    buffer_store_dword v16, v39, s[8:11], s43 offen offset:256 sc1
    buffer_store_dword v20, v11, s[8:11], s44 offen offset:0 sc1
    v_mov_b32 v36, -1
    buffer_store_dword v36, v4, s[8:11], s66 offen sc1
    buffer_store_dword v36, v4, s[8:11], s66 offen offset:256 sc1
    buffer_store_dword v36, v11, s[8:11], s67 offen sc1
    s_cmp_lg_u32 s31, 0
    s_cbranch_scc1 npg_70
    s_max_u32 s34, s32, 2
    s_sub_u32 s34, s34, 2
    v_mov_b32 v40, s34
    s_mov_b64 exec, 1
    buffer_store_dword v40, off, s[12:15], 0 offset:192 sc1
    s_mov_b64 exec, -1
npg_70:
    s_cmp_eq_u32 s32, 63
    s_cbranch_scc1 qkjoin_69
    s_add_u32 s37, s32, 1
    s_and_b32 s36, s37, 1
    s_mul_i32 s36, s36, 24576
    s_add_u32 s36, s36, 108544
    s_add_u32 m0, s36, 0
    s_add_u32 s34, s40, 0
    buffer_load_dwordx4 v5, s[8:11], s34 offen offset:0 sc1 lds
    buffer_load_dwordx4 v5, s[8:11], s34 offen offset:1024 sc1 lds
    buffer_load_dwordx4 v5, s[8:11], s34 offen offset:2048 sc1 lds
    buffer_load_dwordx4 v5, s[8:11], s34 offen offset:3072 sc1 lds
    s_add_u32 m0, s36, 4096
    s_add_u32 s34, s40, 4096
    buffer_load_dwordx4 v5, s[8:11], s34 offen offset:0 sc1 lds
    buffer_load_dwordx4 v5, s[8:11], s34 offen offset:1024 sc1 lds
    buffer_load_dwordx4 v5, s[8:11], s34 offen offset:2048 sc1 lds
    buffer_load_dwordx4 v5, s[8:11], s34 offen offset:3072 sc1 lds
    s_add_u32 m0, s36, 8192
    s_add_u32 s34, s40, 8192
    buffer_load_dwordx4 v5, s[8:11], s34 offen offset:0 sc1 lds
    buffer_load_dwordx4 v5, s[8:11], s34 offen offset:1024 sc1 lds
    buffer_load_dwordx4 v5, s[8:11], s34 offen offset:2048 sc1 lds
    buffer_load_dwordx4 v5, s[8:11], s34 offen offset:3072 sc1 lds
    s_add_u32 m0, s36, 12288
    s_add_u32 s34, s40, 12288
    buffer_load_dwordx4 v5, s[8:11], s34 offen offset:0 sc1 lds
    buffer_load_dwordx4 v5, s[8:11], s34 offen offset:1024 sc1 lds
    buffer_load_dwordx4 v5, s[8:11], s34 offen offset:2048 sc1 lds
    buffer_load_dwordx4 v5, s[8:11], s34 offen offset:3072 sc1 lds
    s_add_u32 m0, s36, 16384
    s_add_u32 s34, s40, 16384
    buffer_load_dwordx4 v5, s[8:11], s34 offen offset:0 sc1 lds
    buffer_load_dwordx4 v5, s[8:11], s34 offen offset:1024 sc1 lds
    buffer_load_dwordx4 v5, s[8:11], s34 offen offset:2048 sc1 lds
    buffer_load_dwordx4 v5, s[8:11], s34 offen offset:3072 sc1 lds
    s_add_u32 m0, s36, 20480
    s_add_u32 s34, s40, 20480
    buffer_load_dwordx4 v5, s[8:11], s34 offen offset:0 sc1 lds
    buffer_load_dwordx4 v5, s[8:11], s34 offen offset:1024 sc1 lds
    buffer_load_dwordx4 v5, s[8:11], s34 offen offset:2048 sc1 lds
    buffer_load_dwordx4 v5, s[8:11], s34 offen offset:3072 sc1 lds
    s_add_u32 s40, s40, 786432
    s_branch qkjoin_69
qkwx_67:
    s_cmp_eq_u32 s28, 3
    s_cbranch_scc1 qkw3_68
    s_sleep 3
    v_bfe_u32 v100, v5, 4, 4
    v_lshrrev_b32 v101, 8, v5
    s_lshl_b32 s34, s28, 10
    s_add_u32 s34, s34, 11264
    v_add_u32 v102, s34, v8
    ds_read_b128 v[64:67], v102 offset:0
    ds_read_b128 v[68:71], v102 offset:2048
    ds_read_b128 v[72:75], v102 offset:4096
    ds_read_b128 v[76:79], v102 offset:6144
    ds_read_b128 v[80:83], v102 offset:8192
    ds_read_b128 v[84:87], v102 offset:10240
    ds_read_b64_tr_b16 v[40:41], v10 offset:23552
    ds_read_b64_tr_b16 v[42:43], v10 offset:23616
    ds_read_b64_tr_b16 v[44:45], v10 offset:24064
    ds_read_b64_tr_b16 v[46:47], v10 offset:24128
    ds_read_b64_tr_b16 v[48:49], v10 offset:24576
    ds_read_b64_tr_b16 v[50:51], v10 offset:24640
    ds_read_b64_tr_b16 v[52:53], v10 offset:25088
    ds_read_b64_tr_b16 v[54:55], v10 offset:25152
    ds_read_b64_tr_b16 v[56:57], v10 offset:25600
    ds_read_b64_tr_b16 v[58:59], v10 offset:25664
    ds_read_b64_tr_b16 v[60:61], v10 offset:26112
    ds_read_b64_tr_b16 v[62:63], v10 offset:26176
    v_sub_u32 v103, v8, v5
    v_lshrrev_b32 v104, 3, v100
    v_lshl_add_u32 v103, v104, 10, v103
    v_bfe_u32 v104, v100, 2, 1
    v_lshl_add_u32 v103, v104, 7, v103
    v_and_b32 v104, 3, v100
    v_lshl_add_u32 v103, v104, 4, v103
    v_lshl_add_u32 v103, v101, 8, v103
    s_waitcnt lgkmcnt(15)
    s_waitcnt lgkmcnt(10)
    v_mfma_f32_16x16x32_bf16 v[96:99], v[40:43], v[64:67], 0
    s_waitcnt lgkmcnt(8)
    v_mfma_f32_16x16x32_bf16 v[96:99], v[44:47], v[68:71], v[96:99]
    s_waitcnt lgkmcnt(6)
    v_mfma_f32_16x16x32_bf16 v[96:99], v[48:51], v[72:75], v[96:99]
    s_waitcnt lgkmcnt(4)
    v_mfma_f32_16x16x32_bf16 v[96:99], v[52:55], v[76:79], v[96:99]
    s_waitcnt lgkmcnt(2)
    v_mfma_f32_16x16x32_bf16 v[96:99], v[56:59], v[80:83], v[96:99]
    s_waitcnt lgkmcnt(0)
    v_mfma_f32_16x16x32_bf16 v[96:99], v[60:63], v[84:87], v[96:99]
    ds_read_b128 v[12:15], v103 offset:0
    ds_read_b128 v[16:19], v103 offset:2048
    ds_read_b128 v[20:23], v103 offset:4096
    ds_read_b128 v[24:27], v103 offset:6144
    ds_read_b128 v[28:31], v103 offset:8192
    ds_read_b128 v[32:35], v103 offset:10240
    s_waitcnt lgkmcnt(5)
    v_mfma_f32_16x16x32_bf16 v[88:91], v[12:15], v[64:67], 0
    s_waitcnt lgkmcnt(4)
    v_mfma_f32_16x16x32_bf16 v[88:91], v[16:19], v[68:71], v[88:91]
    s_waitcnt lgkmcnt(3)
    v_mfma_f32_16x16x32_bf16 v[88:91], v[20:23], v[72:75], v[88:91]
    s_waitcnt lgkmcnt(2)
    v_mfma_f32_16x16x32_bf16 v[88:91], v[24:27], v[76:79], v[88:91]
    s_waitcnt lgkmcnt(1)
    v_mfma_f32_16x16x32_bf16 v[88:91], v[28:31], v[80:83], v[88:91]
    s_waitcnt lgkmcnt(0)
    v_mfma_f32_16x16x32_bf16 v[88:91], v[32:35], v[84:87], v[88:91]
    ds_read_b128 v[12:15], v103 offset:64
    ds_read_b128 v[16:19], v103 offset:2112
    ds_read_b128 v[20:23], v103 offset:4160
    ds_read_b128 v[24:27], v103 offset:6208
    ds_read_b128 v[28:31], v103 offset:8256
    ds_read_b128 v[32:35], v103 offset:10304
    s_waitcnt lgkmcnt(5)
    v_mfma_f32_16x16x32_bf16 v[92:95], v[12:15], v[64:67], 0
    s_waitcnt lgkmcnt(4)
    v_mfma_f32_16x16x32_bf16 v[92:95], v[16:19], v[68:71], v[92:95]
    s_waitcnt lgkmcnt(3)
    v_mfma_f32_16x16x32_bf16 v[92:95], v[20:23], v[72:75], v[92:95]
    s_waitcnt lgkmcnt(2)
    v_mfma_f32_16x16x32_bf16 v[92:95], v[24:27], v[76:79], v[92:95]
    s_waitcnt lgkmcnt(1)
    v_mfma_f32_16x16x32_bf16 v[92:95], v[28:31], v[80:83], v[92:95]
    s_waitcnt lgkmcnt(0)
    v_mfma_f32_16x16x32_bf16 v[92:95], v[32:35], v[84:87], v[92:95]
    s_lshl_b32 s34, s28, 4
    s_sub_u32 s34, s34, 16
    v_lshlrev_b32 v102, 3, v101
    v_sub_u32 v102, v100, v102
    v_add_u32 v102, s34, v102
    v_mov_b32 v103, 0xff800000
    v_cmp_le_i32 vcc, 0, v102
    s_nop 1
    v_cndmask_b32 v88, v103, v88, vcc
    v_cmp_le_i32 vcc, 1, v102
    s_nop 1
    v_cndmask_b32 v89, v103, v89, vcc
    v_cmp_le_i32 vcc, 2, v102
    s_nop 1
    v_cndmask_b32 v90, v103, v90, vcc
    v_cmp_le_i32 vcc, 3, v102
    s_nop 1
    v_cndmask_b32 v91, v103, v91, vcc
    v_cmp_le_i32 vcc, 4, v102
    s_nop 1
    v_cndmask_b32 v92, v103, v92, vcc
    v_cmp_le_i32 vcc, 5, v102
    s_nop 1
    v_cndmask_b32 v93, v103, v93, vcc
    v_cmp_le_i32 vcc, 6, v102
    s_nop 1
    v_cndmask_b32 v94, v103, v94, vcc
    v_cmp_le_i32 vcc, 7, v102
    s_nop 1
    v_cndmask_b32 v95, v103, v95, vcc
    v_cmp_gt_u32 vcc, 2, v101
    s_nop 1
    v_cndmask_b32 v96, v103, v96, vcc
    v_cndmask_b32 v97, v103, v97, vcc
    v_cndmask_b32 v98, v103, v98, vcc
    v_cndmask_b32 v99, v103, v99, vcc
    v_max3_f32 v104, v88, v89, v90
    v_max3_f32 v104, v104, v91, v92
    v_max3_f32 v104, v104, v93, v94
    v_max3_f32 v104, v104, v95, v96
    v_max3_f32 v104, v104, v97, v98
    v_max_f32 v104, v104, v99
    v_mov_b32 v105, v104
    s_nop 1
    v_permlane16_swap_b32 v104, v105
    v_max_f32 v104, v104, v105
    v_mov_b32 v105, v104
    s_nop 1
    v_permlane32_swap_b32 v104, v105
    v_max_f32 v104, v104, v105
    v_mul_f32 v104, s47, v104
    v_fma_f32 v88, v88, s47, -v104
    v_fma_f32 v89, v89, s47, -v104
    v_fma_f32 v90, v90, s47, -v104
    v_fma_f32 v91, v91, s47, -v104
    v_fma_f32 v92, v92, s47, -v104
    v_fma_f32 v93, v93, s47, -v104
    v_fma_f32 v94, v94, s47, -v104
    v_fma_f32 v95, v95, s47, -v104
    v_fma_f32 v96, v96, s47, -v104
    v_fma_f32 v97, v97, s47, -v104
    v_fma_f32 v98, v98, s47, -v104
    v_fma_f32 v99, v99, s47, -v104
    v_exp_f32 v88, v88
    v_exp_f32 v89, v89
    v_exp_f32 v90, v90
    v_exp_f32 v91, v91
    v_exp_f32 v92, v92
    v_exp_f32 v93, v93
    v_exp_f32 v94, v94
    v_exp_f32 v95, v95
    v_exp_f32 v96, v96
    v_exp_f32 v97, v97
    v_exp_f32 v98, v98
    v_exp_f32 v99, v99
    v_add_f32 v104, v88, v89
    v_add_f32 v104, v104, v90
    v_add_f32 v104, v104, v91
    v_add_f32 v104, v104, v92
    v_add_f32 v104, v104, v93
    v_add_f32 v104, v104, v94
    v_add_f32 v104, v104, v95
    v_add_f32 v104, v104, v96
    v_add_f32 v104, v104, v97
    v_add_f32 v104, v104, v98
    v_add_f32 v104, v104, v99
    v_mov_b32 v105, v104
    s_nop 1
    v_permlane16_swap_b32 v104, v105
    v_add_f32 v104, v104, v105
    v_mov_b32 v105, v104
    s_nop 1
    v_permlane32_swap_b32 v104, v105
    v_add_f32 v104, v104, v105
    v_rcp_f32 v104, v104
    s_nop 0
    v_mul_f32 v88, v88, v104
    v_mul_f32 v89, v89, v104
    v_mul_f32 v90, v90, v104
    v_mul_f32 v91, v91, v104
    v_mul_f32 v92, v92, v104
    v_mul_f32 v93, v93, v104
    v_mul_f32 v94, v94, v104
    v_mul_f32 v95, v95, v104
    v_mul_f32 v96, v96, v104
    v_mul_f32 v97, v97, v104
    v_mul_f32 v98, v98, v104
    v_mul_f32 v99, v99, v104
    v_cvt_pk_bf16_f32 v64, v88, v89
    v_cvt_pk_bf16_f32 v65, v90, v91
    v_cvt_pk_bf16_f32 v66, v92, v93
    v_cvt_pk_bf16_f32 v67, v94, v95
    v_cvt_pk_bf16_f32 v68, v96, v97
    v_cvt_pk_bf16_f32 v69, v98, v99
    s_branch qkjoin_69
qkw3_68:
    s_add_u32 s37, s32, 2
    s_and_b32 s34, s37, 0x43
    s_cmp_lg_u32 s34, 0
    s_cbranch_scc1 qkjoin_69
    s_lshr_b32 s36, s37, 2
    s_lshl_b32 s34, s36, 3
    s_lshl_b32 s50, s36, 1
    s_add_u32 s50, s50, s29
    s_cmp_eq_u32 s36, 0
    s_cselect_b32 s51, 32, 16
fl_71:
    buffer_load_dwordx2 v[12:13], off, s[12:15], s34 offset:64 sc1
    buffer_load_ubyte v14, off, s[12:15], s50 offset:200 sc1
    s_waitcnt vmcnt(0)
    v_and_b32 v12, v12, v13
    s_nop 0
    v_readfirstlane_b32 s35, v12
    s_nop 0
    s_bitcmp1_b32 s35, s31
    s_cbranch_scc0 fln_73
    v_readfirstlane_b32 s35, v14
    s_nop 0
    s_cmp_ge_u32 s35, s51
    s_cbranch_scc1 fld_72
fln_73:
    s_sleep 3
    s_sub_u32 s33, s33, 1
    s_cbranch_scc0 fl_71
    s_mov_b32 s33, 0
fld_72:
qkjoin_69:
    s_mov_b32 s41, s62
    s_mov_b32 s42, s49
    s_cmp_eq_u32 s32, 63
    s_cbranch_scc1 qkend_66
    s_add_u32 s32, s32, 1
    s_and_b32 s34, s32, 3
    s_mul_i32 s34, s34, 20480
    s_add_u32 s43, s60, s34
    s_and_b32 s34, s32, 3
    s_mul_i32 s34, s34, 20480
    s_add_u32 s44, s61, s34
    s_add_u32 s34, s32, 2
    s_and_b32 s34, s34, 3
    s_mul_i32 s34, s34, 20480
    s_add_u32 s66, s60, s34
    s_add_u32 s34, s32, 2
    s_and_b32 s34, s34, 3
    s_mul_i32 s34, s34, 20480
    s_add_u32 s67, s61, s34
    s_and_b32 s34, s32, 3
    s_mul_i32 s34, s34, 65536
    s_add_u32 s38, s64, s34
    s_and_b32 s34, s32, 3
    s_mul_i32 s34, s34, 65536
    s_add_u32 s39, s65, s34
    v_mov_b64 v[16:17], 0
    v_mov_b64 v[18:19], 0
    v_mov_b64 v[20:21], 0
    v_mov_b64 v[22:23], 0
    v_mov_b64 v[100:101], 0
    v_mov_b64 v[102:103], 0
    v_mov_b64 v[104:105], 0
    v_mov_b64 v[106:107], 0
    v_mov_b64 v[108:109], 0
    v_mov_b64 v[110:111], 0
    v_bfe_u32 v12, v5, 4, 4
    v_lshrrev_b32 v13, 8, v5
    v_lshlrev_b32 v13, 2, v13
    v_sub_u32 v12, v12, v13
    v_lshlrev_b32 v13, 4, v12
    v_mov_b32 v14, 0x3f80
    v_mov_b32 v15, 0
    v_lshlrev_b64 v[14:15], v13, v[14:15]
    v_cmp_gt_u32 vcc, 4, v12
    s_nop 1
    v_cndmask_b32 v14, 0, v14, vcc
    v_cndmask_b32 v15, 0, v15, vcc
    v_xor_b32 v8, 237568, v8
    s_add_u32 s62, s62, 65536
    s_add_u32 s49, s49, 16384
    s_add_u32 s56, s56, 1310720
    s_add_u32 s57, s57, s59
    s_waitcnt vmcnt(0)
    s_cmp_lg_u32 s28, 0
    s_cbranch_scc1 kxe_76
    ds_read_b128 v[64:67], v8 offset:0
    ds_read_b128 v[72:75], v8 offset:1024
    ds_read_b128 v[68:71], v8 offset:2048
    ds_read_b128 v[76:79], v8 offset:3072
    ds_read_b128 v[80:83], v8 offset:4096
    ds_read_b128 v[88:91], v8 offset:5120
    ds_read_b128 v[84:87], v8 offset:6144
    ds_read_b128 v[92:95], v8 offset:7168
    ds_read_b128 v[96:99], v8 offset:8192
kxe_76:
    s_cmp_lg_u32 s28, 3
    s_cbranch_scc1 np_74
    s_lshl_b32 s35, s29, 8
    s_add_u32 s35, s35, 157286400
    v_bfe_u32 v25, v5, 2, 6
    v_and_b32 v25, 60, v25
    buffer_load_dword v24, v25, s[8:11], s35 offen sc1
    s_sleep 1
    buffer_load_dword v24, v25, s[8:11], s35 offen sc1
    s_sleep 1
pr_75:
    buffer_load_dword v24, v25, s[8:11], s35 offen sc1
    s_waitcnt vmcnt(2)
    v_cmp_gt_u32 vcc, s32, v24
    s_cbranch_vccz np_74_d
    s_sub_u32 s33, s33, 1
    s_cbranch_scc0 pr_75
    s_mov_b32 s33, 0
np_74_d:
    s_sleep 3
np_74:
    s_barrier
    buffer_load_dwordx4 v[44:47], v6, s[8:11], s38 offen sc1
    buffer_load_dwordx4 v[48:51], v6, s[8:11], s38 offen offset:1024 sc1
    buffer_load_dwordx2 v[52:53], v3, s[8:11], s38 offen offset:2048 sc1
    s_barrier
    buffer_load_dwordx4 v[54:57], v6, s[8:11], s39 offen sc1
    buffer_load_dwordx4 v[58:61], v6, s[8:11], s39 offen offset:1024 sc1
    buffer_load_dwordx2 v[62:63], v3, s[8:11], s39 offen offset:2048 sc1
mlc_78:
    s_waitcnt vmcnt(5)
    v_max3_u32 v12, v44, v45, v46
    s_waitcnt vmcnt(4)
    v_max3_u32 v13, v48, v49, v50
    v_max3_u32 v12, v12, v47, v51
    s_waitcnt vmcnt(3)
    v_max3_u32 v13, v13, v52, v53
    v_max_u32 v12, v12, v13
    v_cmp_eq_u32 vcc, -1, v12
    s_cbranch_vccnz ml_77
mld_79:
    v_mfma_f32_16x16x16_bf16 v[24:27], v[14:15], v[44:45], 0
    v_mfma_f32_16x16x16_bf16 v[28:31], v[14:15], v[46:47], 0
    v_mfma_f32_16x16x16_bf16 v[32:35], v[14:15], v[48:49], 0
    v_mfma_f32_16x16x16_bf16 v[36:39], v[14:15], v[50:51], 0
    v_mfma_f32_16x16x16_bf16 v[40:43], v[14:15], v[52:53], 0
    s_waitcnt vmcnt(2)
    v_mfma_f32_16x16x16_bf16 v[24:27], v[14:15], v[54:55], v[24:27]
    v_max3_u32 v12, v54, v55, v56
    v_mfma_f32_16x16x16_bf16 v[28:31], v[14:15], v[56:57], v[28:31]
    s_waitcnt vmcnt(1)
    v_mfma_f32_16x16x16_bf16 v[32:35], v[14:15], v[58:59], v[32:35]
    v_max3_u32 v13, v58, v59, v60
    v_mfma_f32_16x16x16_bf16 v[36:39], v[14:15], v[60:61], v[36:39]
    v_max3_u32 v12, v12, v57, v61
    s_waitcnt vmcnt(0)
    v_mfma_f32_16x16x16_bf16 v[40:43], v[14:15], v[62:63], v[40:43]
    v_max3_u32 v13, v13, v62, v63
    v_cvt_pk_bf16_f32 v24, v24, v25
    v_cvt_pk_bf16_f32 v25, v26, v27
    v_cvt_pk_bf16_f32 v26, v28, v29
    v_cvt_pk_bf16_f32 v27, v30, v31
    ds_write_b128 v6, v[24:27] offset:0
    v_max_u32 v12, v12, v13
    v_cvt_pk_bf16_f32 v28, v32, v33
    v_cvt_pk_bf16_f32 v29, v34, v35
    v_cvt_pk_bf16_f32 v30, v36, v37
    v_cvt_pk_bf16_f32 v31, v38, v39
    ds_write_b128 v6, v[28:31] offset:1024
    v_cmp_eq_u32 vcc, -1, v12
    v_cvt_pk_bf16_f32 v32, v40, v41
    v_cvt_pk_bf16_f32 v33, v42, v43
    ds_write_b64 v3, v[32:33] offset:2048
    s_cbranch_vccnz mr_80
mrd_82:
    v_mov_b64 v[12:13], 0
    v_mov_b64 v[14:15], 0
    buffer_store_dwordx4 v[64:67], v5, s[8:11], s41 offen sc1
    buffer_store_dwordx2 v[68:69], v11, s[8:11], s42 offen sc1
    s_waitcnt lgkmcnt(0)
    s_branch qkloop_65
ml_77:
    s_sub_u32 s33, s33, 1
    s_cbranch_scc1 ml_77_t
    buffer_load_dwordx4 v[44:47], v6, s[8:11], s38 offen sc1
    buffer_load_dwordx4 v[48:51], v6, s[8:11], s38 offen offset:1024 sc1
    buffer_load_dwordx2 v[52:53], v3, s[8:11], s38 offen offset:2048 sc1
    buffer_load_dwordx4 v[54:57], v6, s[8:11], s39 offen sc1
    buffer_load_dwordx4 v[58:61], v6, s[8:11], s39 offen offset:1024 sc1
    buffer_load_dwordx2 v[62:63], v3, s[8:11], s39 offen offset:2048 sc1
    s_branch mlc_78
ml_77_t:
    s_mov_b32 s33, 0
    s_branch mld_79
mr_80:
    s_sub_u32 s33, s33, 1
    s_cbranch_scc1 mr_80_t
    buffer_load_dwordx4 v[54:57], v6, s[8:11], s39 offen sc1
    buffer_load_dwordx4 v[58:61], v6, s[8:11], s39 offen offset:1024 sc1
    buffer_load_dwordx2 v[62:63], v3, s[8:11], s39 offen offset:2048 sc1
    s_waitcnt vmcnt(2)
    v_max3_u32 v12, v54, v55, v56
    s_waitcnt vmcnt(1)
    v_max3_u32 v13, v58, v59, v60
    v_max3_u32 v12, v12, v57, v61
    s_waitcnt vmcnt(0)
    v_max3_u32 v13, v13, v62, v63
    v_max_u32 v12, v12, v13
    v_cmp_eq_u32 vcc, -1, v12
    s_cbranch_vccnz mr_80
    s_branch mld_79
mr_80_t:
    s_mov_b32 s33, 0
    s_branch mrd_82
qkend_66:
    buffer_store_dwordx4 v[64:67], v5, s[8:11], s41 offen sc1
    buffer_store_dwordx2 v[68:69], v11, s[8:11], s42 offen sc1
    s_waitcnt vmcnt(0)
    s_barrier
    s_cmp_lg_u32 s28, 0
    s_cbranch_scc1 dn_83
    v_mov_b32 v24, 1
    s_mov_b64 exec, 1
    buffer_atomic_add v24, off, s[12:15], 0 offset:196 sc1
    s_mov_b64 exec, -1
dn_83:
    s_endpgm
role_vo_33:
    s_mov_b32 s16, s64
    s_mov_b32 s17, s65
    s_mov_b32 s18, 0x780000
    s_mov_b32 s19, 0x20000
    s_mov_b32 s20, s66
    s_mov_b32 s21, s67
    s_mov_b32 s22, 0x780000
    s_mov_b32 s23, 0x20000
    s_lshl_b32 s34, s28, 15
    s_add_u32 s34, s34, 26624
    v_add_u32 v7, s34, v5
    s_and_b32 s34, s30, 1
    s_lshl_b32 s34, s34, 5
    v_lshlrev_b32 v8, 2, v13
    v_xor_b32 v8, s34, v8
    v_mov_b32 v11, -1
    v_lshlrev_b32 v9, 4, v14
    v_mul_u32_u24 v10, 10240, v15
    v_add_u32 v10, v10, v9
    v_cmp_gt_u32 vcc, 2, v15
    v_mov_b32 v16, 0x40000000
    s_nop 0
    v_cndmask_b32 v9, v16, v5, vcc
    s_lshl_b32 s34, s28, 4
    s_add_u32 s34, s34, s30
    s_cmp_lt_u32 s34, 40
    s_cselect_b32 s49, 1, 0
    s_cselect_b64 s[54:55], -1, 0
    s_lshl_b32 s34, s28, 4
    s_add_u32 s34, s34, s30
    s_mul_i32 s43, s29, 163840
    s_add_u32 s43, s43, 180355072
    s_mul_i32 s35, s28, 2560
    s_add_u32 s42, s43, s35
    s_mul_i32 s35, s30, 10240
    s_add_u32 s42, s42, s35
    s_and_b32 s35, s34, 3
    s_mul_i32 s35, s35, 2560
    s_add_u32 s43, s43, s35
    s_lshr_b32 s35, s34, 2
    s_lshl_b32 s35, s35, 8
    s_add_u32 s43, s43, s35
    s_mul_i32 s35, s34, 0x199a
    s_lshr_b32 s35, s35, 16
    s_mul_i32 s36, s35, 10
    s_sub_u32 s36, s34, s36
    s_lshl_b32 s44, s36, 8
    s_and_b32 s36, s35, 1
    s_lshl_b32 s36, s36, 12
    s_add_u32 s44, s44, s36
    s_lshr_b32 s36, s35, 1
    s_lshl_b32 s36, s36, 14
    s_add_u32 s44, s44, s36
    s_lshl_b32 s36, s29, 15
    s_add_u32 s44, s44, s36
    s_add_u32 s44, s44, 203423744
    s_mul_i32 s45, s29, 655360
    s_lshl_b32 s35, s34, 14
    s_add_u32 s45, s45, s35
    s_add_u32 s45, s45, 50331648
    s_sub_u32 s59, s42, 46137344
    s_cmp_eq_u32 s49, 0
    s_cselect_b32 s43, 0x40000000, s43
    s_cselect_b32 s44, 0x40000000, s44
    s_cselect_b32 s45, 0x40000000, s45
    v_mov_b32 v16, -1
    v_mov_b32 v17, -1
    v_mov_b32 v18, -1
    v_mov_b32 v19, -1
    s_add_u32 s34, s44, 65536
    buffer_store_dword v16, v8, s[8:11], s34 offen sc1
    s_add_u32 s34, s44, 73728
    buffer_store_dword v16, v8, s[8:11], s34 offen sc1
    s_add_u32 s34, s44, 131072
    buffer_store_dword v16, v8, s[8:11], s34 offen sc1
    s_add_u32 s34, s44, 139264
    buffer_store_dword v16, v8, s[8:11], s34 offen sc1
    s_lshl_b32 s35, s29, 8
    s_lshl_b32 s34, s30, 2
    s_add_u32 s35, s35, s34
    s_add_u32 s35, s35, 157286400
    s_cmp_eq_u32 s28, 3
    s_cselect_b32 s35, s35, 0x40000000
    v_mov_b32 v20, 0
    s_mov_b64 exec, 1
    buffer_store_dword v20, off, s[8:11], s35 sc1
    s_mov_b64 exec, -1
    s_add_u32 s34, s42, 0
    buffer_store_dwordx4 v[16:19], v5, s[8:11], s34 offen offset:0 sc1
    buffer_store_dwordx4 v[16:19], v5, s[8:11], s34 offen offset:1024 sc1
    buffer_store_dwordx4 v[16:19], v9, s[8:11], s34 offen offset:2048 sc1
    v_add_u32 v20, 0, v13
    v_mul_u32_u24 v21, 0xaaab, v20
    v_lshrrev_b32 v21, 20, v21
    v_mul_u32_u24 v22, 24, v21
    v_sub_u32 v22, v20, v22
    v_mul_u32_u24 v21, 12288, v21
    v_lshl_add_u32 v16, v22, 4, v21
    v_add_u32 v20, 64, v13
    v_mul_u32_u24 v21, 0xaaab, v20
    v_lshrrev_b32 v21, 20, v21
    v_mul_u32_u24 v22, 24, v21
    v_sub_u32 v22, v20, v22
    v_mul_u32_u24 v21, 12288, v21
    v_lshl_add_u32 v17, v22, 4, v21
    v_add_u32 v20, 128, v13
    v_mul_u32_u24 v21, 0xaaab, v20
    v_lshrrev_b32 v21, 20, v21
    v_mul_u32_u24 v22, 24, v21
    v_sub_u32 v22, v20, v22
    v_mul_u32_u24 v21, 12288, v21
    v_lshl_add_u32 v18, v22, 4, v21
    s_mul_i32 s40, s28, 196608
    s_mul_i32 s34, s31, 384
    s_add_u32 s40, s40, s34
    v_lshrrev_b32 v21, 3, v13
    v_mul_u32_u24 v21, 1280, v21
    v_and_b32 v22, 7, v13
    v_lshl_add_u32 v19, v22, 4, v21
    s_mul_i32 s41, s28, 61440
    s_mul_i32 s34, s31, 245760
    s_add_u32 s41, s41, s34
    s_mul_i32 s42, s28, 6144
    v_lshrrev_b32 v21, 2, v14
    v_lshl_add_u32 v21, v15, 3, v21
    v_and_b32 v22, 3, v14
    v_lshlrev_b32 v22, 3, v22
    s_lshl_b32 s34, s28, 5
    v_add_u32 v22, s34, v22
    v_mul_u32_u24 v23, 384, v21
    v_add_u32 v23, v23, v22
    v_lshl_add_u32 v24, v21, 7, v22
    v_lshrrev_b32 v26, 6, v12
    v_lshl_add_u32 v26, v26, 4, v14
    v_lshlrev_b32 v26, 1, v26
    v_mul_u32_u24 v27, 2560, v15
    v_add_u32 v27, v26, v27
    buffer_load_ushort v32, v27, s[24:27], 0 offen offset:0
    buffer_load_ushort v33, v27, s[24:27], 0 offen offset:1280
    buffer_load_ushort v34, v27, s[24:27], 0 offen offset:128
    buffer_load_ushort v35, v27, s[24:27], 0 offen offset:1408
    buffer_load_ushort v36, v27, s[24:27], 0 offen offset:256
    buffer_load_ushort v37, v27, s[24:27], 0 offen offset:1536
    buffer_load_ushort v38, v27, s[24:27], 0 offen offset:384
    buffer_load_ushort v39, v27, s[24:27], 0 offen offset:1664
    buffer_load_ushort v40, v27, s[24:27], 0 offen offset:512
    buffer_load_ushort v41, v27, s[24:27], 0 offen offset:1792
    buffer_load_ushort v42, v27, s[24:27], 0 offen offset:640
    buffer_load_ushort v43, v27, s[24:27], 0 offen offset:1920
    buffer_load_ushort v44, v27, s[24:27], 0 offen offset:768
    buffer_load_ushort v45, v27, s[24:27], 0 offen offset:2048
    buffer_load_ushort v46, v27, s[24:27], 0 offen offset:896
    buffer_load_ushort v47, v27, s[24:27], 0 offen offset:2176
    buffer_load_ushort v48, v27, s[24:27], 0 offen offset:1024
    buffer_load_ushort v49, v27, s[24:27], 0 offen offset:2304
    buffer_load_ushort v50, v27, s[24:27], 0 offen offset:1152
    buffer_load_ushort v51, v27, s[24:27], 0 offen offset:2432
    v_add_u32 v26, 147456, v4
    s_add_u32 m0, s42, 0
    s_add_u32 s34, s40, 0
    buffer_load_dwordx4 v16, s[16:19], s34 offen lds
    s_add_u32 m0, s42, 1024
    s_add_u32 s34, s40, 0
    buffer_load_dwordx4 v17, s[16:19], s34 offen lds
    s_add_u32 m0, s42, 2048
    s_add_u32 s34, s40, 0
    buffer_load_dwordx4 v18, s[16:19], s34 offen lds
    s_add_u32 m0, s42, 3072
    s_add_u32 s34, s40, 98304
    buffer_load_dwordx4 v16, s[16:19], s34 offen lds
    s_add_u32 m0, s42, 4096
    s_add_u32 s34, s40, 98304
    buffer_load_dwordx4 v17, s[16:19], s34 offen lds
    s_add_u32 m0, s42, 5120
    s_add_u32 s34, s40, 98304
    buffer_load_dwordx4 v18, s[16:19], s34 offen lds
    s_add_u32 m0, s42, 24576
    s_add_u32 s34, s40, 786432
    buffer_load_dwordx4 v16, s[16:19], s34 offen lds
    s_add_u32 m0, s42, 25600
    s_add_u32 s34, s40, 786432
    buffer_load_dwordx4 v17, s[16:19], s34 offen lds
    s_add_u32 m0, s42, 26624
    s_add_u32 s34, s40, 786432
    buffer_load_dwordx4 v18, s[16:19], s34 offen lds
    s_add_u32 m0, s42, 27648
    s_add_u32 s34, s40, 884736
    buffer_load_dwordx4 v16, s[16:19], s34 offen lds
    s_add_u32 m0, s42, 28672
    s_add_u32 s34, s40, 884736
    buffer_load_dwordx4 v17, s[16:19], s34 offen lds
    s_add_u32 m0, s42, 29696
    s_add_u32 s34, s40, 884736
    buffer_load_dwordx4 v18, s[16:19], s34 offen lds
    s_add_u32 m0, s42, 49152
    s_add_u32 s34, s40, 1572864
    buffer_load_dwordx4 v16, s[16:19], s34 offen lds
    s_add_u32 m0, s42, 50176
    s_add_u32 s34, s40, 1572864
    buffer_load_dwordx4 v17, s[16:19], s34 offen lds
    s_add_u32 m0, s42, 51200
    s_add_u32 s34, s40, 1572864
    buffer_load_dwordx4 v18, s[16:19], s34 offen lds
    s_add_u32 m0, s42, 52224
    s_add_u32 s34, s40, 1671168
    buffer_load_dwordx4 v16, s[16:19], s34 offen lds
    s_add_u32 m0, s42, 53248
    s_add_u32 s34, s40, 1671168
    buffer_load_dwordx4 v17, s[16:19], s34 offen lds
    s_add_u32 m0, s42, 54272
    s_add_u32 s34, s40, 1671168
    buffer_load_dwordx4 v18, s[16:19], s34 offen lds
    s_add_u32 m0, s42, 73728
    s_add_u32 s34, s40, 2359296
    buffer_load_dwordx4 v16, s[16:19], s34 offen lds
    s_add_u32 m0, s42, 74752
    s_add_u32 s34, s40, 2359296
    buffer_load_dwordx4 v17, s[16:19], s34 offen lds
    s_add_u32 m0, s42, 75776
    s_add_u32 s34, s40, 2359296
    buffer_load_dwordx4 v18, s[16:19], s34 offen lds
    s_add_u32 m0, s42, 76800
    s_add_u32 s34, s40, 2457600
    buffer_load_dwordx4 v16, s[16:19], s34 offen lds
    s_add_u32 m0, s42, 77824
    s_add_u32 s34, s40, 2457600
    buffer_load_dwordx4 v17, s[16:19], s34 offen lds
    s_add_u32 m0, s42, 78848
    s_add_u32 s34, s40, 2457600
    buffer_load_dwordx4 v18, s[16:19], s34 offen lds
    s_add_u32 m0, s42, 98304
    s_add_u32 s34, s40, 3145728
    buffer_load_dwordx4 v16, s[16:19], s34 offen lds
    s_add_u32 m0, s42, 99328
    s_add_u32 s34, s40, 3145728
    buffer_load_dwordx4 v17, s[16:19], s34 offen lds
    s_add_u32 m0, s42, 100352
    s_add_u32 s34, s40, 3145728
    buffer_load_dwordx4 v18, s[16:19], s34 offen lds
    s_add_u32 m0, s42, 101376
    s_add_u32 s34, s40, 3244032
    buffer_load_dwordx4 v16, s[16:19], s34 offen lds
    s_add_u32 m0, s42, 102400
    s_add_u32 s34, s40, 3244032
    buffer_load_dwordx4 v17, s[16:19], s34 offen lds
    s_add_u32 m0, s42, 103424
    s_add_u32 s34, s40, 3244032
    buffer_load_dwordx4 v18, s[16:19], s34 offen lds
    s_waitcnt vmcnt(24) lgkmcnt(0)
    s_barrier
    s_cmp_lg_u32 s28, 0
    s_cbranch_scc1 cens_84
    s_lshl_b32 s34, s48, 3
    s_lshl_b64 s[50:51], 1, s34
    v_mov_b32 v28, s50
    v_mov_b32 v29, s51
    s_lshl_b32 s34, s29, 3
    s_mov_b64 exec, 1
    buffer_atomic_add_x2 v[28:29], off, s[12:15], s34 offset:0 sc1
    s_mov_b64 exec, -1
cens_84:
    v_lshl_or_b32 v32, v33, 16, v32
    ds_write_b32 v26, v32 offset:0
    v_lshl_or_b32 v34, v35, 16, v34
    ds_write_b32 v26, v34 offset:1024
    v_lshl_or_b32 v36, v37, 16, v36
    ds_write_b32 v26, v36 offset:2048
    v_lshl_or_b32 v38, v39, 16, v38
    ds_write_b32 v26, v38 offset:3072
    v_lshl_or_b32 v40, v41, 16, v40
    ds_write_b32 v26, v40 offset:4096
    v_lshl_or_b32 v42, v43, 16, v42
    ds_write_b32 v26, v42 offset:5120
    v_lshl_or_b32 v44, v45, 16, v44
    ds_write_b32 v26, v44 offset:6144
    v_lshl_or_b32 v46, v47, 16, v46
    ds_write_b32 v26, v46 offset:7168
    v_lshl_or_b32 v48, v49, 16, v48
    ds_write_b32 v26, v48 offset:8192
    v_lshl_or_b32 v50, v51, 16, v50
    ds_write_b32 v26, v50 offset:9216
    s_add_u32 m0, s42, 122880
    s_add_u32 s34, s40, 3932160
    buffer_load_dwordx4 v16, s[16:19], s34 offen lds
    s_add_u32 m0, s42, 123904
    s_add_u32 s34, s40, 3932160
    buffer_load_dwordx4 v17, s[16:19], s34 offen lds
    s_add_u32 m0, s42, 124928
    s_add_u32 s34, s40, 3932160
    buffer_load_dwordx4 v18, s[16:19], s34 offen lds
    s_add_u32 m0, s42, 125952
    s_add_u32 s34, s40, 4030464
    buffer_load_dwordx4 v16, s[16:19], s34 offen lds
    s_add_u32 m0, s42, 126976
    s_add_u32 s34, s40, 4030464
    buffer_load_dwordx4 v17, s[16:19], s34 offen lds
    s_add_u32 m0, s42, 128000
    s_add_u32 s34, s40, 4030464
    buffer_load_dwordx4 v18, s[16:19], s34 offen lds
    v_add_u32 v25, 0, v23
    ds_read_b64_tr_b16 a[0:1], v25 offset:0
    ds_read_b64_tr_b16 a[2:3], v25 offset:1536
    ds_read_b64_tr_b16 a[4:5], v25 offset:12288
    ds_read_b64_tr_b16 a[6:7], v25 offset:13824
    ds_read_b64_tr_b16 a[8:9], v25 offset:128
    ds_read_b64_tr_b16 a[10:11], v25 offset:1664
    ds_read_b64_tr_b16 a[12:13], v25 offset:12416
    ds_read_b64_tr_b16 a[14:15], v25 offset:13952
    ds_read_b64_tr_b16 a[16:17], v25 offset:256
    ds_read_b64_tr_b16 a[18:19], v25 offset:1792
    ds_read_b64_tr_b16 a[20:21], v25 offset:12544
    ds_read_b64_tr_b16 a[22:23], v25 offset:14080
    s_waitcnt vmcnt(24) lgkmcnt(0)
    s_barrier
    s_add_u32 m0, s42, 0
    s_add_u32 s34, s40, 4718592
    buffer_load_dwordx4 v16, s[16:19], s34 offen lds
    s_add_u32 m0, s42, 1024
    s_add_u32 s34, s40, 4718592
    buffer_load_dwordx4 v17, s[16:19], s34 offen lds
    s_add_u32 m0, s42, 2048
    s_add_u32 s34, s40, 4718592
    buffer_load_dwordx4 v18, s[16:19], s34 offen lds
    s_add_u32 m0, s42, 3072
    s_add_u32 s34, s40, 4816896
    buffer_load_dwordx4 v16, s[16:19], s34 offen lds
    s_add_u32 m0, s42, 4096
    s_add_u32 s34, s40, 4816896
    buffer_load_dwordx4 v17, s[16:19], s34 offen lds
    s_add_u32 m0, s42, 5120
    s_add_u32 s34, s40, 4816896
    buffer_load_dwordx4 v18, s[16:19], s34 offen lds
    v_add_u32 v25, 24576, v23
    ds_read_b64_tr_b16 a[24:25], v25 offset:0
    ds_read_b64_tr_b16 a[26:27], v25 offset:1536
    ds_read_b64_tr_b16 a[28:29], v25 offset:12288
    ds_read_b64_tr_b16 a[30:31], v25 offset:13824
    ds_read_b64_tr_b16 a[32:33], v25 offset:128
    ds_read_b64_tr_b16 a[34:35], v25 offset:1664
    ds_read_b64_tr_b16 a[36:37], v25 offset:12416
    ds_read_b64_tr_b16 a[38:39], v25 offset:13952
    ds_read_b64_tr_b16 a[40:41], v25 offset:256
    ds_read_b64_tr_b16 a[42:43], v25 offset:1792
    ds_read_b64_tr_b16 a[44:45], v25 offset:12544
    ds_read_b64_tr_b16 a[46:47], v25 offset:14080
    s_waitcnt vmcnt(24) lgkmcnt(0)
    s_barrier
    s_add_u32 m0, s42, 24576
    s_add_u32 s34, s40, 5505024
    buffer_load_dwordx4 v16, s[16:19], s34 offen lds
    s_add_u32 m0, s42, 25600
    s_add_u32 s34, s40, 5505024
    buffer_load_dwordx4 v17, s[16:19], s34 offen lds
    s_add_u32 m0, s42, 26624
    s_add_u32 s34, s40, 5505024
    buffer_load_dwordx4 v18, s[16:19], s34 offen lds
    s_add_u32 m0, s42, 27648
    s_add_u32 s34, s40, 5603328
    buffer_load_dwordx4 v16, s[16:19], s34 offen lds
    s_add_u32 m0, s42, 28672
    s_add_u32 s34, s40, 5603328
    buffer_load_dwordx4 v17, s[16:19], s34 offen lds
    s_add_u32 m0, s42, 29696
    s_add_u32 s34, s40, 5603328
    buffer_load_dwordx4 v18, s[16:19], s34 offen lds
    v_add_u32 v25, 49152, v23
    ds_read_b64_tr_b16 a[48:49], v25 offset:0
    ds_read_b64_tr_b16 a[50:51], v25 offset:1536
    ds_read_b64_tr_b16 a[52:53], v25 offset:12288
    ds_read_b64_tr_b16 a[54:55], v25 offset:13824
    ds_read_b64_tr_b16 a[56:57], v25 offset:128
    ds_read_b64_tr_b16 a[58:59], v25 offset:1664
    ds_read_b64_tr_b16 a[60:61], v25 offset:12416
    ds_read_b64_tr_b16 a[62:63], v25 offset:13952
    ds_read_b64_tr_b16 a[64:65], v25 offset:256
    ds_read_b64_tr_b16 a[66:67], v25 offset:1792
    ds_read_b64_tr_b16 a[68:69], v25 offset:12544
    ds_read_b64_tr_b16 a[70:71], v25 offset:14080
    s_waitcnt vmcnt(24) lgkmcnt(0)
    s_barrier
    s_add_u32 m0, s42, 49152
    s_add_u32 s34, s40, 6291456
    buffer_load_dwordx4 v16, s[16:19], s34 offen lds
    s_add_u32 m0, s42, 50176
    s_add_u32 s34, s40, 6291456
    buffer_load_dwordx4 v17, s[16:19], s34 offen lds
    s_add_u32 m0, s42, 51200
    s_add_u32 s34, s40, 6291456
    buffer_load_dwordx4 v18, s[16:19], s34 offen lds
    s_add_u32 m0, s42, 52224
    s_add_u32 s34, s40, 6389760
    buffer_load_dwordx4 v16, s[16:19], s34 offen lds
    s_add_u32 m0, s42, 53248
    s_add_u32 s34, s40, 6389760
    buffer_load_dwordx4 v17, s[16:19], s34 offen lds
    s_add_u32 m0, s42, 54272
    s_add_u32 s34, s40, 6389760
    buffer_load_dwordx4 v18, s[16:19], s34 offen lds
    v_add_u32 v25, 73728, v23
    ds_read_b64_tr_b16 a[72:73], v25 offset:0
    ds_read_b64_tr_b16 a[74:75], v25 offset:1536
    ds_read_b64_tr_b16 a[76:77], v25 offset:12288
    ds_read_b64_tr_b16 a[78:79], v25 offset:13824
    ds_read_b64_tr_b16 a[80:81], v25 offset:128
    ds_read_b64_tr_b16 a[82:83], v25 offset:1664
    ds_read_b64_tr_b16 a[84:85], v25 offset:12416
    ds_read_b64_tr_b16 a[86:87], v25 offset:13952
    ds_read_b64_tr_b16 a[88:89], v25 offset:256
    ds_read_b64_tr_b16 a[90:91], v25 offset:1792
    ds_read_b64_tr_b16 a[92:93], v25 offset:12544
    ds_read_b64_tr_b16 a[94:95], v25 offset:14080
    s_waitcnt vmcnt(24) lgkmcnt(0)
    s_barrier
    s_add_u32 m0, s42, 73728
    s_add_u32 s34, s40, 7077888
    buffer_load_dwordx4 v16, s[16:19], s34 offen lds
    s_add_u32 m0, s42, 74752
    s_add_u32 s34, s40, 7077888
    buffer_load_dwordx4 v17, s[16:19], s34 offen lds
    s_add_u32 m0, s42, 75776
    s_add_u32 s34, s40, 7077888
    buffer_load_dwordx4 v18, s[16:19], s34 offen lds
    s_add_u32 m0, s42, 76800
    s_add_u32 s34, s40, 7176192
    buffer_load_dwordx4 v16, s[16:19], s34 offen lds
    s_add_u32 m0, s42, 77824
    s_add_u32 s34, s40, 7176192
    buffer_load_dwordx4 v17, s[16:19], s34 offen lds
    s_add_u32 m0, s42, 78848
    s_add_u32 s34, s40, 7176192
    buffer_load_dwordx4 v18, s[16:19], s34 offen lds
    v_add_u32 v25, 98304, v23
    ds_read_b64_tr_b16 a[96:97], v25 offset:0
    ds_read_b64_tr_b16 a[98:99], v25 offset:1536
    ds_read_b64_tr_b16 a[100:101], v25 offset:12288
    ds_read_b64_tr_b16 a[102:103], v25 offset:13824
    ds_read_b64_tr_b16 a[104:105], v25 offset:128
    ds_read_b64_tr_b16 a[106:107], v25 offset:1664
    ds_read_b64_tr_b16 a[108:109], v25 offset:12416
    ds_read_b64_tr_b16 a[110:111], v25 offset:13952
    ds_read_b64_tr_b16 v[32:33], v25 offset:256
    ds_read_b64_tr_b16 v[34:35], v25 offset:1792
    ds_read_b64_tr_b16 v[36:37], v25 offset:12544
    ds_read_b64_tr_b16 v[38:39], v25 offset:14080
    s_waitcnt vmcnt(24) lgkmcnt(0)
    s_barrier
    s_add_u32 m0, s42, 98304
    s_add_u32 s34, s41, 0
    buffer_load_dwordx4 v19, s[20:23], s34 offen lds
    s_add_u32 m0, s42, 99328
    s_add_u32 s34, s41, 10240
    buffer_load_dwordx4 v19, s[20:23], s34 offen lds
    s_add_u32 m0, s42, 100352
    s_add_u32 s34, s41, 20480
    buffer_load_dwordx4 v19, s[20:23], s34 offen lds
    s_add_u32 m0, s42, 101376
    s_add_u32 s34, s41, 30720
    buffer_load_dwordx4 v19, s[20:23], s34 offen lds
    s_add_u32 m0, s42, 102400
    s_add_u32 s34, s41, 40960
    buffer_load_dwordx4 v19, s[20:23], s34 offen lds
    s_add_u32 m0, s42, 103424
    s_add_u32 s34, s41, 51200
    buffer_load_dwordx4 v19, s[20:23], s34 offen lds
    v_add_u32 v25, 122880, v23
    ds_read_b64_tr_b16 a[112:113], v25 offset:0
    ds_read_b64_tr_b16 a[114:115], v25 offset:1536
    ds_read_b64_tr_b16 a[116:117], v25 offset:12288
    ds_read_b64_tr_b16 a[118:119], v25 offset:13824
    ds_read_b64_tr_b16 a[120:121], v25 offset:128
    ds_read_b64_tr_b16 a[122:123], v25 offset:1664
    ds_read_b64_tr_b16 a[124:125], v25 offset:12416
    ds_read_b64_tr_b16 a[126:127], v25 offset:13952
    ds_read_b64_tr_b16 v[40:41], v25 offset:256
    ds_read_b64_tr_b16 v[42:43], v25 offset:1792
    ds_read_b64_tr_b16 v[44:45], v25 offset:12544
    ds_read_b64_tr_b16 v[46:47], v25 offset:14080
    s_waitcnt vmcnt(24) lgkmcnt(0)
    s_barrier
    s_add_u32 m0, s42, 122880
    s_add_u32 s34, s41, 128
    buffer_load_dwordx4 v19, s[20:23], s34 offen lds
    s_add_u32 m0, s42, 123904
    s_add_u32 s34, s41, 10368
    buffer_load_dwordx4 v19, s[20:23], s34 offen lds
    s_add_u32 m0, s42, 124928
    s_add_u32 s34, s41, 20608
    buffer_load_dwordx4 v19, s[20:23], s34 offen lds
    s_add_u32 m0, s42, 125952
    s_add_u32 s34, s41, 30848
    buffer_load_dwordx4 v19, s[20:23], s34 offen lds
    s_add_u32 m0, s42, 126976
    s_add_u32 s34, s41, 41088
    buffer_load_dwordx4 v19, s[20:23], s34 offen lds
    s_add_u32 m0, s42, 128000
    s_add_u32 s34, s41, 51328
    buffer_load_dwordx4 v19, s[20:23], s34 offen lds
    v_add_u32 v25, 0, v23
    ds_read_b64_tr_b16 a[128:129], v25 offset:0
    ds_read_b64_tr_b16 a[130:131], v25 offset:1536
    ds_read_b64_tr_b16 a[132:133], v25 offset:12288
    ds_read_b64_tr_b16 a[134:135], v25 offset:13824
    ds_read_b64_tr_b16 a[136:137], v25 offset:128
    ds_read_b64_tr_b16 a[138:139], v25 offset:1664
    ds_read_b64_tr_b16 a[140:141], v25 offset:12416
    ds_read_b64_tr_b16 a[142:143], v25 offset:13952
    ds_read_b64_tr_b16 v[48:49], v25 offset:256
    ds_read_b64_tr_b16 v[50:51], v25 offset:1792
    ds_read_b64_tr_b16 v[52:53], v25 offset:12544
    ds_read_b64_tr_b16 v[54:55], v25 offset:14080
    s_waitcnt vmcnt(24) lgkmcnt(0)
    s_barrier
    s_add_u32 m0, s42, 0
    s_add_u32 s34, s41, 256
    buffer_load_dwordx4 v19, s[20:23], s34 offen lds
    s_add_u32 m0, s42, 1024
    s_add_u32 s34, s41, 10496
    buffer_load_dwordx4 v19, s[20:23], s34 offen lds
    s_add_u32 m0, s42, 2048
    s_add_u32 s34, s41, 20736
    buffer_load_dwordx4 v19, s[20:23], s34 offen lds
    s_add_u32 m0, s42, 3072
    s_add_u32 s34, s41, 30976
    buffer_load_dwordx4 v19, s[20:23], s34 offen lds
    s_add_u32 m0, s42, 4096
    s_add_u32 s34, s41, 41216
    buffer_load_dwordx4 v19, s[20:23], s34 offen lds
    s_add_u32 m0, s42, 5120
    s_add_u32 s34, s41, 51456
    buffer_load_dwordx4 v19, s[20:23], s34 offen lds
    v_add_u32 v25, 24576, v23
    ds_read_b64_tr_b16 a[144:145], v25 offset:0
    ds_read_b64_tr_b16 a[146:147], v25 offset:1536
    ds_read_b64_tr_b16 a[148:149], v25 offset:12288
    ds_read_b64_tr_b16 a[150:151], v25 offset:13824
    ds_read_b64_tr_b16 a[152:153], v25 offset:128
    ds_read_b64_tr_b16 a[154:155], v25 offset:1664
    ds_read_b64_tr_b16 a[156:157], v25 offset:12416
    ds_read_b64_tr_b16 a[158:159], v25 offset:13952
    ds_read_b64_tr_b16 v[56:57], v25 offset:256
    ds_read_b64_tr_b16 v[58:59], v25 offset:1792
    ds_read_b64_tr_b16 v[60:61], v25 offset:12544
    ds_read_b64_tr_b16 v[62:63], v25 offset:14080
    s_waitcnt vmcnt(24) lgkmcnt(0)
    s_barrier
    s_add_u32 m0, s42, 24576
    s_add_u32 s34, s41, 384
    buffer_load_dwordx4 v19, s[20:23], s34 offen lds
    s_add_u32 m0, s42, 25600
    s_add_u32 s34, s41, 10624
    buffer_load_dwordx4 v19, s[20:23], s34 offen lds
    s_add_u32 m0, s42, 26624
    s_add_u32 s34, s41, 20864
    buffer_load_dwordx4 v19, s[20:23], s34 offen lds
    s_add_u32 m0, s42, 27648
    s_add_u32 s34, s41, 31104
    buffer_load_dwordx4 v19, s[20:23], s34 offen lds
    s_add_u32 m0, s42, 28672
    s_add_u32 s34, s41, 41344
    buffer_load_dwordx4 v19, s[20:23], s34 offen lds
    s_add_u32 m0, s42, 29696
    s_add_u32 s34, s41, 51584
    buffer_load_dwordx4 v19, s[20:23], s34 offen lds
    v_add_u32 v25, 49152, v23
    ds_read_b64_tr_b16 a[160:161], v25 offset:0
    ds_read_b64_tr_b16 a[162:163], v25 offset:1536
    ds_read_b64_tr_b16 a[164:165], v25 offset:12288
    ds_read_b64_tr_b16 a[166:167], v25 offset:13824
    ds_read_b64_tr_b16 a[168:169], v25 offset:128
    ds_read_b64_tr_b16 a[170:171], v25 offset:1664
    ds_read_b64_tr_b16 a[172:173], v25 offset:12416
    ds_read_b64_tr_b16 a[174:175], v25 offset:13952
    ds_read_b64_tr_b16 v[64:65], v25 offset:256
    ds_read_b64_tr_b16 v[66:67], v25 offset:1792
    ds_read_b64_tr_b16 v[68:69], v25 offset:12544
    ds_read_b64_tr_b16 v[70:71], v25 offset:14080
    s_waitcnt vmcnt(24) lgkmcnt(0)
    s_barrier
    s_add_u32 m0, s42, 49152
    s_add_u32 s34, s41, 512
    buffer_load_dwordx4 v19, s[20:23], s34 offen lds
    s_add_u32 m0, s42, 50176
    s_add_u32 s34, s41, 10752
    buffer_load_dwordx4 v19, s[20:23], s34 offen lds
    s_add_u32 m0, s42, 51200
    s_add_u32 s34, s41, 20992
    buffer_load_dwordx4 v19, s[20:23], s34 offen lds
    s_add_u32 m0, s42, 52224
    s_add_u32 s34, s41, 31232
    buffer_load_dwordx4 v19, s[20:23], s34 offen lds
    s_add_u32 m0, s42, 53248
    s_add_u32 s34, s41, 41472
    buffer_load_dwordx4 v19, s[20:23], s34 offen lds
    s_add_u32 m0, s42, 54272
    s_add_u32 s34, s41, 51712
    buffer_load_dwordx4 v19, s[20:23], s34 offen lds
    v_add_u32 v25, 73728, v23
    ds_read_b64_tr_b16 a[176:177], v25 offset:0
    ds_read_b64_tr_b16 a[178:179], v25 offset:1536
    ds_read_b64_tr_b16 a[180:181], v25 offset:12288
    ds_read_b64_tr_b16 a[182:183], v25 offset:13824
    ds_read_b64_tr_b16 a[184:185], v25 offset:128
    ds_read_b64_tr_b16 a[186:187], v25 offset:1664
    ds_read_b64_tr_b16 a[188:189], v25 offset:12416
    ds_read_b64_tr_b16 a[190:191], v25 offset:13952
    ds_read_b64_tr_b16 v[72:73], v25 offset:256
    ds_read_b64_tr_b16 v[74:75], v25 offset:1792
    ds_read_b64_tr_b16 v[76:77], v25 offset:12544
    ds_read_b64_tr_b16 v[78:79], v25 offset:14080
    s_waitcnt vmcnt(24) lgkmcnt(0)
    s_barrier
    s_add_u32 m0, s42, 73728
    s_add_u32 s34, s41, 640
    buffer_load_dwordx4 v19, s[20:23], s34 offen lds
    s_add_u32 m0, s42, 74752
    s_add_u32 s34, s41, 10880
    buffer_load_dwordx4 v19, s[20:23], s34 offen lds
    s_add_u32 m0, s42, 75776
    s_add_u32 s34, s41, 21120
    buffer_load_dwordx4 v19, s[20:23], s34 offen lds
    s_add_u32 m0, s42, 76800
    s_add_u32 s34, s41, 31360
    buffer_load_dwordx4 v19, s[20:23], s34 offen lds
    s_add_u32 m0, s42, 77824
    s_add_u32 s34, s41, 41600
    buffer_load_dwordx4 v19, s[20:23], s34 offen lds
    s_add_u32 m0, s42, 78848
    s_add_u32 s34, s41, 51840
    buffer_load_dwordx4 v19, s[20:23], s34 offen lds
    v_add_u32 v25, 98304, v24
    ds_read_b64_tr_b16 a[192:193], v25 offset:0
    ds_read_b64_tr_b16 a[194:195], v25 offset:512
    ds_read_b64_tr_b16 a[196:197], v25 offset:4096
    ds_read_b64_tr_b16 a[198:199], v25 offset:4608
    ds_read_b64_tr_b16 a[200:201], v25 offset:8192
    ds_read_b64_tr_b16 a[202:203], v25 offset:8704
    ds_read_b64_tr_b16 a[204:205], v25 offset:12288
    ds_read_b64_tr_b16 a[206:207], v25 offset:12800
    ds_read_b64_tr_b16 v[80:81], v25 offset:16384
    ds_read_b64_tr_b16 v[82:83], v25 offset:16896
    ds_read_b64_tr_b16 v[84:85], v25 offset:20480
    ds_read_b64_tr_b16 v[86:87], v25 offset:20992
    s_waitcnt vmcnt(24) lgkmcnt(0)
    s_barrier
    s_add_u32 m0, s42, 98304
    s_add_u32 s34, s41, 768
    buffer_load_dwordx4 v19, s[20:23], s34 offen lds
    s_add_u32 m0, s42, 99328
    s_add_u32 s34, s41, 11008
    buffer_load_dwordx4 v19, s[20:23], s34 offen lds
    s_add_u32 m0, s42, 100352
    s_add_u32 s34, s41, 21248
    buffer_load_dwordx4 v19, s[20:23], s34 offen lds
    s_add_u32 m0, s42, 101376
    s_add_u32 s34, s41, 31488
    buffer_load_dwordx4 v19, s[20:23], s34 offen lds
    s_add_u32 m0, s42, 102400
    s_add_u32 s34, s41, 41728
    buffer_load_dwordx4 v19, s[20:23], s34 offen lds
    s_add_u32 m0, s42, 103424
    s_add_u32 s34, s41, 51968
    buffer_load_dwordx4 v19, s[20:23], s34 offen lds
    v_add_u32 v25, 122880, v24
    ds_read_b64_tr_b16 a[208:209], v25 offset:0
    ds_read_b64_tr_b16 a[210:211], v25 offset:512
    ds_read_b64_tr_b16 a[212:213], v25 offset:4096
    ds_read_b64_tr_b16 a[214:215], v25 offset:4608
    ds_read_b64_tr_b16 a[216:217], v25 offset:8192
    ds_read_b64_tr_b16 a[218:219], v25 offset:8704
    ds_read_b64_tr_b16 a[220:221], v25 offset:12288
    ds_read_b64_tr_b16 a[222:223], v25 offset:12800
    ds_read_b64_tr_b16 v[88:89], v25 offset:16384
    ds_read_b64_tr_b16 v[90:91], v25 offset:16896
    ds_read_b64_tr_b16 v[92:93], v25 offset:20480
    ds_read_b64_tr_b16 v[94:95], v25 offset:20992
    s_waitcnt vmcnt(24) lgkmcnt(0)
    s_barrier
    s_add_u32 m0, s42, 122880
    s_add_u32 s34, s41, 896
    buffer_load_dwordx4 v19, s[20:23], s34 offen lds
    s_add_u32 m0, s42, 123904
    s_add_u32 s34, s41, 11136
    buffer_load_dwordx4 v19, s[20:23], s34 offen lds
    s_add_u32 m0, s42, 124928
    s_add_u32 s34, s41, 21376
    buffer_load_dwordx4 v19, s[20:23], s34 offen lds
    s_add_u32 m0, s42, 125952
    s_add_u32 s34, s41, 31616
    buffer_load_dwordx4 v19, s[20:23], s34 offen lds
    s_add_u32 m0, s42, 126976
    s_add_u32 s34, s41, 41856
    buffer_load_dwordx4 v19, s[20:23], s34 offen lds
    s_add_u32 m0, s42, 128000
    s_add_u32 s34, s41, 52096
    buffer_load_dwordx4 v19, s[20:23], s34 offen lds
    v_add_u32 v25, 0, v24
    ds_read_b64_tr_b16 a[224:225], v25 offset:0
    ds_read_b64_tr_b16 a[226:227], v25 offset:512
    ds_read_b64_tr_b16 a[228:229], v25 offset:4096
    ds_read_b64_tr_b16 a[230:231], v25 offset:4608
    ds_read_b64_tr_b16 a[232:233], v25 offset:8192
    ds_read_b64_tr_b16 a[234:235], v25 offset:8704
    ds_read_b64_tr_b16 a[236:237], v25 offset:12288
    ds_read_b64_tr_b16 a[238:239], v25 offset:12800
    ds_read_b64_tr_b16 v[96:97], v25 offset:16384
    ds_read_b64_tr_b16 v[98:99], v25 offset:16896
    ds_read_b64_tr_b16 v[100:101], v25 offset:20480
    ds_read_b64_tr_b16 v[102:103], v25 offset:20992
    s_waitcnt vmcnt(24) lgkmcnt(0)
    s_barrier
    s_add_u32 m0, s42, 0
    s_add_u32 s34, s41, 1024
    buffer_load_dwordx4 v19, s[20:23], s34 offen lds
    s_add_u32 m0, s42, 1024
    s_add_u32 s34, s41, 11264
    buffer_load_dwordx4 v19, s[20:23], s34 offen lds
    s_add_u32 m0, s42, 2048
    s_add_u32 s34, s41, 21504
    buffer_load_dwordx4 v19, s[20:23], s34 offen lds
    s_add_u32 m0, s42, 3072
    s_add_u32 s34, s41, 31744
    buffer_load_dwordx4 v19, s[20:23], s34 offen lds
    s_add_u32 m0, s42, 4096
    s_add_u32 s34, s41, 41984
    buffer_load_dwordx4 v19, s[20:23], s34 offen lds
    s_add_u32 m0, s42, 5120
    s_add_u32 s34, s41, 52224
    buffer_load_dwordx4 v19, s[20:23], s34 offen lds
    v_add_u32 v25, 24576, v24
    ds_read_b64_tr_b16 a[240:241], v25 offset:0
    ds_read_b64_tr_b16 a[242:243], v25 offset:512
    ds_read_b64_tr_b16 a[244:245], v25 offset:4096
    ds_read_b64_tr_b16 a[246:247], v25 offset:4608
    ds_read_b64_tr_b16 a[248:249], v25 offset:8192
    ds_read_b64_tr_b16 a[250:251], v25 offset:8704
    ds_read_b64_tr_b16 a[252:253], v25 offset:12288
    ds_read_b64_tr_b16 a[254:255], v25 offset:12800
    ds_read_b64_tr_b16 v[104:105], v25 offset:16384
    ds_read_b64_tr_b16 v[106:107], v25 offset:16896
    ds_read_b64_tr_b16 v[108:109], v25 offset:20480
    ds_read_b64_tr_b16 v[110:111], v25 offset:20992
    s_waitcnt vmcnt(24) lgkmcnt(0)
    s_barrier
    s_add_u32 m0, s42, 24576
    s_add_u32 s34, s41, 1152
    buffer_load_dwordx4 v19, s[20:23], s34 offen lds
    s_add_u32 m0, s42, 25600
    s_add_u32 s34, s41, 11392
    buffer_load_dwordx4 v19, s[20:23], s34 offen lds
    s_add_u32 m0, s42, 26624
    s_add_u32 s34, s41, 21632
    buffer_load_dwordx4 v19, s[20:23], s34 offen lds
    s_add_u32 m0, s42, 27648
    s_add_u32 s34, s41, 31872
    buffer_load_dwordx4 v19, s[20:23], s34 offen lds
    s_add_u32 m0, s42, 28672
    s_add_u32 s34, s41, 42112
    buffer_load_dwordx4 v19, s[20:23], s34 offen lds
    s_add_u32 m0, s42, 29696
    s_add_u32 s34, s41, 52352
    buffer_load_dwordx4 v19, s[20:23], s34 offen lds
    v_add_u32 v25, 49152, v24
    ds_read_b64_tr_b16 v[160:161], v25 offset:0
    ds_read_b64_tr_b16 v[162:163], v25 offset:512
    ds_read_b64_tr_b16 v[164:165], v25 offset:4096
    ds_read_b64_tr_b16 v[166:167], v25 offset:4608
    ds_read_b64_tr_b16 v[168:169], v25 offset:8192
    ds_read_b64_tr_b16 v[170:171], v25 offset:8704
    ds_read_b64_tr_b16 v[172:173], v25 offset:12288
    ds_read_b64_tr_b16 v[174:175], v25 offset:12800
    ds_read_b64_tr_b16 v[112:113], v25 offset:16384
    ds_read_b64_tr_b16 v[114:115], v25 offset:16896
    ds_read_b64_tr_b16 v[116:117], v25 offset:20480
    ds_read_b64_tr_b16 v[118:119], v25 offset:20992
    s_waitcnt vmcnt(24) lgkmcnt(0)
    s_barrier
    v_add_u32 v25, 73728, v24
    ds_read_b64_tr_b16 v[176:177], v25 offset:0
    ds_read_b64_tr_b16 v[178:179], v25 offset:512
    ds_read_b64_tr_b16 v[180:181], v25 offset:4096
    ds_read_b64_tr_b16 v[182:183], v25 offset:4608
    ds_read_b64_tr_b16 v[184:185], v25 offset:8192
    ds_read_b64_tr_b16 v[186:187], v25 offset:8704
    ds_read_b64_tr_b16 v[188:189], v25 offset:12288
    ds_read_b64_tr_b16 v[190:191], v25 offset:12800
    ds_read_b64_tr_b16 v[120:121], v25 offset:16384
    ds_read_b64_tr_b16 v[122:123], v25 offset:16896
    ds_read_b64_tr_b16 v[124:125], v25 offset:20480
    ds_read_b64_tr_b16 v[126:127], v25 offset:20992
    s_waitcnt vmcnt(18) lgkmcnt(0)
    s_barrier
    v_add_u32 v25, 98304, v24
    ds_read_b64_tr_b16 v[192:193], v25 offset:0
    ds_read_b64_tr_b16 v[194:195], v25 offset:512
    ds_read_b64_tr_b16 v[196:197], v25 offset:4096
    ds_read_b64_tr_b16 v[198:199], v25 offset:4608
    ds_read_b64_tr_b16 v[200:201], v25 offset:8192
    ds_read_b64_tr_b16 v[202:203], v25 offset:8704
    ds_read_b64_tr_b16 v[204:205], v25 offset:12288
    ds_read_b64_tr_b16 v[206:207], v25 offset:12800
    ds_read_b64_tr_b16 v[128:129], v25 offset:16384
    ds_read_b64_tr_b16 v[130:131], v25 offset:16896
    ds_read_b64_tr_b16 v[132:133], v25 offset:20480
    ds_read_b64_tr_b16 v[134:135], v25 offset:20992
    s_waitcnt vmcnt(12) lgkmcnt(0)
    s_barrier
    v_add_u32 v25, 122880, v24
    ds_read_b64_tr_b16 v[208:209], v25 offset:0
    ds_read_b64_tr_b16 v[210:211], v25 offset:512
    ds_read_b64_tr_b16 v[212:213], v25 offset:4096
    ds_read_b64_tr_b16 v[214:215], v25 offset:4608
    ds_read_b64_tr_b16 v[216:217], v25 offset:8192
    ds_read_b64_tr_b16 v[218:219], v25 offset:8704
    ds_read_b64_tr_b16 v[220:221], v25 offset:12288
    ds_read_b64_tr_b16 v[222:223], v25 offset:12800
    ds_read_b64_tr_b16 v[136:137], v25 offset:16384
    ds_read_b64_tr_b16 v[138:139], v25 offset:16896
    ds_read_b64_tr_b16 v[140:141], v25 offset:20480
    ds_read_b64_tr_b16 v[142:143], v25 offset:20992
    s_waitcnt vmcnt(6) lgkmcnt(0)
    s_barrier
    v_add_u32 v25, 0, v24
    ds_read_b64_tr_b16 v[224:225], v25 offset:0
    ds_read_b64_tr_b16 v[226:227], v25 offset:512
    ds_read_b64_tr_b16 v[228:229], v25 offset:4096
    ds_read_b64_tr_b16 v[230:231], v25 offset:4608
    ds_read_b64_tr_b16 v[232:233], v25 offset:8192
    ds_read_b64_tr_b16 v[234:235], v25 offset:8704
    ds_read_b64_tr_b16 v[236:237], v25 offset:12288
    ds_read_b64_tr_b16 v[238:239], v25 offset:12800
    ds_read_b64_tr_b16 v[144:145], v25 offset:16384
    ds_read_b64_tr_b16 v[146:147], v25 offset:16896
    ds_read_b64_tr_b16 v[148:149], v25 offset:20480
    ds_read_b64_tr_b16 v[150:151], v25 offset:20992
    s_waitcnt vmcnt(0) lgkmcnt(0)
    s_barrier
    v_add_u32 v25, 24576, v24
    ds_read_b64_tr_b16 v[240:241], v25 offset:0
    ds_read_b64_tr_b16 v[242:243], v25 offset:512
    ds_read_b64_tr_b16 v[244:245], v25 offset:4096
    ds_read_b64_tr_b16 v[246:247], v25 offset:4608
    ds_read_b64_tr_b16 v[248:249], v25 offset:8192
    ds_read_b64_tr_b16 v[250:251], v25 offset:8704
    ds_read_b64_tr_b16 v[252:253], v25 offset:12288
    ds_read_b64_tr_b16 v[254:255], v25 offset:12800
    ds_read_b64_tr_b16 v[152:153], v25 offset:16384
    ds_read_b64_tr_b16 v[154:155], v25 offset:16896
    ds_read_b64_tr_b16 v[156:157], v25 offset:20480
    ds_read_b64_tr_b16 v[158:159], v25 offset:20992
    ds_read_b32 v16, v26 offset:0
    ds_read_b32 v17, v26 offset:1024
    ds_read_b32 v18, v26 offset:2048
    ds_read_b32 v19, v26 offset:3072
    ds_read_b32 v20, v26 offset:4096
    ds_read_b32 v21, v26 offset:5120
    ds_read_b32 v22, v26 offset:6144
    ds_read_b32 v23, v26 offset:7168
    ds_read_b32 v24, v26 offset:8192
    ds_read_b32 v25, v26 offset:9216
    s_waitcnt lgkmcnt(0)
    s_barrier
    ds_write_b32 v4, v16 offset:0
    ds_write_b32 v4, v17 offset:1024
    ds_write_b32 v4, v18 offset:2048
    ds_write_b32 v4, v19 offset:3072
    ds_write_b32 v4, v20 offset:4096
    ds_write_b32 v4, v21 offset:5120
    ds_write_b32 v4, v22 offset:6144
    ds_write_b32 v4, v23 offset:7168
    ds_write_b32 v4, v24 offset:8192
    ds_write_b32 v4, v25 offset:9216
    ds_write_b128 v7, v[32:35] offset:0
    ds_write_b128 v7, v[36:39] offset:1024
    ds_write_b128 v7, v[40:43] offset:2048
    ds_write_b128 v7, v[44:47] offset:3072
    ds_write_b128 v7, v[48:51] offset:4096
    ds_write_b128 v7, v[52:55] offset:5120
    ds_write_b128 v7, v[56:59] offset:6144
    ds_write_b128 v7, v[60:63] offset:7168
    ds_write_b128 v7, v[64:67] offset:8192
    ds_write_b128 v7, v[68:71] offset:9216
    ds_write_b128 v7, v[72:75] offset:10240
    ds_write_b128 v7, v[76:79] offset:11264
    ds_write_b128 v7, v[80:83] offset:12288
    ds_write_b128 v7, v[84:87] offset:13312
    ds_write_b128 v7, v[88:91] offset:14336
    ds_write_b128 v7, v[92:95] offset:15360
    ds_write_b128 v7, v[96:99] offset:16384
    ds_write_b128 v7, v[100:103] offset:17408
    ds_write_b128 v7, v[104:107] offset:18432
    ds_write_b128 v7, v[108:111] offset:19456
    ds_write_b128 v7, v[112:115] offset:20480
    ds_write_b128 v7, v[116:119] offset:21504
    ds_write_b128 v7, v[120:123] offset:22528
    ds_write_b128 v7, v[124:127] offset:23552
    ds_write_b128 v7, v[128:131] offset:24576
    ds_write_b128 v7, v[132:135] offset:25600
    ds_write_b128 v7, v[136:139] offset:26624
    ds_write_b128 v7, v[140:143] offset:27648
    ds_write_b128 v7, v[144:147] offset:28672
    ds_write_b128 v7, v[148:151] offset:29696
    ds_write_b128 v7, v[152:155] offset:30720
    ds_write_b128 v7, v[156:159] offset:31744
    s_waitcnt lgkmcnt(0)
    v_mov_b32 v20, 0
cw_85:
    buffer_load_dwordx4 v[16:19], v20, s[12:15], 0 offen offset:0 sc1
    buffer_load_dword v22, v20, s[12:15], 0 offen offset:56 sc1
    s_waitcnt vmcnt(0)
    v_min_u32 v21, 1, v22
    v_sad_u8 v21, v16, 0, v21
    v_sad_u8 v21, v17, 0, v21
    v_sad_u8 v21, v18, 0, v21
    v_sad_u8 v21, v19, 0, v21
    s_nop 0
    v_readfirstlane_b32 s34, v21
    s_nop 0
    s_cmp_eq_u32 s34, 65
    s_cbranch_scc1 cwd_86
    s_sleep 4
    s_sub_u32 s33, s33, 1
    s_cbranch_scc0 cw_85
    s_mov_b32 s33, 0
cwd_86:
    v_readfirstlane_b32 s69, v22
    s_nop 0
    s_and_b32 s69, s69, 2
    s_lshl_b32 s69, s69, 12
    s_add_u32 s39, s39, s69
    s_xor_b32 s69, s69, 8192
    s_add_u32 s38, s38, s69
    v_readfirstlane_b32 s40, v16
    v_readfirstlane_b32 s41, v17
    v_readfirstlane_b32 s42, v18
    v_readfirstlane_b32 s43, v19
    s_cmp_eq_u32 s29, 0
    s_cselect_b32 s50, s40, s42
    s_cselect_b32 s51, s41, s43
    s_lshl_b32 s34, s48, 3
    s_lshr_b64 s[50:51], s[50:51], s34
    s_and_b32 s34, s50, 0xff
    s_cmp_eq_u32 s34, 32
    s_cselect_b32 s46, 1, 0
    s_lshl_b32 s34, s28, 4
    s_add_u32 s34, s34, s30
    s_mul_i32 s43, s29, 163840
    s_add_u32 s43, s43, 180355072
    s_mul_i32 s35, s28, 2560
    s_add_u32 s42, s43, s35
    s_mul_i32 s35, s30, 10240
    s_add_u32 s42, s42, s35
    s_and_b32 s35, s34, 3
    s_mul_i32 s35, s35, 2560
    s_add_u32 s43, s43, s35
    s_lshr_b32 s35, s34, 2
    s_lshl_b32 s35, s35, 8
    s_add_u32 s43, s43, s35
    s_mul_i32 s35, s34, 0x199a
    s_lshr_b32 s35, s35, 16
    s_mul_i32 s36, s35, 10
    s_sub_u32 s36, s34, s36
    s_lshl_b32 s44, s36, 8
    s_and_b32 s36, s35, 1
    s_lshl_b32 s36, s36, 12
    s_add_u32 s44, s44, s36
    s_lshr_b32 s36, s35, 1
    s_lshl_b32 s36, s36, 14
    s_add_u32 s44, s44, s36
    s_lshl_b32 s36, s29, 15
    s_add_u32 s44, s44, s36
    s_add_u32 s44, s44, 203423744
    s_mul_i32 s45, s29, 655360
    s_lshl_b32 s35, s34, 14
    s_add_u32 s45, s45, s35
    s_add_u32 s45, s45, 50331648
    s_sub_u32 s59, s42, 46137344
    s_cmp_eq_u32 s49, 0
    s_cselect_b32 s43, 0x40000000, s43
    s_cselect_b32 s44, 0x40000000, s44
    s_cselect_b32 s45, 0x40000000, s45
    s_add_u32 s44, s44, s69
    s_mov_b32 s40, s45
    s_mul_i32 s41, s29, 10240
    s_add_u32 s41, s41, 160432128
    s_lshl_b32 s34, s29, 4
    s_lshl_b32 s45, 0xffff, s34
    s_mov_b32 s60, s43
    s_mov_b32 s61, s44
    s_mov_b32 s62, s41
    s_mov_b32 s63, s42
    s_mov_b32 s64, s38
    s_mov_b32 s65, s39
    s_and_b32 s34, s32, 3
    s_mul_i32 s34, s34, 20480
    s_add_u32 s41, s62, s34
    s_add_u32 s34, s32, 1
    s_and_b32 s34, s34, 3
    s_mul_i32 s34, s34, 65536
    s_add_u32 s44, s61, s34
    s_add_u32 s34, s32, 2
    s_and_b32 s34, s34, 3
    s_mul_i32 s34, s34, 65536
    s_add_u32 s67, s61, s34
    s_and_b32 s68, s32, 1
    s_add_u32 s56, s40, 4096
    s_add_u32 s57, s40, 8192
    s_add_u32 s58, s40, 12288
    s_lshl_b32 s63, s29, 8
    s_lshl_b32 s34, s30, 2
    s_add_u32 s63, s63, s34
    s_add_u32 s63, s63, 157286400
    s_cmp_eq_u32 s28, 3
    s_cselect_b32 s63, s63, 0x40000000
    s_lshl_b32 s34, s32, 3
    s_lshl_b32 s50, s32, 1
    s_add_u32 s50, s50, s29
    s_cmp_eq_u32 s32, 0
    s_cselect_b32 s51, 32, 16
fl_87:
    buffer_load_ubyte v18, off, s[12:15], s50 offset:200 sc1
    s_waitcnt vmcnt(0)
    v_readfirstlane_b32 s35, v18
    s_nop 0
    s_cmp_ge_u32 s35, s51
    s_cbranch_scc1 fld_88
fln_89:
    s_sleep 3
    s_sub_u32 s33, s33, 1
    s_cbranch_scc0 fl_87
    s_mov_b32 s33, 0
fld_88:
    buffer_load_dwordx4 v[120:123], v5, s[8:11], s56 offen offset:2048 sc1 nt
    buffer_load_dwordx4 v[124:127], v5, s[8:11], s56 offen offset:3072 sc1 nt
    buffer_load_dwordx4 v[128:131], v5, s[8:11], s57 offen offset:0 sc1 nt
    buffer_load_dwordx4 v[132:135], v5, s[8:11], s57 offen offset:1024 sc1 nt
    buffer_load_dwordx4 v[136:139], v5, s[8:11], s57 offen offset:2048 sc1 nt
    buffer_load_dwordx4 v[140:143], v5, s[8:11], s57 offen offset:3072 sc1 nt
    buffer_load_dwordx4 v[144:147], v5, s[8:11], s58 offen offset:0 sc1 nt
    buffer_load_dwordx4 v[148:151], v5, s[8:11], s58 offen offset:1024 sc1 nt
    buffer_load_dwordx4 v[152:155], v5, s[8:11], s58 offen offset:2048 sc1 nt
    buffer_load_dwordx4 v[156:159], v5, s[8:11], s58 offen offset:3072 sc1 nt
    s_mov_b32 s66, 0x40000000
    v_mov_b64 v[96:97], 0
    v_mov_b64 v[98:99], 0
    v_mov_b64 v[100:101], 0
    v_mov_b64 v[102:103], 0
    v_mov_b64 v[104:105], 0
    v_mov_b64 v[106:107], 0
    v_mov_b64 v[32:33], 0
    v_mov_b64 v[34:35], 0
    v_mov_b64 v[36:37], 0
    v_mov_b64 v[38:39], 0
    v_mov_b64 v[40:41], 0
    v_mov_b64 v[42:43], 0
    v_mov_b64 v[44:45], 0
    v_mov_b64 v[46:47], 0
    v_mov_b64 v[48:49], 0
    v_mov_b64 v[50:51], 0
    v_mov_b64 v[52:53], 0
    v_mov_b64 v[54:55], 0
    v_mov_b64 v[56:57], 0
    v_mov_b64 v[58:59], 0
    v_mov_b64 v[60:61], 0
    v_mov_b64 v[62:63], 0
    v_mov_b64 v[64:65], 0
    v_mov_b64 v[66:67], 0
    v_mov_b64 v[68:69], 0
    v_mov_b64 v[70:71], 0
    s_waitcnt lgkmcnt(0)
    s_cmp_eq_u32 s46, 0
    s_cbranch_scc1 voslow_90
voloop_91:
    s_barrier
    ds_read_b64_tr_b16 v[16:17], v2 offset:0
    ds_read_b64_tr_b16 v[18:19], v0 offset:0
    ds_read_b64_tr_b16 v[20:21], v2 offset:1024
    ds_read_b64_tr_b16 v[22:23], v0 offset:1024
    ds_read_b64_tr_b16 v[24:25], v2 offset:2048
    ds_read_b64_tr_b16 v[26:27], v0 offset:2048
    ds_read_b64_tr_b16 v[28:29], v2 offset:3072
    ds_read_b64_tr_b16 v[30:31], v0 offset:3072
    s_waitcnt lgkmcnt(6)
    v_smfmac_f32_16x16x64_bf16 v[96:99], v[16:19], a[0:7], v1
    ds_read_b128 v[72:75], v7 offset:0
    s_xor_b32 s35, s67, 8192
    v_smfmac_f32_16x16x64_bf16 v[100:103], v[16:19], a[8:15], v1
    ds_read_b128 v[76:79], v7 offset:1024
    buffer_store_dword v11, v8, s[8:11], s35 offen sc1
    v_smfmac_f32_16x16x64_bf16 v[104:107], v[16:19], a[16:23], v1
    ds_read_b64_tr_b16 v[16:17], v2 offset:4096
    buffer_store_dword v11, v8, s[8:11], s67 offen
    s_waitcnt lgkmcnt(7)
    v_smfmac_f32_16x16x64_bf16 v[96:99], v[20:23], a[24:31], v1
    ds_read_b64_tr_b16 v[18:19], v0 offset:4096
    v_smfmac_f32_16x16x64_bf16 v[100:103], v[20:23], a[32:39], v1
    ds_read_b128 v[80:83], v7 offset:2048
    buffer_store_dwordx4 v[108:111], v5, s[8:11], s66 offen offset:0 sc1
    v_smfmac_f32_16x16x64_bf16 v[104:107], v[20:23], a[40:47], v1
    ds_read_b128 v[84:87], v7 offset:3072
    s_add_u32 s34, s32, 1
    s_waitcnt lgkmcnt(8)
    v_smfmac_f32_16x16x64_bf16 v[96:99], v[24:27], a[48:55], v1
    ds_read_b64_tr_b16 v[20:21], v2 offset:5120
    s_and_b32 s34, s34, 3
    v_smfmac_f32_16x16x64_bf16 v[100:103], v[24:27], a[56:63], v1
    ds_read_b64_tr_b16 v[22:23], v0 offset:5120
    s_mul_i32 s34, s34, 65536
    v_smfmac_f32_16x16x64_bf16 v[104:107], v[24:27], a[64:71], v1
    ds_read_b128 v[88:91], v7 offset:4096
    s_add_u32 s38, s64, s34
    s_waitcnt lgkmcnt(9)
    v_smfmac_f32_16x16x64_bf16 v[96:99], v[28:31], a[72:79], v1
    ds_read_b128 v[92:95], v7 offset:5120
    s_add_u32 s39, s65, s34
    v_smfmac_f32_16x16x64_bf16 v[100:103], v[28:31], a[80:87], v1
    ds_read_b64_tr_b16 v[24:25], v2 offset:6144
    v_smfmac_f32_16x16x64_bf16 v[104:107], v[28:31], a[88:95], v1
    ds_read_b64_tr_b16 v[26:27], v0 offset:6144
    s_waitcnt lgkmcnt(8)
    v_smfmac_f32_16x16x64_bf16 v[96:99], v[16:19], a[96:103], v1
    ds_read_b64_tr_b16 v[28:29], v2 offset:7168
    buffer_store_dwordx4 v[112:115], v5, s[8:11], s66 offen offset:1024 sc1
    v_smfmac_f32_16x16x64_bf16 v[100:103], v[16:19], a[104:111], v1
    ds_read_b64_tr_b16 v[30:31], v0 offset:7168
    v_smfmac_f32_16x16x64_bf16 v[104:107], v[16:19], v[72:79], v1
    ds_read_b64_tr_b16 v[16:17], v2 offset:8192
    s_waitcnt lgkmcnt(7)
    v_smfmac_f32_16x16x64_bf16 v[96:99], v[20:23], a[112:119], v1
    ds_read_b64_tr_b16 v[18:19], v0 offset:8192
    v_smfmac_f32_16x16x64_bf16 v[100:103], v[20:23], a[120:127], v1
    ds_read_b128 v[72:75], v7 offset:6144
    v_smfmac_f32_16x16x64_bf16 v[104:107], v[20:23], v[80:87], v1
    ds_read_b128 v[76:79], v7 offset:7168
    s_waitcnt lgkmcnt(6)
    v_smfmac_f32_16x16x64_bf16 v[96:99], v[24:27], a[128:135], v1
    ds_read_b64_tr_b16 v[20:21], v2 offset:9216
    v_smfmac_f32_16x16x64_bf16 v[100:103], v[24:27], a[136:143], v1
    ds_read_b64_tr_b16 v[22:23], v0 offset:9216
    v_smfmac_f32_16x16x64_bf16 v[104:107], v[24:27], v[88:95], v1
    ds_read_b128 v[80:83], v7 offset:8192
    buffer_store_dwordx4 v[116:119], v9, s[8:11], s66 offen offset:2048 sc1
    s_waitcnt lgkmcnt(7)
    v_smfmac_f32_16x16x64_bf16 v[96:99], v[28:31], a[144:151], v1
    ds_read_b128 v[84:87], v7 offset:9216
    v_smfmac_f32_16x16x64_bf16 v[100:103], v[28:31], a[152:159], v1
    ds_read_b128 v[88:91], v7 offset:10240
    s_waitcnt lgkmcnt(5)
    v_smfmac_f32_16x16x64_bf16 v[104:107], v[28:31], v[72:79], v1
    ds_read_b128 v[92:95], v7 offset:11264
    v_smfmac_f32_16x16x64_bf16 v[96:99], v[16:19], a[160:167], v1
    ds_read_b128 v[72:75], v7 offset:12288
    v_smfmac_f32_16x16x64_bf16 v[100:103], v[16:19], a[168:175], v1
    ds_read_b128 v[76:79], v7 offset:13312
    s_waitcnt lgkmcnt(4)
    v_smfmac_f32_16x16x64_bf16 v[104:107], v[16:19], v[80:87], v1
    v_smfmac_f32_16x16x64_bf16 v[96:99], v[20:23], a[176:183], v1
    ds_read_b128 v[80:83], v7 offset:14336
    v_smfmac_f32_16x16x64_bf16 v[100:103], v[20:23], a[184:191], v1
    ds_read_b128 v[84:87], v7 offset:15360
    s_waitcnt lgkmcnt(4)
    v_smfmac_f32_16x16x64_bf16 v[104:107], v[20:23], v[88:95], v1
    s_nop 2
    v_add_f32 v96, v96, v98
    v_add_f32 v97, v97, v99
    v_add_f32 v100, v100, v102
    v_add_f32 v101, v101, v103
    s_nop 0
    v_add_f32 v104, v104, v106
    v_add_f32 v105, v105, v107
    v_cvt_pk_bf16_f32 v96, v96, v97
    v_cvt_pk_bf16_f32 v100, v100, v101
    v_cvt_pk_bf16_f32 v104, v104, v105
    ds_write_b32 v4, v96 offset:20480
    ds_write_b32 v4, v100 offset:21504
    ds_write_b32 v4, v104 offset:22528
    s_waitcnt lgkmcnt(0)
    s_barrier
    ds_read_b64_tr_b16 v[16:17], v2 offset:20480
    ds_read_b64_tr_b16 v[18:19], v0 offset:20480
    ds_read_b64_tr_b16 v[20:21], v2 offset:21504
    ds_read_b64_tr_b16 v[22:23], v0 offset:21504
    ds_read_b64_tr_b16 v[24:25], v2 offset:22528
    ds_read_b64_tr_b16 v[26:27], v0 offset:22528
    ds_read_b128 v[88:91], v7 offset:16384
    ds_read_b128 v[92:95], v7 offset:17408
    s_waitcnt lgkmcnt(6)
    v_smfmac_f32_16x16x64_bf16 v[32:35], v[16:19], a[192:199], v1
    buffer_load_dwordx4 v[96:99], v5, s[8:11], s40 offen offset:0 sc1 nt
    v_smfmac_f32_16x16x64_bf16 v[36:39], v[16:19], a[208:215], v1
    s_waitcnt lgkmcnt(4)
    v_smfmac_f32_16x16x64_bf16 v[32:35], v[20:23], a[200:207], v1
    buffer_load_dwordx4 v[100:103], v5, s[8:11], s40 offen offset:1024 sc1 nt
    v_smfmac_f32_16x16x64_bf16 v[36:39], v[20:23], a[216:223], v1
    s_waitcnt lgkmcnt(2)
    v_smfmac_f32_16x16x64_bf16 v[32:35], v[24:27], v[72:79], v1
    ds_read_b128 v[72:75], v7 offset:18432
    buffer_load_dwordx4 v[104:107], v5, s[8:11], s40 offen offset:2048 sc1 nt
    v_smfmac_f32_16x16x64_bf16 v[36:39], v[24:27], v[80:87], v1
    ds_read_b128 v[76:79], v7 offset:19456
    v_smfmac_f32_16x16x64_bf16 v[40:43], v[16:19], a[224:231], v1
    ds_read_b128 v[80:83], v7 offset:20480
    buffer_load_dwordx4 v[108:111], v5, s[8:11], s40 offen offset:3072 sc1 nt
    v_smfmac_f32_16x16x64_bf16 v[44:47], v[16:19], a[240:247], v1
    ds_read_b128 v[84:87], v7 offset:21504
    v_add_f32 v32, v32, v34
    v_add_f32 v33, v33, v35
    v_smfmac_f32_16x16x64_bf16 v[40:43], v[20:23], a[232:239], v1
    v_add_f32 v36, v36, v38
    v_add_f32 v37, v37, v39
    buffer_load_dwordx4 v[112:115], v5, s[8:11], s56 offen offset:0 sc1 nt
    v_smfmac_f32_16x16x64_bf16 v[44:47], v[20:23], a[248:255], v1
    v_cvt_pk_bf16_f32 v12, v32, v33
    s_waitcnt lgkmcnt(4)
    v_smfmac_f32_16x16x64_bf16 v[40:43], v[24:27], v[88:95], v1
    ds_read_b128 v[88:91], v7 offset:22528
    v_cvt_pk_bf16_f32 v13, v36, v37
    buffer_load_dwordx4 v[116:119], v5, s[8:11], s56 offen offset:1024 sc1 nt
    s_waitcnt lgkmcnt(3)
    v_smfmac_f32_16x16x64_bf16 v[44:47], v[24:27], v[72:79], v1
    ds_read_b128 v[92:95], v7 offset:23552
    v_smfmac_f32_16x16x64_bf16 v[48:51], v[16:19], v[160:167], v1
    ds_read_b128 v[72:75], v7 offset:24576
    v_smfmac_f32_16x16x64_bf16 v[52:55], v[16:19], v[176:183], v1
    ds_read_b128 v[76:79], v7 offset:25600
    v_add_f32 v40, v40, v42
    v_add_f32 v41, v41, v43
    v_smfmac_f32_16x16x64_bf16 v[48:51], v[20:23], v[168:175], v1
    v_add_f32 v44, v44, v46
    v_add_f32 v45, v45, v47
    v_smfmac_f32_16x16x64_bf16 v[52:55], v[20:23], v[184:191], v1
    v_cvt_pk_bf16_f32 v14, v40, v41
    s_waitcnt lgkmcnt(4)
    v_smfmac_f32_16x16x64_bf16 v[48:51], v[24:27], v[80:87], v1
    ds_read_b128 v[80:83], v7 offset:26624
    v_cvt_pk_bf16_f32 v15, v44, v45
    s_waitcnt lgkmcnt(3)
    v_smfmac_f32_16x16x64_bf16 v[52:55], v[24:27], v[88:95], v1
    ds_read_b128 v[84:87], v7 offset:27648
    v_permlane32_swap_b32 v12, v14
    v_permlane32_swap_b32 v13, v15
    v_smfmac_f32_16x16x64_bf16 v[56:59], v[16:19], v[192:199], v1
    ds_read_b128 v[88:91], v7 offset:28672
    v_permlane16_swap_b32 v12, v13
    v_permlane16_swap_b32 v14, v15
    v_smfmac_f32_16x16x64_bf16 v[60:63], v[16:19], v[208:215], v1
    ds_read_b128 v[92:95], v7 offset:29696
    v_and_or_b32 v12, v12, -2, s68
    v_add_f32 v48, v48, v50
    v_smfmac_f32_16x16x64_bf16 v[56:59], v[20:23], v[200:207], v1
    v_add_f32 v49, v49, v51
    v_add_f32 v52, v52, v54
    buffer_store_dwordx4 v[12:15], v5, s[8:11], s42 offen offset:0
    v_smfmac_f32_16x16x64_bf16 v[60:63], v[20:23], v[216:223], v1
    v_add_f32 v53, v53, v55
    v_cvt_pk_bf16_f32 v28, v48, v49
    s_waitcnt lgkmcnt(4)
    v_smfmac_f32_16x16x64_bf16 v[56:59], v[24:27], v[72:79], v1
    ds_read_b128 v[72:75], v7 offset:30720
    v_cvt_pk_bf16_f32 v29, v52, v53
    s_waitcnt lgkmcnt(3)
    v_smfmac_f32_16x16x64_bf16 v[60:63], v[24:27], v[80:87], v1
    ds_read_b128 v[76:79], v7 offset:31744
    v_smfmac_f32_16x16x64_bf16 v[64:67], v[16:19], v[224:231], v1
    v_smfmac_f32_16x16x64_bf16 v[68:71], v[16:19], v[240:247], v1
    s_nop 0
    v_add_f32 v56, v56, v58
    v_add_f32 v57, v57, v59
    v_smfmac_f32_16x16x64_bf16 v[64:67], v[20:23], v[232:239], v1
    s_nop 0
    v_add_f32 v60, v60, v62
    v_add_f32 v61, v61, v63
    v_smfmac_f32_16x16x64_bf16 v[68:71], v[20:23], v[248:255], v1
    v_cvt_pk_bf16_f32 v30, v56, v57
    s_waitcnt lgkmcnt(2)
    v_smfmac_f32_16x16x64_bf16 v[64:67], v[24:27], v[88:95], v1
    v_cvt_pk_bf16_f32 v31, v60, v61
    s_waitcnt lgkmcnt(0)
    v_smfmac_f32_16x16x64_bf16 v[68:71], v[24:27], v[72:79], v1
    v_permlane32_swap_b32 v28, v30
    v_permlane32_swap_b32 v29, v31
    s_nop 1
    v_permlane16_swap_b32 v28, v29
    v_permlane16_swap_b32 v30, v31
    v_and_or_b32 v28, v28, -2, s68
    v_add_f32 v64, v64, v66
    v_add_f32 v65, v65, v67
    v_add_f32 v68, v68, v70
    buffer_store_dwordx4 v[28:31], v5, s[8:11], s42 offen offset:1024
    v_add_f32 v69, v69, v71
    v_cvt_pk_bf16_f32 v32, v64, v65
    v_cvt_pk_bf16_f32 v33, v68, v69
    s_nop 0
    v_permlane32_swap_b32 v32, v34
    v_permlane32_swap_b32 v33, v35
    s_nop 1
    v_permlane16_swap_b32 v32, v33
    v_permlane16_swap_b32 v34, v35
    v_and_or_b32 v32, v32, -2, s68
    buffer_store_dwordx4 v[32:35], v9, s[8:11], s42 offen offset:2048
    v_mov_b64 v[88:89], v[12:13]
    v_mov_b64 v[92:93], v[32:33]
    v_mov_b64 v[90:91], v[14:15]
    v_mov_b64 v[94:95], v[34:35]
    s_cmp_eq_u32 s32, 63
    s_cbranch_scc1 voend_92
    s_add_u32 s56, s43, 40960
    s_add_u32 s57, s43, 81920
    s_add_u32 s58, s43, 122880
    buffer_load_dwordx4 v[16:19], v6, s[8:11], s41 offen sc1
    buffer_load_dwordx4 v[20:23], v6, s[8:11], s41 offen offset:1024 sc1
    buffer_load_dwordx2 v[24:25], v3, s[8:11], s41 offen offset:2048 sc1
    s_sleep 2
pp_94:
    buffer_load_dwordx4 v[16:19], v6, s[8:11], s41 offen sc1
    buffer_load_dwordx4 v[20:23], v6, s[8:11], s41 offen offset:1024 sc1
    buffer_load_dwordx2 v[24:25], v3, s[8:11], s41 offen offset:2048 sc1
    s_waitcnt vmcnt(5)
    v_max3_u32 v12, v16, v17, v18
    s_waitcnt vmcnt(4)
    v_max3_u32 v13, v20, v21, v22
    v_max3_u32 v12, v12, v19, v23
    s_waitcnt vmcnt(3)
    v_max3_u32 v13, v13, v24, v25
    v_max_u32 v12, v12, v13
    v_cmp_eq_u32 vcc, -1, v12
    s_cbranch_vccz ppd_96
    s_sub_u32 s33, s33, 1
    s_cbranch_scc0 pp_94
    s_mov_b32 s33, 0
ppd_96:
    ds_write_b128 v6, v[16:19] offset:10240
    ds_write_b128 v6, v[20:23] offset:11264
    ds_write_b64 v3, v[24:25] offset:12288
    buffer_load_dwordx4 v[72:75], v10, s[8:11], s43 offen sc1
    buffer_load_dwordx4 v[76:79], v10, s[8:11], s56 offen sc1
    buffer_load_dwordx4 v[80:83], v10, s[8:11], s57 offen sc1
    buffer_load_dwordx4 v[84:87], v10, s[8:11], s58 offen sc1
    v_mov_b64 v[12:13], 0
    v_mov_b64 v[14:15], 0
    s_waitcnt lgkmcnt(0)
    s_barrier
    s_cmp_eq_u32 s49, 0
    s_cbranch_scc1 vonu_97_f
    ds_read_b64_tr_b16 v[32:33], v2 offset:10240
    ds_read_b64_tr_b16 v[34:35], v0 offset:10240
    ds_read_b64_tr_b16 v[36:37], v2 offset:11264
    ds_read_b64_tr_b16 v[38:39], v0 offset:11264
    ds_read_b64_tr_b16 v[40:41], v2 offset:12288
    ds_read_b64_tr_b16 v[42:43], v0 offset:12288
    ds_read_b64_tr_b16 v[44:45], v2 offset:13312
    ds_read_b64_tr_b16 v[46:47], v0 offset:13312
    ds_read_b64_tr_b16 v[48:49], v2 offset:14336
    ds_read_b64_tr_b16 v[50:51], v0 offset:14336
    ds_read_b64_tr_b16 v[52:53], v2 offset:15360
    ds_read_b64_tr_b16 v[54:55], v0 offset:15360
    ds_read_b64_tr_b16 v[56:57], v2 offset:16384
    ds_read_b64_tr_b16 v[58:59], v0 offset:16384
    s_waitcnt lgkmcnt(12)
    v_smfmac_f32_16x16x64_bf16 v[12:15], v[32:35], v[96:103], v1
    ds_read_b64_tr_b16 v[60:61], v2 offset:17408
    ds_read_b64_tr_b16 v[62:63], v0 offset:17408
    s_waitcnt lgkmcnt(12)
    v_smfmac_f32_16x16x64_bf16 v[12:15], v[36:39], v[104:111], v1
    ds_read_b64_tr_b16 v[64:65], v2 offset:18432
    ds_read_b64_tr_b16 v[66:67], v0 offset:18432
    s_waitcnt lgkmcnt(12)
    v_smfmac_f32_16x16x64_bf16 v[12:15], v[40:43], v[112:119], v1
    ds_read_b64_tr_b16 v[68:69], v2 offset:19456
    ds_read_b64_tr_b16 v[70:71], v0 offset:19456
    s_waitcnt lgkmcnt(12)
    v_smfmac_f32_16x16x64_bf16 v[12:15], v[44:47], v[120:127], v1
    s_waitcnt lgkmcnt(10)
    v_smfmac_f32_16x16x64_bf16 v[12:15], v[48:51], v[128:135], v1
    s_waitcnt lgkmcnt(8)
    v_smfmac_f32_16x16x64_bf16 v[12:15], v[52:55], v[136:143], v1
    s_waitcnt lgkmcnt(6)
    v_smfmac_f32_16x16x64_bf16 v[12:15], v[56:59], v[144:151], v1
    s_waitcnt lgkmcnt(4)
    v_smfmac_f32_16x16x64_bf16 v[12:15], v[60:63], v[152:159], v1
    s_waitcnt vmcnt(0)
    v_bitop3_b32 v26, v72, v76, v80 bitop3:0x7e
    v_bitop3_b32 v27, v72, v84, s68 bitop3:0x7e
    v_bitop3_b32 v26, v26, v27, 1 bitop3:0xa8
    v_cmp_ne_u32 vcc, 0, v26
    s_cbranch_vccnz tl_98
td_99:
    s_waitcnt lgkmcnt(2)
    v_smfmac_f32_16x16x64_bf16 v[12:15], v[64:67], v[72:79], v1
    s_waitcnt lgkmcnt(0)
    v_smfmac_f32_16x16x64_bf16 v[12:15], v[68:71], v[80:87], v1
    s_xor_b32 s34, s44, 8192
    s_nop 6
    v_add_f32 v12, v12, v14
    v_add_f32 v13, v13, v15
    v_cvt_pk_bf16_f32 v12, v12, v13
    buffer_store_dword v12, v8, s[8:11], s34 offen sc1
    buffer_store_dword v12, v8, s[8:11], s44 offen
vonu_97:
    s_add_u32 s40, s40, 1310720
    s_add_u32 s56, s40, 4096
    s_add_u32 s57, s40, 8192
    s_add_u32 s58, s40, 12288
    s_barrier
    s_cmp_eq_u32 s49, 0
    s_cbranch_scc1 vonu3_100_s
    buffer_load_dwordx4 v[120:123], v5, s[8:11], s56 offen offset:2048 sc1 nt
    buffer_load_dwordx4 v[124:127], v5, s[8:11], s56 offen offset:3072 sc1 nt
    buffer_load_dwordx4 v[128:131], v5, s[8:11], s57 offen offset:0 sc1 nt
    buffer_load_dwordx4 v[132:135], v5, s[8:11], s57 offen offset:1024 sc1 nt
    buffer_load_dwordx4 v[136:139], v5, s[8:11], s57 offen offset:2048 sc1 nt
    buffer_load_dwordx4 v[140:143], v5, s[8:11], s57 offen offset:3072 sc1 nt
    buffer_load_dwordx4 v[144:147], v5, s[8:11], s58 offen offset:0 sc1 nt
    buffer_load_dwordx4 v[148:151], v5, s[8:11], s58 offen offset:1024 sc1 nt
    buffer_load_dwordx4 v[152:155], v5, s[8:11], s58 offen offset:2048 sc1 nt
    buffer_load_dwordx4 v[156:159], v5, s[8:11], s58 offen offset:3072 sc1 nt
vonu3_100:
    v_mov_b64 v[108:109], v[88:89]
    v_mov_b64 v[110:111], v[90:91]
    v_mov_b64 v[112:113], v[28:29]
    v_mov_b64 v[114:115], v[30:31]
    v_mov_b64 v[116:117], v[92:93]
    v_mov_b64 v[118:119], v[94:95]
    buffer_load_dwordx4 v[12:15], v6, s[8:11], s38 offen sc1
    buffer_load_dwordx4 v[16:19], v6, s[8:11], s38 offen offset:1024 sc1
    buffer_load_dwordx2 v[20:21], v3, s[8:11], s38 offen offset:2048 sc1
    s_barrier
    buffer_load_dwordx4 v[22:25], v6, s[8:11], s39 offen sc1
    buffer_load_dwordx4 v[26:29], v6, s[8:11], s39 offen offset:1024 sc1
    buffer_load_dwordx2 v[30:31], v3, s[8:11], s39 offen offset:2048 sc1
    v_mov_b64 v[96:97], 0
    v_mov_b64 v[98:99], 0
    v_mov_b64 v[100:101], 0
    v_mov_b64 v[102:103], 0
    v_mov_b64 v[104:105], 0
    v_mov_b64 v[106:107], 0
    v_mov_b64 v[32:33], 0
    v_mov_b64 v[34:35], 0
    v_mov_b64 v[36:37], 0
    v_mov_b64 v[38:39], 0
    v_mov_b64 v[40:41], 0
    v_mov_b64 v[42:43], 0
    v_mov_b64 v[44:45], 0
    v_mov_b64 v[46:47], 0
    v_mov_b64 v[48:49], 0
    v_mov_b64 v[50:51], 0
    v_mov_b64 v[52:53], 0
    v_mov_b64 v[54:55], 0
    v_mov_b64 v[56:57], 0
    v_mov_b64 v[58:59], 0
    v_mov_b64 v[60:61], 0
    v_mov_b64 v[62:63], 0
    v_mov_b64 v[64:65], 0
    v_mov_b64 v[66:67], 0
    v_mov_b64 v[68:69], 0
    v_mov_b64 v[70:71], 0
    s_add_u32 s32, s32, 1
    s_mov_b32 s66, s59
    s_add_u32 s59, s59, 327680
    s_and_b32 s34, s32, 3
    s_mul_i32 s34, s34, 20480
    s_add_u32 s41, s62, s34
    s_add_u32 s34, s32, 1
    s_and_b32 s34, s34, 3
    s_mul_i32 s34, s34, 65536
    s_add_u32 s44, s61, s34
    s_add_u32 s34, s32, 2
    s_and_b32 s34, s34, 3
    s_mul_i32 s34, s34, 65536
    s_add_u32 s67, s61, s34
    s_and_b32 s68, s32, 1
    v_bfe_u32 v92, v5, 4, 4
    v_lshrrev_b32 v93, 8, v5
    v_lshlrev_b32 v93, 2, v93
    v_sub_u32 v92, v92, v93
    v_lshlrev_b32 v93, 4, v92
    v_mov_b32 v94, 0x3f80
    v_mov_b32 v95, 0
    v_lshlrev_b64 v[94:95], v93, v[94:95]
    v_cmp_gt_u32 vcc, 4, v92
    s_nop 1
    v_cndmask_b32 v94, 0, v94, vcc
    v_cndmask_b32 v95, 0, v95, vcc
mlc_102:
    s_waitcnt vmcnt(5)
    v_max3_u32 v92, v12, v13, v14
    s_waitcnt vmcnt(4)
    v_max3_u32 v93, v16, v17, v18
    v_max3_u32 v92, v92, v15, v19
    s_waitcnt vmcnt(3)
    v_max3_u32 v93, v93, v20, v21
    v_max_u32 v92, v92, v93
    v_cmp_eq_u32 vcc, -1, v92
    s_cbranch_vccnz ml_101
mld_103:
    v_mfma_f32_16x16x16_bf16 v[72:75], v[94:95], v[12:13], 0
    v_mfma_f32_16x16x16_bf16 v[76:79], v[94:95], v[14:15], 0
    v_mfma_f32_16x16x16_bf16 v[80:83], v[94:95], v[16:17], 0
    v_mfma_f32_16x16x16_bf16 v[84:87], v[94:95], v[18:19], 0
    v_mfma_f32_16x16x16_bf16 v[88:91], v[94:95], v[20:21], 0
    s_waitcnt vmcnt(2)
    v_mfma_f32_16x16x16_bf16 v[72:75], v[94:95], v[22:23], v[72:75]
    v_max3_u32 v92, v22, v23, v24
    v_mfma_f32_16x16x16_bf16 v[76:79], v[94:95], v[24:25], v[76:79]
    s_waitcnt vmcnt(1)
    v_mfma_f32_16x16x16_bf16 v[80:83], v[94:95], v[26:27], v[80:83]
    v_max3_u32 v93, v26, v27, v28
    v_mfma_f32_16x16x16_bf16 v[84:87], v[94:95], v[28:29], v[84:87]
    v_max3_u32 v92, v92, v25, v29
    s_waitcnt vmcnt(0)
    v_mfma_f32_16x16x16_bf16 v[88:91], v[94:95], v[30:31], v[88:91]
    v_max3_u32 v93, v93, v30, v31
    v_cvt_pk_bf16_f32 v72, v72, v73
    v_cvt_pk_bf16_f32 v73, v74, v75
    v_cvt_pk_bf16_f32 v74, v76, v77
    v_cvt_pk_bf16_f32 v75, v78, v79
    ds_write_b128 v6, v[72:75] offset:0
    v_max_u32 v92, v92, v93
    v_cvt_pk_bf16_f32 v76, v80, v81
    v_cvt_pk_bf16_f32 v77, v82, v83
    v_cvt_pk_bf16_f32 v78, v84, v85
    v_cvt_pk_bf16_f32 v79, v86, v87
    ds_write_b128 v6, v[76:79] offset:1024
    v_cmp_eq_u32 vcc, -1, v92
    v_cvt_pk_bf16_f32 v80, v88, v89
    v_cvt_pk_bf16_f32 v81, v90, v91
    ds_write_b64 v3, v[80:81] offset:2048
    s_cbranch_vccnz mr_104
mrd_106:
    s_waitcnt lgkmcnt(0)
    s_branch voloop_91
ml_101:
    s_sub_u32 s33, s33, 1
    s_cbranch_scc1 ml_101_t
    buffer_load_dwordx4 v[12:15], v6, s[8:11], s38 offen sc1
    buffer_load_dwordx4 v[16:19], v6, s[8:11], s38 offen offset:1024 sc1
    buffer_load_dwordx2 v[20:21], v3, s[8:11], s38 offen offset:2048 sc1
    buffer_load_dwordx4 v[22:25], v6, s[8:11], s39 offen sc1
    buffer_load_dwordx4 v[26:29], v6, s[8:11], s39 offen offset:1024 sc1
    buffer_load_dwordx2 v[30:31], v3, s[8:11], s39 offen offset:2048 sc1
    s_branch mlc_102
ml_101_t:
    s_mov_b32 s33, 0
    s_branch mld_103
mr_104:
    s_sub_u32 s33, s33, 1
    s_cbranch_scc1 mr_104_t
    buffer_load_dwordx4 v[22:25], v6, s[8:11], s39 offen sc1
    buffer_load_dwordx4 v[26:29], v6, s[8:11], s39 offen offset:1024 sc1
    buffer_load_dwordx2 v[30:31], v3, s[8:11], s39 offen offset:2048 sc1
    s_waitcnt vmcnt(2)
    v_max3_u32 v92, v22, v23, v24
    s_waitcnt vmcnt(1)
    v_max3_u32 v93, v26, v27, v28
    v_max3_u32 v92, v92, v25, v29
    s_waitcnt vmcnt(0)
    v_max3_u32 v93, v93, v30, v31
    v_max_u32 v92, v92, v93
    v_cmp_eq_u32 vcc, -1, v92
    s_cbranch_vccnz mr_104
    s_branch mld_103
mr_104_t:
    s_mov_b32 s33, 0
    s_branch mrd_106
vonu_97_f:
    s_add_u32 s34, s32, 1
    v_mov_b32 v12, s34
    s_mov_b64 exec, 1
    buffer_store_dword v12, off, s[8:11], s63
    s_mov_b64 exec, -1
    s_branch vonu_97
tl_98:
    buffer_load_dwordx4 v[72:75], v10, s[8:11], s43 offen sc1
    buffer_load_dwordx4 v[76:79], v10, s[8:11], s56 offen sc1
    buffer_load_dwordx4 v[80:83], v10, s[8:11], s57 offen sc1
    buffer_load_dwordx4 v[84:87], v10, s[8:11], s58 offen sc1
    s_waitcnt vmcnt(0)
    v_bitop3_b32 v26, v72, v76, v80 bitop3:0x7e
    v_bitop3_b32 v27, v72, v84, s68 bitop3:0x7e
    v_bitop3_b32 v26, v26, v27, 1 bitop3:0xa8
    v_cmp_ne_u32 vcc, 0, v26
    s_cbranch_vccz td_99
    s_sub_u32 s33, s33, 1
    s_cbranch_scc0 tl_98
    s_mov_b32 s33, 0
    s_branch td_99
vonu3_100_s:
    s_sleep 4
    s_branch vonu3_100
voend_92:
    buffer_store_dwordx4 v[88:91], v5, s[8:11], s59 offen offset:0 sc1
    buffer_store_dwordx4 v[28:31], v5, s[8:11], s59 offen offset:1024 sc1
    buffer_store_dwordx4 v[92:95], v9, s[8:11], s59 offen offset:2048 sc1
    s_waitcnt vmcnt(0)
    s_barrier
    s_cmp_lg_u32 s28, 0
    s_cbranch_scc1 dn_107
    v_mov_b32 v24, 1
    s_mov_b64 exec, 1
    buffer_atomic_add v24, off, s[12:15], 0 offset:196 sc1
    s_mov_b64 exec, -1
dn_107:
    s_endpgm
voslow_90:
voloop_108:
    s_barrier
    ds_read_b64_tr_b16 v[16:17], v2 offset:0
    ds_read_b64_tr_b16 v[18:19], v0 offset:0
    ds_read_b64_tr_b16 v[20:21], v2 offset:1024
    ds_read_b64_tr_b16 v[22:23], v0 offset:1024
    ds_read_b64_tr_b16 v[24:25], v2 offset:2048
    ds_read_b64_tr_b16 v[26:27], v0 offset:2048
    ds_read_b64_tr_b16 v[28:29], v2 offset:3072
    ds_read_b64_tr_b16 v[30:31], v0 offset:3072
    s_waitcnt lgkmcnt(6)
    v_smfmac_f32_16x16x64_bf16 v[96:99], v[16:19], a[0:7], v1
    ds_read_b128 v[72:75], v7 offset:0
    s_xor_b32 s35, s67, 8192
    v_smfmac_f32_16x16x64_bf16 v[100:103], v[16:19], a[8:15], v1
    ds_read_b128 v[76:79], v7 offset:1024
    buffer_store_dword v11, v8, s[8:11], s35 offen sc1
    v_smfmac_f32_16x16x64_bf16 v[104:107], v[16:19], a[16:23], v1
    ds_read_b64_tr_b16 v[16:17], v2 offset:4096
    buffer_store_dword v11, v8, s[8:11], s67 offen sc1
    s_waitcnt lgkmcnt(7)
    v_smfmac_f32_16x16x64_bf16 v[96:99], v[20:23], a[24:31], v1
    ds_read_b64_tr_b16 v[18:19], v0 offset:4096
    v_smfmac_f32_16x16x64_bf16 v[100:103], v[20:23], a[32:39], v1
    ds_read_b128 v[80:83], v7 offset:2048
    buffer_store_dwordx4 v[108:111], v5, s[8:11], s66 offen offset:0 sc1
    v_smfmac_f32_16x16x64_bf16 v[104:107], v[20:23], a[40:47], v1
    ds_read_b128 v[84:87], v7 offset:3072
    s_add_u32 s34, s32, 1
    s_waitcnt lgkmcnt(8)
    v_smfmac_f32_16x16x64_bf16 v[96:99], v[24:27], a[48:55], v1
    ds_read_b64_tr_b16 v[20:21], v2 offset:5120
    s_and_b32 s34, s34, 3
    v_smfmac_f32_16x16x64_bf16 v[100:103], v[24:27], a[56:63], v1
    ds_read_b64_tr_b16 v[22:23], v0 offset:5120
    s_mul_i32 s34, s34, 65536
    v_smfmac_f32_16x16x64_bf16 v[104:107], v[24:27], a[64:71], v1
    ds_read_b128 v[88:91], v7 offset:4096
    s_add_u32 s38, s64, s34
    s_waitcnt lgkmcnt(9)
    v_smfmac_f32_16x16x64_bf16 v[96:99], v[28:31], a[72:79], v1
    ds_read_b128 v[92:95], v7 offset:5120
    s_add_u32 s39, s65, s34
    v_smfmac_f32_16x16x64_bf16 v[100:103], v[28:31], a[80:87], v1
    ds_read_b64_tr_b16 v[24:25], v2 offset:6144
    v_smfmac_f32_16x16x64_bf16 v[104:107], v[28:31], a[88:95], v1
    ds_read_b64_tr_b16 v[26:27], v0 offset:6144
    s_waitcnt lgkmcnt(8)
    v_smfmac_f32_16x16x64_bf16 v[96:99], v[16:19], a[96:103], v1
    ds_read_b64_tr_b16 v[28:29], v2 offset:7168
    buffer_store_dwordx4 v[112:115], v5, s[8:11], s66 offen offset:1024 sc1
    v_smfmac_f32_16x16x64_bf16 v[100:103], v[16:19], a[104:111], v1
    ds_read_b64_tr_b16 v[30:31], v0 offset:7168
    v_smfmac_f32_16x16x64_bf16 v[104:107], v[16:19], v[72:79], v1
    ds_read_b64_tr_b16 v[16:17], v2 offset:8192
    s_waitcnt lgkmcnt(7)
    v_smfmac_f32_16x16x64_bf16 v[96:99], v[20:23], a[112:119], v1
    ds_read_b64_tr_b16 v[18:19], v0 offset:8192
    v_smfmac_f32_16x16x64_bf16 v[100:103], v[20:23], a[120:127], v1
    ds_read_b128 v[72:75], v7 offset:6144
    v_smfmac_f32_16x16x64_bf16 v[104:107], v[20:23], v[80:87], v1
    ds_read_b128 v[76:79], v7 offset:7168
    s_waitcnt lgkmcnt(6)
    v_smfmac_f32_16x16x64_bf16 v[96:99], v[24:27], a[128:135], v1
    ds_read_b64_tr_b16 v[20:21], v2 offset:9216
    v_smfmac_f32_16x16x64_bf16 v[100:103], v[24:27], a[136:143], v1
    ds_read_b64_tr_b16 v[22:23], v0 offset:9216
    v_smfmac_f32_16x16x64_bf16 v[104:107], v[24:27], v[88:95], v1
    ds_read_b128 v[80:83], v7 offset:8192
    buffer_store_dwordx4 v[116:119], v9, s[8:11], s66 offen offset:2048 sc1
    s_waitcnt lgkmcnt(7)
    v_smfmac_f32_16x16x64_bf16 v[96:99], v[28:31], a[144:151], v1
    ds_read_b128 v[84:87], v7 offset:9216
    v_smfmac_f32_16x16x64_bf16 v[100:103], v[28:31], a[152:159], v1
    ds_read_b128 v[88:91], v7 offset:10240
    s_waitcnt lgkmcnt(5)
    v_smfmac_f32_16x16x64_bf16 v[104:107], v[28:31], v[72:79], v1
    ds_read_b128 v[92:95], v7 offset:11264
    v_smfmac_f32_16x16x64_bf16 v[96:99], v[16:19], a[160:167], v1
    ds_read_b128 v[72:75], v7 offset:12288
    v_smfmac_f32_16x16x64_bf16 v[100:103], v[16:19], a[168:175], v1
    ds_read_b128 v[76:79], v7 offset:13312
    s_waitcnt lgkmcnt(4)
    v_smfmac_f32_16x16x64_bf16 v[104:107], v[16:19], v[80:87], v1
    v_smfmac_f32_16x16x64_bf16 v[96:99], v[20:23], a[176:183], v1
    ds_read_b128 v[80:83], v7 offset:14336
    v_smfmac_f32_16x16x64_bf16 v[100:103], v[20:23], a[184:191], v1
    ds_read_b128 v[84:87], v7 offset:15360
    s_waitcnt lgkmcnt(4)
    v_smfmac_f32_16x16x64_bf16 v[104:107], v[20:23], v[88:95], v1
    s_nop 2
    v_add_f32 v96, v96, v98
    v_add_f32 v97, v97, v99
    v_add_f32 v100, v100, v102
    v_add_f32 v101, v101, v103
    s_nop 0
    v_add_f32 v104, v104, v106
    v_add_f32 v105, v105, v107
    v_cvt_pk_bf16_f32 v96, v96, v97
    v_cvt_pk_bf16_f32 v100, v100, v101
    v_cvt_pk_bf16_f32 v104, v104, v105
    ds_write_b32 v4, v96 offset:20480
    ds_write_b32 v4, v100 offset:21504
    ds_write_b32 v4, v104 offset:22528
    s_waitcnt lgkmcnt(0)
    s_barrier
    ds_read_b64_tr_b16 v[16:17], v2 offset:20480
    ds_read_b64_tr_b16 v[18:19], v0 offset:20480
    ds_read_b64_tr_b16 v[20:21], v2 offset:21504
    ds_read_b64_tr_b16 v[22:23], v0 offset:21504
    ds_read_b64_tr_b16 v[24:25], v2 offset:22528
    ds_read_b64_tr_b16 v[26:27], v0 offset:22528
    ds_read_b128 v[88:91], v7 offset:16384
    ds_read_b128 v[92:95], v7 offset:17408
    s_waitcnt lgkmcnt(6)
    v_smfmac_f32_16x16x64_bf16 v[32:35], v[16:19], a[192:199], v1
    buffer_load_dwordx4 v[96:99], v5, s[8:11], s40 offen offset:0 sc1 nt
    v_smfmac_f32_16x16x64_bf16 v[36:39], v[16:19], a[208:215], v1
    s_waitcnt lgkmcnt(4)
    v_smfmac_f32_16x16x64_bf16 v[32:35], v[20:23], a[200:207], v1
    buffer_load_dwordx4 v[100:103], v5, s[8:11], s40 offen offset:1024 sc1 nt
    v_smfmac_f32_16x16x64_bf16 v[36:39], v[20:23], a[216:223], v1
    s_waitcnt lgkmcnt(2)
    v_smfmac_f32_16x16x64_bf16 v[32:35], v[24:27], v[72:79], v1
    ds_read_b128 v[72:75], v7 offset:18432
    buffer_load_dwordx4 v[104:107], v5, s[8:11], s40 offen offset:2048 sc1 nt
    v_smfmac_f32_16x16x64_bf16 v[36:39], v[24:27], v[80:87], v1
    ds_read_b128 v[76:79], v7 offset:19456
    v_smfmac_f32_16x16x64_bf16 v[40:43], v[16:19], a[224:231], v1
    ds_read_b128 v[80:83], v7 offset:20480
    buffer_load_dwordx4 v[108:111], v5, s[8:11], s40 offen offset:3072 sc1 nt
    v_smfmac_f32_16x16x64_bf16 v[44:47], v[16:19], a[240:247], v1
    ds_read_b128 v[84:87], v7 offset:21504
    v_add_f32 v32, v32, v34
    v_add_f32 v33, v33, v35
    v_smfmac_f32_16x16x64_bf16 v[40:43], v[20:23], a[232:239], v1
    v_add_f32 v36, v36, v38
    v_add_f32 v37, v37, v39
    buffer_load_dwordx4 v[112:115], v5, s[8:11], s56 offen offset:0 sc1 nt
    v_smfmac_f32_16x16x64_bf16 v[44:47], v[20:23], a[248:255], v1
    v_cvt_pk_bf16_f32 v12, v32, v33
    s_waitcnt lgkmcnt(4)
    v_smfmac_f32_16x16x64_bf16 v[40:43], v[24:27], v[88:95], v1
    ds_read_b128 v[88:91], v7 offset:22528
    v_cvt_pk_bf16_f32 v13, v36, v37
    buffer_load_dwordx4 v[116:119], v5, s[8:11], s56 offen offset:1024 sc1 nt
    s_waitcnt lgkmcnt(3)
    v_smfmac_f32_16x16x64_bf16 v[44:47], v[24:27], v[72:79], v1
    ds_read_b128 v[92:95], v7 offset:23552
    v_smfmac_f32_16x16x64_bf16 v[48:51], v[16:19], v[160:167], v1
    ds_read_b128 v[72:75], v7 offset:24576
    v_smfmac_f32_16x16x64_bf16 v[52:55], v[16:19], v[176:183], v1
    ds_read_b128 v[76:79], v7 offset:25600
    v_add_f32 v40, v40, v42
    v_add_f32 v41, v41, v43
    v_smfmac_f32_16x16x64_bf16 v[48:51], v[20:23], v[168:175], v1
    v_add_f32 v44, v44, v46
    v_add_f32 v45, v45, v47
    v_smfmac_f32_16x16x64_bf16 v[52:55], v[20:23], v[184:191], v1
    v_cvt_pk_bf16_f32 v14, v40, v41
    s_waitcnt lgkmcnt(4)
    v_smfmac_f32_16x16x64_bf16 v[48:51], v[24:27], v[80:87], v1
    ds_read_b128 v[80:83], v7 offset:26624
    v_cvt_pk_bf16_f32 v15, v44, v45
    s_waitcnt lgkmcnt(3)
    v_smfmac_f32_16x16x64_bf16 v[52:55], v[24:27], v[88:95], v1
    ds_read_b128 v[84:87], v7 offset:27648
    v_permlane32_swap_b32 v12, v14
    v_permlane32_swap_b32 v13, v15
    v_smfmac_f32_16x16x64_bf16 v[56:59], v[16:19], v[192:199], v1
    ds_read_b128 v[88:91], v7 offset:28672
    v_permlane16_swap_b32 v12, v13
    v_permlane16_swap_b32 v14, v15
    v_smfmac_f32_16x16x64_bf16 v[60:63], v[16:19], v[208:215], v1
    ds_read_b128 v[92:95], v7 offset:29696
    v_and_or_b32 v12, v12, -2, s68
    v_add_f32 v48, v48, v50
    v_smfmac_f32_16x16x64_bf16 v[56:59], v[20:23], v[200:207], v1
    v_add_f32 v49, v49, v51
    v_add_f32 v52, v52, v54
    buffer_store_dwordx4 v[12:15], v5, s[8:11], s42 offen offset:0 sc1
    v_smfmac_f32_16x16x64_bf16 v[60:63], v[20:23], v[216:223], v1
    v_add_f32 v53, v53, v55
    v_cvt_pk_bf16_f32 v28, v48, v49
    s_waitcnt lgkmcnt(4)
    v_smfmac_f32_16x16x64_bf16 v[56:59], v[24:27], v[72:79], v1
    ds_read_b128 v[72:75], v7 offset:30720
    v_cvt_pk_bf16_f32 v29, v52, v53
    s_waitcnt lgkmcnt(3)
    v_smfmac_f32_16x16x64_bf16 v[60:63], v[24:27], v[80:87], v1
    ds_read_b128 v[76:79], v7 offset:31744
    v_smfmac_f32_16x16x64_bf16 v[64:67], v[16:19], v[224:231], v1
    v_smfmac_f32_16x16x64_bf16 v[68:71], v[16:19], v[240:247], v1
    s_nop 0
    v_add_f32 v56, v56, v58
    v_add_f32 v57, v57, v59
    v_smfmac_f32_16x16x64_bf16 v[64:67], v[20:23], v[232:239], v1
    s_nop 0
    v_add_f32 v60, v60, v62
    v_add_f32 v61, v61, v63
    v_smfmac_f32_16x16x64_bf16 v[68:71], v[20:23], v[248:255], v1
    v_cvt_pk_bf16_f32 v30, v56, v57
    s_waitcnt lgkmcnt(2)
    v_smfmac_f32_16x16x64_bf16 v[64:67], v[24:27], v[88:95], v1
    v_cvt_pk_bf16_f32 v31, v60, v61
    s_waitcnt lgkmcnt(0)
    v_smfmac_f32_16x16x64_bf16 v[68:71], v[24:27], v[72:79], v1
    v_permlane32_swap_b32 v28, v30
    v_permlane32_swap_b32 v29, v31
    s_nop 1
    v_permlane16_swap_b32 v28, v29
    v_permlane16_swap_b32 v30, v31
    v_and_or_b32 v28, v28, -2, s68
    v_add_f32 v64, v64, v66
    v_add_f32 v65, v65, v67
    v_add_f32 v68, v68, v70
    buffer_store_dwordx4 v[28:31], v5, s[8:11], s42 offen offset:1024 sc1
    v_add_f32 v69, v69, v71
    v_cvt_pk_bf16_f32 v32, v64, v65
    v_cvt_pk_bf16_f32 v33, v68, v69
    s_nop 0
    v_permlane32_swap_b32 v32, v34
    v_permlane32_swap_b32 v33, v35
    s_nop 1
    v_permlane16_swap_b32 v32, v33
    v_permlane16_swap_b32 v34, v35
    v_and_or_b32 v32, v32, -2, s68
    buffer_store_dwordx4 v[32:35], v9, s[8:11], s42 offen offset:2048 sc1
    v_mov_b64 v[88:89], v[12:13]
    v_mov_b64 v[92:93], v[32:33]
    v_mov_b64 v[90:91], v[14:15]
    v_mov_b64 v[94:95], v[34:35]
    s_cmp_eq_u32 s32, 63
    s_cbranch_scc1 voend_109
    s_add_u32 s56, s43, 40960
    s_add_u32 s57, s43, 81920
    s_add_u32 s58, s43, 122880
    buffer_load_dwordx4 v[16:19], v6, s[8:11], s41 offen sc1
    buffer_load_dwordx4 v[20:23], v6, s[8:11], s41 offen offset:1024 sc1
    buffer_load_dwordx2 v[24:25], v3, s[8:11], s41 offen offset:2048 sc1
    s_sleep 2
pp_111:
    buffer_load_dwordx4 v[16:19], v6, s[8:11], s41 offen sc1
    buffer_load_dwordx4 v[20:23], v6, s[8:11], s41 offen offset:1024 sc1
    buffer_load_dwordx2 v[24:25], v3, s[8:11], s41 offen offset:2048 sc1
    s_waitcnt vmcnt(5)
    v_max3_u32 v12, v16, v17, v18
    s_waitcnt vmcnt(4)
    v_max3_u32 v13, v20, v21, v22
    v_max3_u32 v12, v12, v19, v23
    s_waitcnt vmcnt(3)
    v_max3_u32 v13, v13, v24, v25
    v_max_u32 v12, v12, v13
    v_cmp_eq_u32 vcc, -1, v12
    s_cbranch_vccz ppd_113
    s_sub_u32 s33, s33, 1
    s_cbranch_scc0 pp_111
    s_mov_b32 s33, 0
ppd_113:
    ds_write_b128 v6, v[16:19] offset:10240
    ds_write_b128 v6, v[20:23] offset:11264
    ds_write_b64 v3, v[24:25] offset:12288
    buffer_load_dwordx4 v[72:75], v10, s[8:11], s43 offen sc1
    buffer_load_dwordx4 v[76:79], v10, s[8:11], s56 offen sc1
    buffer_load_dwordx4 v[80:83], v10, s[8:11], s57 offen sc1
    buffer_load_dwordx4 v[84:87], v10, s[8:11], s58 offen sc1
    v_mov_b64 v[12:13], 0
    v_mov_b64 v[14:15], 0
    s_waitcnt lgkmcnt(0)
    s_barrier
    s_cmp_eq_u32 s49, 0
    s_cbranch_scc1 vonu_114_f
    ds_read_b64_tr_b16 v[32:33], v2 offset:10240
    ds_read_b64_tr_b16 v[34:35], v0 offset:10240
    ds_read_b64_tr_b16 v[36:37], v2 offset:11264
    ds_read_b64_tr_b16 v[38:39], v0 offset:11264
    ds_read_b64_tr_b16 v[40:41], v2 offset:12288
    ds_read_b64_tr_b16 v[42:43], v0 offset:12288
    ds_read_b64_tr_b16 v[44:45], v2 offset:13312
    ds_read_b64_tr_b16 v[46:47], v0 offset:13312
    ds_read_b64_tr_b16 v[48:49], v2 offset:14336
    ds_read_b64_tr_b16 v[50:51], v0 offset:14336
    ds_read_b64_tr_b16 v[52:53], v2 offset:15360
    ds_read_b64_tr_b16 v[54:55], v0 offset:15360
    ds_read_b64_tr_b16 v[56:57], v2 offset:16384
    ds_read_b64_tr_b16 v[58:59], v0 offset:16384
    s_waitcnt lgkmcnt(12)
    v_smfmac_f32_16x16x64_bf16 v[12:15], v[32:35], v[96:103], v1
    ds_read_b64_tr_b16 v[60:61], v2 offset:17408
    ds_read_b64_tr_b16 v[62:63], v0 offset:17408
    s_waitcnt lgkmcnt(12)
    v_smfmac_f32_16x16x64_bf16 v[12:15], v[36:39], v[104:111], v1
    ds_read_b64_tr_b16 v[64:65], v2 offset:18432
    ds_read_b64_tr_b16 v[66:67], v0 offset:18432
    s_waitcnt lgkmcnt(12)
    v_smfmac_f32_16x16x64_bf16 v[12:15], v[40:43], v[112:119], v1
    ds_read_b64_tr_b16 v[68:69], v2 offset:19456
    ds_read_b64_tr_b16 v[70:71], v0 offset:19456
    s_waitcnt lgkmcnt(12)
    v_smfmac_f32_16x16x64_bf16 v[12:15], v[44:47], v[120:127], v1
    s_waitcnt lgkmcnt(10)
    v_smfmac_f32_16x16x64_bf16 v[12:15], v[48:51], v[128:135], v1
    s_waitcnt lgkmcnt(8)
    v_smfmac_f32_16x16x64_bf16 v[12:15], v[52:55], v[136:143], v1
    s_waitcnt lgkmcnt(6)
    v_smfmac_f32_16x16x64_bf16 v[12:15], v[56:59], v[144:151], v1
    s_waitcnt lgkmcnt(4)
    v_smfmac_f32_16x16x64_bf16 v[12:15], v[60:63], v[152:159], v1
    s_waitcnt vmcnt(0)
    v_bitop3_b32 v26, v72, v76, v80 bitop3:0x7e
    v_bitop3_b32 v27, v72, v84, s68 bitop3:0x7e
    v_bitop3_b32 v26, v26, v27, 1 bitop3:0xa8
    v_cmp_ne_u32 vcc, 0, v26
    s_cbranch_vccnz tl_115
td_116:
    s_waitcnt lgkmcnt(2)
    v_smfmac_f32_16x16x64_bf16 v[12:15], v[64:67], v[72:79], v1
    s_waitcnt lgkmcnt(0)
    v_smfmac_f32_16x16x64_bf16 v[12:15], v[68:71], v[80:87], v1
    s_xor_b32 s34, s44, 8192
    s_nop 6
    v_add_f32 v12, v12, v14
    v_add_f32 v13, v13, v15
    v_cvt_pk_bf16_f32 v12, v12, v13
    buffer_store_dword v12, v8, s[8:11], s34 offen sc1
    buffer_store_dword v12, v8, s[8:11], s44 offen sc1
vonu_114:
    s_add_u32 s40, s40, 1310720
    s_add_u32 s56, s40, 4096
    s_add_u32 s57, s40, 8192
    s_add_u32 s58, s40, 12288
    s_barrier
    s_cmp_eq_u32 s49, 0
    s_cbranch_scc1 vonu3_117_s
    buffer_load_dwordx4 v[120:123], v5, s[8:11], s56 offen offset:2048 sc1 nt
    buffer_load_dwordx4 v[124:127], v5, s[8:11], s56 offen offset:3072 sc1 nt
    buffer_load_dwordx4 v[128:131], v5, s[8:11], s57 offen offset:0 sc1 nt
    buffer_load_dwordx4 v[132:135], v5, s[8:11], s57 offen offset:1024 sc1 nt
    buffer_load_dwordx4 v[136:139], v5, s[8:11], s57 offen offset:2048 sc1 nt
    buffer_load_dwordx4 v[140:143], v5, s[8:11], s57 offen offset:3072 sc1 nt
    buffer_load_dwordx4 v[144:147], v5, s[8:11], s58 offen offset:0 sc1 nt
    buffer_load_dwordx4 v[148:151], v5, s[8:11], s58 offen offset:1024 sc1 nt
    buffer_load_dwordx4 v[152:155], v5, s[8:11], s58 offen offset:2048 sc1 nt
    buffer_load_dwordx4 v[156:159], v5, s[8:11], s58 offen offset:3072 sc1 nt
vonu3_117:
    v_mov_b64 v[108:109], v[88:89]
    v_mov_b64 v[110:111], v[90:91]
    v_mov_b64 v[112:113], v[28:29]
    v_mov_b64 v[114:115], v[30:31]
    v_mov_b64 v[116:117], v[92:93]
    v_mov_b64 v[118:119], v[94:95]
    buffer_load_dwordx4 v[12:15], v6, s[8:11], s38 offen sc1
    buffer_load_dwordx4 v[16:19], v6, s[8:11], s38 offen offset:1024 sc1
    buffer_load_dwordx2 v[20:21], v3, s[8:11], s38 offen offset:2048 sc1
    s_barrier
    buffer_load_dwordx4 v[22:25], v6, s[8:11], s39 offen sc1
    buffer_load_dwordx4 v[26:29], v6, s[8:11], s39 offen offset:1024 sc1
    buffer_load_dwordx2 v[30:31], v3, s[8:11], s39 offen offset:2048 sc1
    v_mov_b64 v[96:97], 0
    v_mov_b64 v[98:99], 0
    v_mov_b64 v[100:101], 0
    v_mov_b64 v[102:103], 0
    v_mov_b64 v[104:105], 0
    v_mov_b64 v[106:107], 0
    v_mov_b64 v[32:33], 0
    v_mov_b64 v[34:35], 0
    v_mov_b64 v[36:37], 0
    v_mov_b64 v[38:39], 0
    v_mov_b64 v[40:41], 0
    v_mov_b64 v[42:43], 0
    v_mov_b64 v[44:45], 0
    v_mov_b64 v[46:47], 0
    v_mov_b64 v[48:49], 0
    v_mov_b64 v[50:51], 0
    v_mov_b64 v[52:53], 0
    v_mov_b64 v[54:55], 0
    v_mov_b64 v[56:57], 0
    v_mov_b64 v[58:59], 0
    v_mov_b64 v[60:61], 0
    v_mov_b64 v[62:63], 0
    v_mov_b64 v[64:65], 0
    v_mov_b64 v[66:67], 0
    v_mov_b64 v[68:69], 0
    v_mov_b64 v[70:71], 0
    s_add_u32 s32, s32, 1
    s_mov_b32 s66, s59
    s_add_u32 s59, s59, 327680
    s_and_b32 s34, s32, 3
    s_mul_i32 s34, s34, 20480
    s_add_u32 s41, s62, s34
    s_add_u32 s34, s32, 1
    s_and_b32 s34, s34, 3
    s_mul_i32 s34, s34, 65536
    s_add_u32 s44, s61, s34
    s_add_u32 s34, s32, 2
    s_and_b32 s34, s34, 3
    s_mul_i32 s34, s34, 65536
    s_add_u32 s67, s61, s34
    s_and_b32 s68, s32, 1
    v_bfe_u32 v92, v5, 4, 4
    v_lshrrev_b32 v93, 8, v5
    v_lshlrev_b32 v93, 2, v93
    v_sub_u32 v92, v92, v93
    v_lshlrev_b32 v93, 4, v92
    v_mov_b32 v94, 0x3f80
    v_mov_b32 v95, 0
    v_lshlrev_b64 v[94:95], v93, v[94:95]
    v_cmp_gt_u32 vcc, 4, v92
    s_nop 1
    v_cndmask_b32 v94, 0, v94, vcc
    v_cndmask_b32 v95, 0, v95, vcc
mlc_119:
    s_waitcnt vmcnt(5)
    v_max3_u32 v92, v12, v13, v14
    s_waitcnt vmcnt(4)
    v_max3_u32 v93, v16, v17, v18
    v_max3_u32 v92, v92, v15, v19
    s_waitcnt vmcnt(3)
    v_max3_u32 v93, v93, v20, v21
    v_max_u32 v92, v92, v93
    v_cmp_eq_u32 vcc, -1, v92
    s_cbranch_vccnz ml_118
mld_120:
    v_mfma_f32_16x16x16_bf16 v[72:75], v[94:95], v[12:13], 0
    v_mfma_f32_16x16x16_bf16 v[76:79], v[94:95], v[14:15], 0
    v_mfma_f32_16x16x16_bf16 v[80:83], v[94:95], v[16:17], 0
    v_mfma_f32_16x16x16_bf16 v[84:87], v[94:95], v[18:19], 0
    v_mfma_f32_16x16x16_bf16 v[88:91], v[94:95], v[20:21], 0
    s_waitcnt vmcnt(2)
    v_mfma_f32_16x16x16_bf16 v[72:75], v[94:95], v[22:23], v[72:75]
    v_max3_u32 v92, v22, v23, v24
    v_mfma_f32_16x16x16_bf16 v[76:79], v[94:95], v[24:25], v[76:79]
    s_waitcnt vmcnt(1)
    v_mfma_f32_16x16x16_bf16 v[80:83], v[94:95], v[26:27], v[80:83]
    v_max3_u32 v93, v26, v27, v28
    v_mfma_f32_16x16x16_bf16 v[84:87], v[94:95], v[28:29], v[84:87]
    v_max3_u32 v92, v92, v25, v29
    s_waitcnt vmcnt(0)
    v_mfma_f32_16x16x16_bf16 v[88:91], v[94:95], v[30:31], v[88:91]
    v_max3_u32 v93, v93, v30, v31
    v_cvt_pk_bf16_f32 v72, v72, v73
    v_cvt_pk_bf16_f32 v73, v74, v75
    v_cvt_pk_bf16_f32 v74, v76, v77
    v_cvt_pk_bf16_f32 v75, v78, v79
    ds_write_b128 v6, v[72:75] offset:0
    v_max_u32 v92, v92, v93
    v_cvt_pk_bf16_f32 v76, v80, v81
    v_cvt_pk_bf16_f32 v77, v82, v83
    v_cvt_pk_bf16_f32 v78, v84, v85
    v_cvt_pk_bf16_f32 v79, v86, v87
    ds_write_b128 v6, v[76:79] offset:1024
    v_cmp_eq_u32 vcc, -1, v92
    v_cvt_pk_bf16_f32 v80, v88, v89
    v_cvt_pk_bf16_f32 v81, v90, v91
    ds_write_b64 v3, v[80:81] offset:2048
    s_cbranch_vccnz mr_121
mrd_123:
    s_waitcnt lgkmcnt(0)
    s_branch voloop_108
ml_118:
    s_sub_u32 s33, s33, 1
    s_cbranch_scc1 ml_118_t
    buffer_load_dwordx4 v[12:15], v6, s[8:11], s38 offen sc1
    buffer_load_dwordx4 v[16:19], v6, s[8:11], s38 offen offset:1024 sc1
    buffer_load_dwordx2 v[20:21], v3, s[8:11], s38 offen offset:2048 sc1
    buffer_load_dwordx4 v[22:25], v6, s[8:11], s39 offen sc1
    buffer_load_dwordx4 v[26:29], v6, s[8:11], s39 offen offset:1024 sc1
    buffer_load_dwordx2 v[30:31], v3, s[8:11], s39 offen offset:2048 sc1
    s_branch mlc_119
ml_118_t:
    s_mov_b32 s33, 0
    s_branch mld_120
mr_121:
    s_sub_u32 s33, s33, 1
    s_cbranch_scc1 mr_121_t
    buffer_load_dwordx4 v[22:25], v6, s[8:11], s39 offen sc1
    buffer_load_dwordx4 v[26:29], v6, s[8:11], s39 offen offset:1024 sc1
    buffer_load_dwordx2 v[30:31], v3, s[8:11], s39 offen offset:2048 sc1
    s_waitcnt vmcnt(2)
    v_max3_u32 v92, v22, v23, v24
    s_waitcnt vmcnt(1)
    v_max3_u32 v93, v26, v27, v28
    v_max3_u32 v92, v92, v25, v29
    s_waitcnt vmcnt(0)
    v_max3_u32 v93, v93, v30, v31
    v_max_u32 v92, v92, v93
    v_cmp_eq_u32 vcc, -1, v92
    s_cbranch_vccnz mr_121
    s_branch mld_120
mr_121_t:
    s_mov_b32 s33, 0
    s_branch mrd_123
vonu_114_f:
    s_add_u32 s34, s32, 1
    v_mov_b32 v12, s34
    s_mov_b64 exec, 1
    buffer_store_dword v12, off, s[8:11], s63 sc1
    s_mov_b64 exec, -1
    s_branch vonu_114
tl_115:
    buffer_load_dwordx4 v[72:75], v10, s[8:11], s43 offen sc1
    buffer_load_dwordx4 v[76:79], v10, s[8:11], s56 offen sc1
    buffer_load_dwordx4 v[80:83], v10, s[8:11], s57 offen sc1
    buffer_load_dwordx4 v[84:87], v10, s[8:11], s58 offen sc1
    s_waitcnt vmcnt(0)
    v_bitop3_b32 v26, v72, v76, v80 bitop3:0x7e
    v_bitop3_b32 v27, v72, v84, s68 bitop3:0x7e
    v_bitop3_b32 v26, v26, v27, 1 bitop3:0xa8
    v_cmp_ne_u32 vcc, 0, v26
    s_cbranch_vccz td_116
    s_sub_u32 s33, s33, 1
    s_cbranch_scc0 tl_115
    s_mov_b32 s33, 0
    s_branch td_116
vonu3_117_s:
    s_sleep 4
    s_branch vonu3_117
voend_109:
    buffer_store_dwordx4 v[88:91], v5, s[8:11], s59 offen offset:0 sc1
    buffer_store_dwordx4 v[28:31], v5, s[8:11], s59 offen offset:1024 sc1
    buffer_store_dwordx4 v[92:95], v9, s[8:11], s59 offen offset:2048 sc1
    s_waitcnt vmcnt(0)
    s_barrier
    s_cmp_lg_u32 s28, 0
    s_cbranch_scc1 dn_124
    v_mov_b32 v24, 1
    s_mov_b64 exec, 1
    buffer_atomic_add v24, off, s[12:15], 0 offset:196 sc1
    s_mov_b64 exec, -1
dn_124:
    s_endpgm
.section .rodata,"a"
.p2align 6
.amdhsa_kernel concat_heads__memory_aug_recurrent_mem_tr__ssm_conv_s5__prompt_kernel
  .amdhsa_next_free_vgpr 512
  .amdhsa_next_free_sgpr 102
  .amdhsa_accum_offset 256
  .amdhsa_group_segment_fixed_size 0
  .amdhsa_kernarg_size 152
  .amdhsa_user_sgpr_count 2
  .amdhsa_user_sgpr_kernarg_segment_ptr 1
  .amdhsa_system_sgpr_workgroup_id_x 1
.end_amdhsa_kernel
```
